```python
import torch

def _softmax(x, axis=-1):
    return torch.softmax(x, dim=axis)

def _gelu(x):
    return torch.nn.functional.gelu(x, approximate='tanh')

def _silu(x):
    return torch.nn.functional.silu(x)

def _sigmoid(x):
    return torch.sigmoid(x)

def _layernorm(x, axis=-1, eps=1e-05):
    m = x.mean(dim=axis, keepdim=True)
    v = x.var(dim=axis, keepdim=True, unbiased=False)
    return (x - m) / torch.sqrt(v + eps)

def _scatter_add(tgt, idx, src, axis=0):
    return tgt.clone().index_add_(axis, idx, src)

def _segment_sum(src, seg, n):
    out = torch.zeros((n,) + src.shape[1:], dtype=src.dtype)
    return out.index_add_(0, seg, src)

def _pad(x, pw):
    flat = tuple((v for pair in reversed(pw) for v in pair))
    return torch.nn.functional.pad(x, flat)
kernel_name = 'interleave_layers__linear_attn_block__mixer_gmlp__prompt'

def setup_inputs():

    _w = lambda a: (lambda t: t.to(torch.bfloat16) if t.is_floating_point() else t)(torch.as_tensor(a))

    def _A_setup():
        B, S, D = (1, 2048, 1024)
        return {'x': _w((lambda *s: torch.randn(*s, dtype=torch.bfloat16) * 0.05)(B, S, D)), 'wqkv': _w((lambda *s: torch.randn(*s, dtype=torch.bfloat16) * 0.05)(D, 3 * D)), 'wo': _w((lambda *s: torch.randn(*s, dtype=torch.bfloat16) * 0.05)(D, D))}
    _A_in = _A_setup()

    def _B_setup():
        B, S, D, F = (1, 2048, 1024, 3584)
        Fh = F // 2
        return {'x': _w((lambda *s: torch.randn(*s, dtype=torch.bfloat16) * 0.05)(B, S, D)), 'w_in': _w((lambda *s: torch.randn(*s, dtype=torch.bfloat16) * 0.2)(D, 2 * Fh)), 'w_sp': _w(0.01 * (lambda *s: torch.randn(*s, dtype=torch.bfloat16) * 0.2)(S, S)), 'b_sp': _w(1.0 + 0.01 * (lambda *s: torch.randn(*s, dtype=torch.bfloat16) * 0.05)(S)), 'w_out': _w((lambda *s: torch.randn(*s, dtype=torch.bfloat16) * 0.05)(Fh, D))}
    _B_in = _B_setup()
    return {'A_x': _A_in['x'], 'A_wqkv': _A_in['wqkv'], 'A_wo': _A_in['wo'], 'B_x': _B_in['x'], 'B_w_in': _B_in['w_in'], 'B_w_sp': _B_in['w_sp'], 'B_b_sp': _B_in['b_sp'], 'B_w_out': _B_in['w_out']}

def reference(A_x, A_wqkv, A_wo, B_x, B_w_in, B_w_sp, B_b_sp, B_w_out):

    def _A_ref(x, wqkv, wo):
        B, S, D = x.shape
        H = 32
        Dh = D // H
        qkv = (lambda x, *d: x.permute(*d))((x @ wqkv).reshape(B, S, 3, H, Dh), 2, 0, 3, 1, 4)
        q, k, v = (qkv[0], qkv[1], qkv[2])
        phi = lambda t: torch.where(t > 0, t + 1, torch.exp(t)) + 1e-06
        pq, pk = (phi(q), phi(k))
        kv = torch.einsum('bhsd,bhse->bhde', pk, v)
        z = torch.einsum('bhsd->bhd', pk)
        num = torch.einsum('bhqd,bhde->bhqe', pq, kv)
        den = torch.einsum('bhqd,bhd->bhq', pq, z)[..., None] + 1e-06
        o = num / den
        return (lambda x, *d: x.permute(*d))(o, 0, 2, 1, 3).reshape(B, S, D) @ wo

    def _B_ref(x, w_in, w_sp, b_sp, w_out):
        B, S, D = x.shape
        F = w_in.shape[-1]
        Fh = F // 2
        z = _gelu(torch.einsum('bsd,df->bsf', x, w_in))
        z1 = z[..., :Fh].clone()
        z2 = _layernorm(z[..., Fh:], axis=-1)
        g = torch.einsum('ts,bsf->btf', w_sp, z2) + b_sp[None, :, None]
        return torch.einsum('bsf,fd->bsd', z1 * g, w_out)
    x = A_x
    x = x + _A_ref(_layernorm(x, axis=-1), A_wqkv, A_wo)
    x = x + _B_ref(_layernorm(x, axis=-1), B_w_in, B_w_sp, B_b_sp, B_w_out)
    x = x + _A_ref(_layernorm(x, axis=-1), A_wqkv, A_wo)
    x = x + _B_ref(_layernorm(x, axis=-1), B_w_in, B_w_sp, B_b_sp, B_w_out)
    return x
```

```asm
; @launch grid=(256,1,1) block=(256,1,1) lds=163840
.amdgcn_target "amdgcn-amd-amdhsa--gfx950"
.macro mT d,w,x
v_mfma_f32_16x16x32_bf16 v[\d:\d+3], v[\w:\w+3], a[\x:\x+3], v[\d:\d+3]
.endm
.macro mF d,w,x
v_mfma_f32_16x16x32_bf16 v[\d:\d+3], a[\x:\x+3], v[\w:\w+3], v[\d:\d+3]
.endm
.macro rd d,b,o
ds_read_b128 v[\d:\d+3], v\b offset:\o
.endm
.macro wl n
s_waitcnt lgkmcnt(\n)
.endm
.macro lx d,o
buffer_load_dwordx4 a[\d:\d+3], v0, s[4:7], s24 offen offset:\o sc1
.endm
.macro lw o
buffer_load_dwordx4 v0, s[4:7], s23 offen offset:\o sc1 lds
.endm
.text
.globl interleave_layers__linear_attn_block__mixer_gmlp__prompt_kernel
.p2align 8
.type interleave_layers__linear_attn_block__mixer_gmlp__prompt_kernel,@function
interleave_layers__linear_attn_block__mixer_gmlp__prompt_kernel:
s_cmp_lt_u32 s2, 256
s_cbranch_scc1 main_go
s_endpgm
main_go:
s_load_dwordx4 s[88:91], s[0:1], 0
s_load_dwordx2 s[82:83], s[0:1], 16
s_load_dwordx2 s[66:67], s[0:1], 32
s_load_dwordx2 s[68:69], s[0:1], 40
s_load_dwordx2 s[64:65], s[0:1], 48
s_load_dwordx2 s[70:71], s[0:1], 56
s_load_dwordx2 s[8:9], s[0:1], 64
s_load_dwordx2 s[98:99], s[0:1], 72
s_load_dwordx2 s[4:5], s[0:1], 80
s_getpc_b64 s[84:85]
main_pc:
s_lshr_b32 s86, s2, 3
s_lshl_b32 s86, s86, 9
v_and_b32 v2, 0xc0, v0
v_lshlrev_b32 v2, 1, v2
v_add_u32 v2, s86, v2
v_mov_b32 v3, 0
v_lshl_add_u64 v[220:221], v[2:3], 0, s[84:85]
global_load_dword v254, v[220:221], off
v_lshrrev_b32 v1, 6, v0
v_and_b32 v31, 63, v0
v_readfirstlane_b32 s18, v1
v_lshlrev_b32 v30, 4, v0
s_and_b32 s32, s2, 7
s_lshr_b32 s33, s2, 3
s_and_b32 s16, s32, 3
s_lshl_b32 s16, s16, 2
s_and_b32 s34, s33, 3
s_add_u32 s16, s16, s34
s_lshr_b32 s17, s32, 2
s_lshl_b32 s17, s17, 3
s_lshr_b32 s34, s33, 2
s_add_u32 s17, s17, s34
v_lshlrev_b32 v0, 4, v31
s_lshl_b32 s21, s18, 12
s_mul_i32 s22, s18, 3584
s_mul_i32 s25, s17, 393216
s_add_u32 s25, s25, s21
s_add_u32 s32, s16, s17
s_and_b32 s32, s32, 3
s_add_u32 s33, s32, 1
s_and_b32 s33, s33, 3
s_lshl_b32 s30, s16, 2
s_add_u32 s30, s30, s18
s_lshl_b32 s31, s17, 2
s_add_u32 s31, s31, s18
s_cmp_eq_u32 s32, 0
s_cselect_b32 s76, 1, 0
s_cmp_eq_u32 s33, 0
s_cselect_b32 s76, -1, s76
s_cmp_eq_u32 s32, 1
s_cselect_b32 s77, 1, 0
s_cmp_eq_u32 s33, 1
s_cselect_b32 s77, -1, s77
s_cmp_eq_u32 s32, 2
s_cselect_b32 s78, 1, 0
s_cmp_eq_u32 s33, 2
s_cselect_b32 s78, -1, s78
s_cmp_eq_u32 s32, 3
s_cselect_b32 s79, 1, 0
s_cmp_eq_u32 s33, 3
s_cselect_b32 s79, -1, s79
s_add_u32 s101, s17, s18
s_and_b32 s101, s101, 15
v_lshrrev_b32 v220, 5, v31
v_bfe_u32 v221, v31, 3, 2
v_lshl_add_u32 v220, v220, 3, v221
v_and_b32 v231, 7, v31
v_lshlrev_b32 v231, 4, v231
v_lshl_add_u32 v228, v220, 11, v231
s_lshl_b32 s34, s30, 16
s_lshl_b32 s35, s101, 7
s_add_u32 s34, s34, s35
s_mov_b32 s6, 268435456
s_mov_b32 s7, 0x20000
s_mov_b32 s10, 4194304
s_mov_b32 s11, 0x20000
s_mov_b32 s14, 4194304
s_mov_b32 s15, 0x20000
s_cmp_eq_u32 s18, 3
s_mov_b32 s37, 6144
s_cselect_b32 s37, 2048, s37
v_lshrrev_b32 v230, 3, v31
v_mul_lo_u32 v230, v230, s37
v_add_u32 v230, v231, v230
v_lshlrev_b32 v232, 4, v30
v_mov_b32 v233, 2147483392
s_cmp_eq_u32 s2, 0
s_cselect_b64 vcc, -1, 0
v_cndmask_b32 v232, v233, v232, vcc
v_add_u32 v234, 98304, v232
v_cmp_gt_u32 vcc, 16384, v232
s_nop 1
v_cndmask_b32 v234, v234, v232, vcc
v_cmp_gt_u32 vcc, 32768, v232
s_nop 1
v_cndmask_b32 v234, v233, v234, vcc
v_mov_b32 v233, 0
wl 0
s_mov_b32 s12, s88
s_mov_b32 s13, s89
s_mov_b32 s80, 52428800
buffer_store_dword v233, v234, s[4:7], s80 offen sc1
s_add_u32 m0, s21, 32768
s_add_u32 s36, s34, 0
buffer_load_dwordx4 v228, s[12:15], s36 offen nt lds
s_add_u32 m0, s21, 33792
s_add_u32 s36, s34, 32768
buffer_load_dwordx4 v228, s[12:15], s36 offen nt lds
s_add_u32 m0, s21, 34816
s_add_u32 s36, s34, 8192
buffer_load_dwordx4 v228, s[12:15], s36 offen nt lds
s_add_u32 m0, s21, 35840
s_add_u32 s36, s34, 40960
buffer_load_dwordx4 v228, s[12:15], s36 offen nt lds
s_cmp_eq_u32 s18, 3
s_cselect_b32 s12, s82, s90
s_cselect_b32 s13, s83, s91
s_cselect_b32 s14, 2097152, s14
s_cselect_b32 s34, 0, 2097152
s_add_u32 s14, s14, s34
s_add_u32 s34, s18, 1
s_cmp_ge_u32 s18, 2
s_cselect_b32 s34, 0, s34
s_lshl_b32 s34, s34, 11
s_add_u32 s34, s34, s35
s_mul_i32 s36, s16, s37
s_lshl_b32 s36, s36, 6
s_add_u32 s34, s34, s36
s_lshl_b32 s37, s37, 3
s_lshl_b32 s36, s18, 13
s_add_u32 m0, s36, 0
s_nop 0
buffer_load_dwordx4 v230, s[12:15], s34 offen nt lds
s_add_u32 s34, s34, s37
s_add_u32 m0, s36, 1024
s_nop 0
buffer_load_dwordx4 v230, s[12:15], s34 offen nt lds
s_add_u32 s34, s34, s37
s_add_u32 m0, s36, 2048
s_nop 0
buffer_load_dwordx4 v230, s[12:15], s34 offen nt lds
s_add_u32 s34, s34, s37
s_add_u32 m0, s36, 3072
s_nop 0
buffer_load_dwordx4 v230, s[12:15], s34 offen nt lds
s_add_u32 s34, s34, s37
s_add_u32 m0, s36, 4096
s_nop 0
buffer_load_dwordx4 v230, s[12:15], s34 offen nt lds
s_add_u32 s34, s34, s37
s_add_u32 m0, s36, 5120
s_nop 0
buffer_load_dwordx4 v230, s[12:15], s34 offen nt lds
s_add_u32 s34, s34, s37
s_add_u32 m0, s36, 6144
s_nop 0
buffer_load_dwordx4 v230, s[12:15], s34 offen nt lds
s_add_u32 s34, s34, s37
s_add_u32 m0, s36, 7168
s_nop 0
buffer_load_dwordx4 v230, s[12:15], s34 offen nt lds
s_add_u32 s34, s34, s37
s_mov_b32 s12, s98
s_mov_b32 s13, s99
s_mov_b32 s14, 4
v_mov_b32 v233, 1
s_waitcnt vmcnt(12)
s_barrier
buffer_store_dword v233, v232, s[12:15], 0 offen sc1
s_lshl_b32 s51, s30, 16
s_add_u32 s51, s51, 29360128
s_lshl_b32 s54, s30, 12
s_add_u32 s54, s54, 51380224
v_mov_b32 v222, 2147483392
v_cmp_eq_u32 vcc, 0, v31
s_nop 1
v_cndmask_b32 v4, v222, v31, vcc
v_lshlrev_b32 v6, 2, v31
v_mov_b32 v246, v31
v_mov_b32 v24, 1065369472
v_mov_b32 v25, 1065369472
v_mov_b32 v26, 1065369472
v_mov_b32 v27, 1065369472
v_and_b32 v220, 0xf0, v0
v_lshlrev_b32 v220, 3, v220
v_lshrrev_b32 v221, 8, v0
v_lshl_add_u32 v220, v221, 3, v220
v_add_u32 v224, s21, v220
s_waitcnt vmcnt(9)
s_mov_b32 s12, s98
s_mov_b32 s13, s99
s_mov_b32 s14, 4
buffer_load_dword v31, v4, s[12:15], 0 offen sc1
ds_read_b64 v[32:33], v224 offset:32768
ds_read_b64 v[34:35], v224 offset:32800
ds_read_b64 v[36:37], v224 offset:32832
ds_read_b64 v[38:39], v224 offset:32864
ds_read_b64 v[40:41], v224 offset:34816
ds_read_b64 v[42:43], v224 offset:34848
ds_read_b64 v[44:45], v224 offset:34880
ds_read_b64 v[46:47], v224 offset:34912
s_lshl_b32 s32, s101, 12
s_add_u32 s32, s32, s51
s_add_u32 s32, s32, 0
wl 6
buffer_store_dwordx4 v[32:35], v0, s[4:7], s32 offen offset:0 sc1
wl 2
buffer_store_dwordx4 v[40:43], v0, s[4:7], s32 offen offset:1024 sc1
buffer_store_dwordx4 v[36:39], v0, s[4:7], s32 offen offset:2048 sc1
wl 0
buffer_store_dwordx4 v[44:47], v0, s[4:7], s32 offen offset:3072 sc1
v_dot2_f32_bf16 v220, v32, v24, 0
v_dot2_f32_bf16 v222, v32, v32, 0
v_dot2_f32_bf16 v221, v40, v24, 0
v_dot2_f32_bf16 v223, v40, v40, 0
v_dot2_f32_bf16 v220, v33, v24, v220
v_dot2_f32_bf16 v222, v33, v33, v222
v_dot2_f32_bf16 v221, v41, v24, v221
v_dot2_f32_bf16 v223, v41, v41, v223
v_dot2_f32_bf16 v220, v34, v24, v220
v_dot2_f32_bf16 v222, v34, v34, v222
v_dot2_f32_bf16 v221, v42, v24, v221
v_dot2_f32_bf16 v223, v42, v42, v223
v_dot2_f32_bf16 v220, v35, v24, v220
v_dot2_f32_bf16 v222, v35, v35, v222
v_dot2_f32_bf16 v221, v43, v24, v221
v_dot2_f32_bf16 v223, v43, v43, v223
v_dot2_f32_bf16 v220, v36, v24, v220
v_dot2_f32_bf16 v222, v36, v36, v222
v_dot2_f32_bf16 v221, v44, v24, v221
v_dot2_f32_bf16 v223, v44, v44, v223
v_dot2_f32_bf16 v220, v37, v24, v220
v_dot2_f32_bf16 v222, v37, v37, v222
v_dot2_f32_bf16 v221, v45, v24, v221
v_dot2_f32_bf16 v223, v45, v45, v223
v_dot2_f32_bf16 v220, v38, v24, v220
v_dot2_f32_bf16 v222, v38, v38, v222
v_dot2_f32_bf16 v221, v46, v24, v221
v_dot2_f32_bf16 v223, v46, v46, v223
v_dot2_f32_bf16 v220, v39, v24, v220
v_dot2_f32_bf16 v222, v39, v39, v222
v_dot2_f32_bf16 v221, v47, v24, v221
v_dot2_f32_bf16 v223, v47, v47, v223
s_nop 1
v_permlane32_swap_b32 v220, v221
v_permlane32_swap_b32 v222, v223
v_add_f32 v220, v220, v221
v_add_f32 v222, v222, v223
s_nop 1
v_permlane16_swap_b32 v220, v222
v_add_f32 v220, v220, v222
s_lshl_b32 s33, s101, 8
s_add_u32 s33, s33, s54
s_add_u32 s33, s33, 0
buffer_store_dword v220, v6, s[4:7], s33 offen sc1
v_lshrrev_b32 v244, 6, v0
v_lshlrev_b32 v244, 7, v244
v_bfe_u32 v221, v0, 4, 2
v_lshl_add_u32 v244, v221, 3, v244
s_lshl_b32 s36, s18, 13
v_add_u32 v244, s36, v244
s_mul_i32 s32, s101, 393216
s_lshl_b32 s33, s18, 17
s_add_u32 s32, s32, s33
s_lshl_b32 s33, s101, 17
s_add_u32 s33, s33, 6291456
s_cmp_eq_u32 s18, 3
s_cselect_b32 s32, s33, s32
s_lshl_b32 s33, s16, 13
s_add_u32 s32, s32, s33
s_lshl_b32 s33, s101, 4
s_add_u32 s33, s33, s16
s_lshl_b32 s33, s33, 10
s_lshl_b32 s34, s18, 8
s_add_u32 s33, s33, s34
s_add_u32 s33, s33, 28311552
v_mov_b32 v222, 2147483392
v_cmp_gt_u32 vcc, 64, v6
s_nop 1
v_cndmask_b32 v245, v222, v6, vcc
s_waitcnt vmcnt(11)
ds_read_b64_tr_b16 v[80:81], v244 offset:0
ds_read_b64_tr_b16 v[82:83], v244 offset:2048
ds_read_b64_tr_b16 v[84:85], v244 offset:32
ds_read_b64_tr_b16 v[86:87], v244 offset:2080
ds_read_b64_tr_b16 v[88:89], v244 offset:64
ds_read_b64_tr_b16 v[90:91], v244 offset:2112
ds_read_b64_tr_b16 v[92:93], v244 offset:96
ds_read_b64_tr_b16 v[94:95], v244 offset:2144
wl 6
buffer_store_dwordx4 v[80:83], v0, s[4:7], s32 offen offset:0 sc1
v_mfma_f32_16x16x32_bf16 v[136:139], v[24:27], v[80:83], 0
wl 4
buffer_store_dwordx4 v[84:87], v0, s[4:7], s32 offen offset:1024 sc1
v_mfma_f32_16x16x32_bf16 v[140:143], v[24:27], v[84:87], 0
wl 2
buffer_store_dwordx4 v[88:91], v0, s[4:7], s32 offen offset:2048 sc1
v_mfma_f32_16x16x32_bf16 v[144:147], v[24:27], v[88:91], 0
wl 0
buffer_store_dwordx4 v[92:95], v0, s[4:7], s32 offen offset:3072 sc1
v_mfma_f32_16x16x32_bf16 v[148:151], v[24:27], v[92:95], 0
s_waitcnt vmcnt(11)
s_add_u32 s32, s32, 4096
ds_read_b64_tr_b16 v[96:97], v244 offset:4096
ds_read_b64_tr_b16 v[98:99], v244 offset:6144
ds_read_b64_tr_b16 v[100:101], v244 offset:4128
ds_read_b64_tr_b16 v[102:103], v244 offset:6176
ds_read_b64_tr_b16 v[104:105], v244 offset:4160
ds_read_b64_tr_b16 v[106:107], v244 offset:6208
ds_read_b64_tr_b16 v[108:109], v244 offset:4192
ds_read_b64_tr_b16 v[110:111], v244 offset:6240
wl 6
buffer_store_dwordx4 v[96:99], v0, s[4:7], s32 offen offset:0 sc1
v_mfma_f32_16x16x32_bf16 v[136:139], v[24:27], v[96:99], v[136:139]
wl 4
buffer_store_dwordx4 v[100:103], v0, s[4:7], s32 offen offset:1024 sc1
v_mfma_f32_16x16x32_bf16 v[140:143], v[24:27], v[100:103], v[140:143]
wl 2
buffer_store_dwordx4 v[104:107], v0, s[4:7], s32 offen offset:2048 sc1
v_mfma_f32_16x16x32_bf16 v[144:147], v[24:27], v[104:107], v[144:147]
wl 0
buffer_store_dwordx4 v[108:111], v0, s[4:7], s32 offen offset:3072 sc1
v_mfma_f32_16x16x32_bf16 v[148:151], v[24:27], v[108:111], v[148:151]
s_add_u32 s32, s32, 4096
buffer_store_dword v136, v245, s[4:7], s33 offen offset:0 sc1
buffer_store_dword v140, v245, s[4:7], s33 offen offset:64 sc1
s_nop 1
buffer_store_dword v144, v245, s[4:7], s33 offen offset:128 sc1
s_nop 1
buffer_store_dword v148, v245, s[4:7], s33 offen offset:192 sc1
s_mov_b32 s12, s64
s_mov_b32 s13, s65
s_mov_b32 s14, 4096
s_mov_b32 s15, 0x20000
s_lshl_b32 s32, s18, 12
s_lshl_b32 s26, s17, 17
s_add_u32 s26, s26, s32
s_add_u32 s26, s26, 6291456
s_mul_i32 s27, s17, 458752
s_add_u32 s27, s27, s22
s_add_u32 s28, s27, 41943040
s_and_b32 s34, s17, 1
s_mul_i32 s33, s34, 229376
s_add_u32 s28, s28, s33
s_mul_i32 s33, s34, 917504
s_add_u32 s73, s28, 458752
s_sub_u32 s73, s73, s33
s_add_u32 s27, s27, 8388608
s_mul_i32 s29, s17, 229376
s_add_u32 s29, s29, s32
s_add_u32 s29, s29, 15728640
s_and_b32 s34, s17, 1
s_mul_i32 s33, s34, 114688
s_add_u32 s29, s29, s33
s_mul_i32 s33, s34, 458752
s_add_u32 s72, s29, 229376
s_sub_u32 s72, s72, s33
s_lshl_b32 s75, s30, 4
s_add_u32 s75, s75, s17
s_lshr_b32 s3, s75, 1
s_lshl_b32 s3, s3, 7
s_add_u32 s3, s3, 52690944
s_lshl_b32 s75, s75, 10
s_add_u32 s75, s75, 49283072
s_lshl_b32 s48, s30, 8
s_add_u32 s48, s48, 52428800
s_lshl_b32 s49, s31, 8
s_add_u32 s49, s49, 52428800
s_lshl_b32 s50, s17, 10
s_add_u32 s50, s50, 52428800
s_min_u32 s33, s18, 1
s_lshl_b32 s33, s33, 30
s_add_u32 s50, s50, s33
s_and_b32 s42, s17, 14
s_lshr_b32 s34, s16, 3
s_add_u32 s42, s42, s34
s_lshl_b32 s42, s42, 10
s_add_u32 s42, s42, 52428800
s_add_u32 s42, s42, s33
s_lshl_b32 s52, s30, 17
s_add_u32 s52, s52, 33554432
s_lshl_b32 s53, s30, 17
s_add_u32 s53, s53, 19922944
s_lshl_b32 s55, s31, 14
s_add_u32 s55, s55, 50331648
s_lshl_b32 s56, s31, 11
s_add_u32 s56, s56, 52166656
s_mul_i32 s57, s17, 458752
s_mul_i32 s33, s30, 7168
s_add_u32 s57, s57, s33
s_add_u32 s57, s57, 41943040
s_lshr_b32 s33, s17, 1
s_mul_i32 s33, s33, 14336
s_add_u32 s33, s33, s52
s_and_b32 s34, s17, 1
s_lshl_b32 s58, s34, 13
s_xor_b32 s74, s58, 8192
s_add_u32 s74, s74, s33
s_add_u32 s58, s58, s33
s_lshl_b32 s59, s34, 3
s_add_u32 s59, s59, s33
s_add_u32 s59, s59, 6144
s_mov_b32 s40, 0x358637bd
s_mov_b32 s43, 0xbdd2d3e8
s_mov_b32 s41, 0x3fb8aa3b
s_mov_b32 s44, 0x3727c5ac
s_mov_b32 s19, 0
v_and_b32 v240, 15, v246
v_lshrrev_b32 v241, 4, v246
v_bfe_u32 v220, v246, 2, 2
v_lshlrev_b32 v220, 3, v220
v_and_b32 v221, 3, v246
v_add_u32 v220, v220, v221
v_lshlrev_b32 v220, 1, v220
s_lshl_b32 s33, s30, 6
buffer_load_ushort v192, v220, s[12:15], s33 offen
buffer_load_ushort v196, v220, s[12:15], s33 offen offset:8
v_mov_b32 v222, 2147483392
v_add_u32 v1, 0x10000, v0
v_and_b32 v2, 8191, v2
v_add_u32 v2, 6144, v2
v_lshl_add_u64 v[2:3], v[2:3], 0, s[84:85]
s_mov_b32 s97, 0
s_lshl_b32 s33, s2, 2
s_add_u32 s33, s33, s18
s_lshl_b32 s33, s33, 8
v_and_b32 v224, 1, v246
v_lshl_add_u32 v224, v224, 7, s33
v_min_u32 v224, main_last-main_pc-4, v224
v_mov_b32 v225, 0
v_lshl_add_u64 v[224:225], v[224:225], 0, s[84:85]
global_load_dword v254, v[224:225], off
v_lshlrev_b32 v5, 2, v240
v_lshlrev_b32 v7, 3, v246
v_add_u32 v29, 131072, v0
v_add_u32 v8, s32, v29
s_lshr_b32 s33, s18, 1
s_lshl_b32 s33, s33, 11
v_add_u32 v9, s33, v29
s_lshl_b32 s33, s18, 10
v_add_u32 v10, s33, v29
v_add_u32 v11, 159744, v5
v_lshlrev_b32 v223, 4, v241
v_add_u32 v12, 159744, v223
s_lshl_b32 s33, s18, 9
s_add_u32 s33, s33, 161792
v_add_u32 v14, s33, v5
v_add_u32 v15, s33, v223
v_lshlrev_b32 v224, 4, v240
v_lshl_add_u32 v224, v241, 2, v224
v_add_u32 v13, s33, v224
v_lshlrev_b32 v224, 5, v241
v_cmp_eq_u32 vcc, 0, v240
s_nop 1
v_cndmask_b32 v22, v222, v224, vcc
v_lshl_add_u32 v23, v240, 7, v224
v_lshrrev_b32 v224, 2, v240
v_lshl_add_u32 v225, v224, 6, v223
v_cmp_eq_u32 vcc, 0, v221
s_nop 1
v_cndmask_b32 v28, v222, v225, vcc
v_mov_b32 v16, 0
v_mov_b32 v17, 0
v_mov_b32 v20, 0
v_mov_b32 v21, 0
v_and_b32 v225, 1, v246
v_lshlrev_b32 v225, 4, v225
v_mov_b32 v226, 0x3f80
v_lshlrev_b32 v226, v225, v226
v_cmp_eq_u32 vcc, v224, v241
s_nop 1
v_cndmask_b32 v226, 0, v226, vcc
v_cmp_gt_u32 vcc, 2, v221
s_nop 1
v_cndmask_b32 v18, 0, v226, vcc
v_cndmask_b32 v19, v226, v16, vcc
v_mov_b32 v30, 0xc0135761
s_mov_b32 s32, 2147483392
s_mov_b32 s33, 2147483392
s_lshl_b32 s35, s101, 2
s_add_u32 s35, s35, s18
s_lshl_b32 s35, s35, 8
s_add_u32 s34, s48, 32768
s_cmp_eq_u32 s17, 0
s_cselect_b32 s32, s34, s32
s_add_u32 s34, s48, 49152
s_cmp_eq_u32 s17, 1
s_cselect_b32 s32, s34, s32
s_add_u32 s34, s48, 65536
s_cmp_eq_u32 s17, 2
s_cselect_b32 s32, s34, s32
s_add_u32 s34, s48, 98304
s_cmp_eq_u32 s17, 3
s_cselect_b32 s32, s34, s32
s_add_u32 s34, s48, 524288
s_cmp_eq_u32 s17, 4
s_cselect_b32 s32, s34, s32
s_add_u32 s34, s48, 557056
s_cmp_eq_u32 s17, 5
s_cselect_b32 s32, s34, s32
s_add_u32 s34, s48, 573440
s_cmp_eq_u32 s17, 6
s_cselect_b32 s32, s34, s32
s_add_u32 s34, s48, 589824
s_cmp_eq_u32 s17, 7
s_cselect_b32 s32, s34, s32
s_add_u32 s34, s48, 622592
s_cmp_eq_u32 s17, 8
s_cselect_b32 s32, s34, s32
s_add_u32 s34, s35, 52445184
s_cmp_eq_u32 s16, 0
s_cselect_b32 s33, s34, s33
s_add_u32 s34, s35, 52969472
s_cmp_eq_u32 s16, 1
s_cselect_b32 s33, s34, s33
s_add_u32 s34, s35, 52510720
s_cmp_eq_u32 s16, 2
s_cselect_b32 s33, s34, s33
s_add_u32 s34, s35, 53035008
s_cmp_eq_u32 s16, 3
s_cselect_b32 s33, s34, s33
s_add_u32 s34, s35, 52559872
s_cmp_eq_u32 s16, 4
s_cselect_b32 s33, s34, s33
v_mov_b32 v233, 0
s_and_b32 s34, s17, 1
s_lshl_b32 s34, s34, 16
s_add_u32 s34, s34, s3
s_add_u32 s35, s34, 524288
buffer_store_dword v233, v4, s[4:7], s32 offen sc1
buffer_store_dword v233, v4, s[4:7], s33 offen sc1
buffer_store_dword v233, v4, s[4:7], s34 offen sc1
buffer_store_dword v233, v4, s[4:7], s35 offen sc1
v_and_b32 v220, 0x70, v0
v_lshrrev_b32 v221, 7, v0
v_mul_u32_u24 v252, 7168, v221
v_add_u32 v252, v252, v220
v_lshl_add_u32 v5, v221, 11, v220
v_lshrrev_b32 v221, 9, v0
v_bfe_u32 v222, v0, 7, 2
v_lshl_add_u32 v221, v221, 3, v222
v_lshl_add_u32 v253, v221, 12, v220
v_lshrrev_b32 v220, 6, v0
v_lshlrev_b32 v220, 7, v220
v_bfe_u32 v221, v0, 4, 2
v_lshl_add_u32 v220, v221, 3, v220
v_add_u32 v7, s21, v220
s_lshl_b32 s38, s30, 17
s_lshl_b32 s32, s101, 8
s_add_u32 s38, s38, s32
s_mul_i32 s81, s16, 458752
s_mul_i32 s32, s17, 224
s_add_u32 s81, s81, s32
s_and_b32 s32, s18, 1
s_lshl_b32 s32, s32, 7
s_add_u32 s81, s81, s32
s_lshr_b32 s32, s18, 1
s_mul_i32 s32, s32, 3584
s_sub_u32 s81, s81, s32
s_add_u32 s81, s81, 3584
s_lshl_b32 s39, s30, 16
s_lshl_b32 s32, s101, 7
s_add_u32 s39, s39, s32
s_lshl_b32 s32, s101, 13
s_add_u32 s45, s32, s53
s_mul_i32 s32, s101, 56
s_add_u32 s32, s32, s30
s_lshl_b32 s32, s32, 12
s_add_u32 s32, s32, 15728640
s_cmp_lt_u32 s30, 56
s_cselect_b32 s100, s32, 2147483392
s_lshr_b32 s32, s18, 1
s_lshl_b32 s33, s17, 1
s_add_u32 s33, s33, s32
s_lshl_b32 s33, s33, 4
s_add_u32 s33, s33, s16
s_mul_i32 s33, s33, 14336
s_add_u32 s33, s33, 8388608
s_mul_i32 s32, s32, 448
s_lshl_b32 s34, s17, 4
s_add_u32 s34, s34, s16
s_lshl_b32 s34, s34, 10
s_add_u32 s32, s32, s34
s_add_u32 s32, s32, 28573696
s_and_b32 s34, s18, 1
s_lshl_b32 s34, s34, 2
s_add_u32 s34, s34, 0
s_and_b32 s35, s17, 1
s_sub_u32 s35, s34, s35
s_cmp_lt_i32 s35, 0
s_cselect_b32 s35, 6, s35
s_lshl_b32 s88, s35, 10
s_add_u32 s88, s88, s33
s_lshl_b32 s82, s35, 6
s_add_u32 s82, s82, s32
s_cmp_eq_u32 s34, 7
s_cselect_b32 s88, 2147483392, s88
s_cselect_b32 s82, 2147483392, s82
s_and_b32 s34, s18, 1
s_lshl_b32 s34, s34, 2
s_add_u32 s34, s34, 1
s_and_b32 s35, s17, 1
s_sub_u32 s35, s34, s35
s_cmp_lt_i32 s35, 0
s_cselect_b32 s35, 6, s35
s_lshl_b32 s89, s35, 10
s_add_u32 s89, s89, s33
s_lshl_b32 s83, s35, 6
s_add_u32 s83, s83, s32
s_cmp_eq_u32 s34, 7
s_cselect_b32 s89, 2147483392, s89
s_cselect_b32 s83, 2147483392, s83
s_and_b32 s34, s18, 1
s_lshl_b32 s34, s34, 2
s_add_u32 s34, s34, 2
s_and_b32 s35, s17, 1
s_sub_u32 s35, s34, s35
s_cmp_lt_i32 s35, 0
s_cselect_b32 s35, 6, s35
s_lshl_b32 s90, s35, 10
s_add_u32 s90, s90, s33
s_lshl_b32 s64, s35, 6
s_add_u32 s64, s64, s32
s_cmp_eq_u32 s34, 7
s_cselect_b32 s90, 2147483392, s90
s_cselect_b32 s64, 2147483392, s64
s_and_b32 s34, s18, 1
s_lshl_b32 s34, s34, 2
s_add_u32 s34, s34, 3
s_and_b32 s35, s17, 1
s_sub_u32 s35, s34, s35
s_cmp_lt_i32 s35, 0
s_cselect_b32 s35, 6, s35
s_lshl_b32 s91, s35, 10
s_add_u32 s91, s91, s33
s_lshl_b32 s65, s35, 6
s_add_u32 s65, s65, s32
s_cmp_eq_u32 s34, 7
s_cselect_b32 s91, 2147483392, s91
s_cselect_b32 s65, 2147483392, s65
s_waitcnt vmcnt(6)
v_lshlrev_b32 v192, 16, v192
v_mov_b32 v193, v192
v_mov_b32 v194, v192
v_mov_b32 v195, v192
s_waitcnt vmcnt(5)
v_lshlrev_b32 v196, 16, v196
v_mov_b32 v197, v196
v_mov_b32 v198, v196
v_mov_b32 v199, v196
s_mov_b32 s12, s98
s_mov_b32 s13, s99
s_mov_b32 s14, 4
v_readfirstlane_b32 s46, v31
s_nop 0
s_cmp_lg_u32 s46, 0
s_cbranch_scc1 main_dok2
s_mov_b32 s47, 0
main_dbg1:
buffer_load_dword v31, v4, s[12:15], 0 offen sc1
s_add_u32 s47, s47, 1
s_cmp_gt_u32 s47, 400000
s_cbranch_scc1 main_dok2
s_waitcnt vmcnt(0)
v_readfirstlane_b32 s46, v31
s_nop 0
s_cmp_eq_u32 s46, 0
s_cbranch_scc1 main_dbg1
main_dok2:
s_add_u32 s37, s48, 0
v_mov_b32 v220, 1
v_mov_b32 v221, 1
s_lshl_b32 s36, s101, 10
s_add_u32 s36, s36, 52543488
s_waitcnt vmcnt(0)
buffer_atomic_add v220, v4, s[4:7], s37 offen sc0 sc1
buffer_atomic_add v221, v4, s[4:7], s36 offen sc1
s_mov_b64 s[12:13], s[66:67]
s_mov_b32 s14, 7340032
s_add_u32 s80, s81, 0
s_add_u32 m0, s21, 98304
s_nop 0
buffer_load_dwordx4 v252, s[12:15], s80 offen nt lds
s_add_u32 s80, s81, 57344
s_add_u32 m0, s21, 99328
s_nop 0
buffer_load_dwordx4 v252, s[12:15], s80 offen nt lds
s_add_u32 s80, s81, 114688
s_add_u32 m0, s21, 100352
s_nop 0
buffer_load_dwordx4 v252, s[12:15], s80 offen nt lds
s_add_u32 s80, s81, 172032
s_add_u32 m0, s21, 101376
s_nop 0
buffer_load_dwordx4 v252, s[12:15], s80 offen nt lds
s_add_u32 s80, s81, 229376
s_add_u32 m0, s21, 114688
s_nop 0
buffer_load_dwordx4 v252, s[12:15], s80 offen nt lds
s_add_u32 s80, s81, 286720
s_add_u32 m0, s21, 115712
s_nop 0
buffer_load_dwordx4 v252, s[12:15], s80 offen nt lds
s_add_u32 s80, s81, 344064
s_add_u32 m0, s21, 116736
s_nop 0
buffer_load_dwordx4 v252, s[12:15], s80 offen nt lds
s_add_u32 s80, s81, 401408
s_add_u32 m0, s21, 117760
s_nop 0
buffer_load_dwordx4 v252, s[12:15], s80 offen nt lds
s_mov_b32 s36, s37
s_waitcnt vmcnt(9)
v_mov_b32 v31, v220
s_nop 0
v_readfirstlane_b32 s46, v31
s_nop 0
s_nop 0
s_cmp_ge_u32 s46, 15
s_cbranch_scc1 main_ok4
s_mov_b32 s47, 0
main_poll3:
v_mov_b32 v31, 0
buffer_atomic_add v31, v4, s[4:7], s36 offen sc0 sc1
s_add_u32 s47, s47, 1
s_cmp_gt_u32 s47, 400000
s_cbranch_scc1 main_ok4
s_waitcnt vmcnt(0)
v_readfirstlane_b32 s46, v31
s_nop 0
s_cmp_lt_u32 s46, 16
s_cbranch_scc1 main_poll3
main_ok4:
s_max_i32 s24, s76, 0
s_mul_i32 s24, s24, 8192
s_add_u32 s24, s24, s51
s_add_u32 s24, s24, 0
lx 0,0
lx 4,1024
lx 8,2048
lx 12,3072
s_add_u32 s24, s24, 4096
lx 16,0
lx 20,1024
lx 24,2048
lx 28,3072
s_mul_i32 s24, s77, 8192
s_add_u32 s24, s24, s51
s_add_u32 s24, s24, 8192
lx 32,0
lx 36,1024
lx 40,2048
lx 44,3072
s_add_u32 s24, s24, 4096
lx 48,0
lx 52,1024
lx 56,2048
lx 60,3072
s_add_u32 s36, s50, 114688
v_mov_b32 v31, 0
buffer_atomic_add v31, v4, s[4:7], s36 offen sc0 sc1
s_waitcnt vmcnt(0)
v_readfirstlane_b32 s46, v31
s_nop 0
s_add_u32 s46, s46, s21
s_cmp_ge_u32 s46, 64
s_cbranch_scc1 main_ok6
s_mov_b32 s47, 0
main_poll5:
v_mov_b32 v31, 0
buffer_atomic_add v31, v4, s[4:7], s36 offen sc0 sc1
s_add_u32 s47, s47, 1
s_cmp_gt_u32 s47, 400000
s_cbranch_scc1 main_ok6
s_waitcnt vmcnt(0)
v_readfirstlane_b32 s46, v31
s_nop 0
s_cmp_lt_u32 s46, 64
s_cbranch_scc1 main_poll5
main_ok6:
s_barrier
s_max_i32 s23, s76, 0
s_mul_i32 s23, s23, 16384
s_add_u32 s23, s23, s25
s_add_u32 s23, s23, 0
s_add_u32 m0, s21, 0
s_nop 0
lw 0
lw 1024
lw 2048
lw 3072
s_max_i32 s23, s76, 0
s_mul_i32 s23, s23, 16384
s_add_u32 s23, s23, s25
s_add_u32 s23, s23, 131072
s_add_u32 m0, s21, 16384
s_nop 0
lw 0
lw 1024
lw 2048
lw 3072
s_mul_i32 s23, s77, 16384
s_add_u32 s23, s23, s25
s_add_u32 s23, s23, 16384
s_add_u32 m0, s21, 32768
s_nop 0
lw 0
lw 1024
lw 2048
lw 3072
s_mul_i32 s23, s78, 16384
s_add_u32 s23, s23, s25
s_add_u32 s23, s23, 32768
s_add_u32 m0, s21, 49152
s_nop 0
lw 0
lw 1024
lw 2048
lw 3072
s_waitcnt vmcnt(8)
s_barrier
rd 48,0,0
rd 52,0,1024
rd 56,0,2048
rd 60,0,3072
rd 64,0,16384
rd 68,0,17408
rd 72,0,18432
wl 5
v_mfma_f32_16x16x32_bf16 v[80:83], a[0:3], v[48:51], 0
s_mul_i32 s24, s78, 8192
rd 76,0,19456
v_mfma_f32_16x16x32_bf16 v[84:87], a[4:7], v[48:51], 0
main_cp0:
s_mov_b32 s96, main_cp0-main_pc
v_lshl_add_u64 v[2:3], v[2:3], 0, s[96:97]
global_load_dword v254, v[2:3], off
v_mfma_f32_16x16x32_bf16 v[92:95], a[4:7], v[52:55], 0
s_add_u32 s24, s24, s51
rd 48,0,4096
v_mfma_f32_16x16x32_bf16 v[88:91], a[0:3], v[52:55], 0
wl 5
v_mfma_f32_16x16x32_bf16 v[96:99], a[0:3], v[56:59], 0
s_add_u32 s24, s24, 16384
rd 52,0,5120
v_mfma_f32_16x16x32_bf16 v[100:103], a[4:7], v[56:59], 0
lx 64,0
v_mfma_f32_16x16x32_bf16 v[108:111], a[4:7], v[60:63], 0
rd 56,0,6144
v_mfma_f32_16x16x32_bf16 v[104:107], a[0:3], v[60:63], 0
wl 5
lx 68,1024
v_mfma_f32_16x16x32_bf16 v[136:139], a[0:3], v[64:67], 0
rd 60,0,7168
v_mfma_f32_16x16x32_bf16 v[140:143], a[4:7], v[64:67], 0
v_mfma_f32_16x16x32_bf16 v[148:151], a[4:7], v[68:71], 0
rd 64,0,20480
v_mfma_f32_16x16x32_bf16 v[144:147], a[0:3], v[68:71], 0
wl 5
lx 72,2048
v_mfma_f32_16x16x32_bf16 v[152:155], a[0:3], v[72:75], 0
rd 68,0,21504
v_mfma_f32_16x16x32_bf16 v[156:159], a[4:7], v[72:75], 0
lx 76,3072
v_mfma_f32_16x16x32_bf16 v[164:167], a[4:7], v[76:79], 0
s_add_u32 s24, s24, 4096
rd 72,0,22528
v_mfma_f32_16x16x32_bf16 v[160:163], a[0:3], v[76:79], 0
wl 5
mF 80,48,8
rd 76,0,23552
mF 84,48,12
lx 80,0
mF 92,52,12
rd 48,0,8192
mF 88,52,8
wl 5
mF 96,56,8
rd 52,0,9216
mF 100,56,12
lx 84,1024
mF 108,60,12
rd 56,0,10240
mF 104,60,8
wl 5
lx 88,2048
mF 136,64,8
rd 60,0,11264
mF 140,64,12
mF 148,68,12
rd 64,0,24576
mF 144,68,8
wl 5
lx 92,3072
mF 152,72,8
s_mul_i32 s24, s79, 8192
rd 68,0,25600
mF 156,72,12
mF 164,76,12
s_add_u32 s24, s24, s51
rd 72,0,26624
mF 160,76,8
wl 5
mF 80,48,16
s_add_u32 s24, s24, 24576
rd 76,0,27648
mF 84,48,20
lx 96,0
mF 92,52,20
rd 48,0,12288
mF 88,52,16
wl 5
lx 100,1024
mF 96,56,16
rd 52,0,13312
mF 100,56,20
mF 108,60,20
rd 56,0,14336
mF 104,60,16
wl 5
lx 104,2048
mF 136,64,16
rd 60,0,15360
mF 140,64,20
lx 108,3072
mF 148,68,20
rd 64,0,28672
mF 144,68,16
wl 5
mF 152,72,16
s_mul_i32 s23, s79, 16384
rd 68,0,29696
mF 156,72,20
mF 164,76,20
s_add_u32 s23, s23, s25
rd 72,0,30720
mF 160,76,16
wl 5
mF 80,48,24
s_add_u32 s23, s23, 49152
rd 76,0,31744
mF 84,48,28
s_waitcnt vmcnt(17)
s_barrier
mF 92,52,28
s_add_u32 m0, s21, 65536
rd 48,0,32768
mF 88,52,24
wl 5
lw 0
mF 96,56,24
rd 52,0,33792
mF 100,56,28
lw 1024
mF 108,60,28
rd 56,0,34816
mF 104,60,24
wl 5
mF 136,64,24
rd 60,0,35840
mF 140,64,28
lw 2048
mF 148,68,28
rd 64,0,36864
mF 144,68,24
wl 5
lw 3072
mF 152,72,24
s_add_u32 s37, s54, 0
rd 68,0,37888
mF 156,72,28
mF 164,76,28
rd 72,0,38912
mF 160,76,24
wl 5
buffer_load_dwordx4 v[220:223], v0, s[4:7], s37 offen offset:0 sc1
mF 80,48,32
rd 76,0,39936
mF 84,48,36
buffer_load_dwordx4 v[224:227], v0, s[4:7], s37 offen offset:1024 sc1
mF 92,52,36
rd 48,0,40960
mF 88,52,32
wl 5
mF 96,56,32
rd 52,0,41984
mF 100,56,36
buffer_load_dwordx4 v[228:231], v0, s[4:7], s37 offen offset:2048 sc1
mF 108,60,36
rd 56,0,43008
mF 104,60,32
wl 5
mF 80,64,40
s_add_u32 s24, s24, 4096
rd 60,0,44032
mF 84,64,44
buffer_load_dwordx4 v[232:235], v0, s[4:7], s37 offen offset:3072 sc1
mF 92,68,44
rd 64,0,45056
mF 88,68,40
wl 5
lx 112,0
mF 96,72,40
rd 68,0,46080
mF 100,72,44
mF 108,76,44
s_mul_i32 s23, s76, 16384
rd 72,0,47104
mF 104,76,40
wl 5
lx 116,1024
mF 80,48,48
s_add_u32 s23, s23, s25
rd 76,0,48128
mF 84,48,52
s_waitcnt vmcnt(23)
s_barrier
mF 92,52,52
s_add_u32 s23, s23, 65536
rd 48,0,49152
mF 88,52,48
wl 5
mF 96,56,48
s_add_u32 m0, s21, 81920
rd 52,0,50176
mF 100,56,52
lw 0
mF 108,60,52
rd 56,0,51200
mF 104,60,48
wl 5
lw 1024
mF 80,64,56
rd 60,0,52224
mF 84,64,60
mF 92,68,60
rd 64,0,53248
mF 88,68,56
wl 5
lw 2048
mF 96,72,56
rd 68,0,54272
mF 100,72,60
lw 3072
mF 108,76,60
s_lshl_b32 s37, s31, 12
rd 72,0,55296
mF 104,76,56
s_waitcnt vmcnt(25) lgkmcnt(5)
mF 80,48,64
s_waitcnt vmcnt(24)
s_add_u32 s37, s37, 28311552
rd 76,0,56320
mF 84,48,68
buffer_load_dwordx4 v[112:115], v0, s[4:7], s37 offen offset:0 sc1
mF 92,52,68
rd 48,0,57344
mF 88,52,64
wl 5
buffer_load_dwordx4 v[116:119], v0, s[4:7], s37 offen offset:1024 sc1
mF 96,56,64
rd 52,0,58368
mF 100,56,68
mF 108,60,68
rd 56,0,59392
mF 104,60,64
s_waitcnt vmcnt(25) lgkmcnt(5)
buffer_load_dwordx4 v[120:123], v0, s[4:7], s37 offen offset:2048 sc1
mF 80,64,72
s_waitcnt vmcnt(25)
rd 60,0,60416
mF 84,64,76
buffer_load_dwordx4 v[124:127], v0, s[4:7], s37 offen offset:3072 sc1
mF 92,68,76
rd 64,0,61440
mF 88,68,72
wl 5
mF 96,72,72
rd 68,0,62464
mF 100,72,76
lx 120,2048
mF 108,76,76
rd 72,0,63488
mF 104,76,72
s_waitcnt vmcnt(26) lgkmcnt(5)
lx 124,3072
mF 80,48,80
s_waitcnt vmcnt(26)
s_mul_i32 s23, s77, 16384
rd 76,0,64512
mF 84,48,84
s_waitcnt vmcnt(16)
s_barrier
mF 92,52,84
s_add_u32 s23, s23, s25
rd 48,1,0
mF 88,52,80
wl 5
mF 96,56,80
s_add_u32 s23, s23, 81920
rd 52,1,1024
mF 100,56,84
mF 108,60,84
s_add_u32 m0, s21, 0
rd 56,1,2048
mF 104,60,80
wl 5
lw 0
mF 80,64,88
s_mul_i32 s24, s76, 8192
rd 60,1,3072
mF 84,64,92
mF 92,68,92
s_add_u32 s24, s24, s51
rd 64,1,4096
mF 88,68,88
wl 5
mF 96,72,88
s_add_u32 s24, s24, 32768
rd 68,1,5120
mF 100,72,92
lx 128,0
mF 108,76,92
rd 72,1,6144
mF 104,76,88
wl 5
lx 132,1024
mF 80,48,96
rd 76,1,7168
mF 84,48,100
lx 136,2048
mF 92,52,100
rd 48,1,8192
v_add_u32 v251, 98304, v7
ds_read_b64_tr_b16 v[176:177], v251 offset:0
mF 88,52,96
wl 6
lx 140,3072
ds_read_b64_tr_b16 v[178:179], v251 offset:2048
mF 96,56,96
s_add_u32 s24, s24, 4096
rd 52,1,9216
ds_read_b64_tr_b16 v[180:181], v251 offset:32
ds_read_b64_tr_b16 v[182:183], v251 offset:2080
mF 100,56,100
lw 1024
ds_read_b64_tr_b16 v[184:185], v251 offset:64
mF 108,60,100
rd 56,1,10240
ds_read_b64_tr_b16 v[186:187], v251 offset:2112
ds_read_b64_tr_b16 v[188:189], v251 offset:96
mF 104,60,96
wl 12
lx 144,0
ds_read_b64_tr_b16 v[190:191], v251 offset:2144
mF 80,64,104
rd 60,1,11264
mF 84,64,108
lx 148,1024
mF 92,68,108
rd 64,1,12288
mF 88,68,104
wl 13
lw 2048
mF 96,72,104
rd 68,1,13312
mF 100,72,108
wl 10
lw 3072
v_mfma_f32_16x16x32_bf16 v[128:131], v[24:27], v[176:179], 0
wl 7
v_mfma_f32_16x16x32_bf16 v[132:135], v[24:27], v[180:183], 0
wl 4
v_mfma_f32_16x16x32_bf16 v[168:171], v[24:27], v[184:187], 0
wl 3
v_mfma_f32_16x16x32_bf16 v[172:175], v[24:27], v[188:191], 0
buffer_store_dwordx4 v[176:179], v0, s[4:7], s88 offen sc1
mF 108,76,108
rd 72,1,14336
lx 152,2048
lx 156,3072
mF 104,76,104
s_waitcnt vmcnt(24)
mF 80,48,112
s_waitcnt vmcnt(23)
s_mul_i32 s24, s77, 8192
rd 76,1,15360
mF 84,48,116
s_waitcnt vmcnt(19)
s_barrier
mF 92,52,116
s_add_u32 s24, s24, s51
rd 48,1,16384
mF 88,52,112
mF 96,56,112
s_add_u32 s24, s24, 40960
rd 52,1,17408
mF 100,56,116
wl 5
lx 160,0
mF 108,60,116
rd 56,1,18432
mF 104,60,112
s_waitcnt vmcnt(15)
lx 164,1024
mF 80,64,120
s_waitcnt vmcnt(15)
rd 60,1,19456
v_add_f32 v112, v112, v116
v_add_f32 v113, v113, v117
v_add_f32 v114, v114, v118
mF 84,64,124
wl 5
lx 168,2048
v_add_f32 v115, v115, v119
v_add_f32 v120, v120, v124
mF 92,68,124
rd 64,1,20480
v_add_f32 v121, v121, v125
v_add_f32 v122, v122, v126
v_add_f32 v123, v123, v127
mF 88,68,120
lx 172,3072
v_add_f32 v112, v112, v120
v_add_f32 v113, v113, v121
mF 96,72,120
s_add_u32 s24, s24, 4096
rd 68,1,21504
v_add_f32 v114, v114, v122
v_add_f32 v115, v115, v123
mF 100,72,124
wl 5
lx 176,0
ds_write_b128 v10, v[112:115] offset:0
mF 108,76,124
rd 72,1,22528
mF 104,76,120
s_waitcnt vmcnt(16)
mF 80,48,128
s_waitcnt vmcnt(15)
s_mul_i32 s23, s78, 16384
rd 76,1,23552
mF 84,48,132
wl 6
lx 180,1024
mF 92,52,132
s_add_u32 s23, s23, s25
rd 48,1,24576
mF 88,52,128
buffer_store_dwordx4 v[180:183], v0, s[4:7], s89 offen sc1
mF 96,56,128
s_add_u32 s23, s23, 98304
rd 52,1,25600
mF 100,56,132
wl 6
mF 108,60,132
s_add_u32 m0, s21, 16384
rd 56,1,26624
mF 104,60,128
s_waitcnt vmcnt(16)
lw 0
mF 80,64,136
s_waitcnt vmcnt(16)
rd 60,1,27648
mF 84,64,140
wl 6
lw 1024
mF 92,68,140
rd 64,1,28672
mF 88,68,136
wl 5
lw 2048
mF 96,72,136
rd 68,1,29696
mF 100,72,140
lw 3072
mF 108,76,140
rd 72,1,30720
mF 104,76,136
s_waitcnt vmcnt(17) lgkmcnt(5)
mF 80,48,144
s_waitcnt vmcnt(16)
rd 76,1,31744
mF 84,48,148
s_waitcnt vmcnt(14)
s_barrier
mF 92,52,148
rd 48,0,0
rd 112,29,0
rd 116,29,1024
rd 120,29,2048
mF 88,52,144
wl 8
lx 184,2048
rd 124,29,3072
mF 96,56,144
s_min_i32 s23, s79, 0
rd 52,0,1024
mF 100,56,148
lx 188,3072
mF 108,60,148
s_mul_i32 s23, s23, 16384
rd 56,0,2048
mF 104,60,144
s_waitcnt vmcnt(14) lgkmcnt(9)
mF 80,64,152
s_waitcnt vmcnt(13)
s_add_u32 s23, s23, s25
rd 60,0,3072
mF 84,64,156
wl 5
v_add_f32 v112, v112, v116
v_add_f32 v113, v113, v117
v_add_f32 v114, v114, v118
v_add_f32 v115, v115, v119
mF 92,68,156
wl 3
s_add_u32 s23, s23, 114688
rd 64,0,4096
v_add_f32 v120, v120, v124
v_add_f32 v121, v121, v125
v_add_f32 v122, v122, v126
mF 88,68,152
v_add_f32 v123, v123, v127
v_add_f32 v112, v112, v120
v_add_f32 v113, v113, v121
v_add_f32 v114, v114, v122
mF 96,72,152
s_add_u32 m0, s21, 32768
rd 68,0,5120
v_add_f32 v115, v115, v123
ds_write_b128 v29, v[112:115] offset:28672
mF 100,72,156
lw 0
v_add_f32 v220, v220, v224
v_add_f32 v221, v221, v225
mF 108,76,156
s_mul_i32 s24, s78, 8192
rd 72,0,6144
v_add_f32 v222, v222, v226
v_add_f32 v223, v223, v227
v_add_f32 v228, v228, v232
mF 104,76,152
s_waitcnt vmcnt(13)
v_add_f32 v229, v229, v233
v_add_f32 v230, v230, v234
v_add_f32 v231, v231, v235
v_add_f32 v220, v220, v228
mF 80,48,160
s_add_u32 s24, s24, s51
rd 76,0,7168
v_add_f32 v221, v221, v229
v_add_f32 v222, v222, v230
v_add_f32 v223, v223, v231
s_waitcnt vmcnt(12)
mF 84,48,164
wl 6
v_permlane32_swap_b32 v220, v222
v_permlane32_swap_b32 v221, v223
v_add_f32 v220, v220, v222
v_add_f32 v221, v221, v223
mF 92,52,164
s_add_u32 s24, s24, 49152
rd 48,0,8192
v_permlane16_swap_b32 v220, v221
v_add_f32 v220, v220, v221
mF 88,52,160
lx 192,0
ds_write_b32 v13, v220
mF 96,56,160
rd 52,0,9216
ds_read2_b32 v[224:225], v14 offset0:0 offset1:16
ds_read2_b32 v[226:227], v14 offset0:32 offset1:48
mF 100,56,164
wl 9
lx 196,1024
mF 108,60,164
rd 56,0,10240
buffer_store_dwordx4 v[184:187], v0, s[4:7], s90 offen sc1
mF 104,60,160
s_waitcnt vmcnt(14)
lx 200,2048
mF 80,64,168
s_waitcnt vmcnt(14)
rd 60,0,11264
mF 84,64,172
wl 9
lx 204,3072
mF 92,68,172
s_add_u32 s24, s24, 4096
rd 64,0,12288
mF 88,68,168
wl 8
lx 208,0
mF 96,72,168
wl 3
rd 68,0,13312
v_mul_f32 v216, 0xba800000, v224
v_mul_f32 v218, 0xba800000, v226
v_mul_f32 v225, 0x3a800000, v225
mF 100,72,172
lx 212,1024
v_mul_f32 v227, 0x3a800000, v227
v_fma_f32 v225, -v216, v216, v225
mF 108,76,172
rd 72,0,14336
v_fma_f32 v227, -v218, v218, v227
v_max_f32 v225, 0, v225
v_max_f32 v227, 0, v227
mF 104,76,168
s_waitcnt vmcnt(16)
lw 1024
v_add_f32 v225, s44, v225
v_add_f32 v227, s44, v227
mF 80,48,176
s_waitcnt vmcnt(16)
rd 76,0,15360
v_rsq_f32 v217, v225
mF 84,48,180
s_waitcnt vmcnt(11)
s_barrier
v_rsq_f32 v219, v227
mF 92,52,180
rd 48,0,16384
ds_write2_b32 v14, v216, v217 offset0:64 offset1:80
mF 88,52,176
wl 6
lw 2048
ds_write2_b32 v14, v218, v219 offset0:96 offset1:112
mF 96,56,176
rd 52,0,17408
rd 200,15,256
rd 204,15,320
rd 208,15,384
mF 100,56,180
lw 3072
rd 212,15,448
mF 108,60,180
rd 56,0,18432
mF 104,60,176
s_waitcnt vmcnt(12) lgkmcnt(11)
lx 216,2048
mF 80,64,184
s_waitcnt vmcnt(12)
rd 60,0,19456
mF 84,64,188
lx 220,3072
mF 92,68,188
s_min_i32 s24, s79, 0
rd 64,0,20480
mF 88,68,184
main_cp1:
s_mov_b32 s96, main_cp1-main_cp0
v_lshl_add_u64 v[2:3], v[2:3], 0, s[96:97]
global_load_dword v254, v[2:3], off
wl 11
mF 96,72,184
s_mul_i32 s24, s24, 8192
rd 68,0,21504
buffer_store_dwordx4 v[188:191], v0, s[4:7], s91 offen sc1
mF 100,72,188
ds_read_b32 v236, v11 offset:0
ds_read_b32 v240, v11 offset:256
ds_read_b32 v237, v11 offset:64
ds_read_b32 v241, v11 offset:320
mF 108,76,188
s_add_u32 s24, s24, s51
rd 72,0,22528
ds_read_b32 v238, v11 offset:128
ds_read_b32 v242, v11 offset:384
ds_read_b32 v239, v11 offset:192
mF 104,76,184
s_waitcnt vmcnt(13) lgkmcnt(15)
ds_read_b32 v243, v11 offset:448
mF 80,48,192
s_waitcnt vmcnt(12)
s_add_u32 s24, s24, 57344
rd 76,0,23552
mF 84,48,196
lx 224,0
mF 92,52,196
rd 48,0,24576
mF 88,52,192
wl 13
lx 228,1024
mF 96,56,192
rd 52,0,25600
mF 100,56,196
lx 232,2048
mF 108,60,196
rd 56,0,26624
mF 104,60,192
s_waitcnt vmcnt(13) lgkmcnt(13)
lx 236,3072
mF 80,64,200
s_waitcnt vmcnt(13)
s_add_u32 s24, s24, 4096
rd 60,0,27648
mF 84,64,204
lx 240,0
mF 92,68,204
s_mul_i32 s23, s77, 16384
rd 64,0,28672
mF 88,68,200
wl 9
lx 244,1024
v_add_u32 v251, 114688, v7
mF 96,72,200
s_add_u32 s23, s23, s25
rd 68,0,29696
s_add_u32 s88, s88, 7168
s_add_u32 s89, s89, 7168
mF 100,72,204
wl 5
s_add_u32 s90, s90, 7168
s_add_u32 s91, s91, 7168
ds_read_b64_tr_b16 v[176:177], v251 offset:0
mF 108,76,204
s_add_u32 s23, s23, 147456
rd 72,0,30720
ds_read_b64_tr_b16 v[178:179], v251 offset:2048
ds_read_b64_tr_b16 v[180:181], v251 offset:32
mF 104,76,200
s_waitcnt vmcnt(14)
ds_read_b64_tr_b16 v[182:183], v251 offset:2080
ds_read_b64_tr_b16 v[184:185], v251 offset:64
ds_read_b64_tr_b16 v[186:187], v251 offset:2112
mF 80,48,208
s_waitcnt vmcnt(13)
s_add_u32 m0, s21, 49152
rd 76,0,31744
ds_read_b64_tr_b16 v[188:189], v251 offset:96
ds_read_b64_tr_b16 v[190:191], v251 offset:2144
mF 84,48,212
s_waitcnt lgkmcnt(13) vmcnt(10)
s_barrier
mF 92,52,212
rd 48,0,32768
mF 88,52,208
lw 0
mF 96,56,208
rd 52,0,33792
mF 100,56,212
wl 13
lw 1024
mF 108,60,212
wl 8
rd 56,0,34816
v_mfma_f32_16x16x32_bf16 v[128:131], v[24:27], v[176:179], v[128:131]
wl 7
v_mfma_f32_16x16x32_bf16 v[132:135], v[24:27], v[180:183], v[132:135]
wl 5
v_mfma_f32_16x16x32_bf16 v[168:171], v[24:27], v[184:187], v[168:171]
wl 3
v_mfma_f32_16x16x32_bf16 v[172:175], v[24:27], v[188:191], v[172:175]
buffer_store_dwordx4 v[176:179], v0, s[4:7], s88 offen sc1
mF 104,60,208
s_waitcnt vmcnt(12)
lw 2048
lx 248,2048
lx 252,3072
mF 80,64,216
s_waitcnt vmcnt(14)
rd 60,0,35840
lw 3072
mF 84,64,220
mF 92,68,220
s_mul_i32 s23, s78, 16384
rd 64,0,36864
mF 88,68,216
mF 96,72,216
s_add_u32 s23, s23, s25
rd 68,0,37888
mF 100,72,220
mF 108,76,220
s_add_u32 s23, s23, 163840
rd 72,0,38912
mF 104,76,216
s_waitcnt vmcnt(12) lgkmcnt(5)
mF 80,48,224
s_waitcnt vmcnt(11)
s_add_u32 m0, s21, 65536
rd 76,0,39936
mF 84,48,228
lw 0
mF 92,52,228
rd 48,0,40960
mF 88,52,224
wl 5
lw 1024
mF 96,56,224
rd 52,0,41984
mF 100,56,228
lw 2048
mF 108,60,228
rd 56,0,43008
mF 104,60,224
s_waitcnt vmcnt(13) lgkmcnt(5)
lw 3072
mF 80,64,232
s_waitcnt vmcnt(13)
s_mul_i32 s23, s79, 16384
rd 60,0,44032
mF 84,64,236
mF 92,68,236
s_add_u32 s23, s23, s25
rd 64,0,45056
mF 88,68,232
wl 5
mF 96,72,232
s_add_u32 s23, s23, 180224
rd 68,0,46080
buffer_store_dwordx4 v[180:183], v0, s[4:7], s89 offen sc1
mF 100,72,236
mF 108,76,236
s_add_u32 m0, s21, 98304
rd 72,0,47104
mF 104,76,232
s_waitcnt vmcnt(13) lgkmcnt(5)
lw 0
mF 80,48,240
s_waitcnt vmcnt(13)
s_lshl_b32 s37, s17, 12
rd 76,0,48128
mF 84,48,244
s_waitcnt vmcnt(6)
s_barrier
mF 92,52,244
s_add_u32 s37, s37, s51
rd 48,0,49152
mF 88,52,240
wl 5
buffer_load_dwordx4 v[32:35], v0, s[4:7], s37 offen offset:0 sc1
mF 96,56,240
rd 52,0,50176
mF 100,56,244
mF 108,60,244
rd 56,0,51200
mF 104,60,240
wl 5
buffer_load_dwordx4 v[40:43], v0, s[4:7], s37 offen offset:1024 sc1
mF 80,64,248
rd 60,0,52224
mF 84,64,252
mF 92,68,252
rd 64,0,53248
mF 88,68,248
wl 5
buffer_load_dwordx4 v[36:39], v0, s[4:7], s37 offen offset:2048 sc1
mF 96,72,248
rd 68,0,54272
mF 100,72,252
mF 108,76,252
rd 72,0,55296
mF 104,76,248
wl 5
mF 136,48,32
rd 76,0,56320
mF 140,48,36
buffer_load_dwordx4 v[44:47], v0, s[4:7], s37 offen offset:3072 sc1
mF 148,52,36
rd 48,0,57344
buffer_store_dwordx4 v[184:187], v0, s[4:7], s90 offen sc1
mF 144,52,32
wl 5
mF 152,56,32
rd 52,0,58368
mF 156,56,36
lw 1024
mF 164,60,36
rd 56,0,59392
v_fmac_f32 v80, v200, v236
v_fmac_f32 v81, v201, v236
mF 160,60,32
wl 5
v_fmac_f32 v82, v202, v236
v_fmac_f32 v83, v203, v236
v_fma_f32 v80, v80, v204, s40
mF 136,64,40
rd 60,0,60416
v_fma_f32 v81, v81, v205, s40
v_fma_f32 v82, v82, v206, s40
mF 140,64,44
lw 2048
v_fma_f32 v83, v83, v207, s40
mF 148,68,44
rd 64,0,61440
v_mul_f32 v220, s41, v80
v_mul_f32 v221, s41, v81
mF 144,68,40
wl 5
v_mul_f32 v222, s41, v82
v_mul_f32 v223, s41, v83
v_max_f32 v80, s40, v80
mF 152,72,40
rd 68,0,62464
v_exp_f32_e64 v220, v220 clamp
mF 156,72,44
lw 3072
v_max_f32 v81, s40, v81
mF 164,76,44
rd 72,0,63488
v_exp_f32_e64 v221, v221 clamp
mF 160,76,40
wl 5
v_exp_f32_e64 v222, v222 clamp
v_max_f32 v82, s40, v82
mF 136,48,48
s_mul_i32 s23, s76, 16384
rd 76,0,64512
v_exp_f32_e64 v223, v223 clamp
mF 140,48,52
s_waitcnt vmcnt(10)
s_barrier
v_max_f32 v83, s40, v83
v_add_f32 v80, v80, v220
mF 148,52,52
s_add_u32 s23, s23, s25
rd 48,1,0
v_add_f32 v81, v81, v221
v_add_f32 v82, v82, v222
mF 144,52,48
wl 5
v_add_f32 v83, v83, v223
v_cvt_pk_bf16_f32 v112, v80, v81
v_cvt_pk_bf16_f32 v113, v82, v83
mF 152,56,48
s_add_u32 s23, s23, 196608
rd 52,1,1024
v_fmac_f32 v84, v208, v236
v_fmac_f32 v85, v209, v236
mF 156,56,52
v_fmac_f32 v86, v210, v236
v_fmac_f32 v87, v211, v236
v_fma_f32 v84, v84, v212, s40
mF 164,60,52
s_add_u32 m0, s21, 81920
rd 56,1,2048
v_fma_f32 v85, v85, v213, s40
v_fma_f32 v86, v86, v214, s40
mF 160,60,48
wl 5
lw 0
v_fma_f32 v87, v87, v215, s40
mF 136,64,56
rd 60,1,3072
buffer_store_dwordx4 v[188:191], v0, s[4:7], s91 offen sc1
mF 140,64,60
v_mov_b32 v176, 2147483392
v_cmp_gt_u32 vcc, 64, v6
s_nop 1
v_cndmask_b32 v176, v176, v6, vcc
mF 148,68,60
rd 64,1,4096
v_mul_f32 v224, s41, v84
v_mul_f32 v225, s41, v85
mF 144,68,56
wl 5
lw 1024
v_mul_f32 v226, s41, v86
mF 152,72,56
rd 68,1,5120
buffer_store_dword v128, v176, s[4:7], s82 offen sc1
mF 156,72,60
buffer_store_dword v132, v176, s[4:7], s83 offen sc1
v_mul_f32 v227, s41, v87
mF 164,76,60
rd 72,1,6144
buffer_store_dword v168, v176, s[4:7], s64 offen sc1
mF 160,76,56
wl 5
buffer_store_dword v172, v176, s[4:7], s65 offen sc1
v_max_f32 v84, s40, v84
mF 136,48,64
rd 76,1,7168
v_exp_f32_e64 v224, v224 clamp
mF 140,48,68
lw 2048
v_max_f32 v85, s40, v85
mF 148,52,68
rd 48,1,8192
v_exp_f32_e64 v225, v225 clamp
mF 144,52,64
wl 5
v_exp_f32_e64 v226, v226 clamp
v_max_f32 v86, s40, v86
mF 152,56,64
rd 52,1,9216
v_exp_f32_e64 v227, v227 clamp
mF 156,56,68
v_max_f32 v87, s40, v87
v_add_f32 v84, v84, v224
v_add_f32 v85, v85, v225
mF 164,60,68
rd 56,1,10240
v_add_f32 v86, v86, v226
v_add_f32 v87, v87, v227
mF 160,60,64
wl 5
lw 3072
v_cvt_pk_bf16_f32 v114, v84, v85
mF 136,64,72
s_mul_i32 s23, s77, 16384
rd 60,1,11264
v_cvt_pk_bf16_f32 v115, v86, v87
v_fmac_f32 v88, v200, v237
mF 140,64,76
v_fmac_f32 v89, v201, v237
v_fmac_f32 v90, v202, v237
v_fmac_f32 v91, v203, v237
mF 148,68,76
s_add_u32 s23, s23, s25
rd 64,1,12288
v_fma_f32 v88, v88, v204, s40
v_fma_f32 v89, v89, v205, s40
mF 144,68,72
wl 5
v_fma_f32 v90, v90, v206, s40
v_fma_f32 v91, v91, v207, s40
v_mul_f32 v228, s41, v88
mF 152,72,72
s_add_u32 s23, s23, 212992
rd 68,1,13312
v_mul_f32 v229, s41, v89
v_mul_f32 v230, s41, v90
mF 156,72,76
v_mul_f32 v231, s41, v91
v_exp_f32_e64 v228, v228 clamp
mF 164,76,76
s_add_u32 m0, s21, 0
rd 72,1,14336
v_max_f32 v88, s40, v88
v_max_f32 v89, s40, v89
mF 160,76,72
wl 5
lw 0
v_max_f32 v90, s40, v90
mF 136,48,80
rd 76,1,15360
v_exp_f32_e64 v229, v229 clamp
mF 140,48,84
s_waitcnt vmcnt(10)
s_barrier
v_exp_f32_e64 v230, v230 clamp
mF 148,52,84
rd 48,1,32768
v_exp_f32_e64 v231, v231 clamp
mF 144,52,80
wl 5
lw 1024
v_max_f32 v91, s40, v91
mF 152,56,80
rd 52,1,33792
v_add_f32 v88, v88, v228
v_add_f32 v89, v89, v229
mF 156,56,84
v_add_f32 v90, v90, v230
v_add_f32 v91, v91, v231
v_cvt_pk_bf16_f32 v116, v88, v89
mF 164,60,84
rd 56,1,34816
v_cvt_pk_bf16_f32 v117, v90, v91
v_fmac_f32 v92, v208, v237
mF 160,60,80
wl 5
v_fmac_f32 v93, v209, v237
v_fmac_f32 v94, v210, v237
v_fmac_f32 v95, v211, v237
mF 136,64,88
rd 60,1,35840
v_fma_f32 v92, v92, v212, s40
v_fma_f32 v93, v93, v213, s40
mF 140,64,92
lw 2048
v_fma_f32 v94, v94, v214, s40
mF 148,68,92
rd 64,1,36864
v_fma_f32 v95, v95, v215, s40
v_mul_f32 v232, s41, v92
mF 144,68,88
wl 5
v_mul_f32 v233, s41, v93
v_mul_f32 v234, s41, v94
v_mul_f32 v235, s41, v95
mF 152,72,88
rd 68,1,37888
v_exp_f32_e64 v232, v232 clamp
mF 156,72,92
v_max_f32 v92, s40, v92
v_exp_f32_e64 v233, v233 clamp
mF 164,76,92
rd 72,1,38912
v_max_f32 v93, s40, v93
v_max_f32 v94, s40, v94
mF 160,76,88
wl 5
lw 3072
v_max_f32 v95, s40, v95
mF 136,48,96
s_mul_i32 s23, s78, 16384
rd 76,1,39936
v_exp_f32_e64 v234, v234 clamp
mF 140,48,100
v_exp_f32_e64 v235, v235 clamp
v_add_f32 v92, v92, v232
mF 148,52,100
s_add_u32 s23, s23, s25
rd 48,1,40960
v_add_f32 v93, v93, v233
v_add_f32 v94, v94, v234
mF 144,52,96
wl 5
v_add_f32 v95, v95, v235
v_cvt_pk_bf16_f32 v118, v92, v93
v_cvt_pk_bf16_f32 v119, v94, v95
mF 152,56,96
s_add_u32 s23, s23, 229376
rd 52,1,41984
v_fmac_f32 v96, v200, v238
v_fmac_f32 v97, v201, v238
mF 156,56,100
v_fmac_f32 v98, v202, v238
v_fmac_f32 v99, v203, v238
v_fma_f32 v96, v96, v204, s40
mF 164,60,100
s_add_u32 m0, s21, 16384
rd 56,1,43008
v_fma_f32 v97, v97, v205, s40
v_fma_f32 v98, v98, v206, s40
mF 160,60,96
wl 5
lw 0
v_fma_f32 v99, v99, v207, s40
mF 136,64,104
rd 60,1,44032
v_mul_f32 v220, s41, v96
v_mul_f32 v221, s41, v97
mF 140,64,108
v_mul_f32 v222, s41, v98
v_mul_f32 v223, s41, v99
v_max_f32 v96, s40, v96
mF 148,68,108
rd 64,1,45056
v_exp_f32_e64 v220, v220 clamp
mF 144,68,104
wl 5
lw 1024
v_max_f32 v97, s40, v97
mF 152,72,104
rd 68,1,46080
v_exp_f32_e64 v221, v221 clamp
mF 156,72,108
v_exp_f32_e64 v222, v222 clamp
v_max_f32 v98, s40, v98
mF 164,76,108
rd 72,1,47104
v_exp_f32_e64 v223, v223 clamp
mF 160,76,104
wl 5
v_max_f32 v99, s40, v99
v_add_f32 v96, v96, v220
v_add_f32 v97, v97, v221
mF 136,48,112
rd 76,1,48128
v_add_f32 v98, v98, v222
v_add_f32 v99, v99, v223
mF 140,48,116
s_waitcnt vmcnt(6)
s_barrier
v_cvt_pk_bf16_f32 v120, v96, v97
v_cvt_pk_bf16_f32 v121, v98, v99
mF 148,52,116
rd 48,1,16384
v_fmac_f32 v100, v208, v238
v_fmac_f32 v101, v209, v238
mF 144,52,112
wl 5
lw 2048
v_fmac_f32 v102, v210, v238
mF 152,56,112
rd 52,1,17408
v_fmac_f32 v103, v211, v238
v_fma_f32 v100, v100, v212, s40
mF 156,56,116
v_fma_f32 v101, v101, v213, s40
v_fma_f32 v102, v102, v214, s40
v_fma_f32 v103, v103, v215, s40
mF 164,60,116
rd 56,1,18432
v_mul_f32 v224, s41, v100
v_mul_f32 v225, s41, v101
mF 160,60,112
wl 5
lw 3072
v_mul_f32 v226, s41, v102
mF 136,64,120
rd 60,1,19456
v_mul_f32 v227, s41, v103
v_max_f32 v100, s40, v100
mF 140,64,124
v_exp_f32_e64 v224, v224 clamp
v_max_f32 v101, s40, v101
mF 148,68,124
s_mov_b64 s[12:13], s[68:69]
rd 64,1,20480
v_exp_f32_e64 v225, v225 clamp
mF 144,68,120
wl 5
v_exp_f32_e64 v226, v226 clamp
v_max_f32 v102, s40, v102
mF 152,72,120
s_mov_b32 s14, 8388608
rd 68,1,21504
v_exp_f32_e64 v227, v227 clamp
mF 156,72,124
v_max_f32 v103, s40, v103
v_add_f32 v100, v100, v224
v_add_f32 v101, v101, v225
mF 164,76,124
s_add_u32 s80, s38, 0
rd 72,1,22528
v_add_f32 v102, v102, v226
v_add_f32 v103, v103, v227
mF 160,76,120
wl 5
v_cvt_pk_bf16_f32 v122, v100, v101
v_cvt_pk_bf16_f32 v123, v102, v103
v_fmac_f32 v104, v200, v239
mF 136,48,128
s_add_u32 m0, s21, 114688
rd 76,1,23552
v_fmac_f32 v105, v201, v239
v_fmac_f32 v106, v202, v239
mF 140,48,132
buffer_load_dwordx4 v253, s[12:15], s80 offen nt lds
v_fmac_f32 v107, v203, v239
mF 148,52,132
s_add_u32 s80, s38, 65536
rd 48,1,24576
v_fma_f32 v104, v104, v204, s40
v_fma_f32 v105, v105, v205, s40
mF 144,52,128
wl 5
v_fma_f32 v106, v106, v206, s40
v_fma_f32 v107, v107, v207, s40
v_mul_f32 v228, s41, v104
mF 152,56,128
s_add_u32 m0, s21, 115712
rd 52,1,25600
v_mul_f32 v229, s41, v105
v_mul_f32 v230, s41, v106
mF 156,56,132
buffer_load_dwordx4 v253, s[12:15], s80 offen nt lds
v_mul_f32 v231, s41, v107
mF 164,60,132
rd 56,1,26624
v_exp_f32_e64 v228, v228 clamp
mF 160,60,128
wl 5
v_max_f32 v104, s40, v104
v_exp_f32_e64 v229, v229 clamp
mF 136,64,136
s_add_u32 s80, s38, 16384
rd 60,1,27648
v_max_f32 v105, s40, v105
v_max_f32 v106, s40, v106
mF 140,64,140
v_exp_f32_e64 v230, v230 clamp
v_max_f32 v107, s40, v107
mF 148,68,140
s_add_u32 m0, s21, 116736
rd 64,1,28672
v_exp_f32_e64 v231, v231 clamp
mF 144,68,136
wl 5
buffer_load_dwordx4 v253, s[12:15], s80 offen nt lds
v_add_f32 v104, v104, v228
mF 152,72,136
s_add_u32 s80, s38, 81920
rd 68,1,29696
v_add_f32 v105, v105, v229
v_add_f32 v106, v106, v230
mF 156,72,140
v_add_f32 v107, v107, v231
v_cvt_pk_bf16_f32 v124, v104, v105
v_cvt_pk_bf16_f32 v125, v106, v107
mF 164,76,140
s_add_u32 m0, s21, 117760
rd 72,1,30720
v_fmac_f32 v108, v208, v239
v_fmac_f32 v109, v209, v239
mF 160,76,136
wl 5
buffer_load_dwordx4 v253, s[12:15], s80 offen nt lds
v_fmac_f32 v110, v210, v239
mF 136,48,144
rd 76,1,31744
v_fmac_f32 v111, v211, v239
v_fma_f32 v108, v108, v212, s40
s_barrier
mF 140,48,148
s_waitcnt vmcnt(8)
s_barrier
v_fma_f32 v109, v109, v213, s40
v_fma_f32 v110, v110, v214, s40
s_add_u32 s33, s50, 131072
mF 148,52,148
s_min_i32 s23, s79, 0
rd 48,0,0
v_fma_f32 v111, v111, v215, s40
v_mul_f32 v232, s41, v108
v_mov_b32 v31, 1
mF 144,52,144
wl 5
v_mul_f32 v233, s41, v109
v_mul_f32 v234, s41, v110
v_mul_f32 v235, s41, v111
mF 152,56,144
s_mul_i32 s23, s23, 16384
rd 52,0,1024
v_exp_f32_e64 v232, v232 clamp
mF 156,56,148
v_max_f32 v108, s40, v108
v_exp_f32_e64 v233, v233 clamp
mF 164,60,148
s_add_u32 s23, s23, s25
rd 56,0,2048
v_max_f32 v109, s40, v109
v_max_f32 v110, s40, v110
mF 160,60,144
wl 5
v_exp_f32_e64 v234, v234 clamp
v_max_f32 v111, s40, v111
mF 136,64,152
s_add_u32 s23, s23, 245760
rd 60,0,3072
v_exp_f32_e64 v235, v235 clamp
mF 140,64,156
v_add_f32 v108, v108, v232
main_cp2:
s_mov_b32 s96, main_cp2-main_cp1
v_lshl_add_u64 v[2:3], v[2:3], 0, s[96:97]
global_load_dword v254, v[2:3], off
v_add_f32 v109, v109, v233
v_add_f32 v110, v110, v234
mF 148,68,156
s_add_u32 m0, s21, 32768
rd 64,0,4096
v_add_f32 v111, v111, v235
v_cvt_pk_bf16_f32 v126, v108, v109
mF 144,68,152
wl 5
lw 0
v_cvt_pk_bf16_f32 v127, v110, v111
mF 152,72,152
rd 68,0,5120
ds_write_b128 v8, v[112:115] offset:0
mF 156,72,156
ds_write_b128 v8, v[116:119] offset:1024
ds_write_b128 v8, v[120:123] offset:2048
mF 164,76,156
rd 72,0,6144
ds_write_b128 v8, v[124:127] offset:3072
mF 160,76,152
wl 9
lw 1024
buffer_atomic_add v31, v4, s[4:7], s33 offen sc1
mF 136,48,160
rd 76,0,7168
mF 140,48,164
mF 148,52,164
rd 48,0,8192
mF 144,52,160
wl 9
mF 152,56,160
rd 52,0,9216
mF 156,56,164
lw 2048
mF 164,60,164
rd 56,0,10240
mF 160,60,160
wl 9
mF 136,64,168
rd 60,0,11264
mF 140,64,172
mF 148,68,172
rd 64,0,12288
mF 144,68,168
wl 6
lw 3072
mF 152,72,168
rd 68,0,13312
mF 156,72,172
wl 5
mF 164,76,172
s_max_i32 s23, s76, 0
rd 72,0,14336
mF 160,76,168
mF 136,48,176
s_mul_i32 s23, s23, 16384
rd 76,0,15360
mF 140,48,180
s_waitcnt lgkmcnt(5) vmcnt(10)
s_barrier
mF 148,52,180
s_add_u32 s23, s23, s25
rd 48,0,16384
rd 112,9,0
rd 116,9,1024
mF 144,52,176
rd 120,9,4096
rd 124,9,5120
rd 128,9,8192
mF 152,56,176
s_add_u32 s23, s23, 262144
rd 52,0,17408
rd 132,9,9216
rd 168,9,12288
mF 156,56,180
wl 12
rd 172,9,13312
mF 164,60,180
s_add_u32 m0, s21, 49152
rd 56,0,18432
mF 160,60,176
lw 0
mF 136,64,184
rd 60,0,19456
mF 140,64,188
wl 13
mF 148,68,188
rd 64,0,20480
mF 144,68,184
wl 10
lw 1024
v_mfma_f32_16x16x32_bf16 v[228:231], v[112:115], v[24:27], 0
v_mfma_f32_16x16x32_bf16 v[232:235], v[116:119], v[24:27], 0
wl 8
v_mfma_f32_16x16x32_bf16 v[228:231], v[120:123], v[24:27], v[228:231]
v_mfma_f32_16x16x32_bf16 v[232:235], v[124:127], v[24:27], v[232:235]
wl 6
v_mfma_f32_16x16x32_bf16 v[228:231], v[128:131], v[24:27], v[228:231]
wl 4
v_mfma_f32_16x16x32_bf16 v[232:235], v[132:135], v[24:27], v[232:235]
v_mfma_f32_16x16x32_bf16 v[228:231], v[168:171], v[24:27], v[228:231]
wl 3
v_mfma_f32_16x16x32_bf16 v[232:235], v[172:175], v[24:27], v[232:235]
s_lshl_b32 s37, s16, 7
s_add_u32 s37, s37, s56
mF 152,72,184
rd 68,0,21504
lw 2048
mF 156,72,188
mF 164,76,188
rd 72,0,22528
buffer_store_dwordx4 v[228:231], v22, s[4:7], s37 offen offset:0 sc1
mF 160,76,184
buffer_store_dwordx4 v[232:235], v22, s[4:7], s37 offen offset:16 sc1
s_lshl_b32 s37, s16, 10
mF 136,48,192
s_add_u32 s37, s37, s55
rd 76,0,23552
mF 140,48,196
lw 3072
mF 148,52,196
rd 48,0,24576
mF 144,52,192
wl 5
mF 152,56,192
s_mul_i32 s23, s77, 16384
rd 52,0,25600
mF 156,56,196
mF 164,60,196
s_add_u32 s23, s23, s25
rd 56,0,26624
mF 160,60,192
wl 5
mF 136,64,200
s_add_u32 s23, s23, 278528
rd 60,0,27648
mF 140,64,204
mF 148,68,204
s_add_u32 m0, s21, 65536
rd 64,0,28672
mF 144,68,200
wl 5
lw 0
mF 152,72,200
rd 68,0,29696
mF 156,72,204
mF 164,76,204
rd 72,0,30720
mF 160,76,200
wl 5
mF 136,48,208
rd 76,0,31744
mF 140,48,212
s_waitcnt vmcnt(7)
s_barrier
v_mov_b32 v31, 0
buffer_atomic_add v31, v4, s[4:7], s33 offen sc0 sc1
mF 148,52,212
rd 48,0,32768
mF 144,52,208
wl 5
lw 1024
mF 152,56,208
rd 52,0,33792
mF 156,56,212
mF 164,60,212
rd 56,0,34816
mF 160,60,208
wl 5
mF 136,64,216
rd 60,0,35840
mF 140,64,220
lw 2048
mF 148,68,220
rd 64,0,36864
mF 144,68,216
wl 5
mF 152,72,216
rd 68,0,37888
mF 156,72,220
mF 164,76,220
rd 72,0,38912
mF 160,76,216
wl 5
lw 3072
mF 136,48,224
rd 76,0,39936
mF 140,48,228
mF 148,52,228
s_add_u32 s80, s38, 128
rd 48,0,40960
mF 144,52,224
wl 5
mF 152,56,224
s_add_u32 m0, s21, 98304
rd 52,0,41984
mF 156,56,228
buffer_load_dwordx4 v253, s[12:15], s80 offen nt lds
mF 164,60,228
rd 56,0,43008
mF 160,60,224
wl 5
mF 136,64,232
s_add_u32 s80, s38, 65664
rd 60,0,44032
mF 140,64,236
mF 148,68,236
s_add_u32 m0, s21, 99328
rd 64,0,45056
mF 144,68,232
wl 5
buffer_load_dwordx4 v253, s[12:15], s80 offen nt lds
mF 152,72,232
rd 68,0,46080
mF 156,72,236
mF 164,76,236
s_add_u32 s80, s38, 16512
rd 72,0,47104
mF 160,76,232
wl 5
mF 136,48,240
s_add_u32 m0, s21, 100352
rd 76,0,48128
mF 140,48,244
s_waitcnt vmcnt(7)
s_barrier
mF 148,52,244
rd 48,0,49152
mF 144,52,240
wl 5
buffer_load_dwordx4 v253, s[12:15], s80 offen nt lds
mF 152,56,240
rd 52,0,50176
mF 156,56,244
mF 164,60,244
s_add_u32 s80, s38, 82048
rd 56,0,51200
mF 160,60,240
wl 5
mF 136,64,248
s_add_u32 m0, s21, 101376
rd 60,0,52224
mF 140,64,252
s_waitcnt vmcnt(6)
buffer_load_dwordx4 v253, s[12:15], s80 offen nt lds
v_readfirstlane_b32 s46, v31
s_nop 0
s_add_u32 s46, s46, s21
s_cmp_ge_u32 s46, 16
s_cbranch_scc1 main_ok34
s_mov_b32 s47, 0
main_poll33:
v_mov_b32 v31, 0
buffer_atomic_add v31, v4, s[4:7], s33 offen sc0 sc1
s_add_u32 s47, s47, 1
s_cmp_gt_u32 s47, 400000
s_cbranch_scc1 main_ok34
s_waitcnt vmcnt(0)
v_readfirstlane_b32 s46, v31
s_nop 0
s_cmp_lt_u32 s46, 16
s_cbranch_scc1 main_poll33
main_ok34:
s_barrier
mF 148,68,252
s_mul_i32 s23, s78, 16384
rd 64,0,53248
mF 144,68,248
wl 5
mF 152,72,248
s_add_u32 s23, s23, s25
rd 68,0,54272
mF 156,72,252
mF 164,76,252
s_add_u32 s23, s23, 294912
rd 72,0,55296
mF 160,76,248
wl 5
v_mfma_f32_16x16x32_bf16 v[80:83], v[48:51], a[0:3], 0
s_add_u32 m0, s21, 81920
rd 76,0,56320
v_mfma_f32_16x16x32_bf16 v[84:87], v[48:51], a[4:7], 0
lw 0
v_pk_fma_f32 v[136:137], v[200:201], v[240:241], v[136:137] op_sel_hi:[1,0,1]
v_pk_fma_f32 v[138:139], v[202:203], v[240:241], v[138:139] op_sel_hi:[1,0,1]
v_pk_fma_f32 v[140:141], v[208:209], v[240:241], v[140:141] op_sel_hi:[1,0,1]
v_pk_fma_f32 v[142:143], v[210:211], v[240:241], v[142:143] op_sel_hi:[1,0,1]
v_pk_mul_f32 v[136:137], v[136:137], v[204:205]
v_pk_mul_f32 v[138:139], v[138:139], v[206:207]
v_pk_mul_f32 v[140:141], v[140:141], v[212:213]
v_pk_mul_f32 v[142:143], v[142:143], v[214:215]
v_cvt_pk_bf16_f32 v176, v136, v137
v_cvt_pk_bf16_f32 v177, v138, v139
v_cvt_pk_bf16_f32 v178, v140, v141
v_cvt_pk_bf16_f32 v179, v142, v143
ds_write_b128 v8, v[176:179] offset:0
v_pk_fma_f32 v[144:145], v[200:201], v[240:241], v[144:145] op_sel:[0,1,0]
v_pk_fma_f32 v[146:147], v[202:203], v[240:241], v[146:147] op_sel:[0,1,0]
v_pk_fma_f32 v[148:149], v[208:209], v[240:241], v[148:149] op_sel:[0,1,0]
v_pk_fma_f32 v[150:151], v[210:211], v[240:241], v[150:151] op_sel:[0,1,0]
v_pk_mul_f32 v[144:145], v[144:145], v[204:205]
v_pk_mul_f32 v[146:147], v[146:147], v[206:207]
v_pk_mul_f32 v[148:149], v[148:149], v[212:213]
v_pk_mul_f32 v[150:151], v[150:151], v[214:215]
v_cvt_pk_bf16_f32 v180, v144, v145
v_cvt_pk_bf16_f32 v181, v146, v147
v_cvt_pk_bf16_f32 v182, v148, v149
v_cvt_pk_bf16_f32 v183, v150, v151
ds_write_b128 v8, v[180:183] offset:1024
v_pk_fma_f32 v[152:153], v[200:201], v[242:243], v[152:153] op_sel_hi:[1,0,1]
v_pk_fma_f32 v[154:155], v[202:203], v[242:243], v[154:155] op_sel_hi:[1,0,1]
v_pk_fma_f32 v[156:157], v[208:209], v[242:243], v[156:157] op_sel_hi:[1,0,1]
v_pk_fma_f32 v[158:159], v[210:211], v[242:243], v[158:159] op_sel_hi:[1,0,1]
v_pk_mul_f32 v[152:153], v[152:153], v[204:205]
v_pk_mul_f32 v[154:155], v[154:155], v[206:207]
v_pk_mul_f32 v[156:157], v[156:157], v[212:213]
v_pk_mul_f32 v[158:159], v[158:159], v[214:215]
v_cvt_pk_bf16_f32 v184, v152, v153
v_cvt_pk_bf16_f32 v185, v154, v155
v_cvt_pk_bf16_f32 v186, v156, v157
v_cvt_pk_bf16_f32 v187, v158, v159
ds_write_b128 v8, v[184:187] offset:2048
v_pk_fma_f32 v[160:161], v[200:201], v[242:243], v[160:161] op_sel:[0,1,0]
v_pk_fma_f32 v[162:163], v[202:203], v[242:243], v[162:163] op_sel:[0,1,0]
v_pk_fma_f32 v[164:165], v[208:209], v[242:243], v[164:165] op_sel:[0,1,0]
v_pk_fma_f32 v[166:167], v[210:211], v[242:243], v[166:167] op_sel:[0,1,0]
v_pk_mul_f32 v[160:161], v[160:161], v[204:205]
v_pk_mul_f32 v[162:163], v[162:163], v[206:207]
v_pk_mul_f32 v[164:165], v[164:165], v[212:213]
v_pk_mul_f32 v[166:167], v[166:167], v[214:215]
v_cvt_pk_bf16_f32 v188, v160, v161
v_cvt_pk_bf16_f32 v189, v162, v163
v_cvt_pk_bf16_f32 v190, v164, v165
v_cvt_pk_bf16_f32 v191, v166, v167
ds_write_b128 v8, v[188:191] offset:3072
v_mfma_f32_16x16x32_bf16 v[92:95], v[52:55], a[4:7], 0
rd 48,0,57344
lw 1024
lw 2048
lw 3072
v_mfma_f32_16x16x32_bf16 v[88:91], v[52:55], a[0:3], 0
wl 9
v_mfma_f32_16x16x32_bf16 v[96:99], v[56:59], a[0:3], 0
wl 1
s_mul_i32 s23, s79, 16384
rd 52,0,58368
s_barrier
rd 176,10,0
v_mfma_f32_16x16x32_bf16 v[100:103], v[56:59], a[4:7], 0
rd 180,10,4096
rd 184,10,8192
rd 188,10,12288
v_mfma_f32_16x16x32_bf16 v[108:111], v[60:63], a[4:7], 0
s_add_u32 s23, s23, s25
rd 56,0,59392
v_mfma_f32_16x16x32_bf16 v[104:107], v[60:63], a[0:3], 0
mT 80,64,8
s_add_u32 s23, s23, 311296
rd 60,0,60416
mT 84,64,12
mT 92,68,12
wl 4
s_add_u32 m0, s21, 0
rd 64,0,61440
v_mfma_f32_16x16x32_bf16 v[220:223], v[112:115], v[176:179], 0
v_mfma_f32_16x16x32_bf16 v[224:227], v[116:119], v[176:179], 0
v_mfma_f32_16x16x32_bf16 v[220:223], v[120:123], v[180:183], v[220:223]
v_mfma_f32_16x16x32_bf16 v[224:227], v[124:127], v[180:183], v[224:227]
wl 4
v_mfma_f32_16x16x32_bf16 v[220:223], v[128:131], v[184:187], v[220:223]
v_mfma_f32_16x16x32_bf16 v[224:227], v[132:135], v[184:187], v[224:227]
wl 3
v_mfma_f32_16x16x32_bf16 v[220:223], v[168:171], v[188:191], v[220:223]
v_mfma_f32_16x16x32_bf16 v[224:227], v[172:175], v[188:191], v[224:227]
mT 88,68,8
lw 0
mT 96,72,8
rd 68,0,62464
lw 1024
mT 100,72,12
s_nop 0
v_cvt_pk_bf16_f32 v236, v220, v221
v_cvt_pk_bf16_f32 v237, v222, v223
v_cvt_pk_bf16_f32 v238, v224, v225
mT 108,76,12
rd 72,0,63488
v_cvt_pk_bf16_f32 v239, v226, v227
s_lshl_b32 s34, s31, 12
mT 104,76,8
lw 2048
s_add_u32 s34, s34, 28573696
mT 80,48,16
rd 76,0,64512
buffer_store_dwordx4 v[236:239], v0, s[4:7], s37 offen sc1
mT 84,48,20
s_waitcnt vmcnt(12)
s_barrier
buffer_load_dwordx4 v[176:179], v0, s[4:7], s34 offen offset:0 sc1
mT 92,52,20
rd 48,1,0
buffer_load_dwordx4 v[180:183], v0, s[4:7], s34 offen offset:1024 sc1
mT 88,52,16
wl 5
lw 3072
mT 96,56,16
s_mul_i32 s23, s76, 16384
rd 52,1,1024
buffer_load_dwordx4 v[184:187], v0, s[4:7], s34 offen offset:2048 sc1
mT 100,56,20
buffer_load_dwordx4 v[188:191], v0, s[4:7], s34 offen offset:3072 sc1
mT 108,60,20
s_add_u32 s23, s23, s25
rd 56,1,2048
mT 104,60,16
wl 5
mT 80,64,24
s_add_u32 s23, s23, 327680
rd 60,1,3072
mT 84,64,28
mT 92,68,28
s_add_u32 m0, s21, 16384
rd 64,1,4096
mT 88,68,24
wl 5
lw 0
mT 96,72,24
rd 68,1,5120
mT 100,72,28
mT 108,76,28
rd 72,1,6144
mT 104,76,24
wl 5
lw 1024
mT 80,48,32
rd 76,1,7168
mT 84,48,36
mT 92,52,36
rd 48,1,8192
mT 88,52,32
wl 5
lw 2048
mT 96,56,32
rd 52,1,9216
mT 100,56,36
mT 108,60,36
rd 56,1,10240
mT 104,60,32
wl 5
lw 3072
mT 80,64,40
s_mov_b64 s[12:13], s[70:71]
rd 60,1,11264
mT 84,64,44
mT 92,68,44
s_mov_b32 s14, 3670016
rd 64,1,12288
mT 88,68,40
wl 5
mT 96,72,40
s_add_u32 s80, s39, 0
rd 68,1,13312
mT 100,72,44
mT 108,76,44
s_add_u32 m0, s21, 32768
rd 72,1,14336
mT 104,76,40
wl 5
buffer_load_dwordx4 v5, s[12:15], s80 offen nt lds
mT 80,48,48
s_add_u32 s80, s39, 16384
rd 76,1,15360
mT 84,48,52
s_waitcnt vmcnt(14)
s_barrier
mT 92,52,52
s_add_u32 m0, s21, 33792
rd 48,1,16384
mT 88,52,48
wl 5
buffer_load_dwordx4 v5, s[12:15], s80 offen nt lds
mT 96,56,48
s_add_u32 s80, s39, 32768
rd 52,1,17408
mT 100,56,52
mT 108,60,52
s_add_u32 m0, s21, 34816
rd 56,1,18432
mT 104,60,48
wl 5
buffer_load_dwordx4 v5, s[12:15], s80 offen nt lds
mT 80,64,56
s_add_u32 s80, s39, 49152
rd 60,1,19456
mT 84,64,60
mT 92,68,60
s_add_u32 m0, s21, 35840
rd 64,1,20480
mT 88,68,56
wl 5
buffer_load_dwordx4 v5, s[12:15], s80 offen nt lds
mT 96,72,56
s_mul_i32 s23, s77, 16384
rd 68,1,21504
mT 100,72,60
s_waitcnt vmcnt(11)
s_add_u32 s36, s49, 16384
v_mov_b32 v31, 1
v_add_f32 v176, v176, v180
mT 108,76,60
s_add_u32 s23, s23, s25
rd 72,1,22528
buffer_atomic_add v31, v4, s[4:7], s36 offen sc1
mT 104,76,56
wl 5
v_add_f32 v177, v177, v181
v_add_f32 v178, v178, v182
v_add_f32 v179, v179, v183
mT 80,48,64
s_waitcnt vmcnt(9)
s_add_u32 s23, s23, 344064
rd 76,1,23552
v_add_f32 v184, v184, v188
v_add_f32 v185, v185, v189
mT 84,48,68
v_add_f32 v186, v186, v190
v_add_f32 v187, v187, v191
v_add_f32 v176, v176, v184
mT 92,52,68
s_add_u32 m0, s21, 49152
rd 48,1,24576
v_add_f32 v177, v177, v185
v_add_f32 v178, v178, v186
mT 88,52,64
wl 5
lw 0
v_add_f32 v179, v179, v187
mT 96,56,64
rd 52,1,25600
ds_write_b128 v10, v[176:179] offset:16384
mT 100,56,68
lw 1024
mT 108,60,68
rd 56,1,26624
mT 104,60,64
wl 6
mT 80,64,72
rd 60,1,27648
mT 84,64,76
mT 92,68,76
rd 64,1,28672
mT 88,68,72
wl 6
lw 2048
mT 96,72,72
rd 68,1,29696
mT 100,72,76
mT 108,76,76
rd 72,1,30720
v_and_b32 v251, 0xf0, v0
v_lshlrev_b32 v251, 3, v251
mT 104,76,72
wl 6
lw 3072
v_lshrrev_b32 v250, 8, v0
mT 80,48,80
rd 76,1,31744
v_lshl_add_u32 v251, v250, 4, v251
s_add_u32 s32, s21, 114688
mT 84,48,84
wl 6
s_barrier
v_add_u32 v251, s32, v251
ds_read_b128 a[0:3], v251 offset:0
mT 92,52,84
s_mul_i32 s23, s78, 16384
rd 48,0,0
rd 176,29,16384
rd 180,29,17408
mT 88,52,80
wl 8
rd 184,29,18432
rd 188,29,19456
ds_read_b128 a[4:7], v251 offset:2048
mT 96,56,80
s_add_u32 s23, s23, s25
rd 52,0,1024
ds_read_b128 a[8:11], v251 offset:64
ds_read_b128 a[12:15], v251 offset:2112
mT 100,56,84
mT 108,60,84
s_add_u32 s23, s23, 360448
rd 56,0,2048
mT 104,60,80
wl 13
mT 80,64,88
s_add_u32 m0, s21, 65536
rd 60,0,3072
mT 84,64,92
wl 8
lw 0
v_add_f32 v176, v176, v180
mT 92,68,92
rd 64,0,4096
v_add_f32 v177, v177, v181
v_add_f32 v178, v178, v182
wl 0
mT 88,68,88
lw 1024
v_add_f32 v179, v179, v183
mT 96,72,88
rd 68,0,5120
v_mov_b32 v31, 0
v_add_f32 v184, v184, v188
mT 100,72,92
buffer_atomic_add v31, v4, s[4:7], s36 offen sc0 sc1
v_add_f32 v185, v185, v189
mT 108,76,92
rd 72,0,6144
v_add_f32 v186, v186, v190
v_add_f32 v187, v187, v191
mT 104,76,88
lw 2048
v_add_f32 v176, v176, v184
mT 80,48,96
rd 76,0,7168
v_add_f32 v177, v177, v185
v_add_f32 v178, v178, v186
mT 84,48,100
v_add_f32 v179, v179, v187
ds_write_b128 v29, v[176:179] offset:29440
mT 92,52,100
rd 48,0,8192
mT 88,52,96
lw 3072
mT 96,56,96
rd 52,0,9216
mT 100,56,100
main_cp3:
s_mov_b32 s96, main_cp3-main_cp2
v_lshl_add_u64 v[2:3], v[2:3], 0, s[96:97]
global_load_dword v254, v[2:3], off
mT 108,60,100
rd 56,0,10240
mT 104,60,96
mT 80,64,104
rd 60,0,11264
mT 84,64,108
wl 6
mT 92,68,108
rd 64,0,12288
mT 88,68,104
mT 96,72,104
rd 68,0,13312
mT 100,72,108
wl 6
mT 108,76,108
rd 72,0,14336
mT 104,76,104
wl 5
mT 80,48,112
rd 76,0,15360
mT 84,48,116
s_waitcnt vmcnt(15)
s_barrier
mT 92,52,116
s_min_i32 s23, s79, 0
rd 48,0,16384
mT 88,52,112
wl 5
mT 96,56,112
s_mul_i32 s23, s23, 16384
rd 52,0,17408
mT 100,56,116
mT 108,60,116
s_add_u32 s23, s23, s25
rd 56,0,18432
mT 104,60,112
wl 5
mT 80,64,120
s_add_u32 s23, s23, 376832
rd 60,0,19456
mT 84,64,124
mT 92,68,124
s_add_u32 m0, s21, 81920
rd 64,0,20480
mT 88,68,120
wl 5
lw 0
mT 96,72,120
rd 68,0,21504
mT 100,72,124
s_waitcnt vmcnt(4)
lw 1024
v_readfirstlane_b32 s46, v31
s_nop 0
s_nop 0
s_cmp_ge_u32 s46, 16
s_cbranch_scc1 main_ok32
s_mov_b32 s47, 0
main_poll31:
v_mov_b32 v31, 0
buffer_atomic_add v31, v4, s[4:7], s36 offen sc0 sc1
s_add_u32 s47, s47, 1
s_cmp_gt_u32 s47, 400000
s_cbranch_scc1 main_ok32
s_waitcnt vmcnt(0)
v_readfirstlane_b32 s46, v31
s_nop 0
s_cmp_lt_u32 s46, 16
s_cbranch_scc1 main_poll31
main_ok32:
mT 108,76,124
rd 72,0,22528
mT 104,76,120
wl 5
buffer_load_dwordx4 v[244:247], v23, s[4:7], s56 offen offset:0 sc1
mT 80,48,128
rd 76,0,23552
mT 84,48,132
lw 2048
mT 92,52,132
rd 48,0,24576
mT 88,52,128
wl 5
lw 3072
mT 96,56,128
rd 52,0,25600
mT 100,56,132
buffer_load_dwordx4 v[248:251], v23, s[4:7], s56 offen offset:16 sc1
mT 108,60,132
rd 56,0,26624
mT 104,60,128
wl 5
mT 80,64,136
s_mov_b32 s37, s55
rd 60,0,27648
mT 84,64,140
buffer_load_dwordx4 v[112:115], v0, s[4:7], s37 offen offset:0 sc1
mT 92,68,140
rd 64,0,28672
mT 88,68,136
wl 5
mT 96,72,136
rd 68,0,29696
mT 100,72,140
buffer_load_dwordx4 v[116:119], v0, s[4:7], s37 offen offset:1024 sc1
mT 108,76,140
rd 72,0,30720
mT 104,76,136
wl 5
mT 80,48,144
rd 76,0,31744
mT 84,48,148
s_barrier
mT 92,52,148
rd 48,0,49152
mT 88,52,144
wl 5
buffer_load_dwordx4 v[120:123], v0, s[4:7], s37 offen offset:2048 sc1
mT 96,56,144
rd 52,0,50176
mT 100,56,148
mT 108,60,148
rd 56,0,51200
mT 104,60,144
wl 5
buffer_load_dwordx4 v[124:127], v0, s[4:7], s37 offen offset:3072 sc1
mT 80,64,152
rd 60,0,52224
mT 84,64,156
mT 92,68,156
rd 64,0,53248
mT 88,68,152
wl 5
mT 96,72,152
s_add_u32 s37, s37, 4096
rd 68,0,54272
mT 100,72,156
buffer_load_dwordx4 v[128:131], v0, s[4:7], s37 offen offset:0 sc1
mT 108,76,156
rd 72,0,55296
mT 104,76,152
wl 5
mT 80,48,160
rd 76,0,56320
mT 84,48,164
buffer_load_dwordx4 v[132:135], v0, s[4:7], s37 offen offset:1024 sc1
mT 92,52,164
rd 48,0,57344
mT 88,52,160
wl 5
mT 96,56,160
rd 52,0,58368
mT 100,56,164
buffer_load_dwordx4 v[136:139], v0, s[4:7], s37 offen offset:2048 sc1
mT 108,60,164
rd 56,0,59392
mT 104,60,160
wl 5
mT 80,64,168
rd 60,0,60416
mT 84,64,172
buffer_load_dwordx4 v[140:143], v0, s[4:7], s37 offen offset:3072 sc1
mT 92,68,172
rd 64,0,61440
mT 88,68,168
wl 5
mT 96,72,168
rd 68,0,62464
mT 100,72,172
mT 108,76,172
s_add_u32 s37, s37, 4096
rd 72,0,63488
mT 104,76,168
wl 5
buffer_load_dwordx4 v[144:147], v0, s[4:7], s37 offen offset:0 sc1
mT 80,48,176
rd 76,0,64512
mT 84,48,180
s_waitcnt vmcnt(10)
s_barrier
mT 92,52,180
rd 48,1,0
mT 88,52,176
wl 5
buffer_load_dwordx4 v[148:151], v0, s[4:7], s37 offen offset:1024 sc1
mT 96,56,176
rd 52,1,1024
mT 100,56,180
mT 108,60,180
rd 56,1,4096
mT 104,60,176
wl 5
buffer_load_dwordx4 v[152:155], v0, s[4:7], s37 offen offset:2048 sc1
mT 80,64,184
rd 60,1,5120
mT 84,64,188
mT 92,68,188
rd 64,1,8192
mT 88,68,184
wl 5
buffer_load_dwordx4 v[156:159], v0, s[4:7], s37 offen offset:3072 sc1
mT 96,72,184
rd 68,1,9216
mT 100,72,188
mT 108,76,188
rd 72,1,12288
mT 104,76,184
wl 5
mT 80,48,192
s_add_u32 s37, s37, 4096
rd 76,1,13312
mT 84,48,196
buffer_load_dwordx4 v[160:163], v0, s[4:7], s37 offen offset:0 sc1
mT 92,52,196
rd 48,1,16384
mT 88,52,192
wl 5
mT 80,56,200
rd 52,1,17408
mT 84,56,204
buffer_load_dwordx4 v[164:167], v0, s[4:7], s37 offen offset:1024 sc1
mT 92,60,204
rd 56,1,20480
mT 88,60,200
wl 5
mT 80,64,208
rd 60,1,21504
mT 84,64,212
buffer_load_dwordx4 v[168:171], v0, s[4:7], s37 offen offset:2048 sc1
mT 92,68,212
rd 64,1,24576
mT 88,68,208
wl 5
mT 80,72,216
rd 68,1,25600
mT 84,72,220
buffer_load_dwordx4 v[172:175], v0, s[4:7], s37 offen offset:3072 sc1
mT 92,76,220
rd 72,1,28672
mT 88,76,216
wl 5
mT 80,48,224
rd 76,1,29696
mT 84,48,228
mT 92,52,228
s_add_u32 s37, s37, 4096
rd 48,1,2048
mT 88,52,224
wl 5
rd 176,12,512
mT 80,56,232
rd 52,1,3072
mT 84,56,236
rd 180,12,576
mT 92,60,236
rd 56,1,6144
mT 88,60,232
wl 7
rd 184,12,640
mT 80,64,240
s_max_i32 s23, s76, 0
rd 60,1,7168
mT 84,64,244
rd 188,12,704
mT 92,68,244
s_mul_i32 s23, s23, 16384
rd 64,1,10240
mT 88,68,240
wl 9
mT 80,72,248
s_add_u32 s23, s23, s26
rd 68,1,11264
mT 84,72,252
mT 92,76,252
s_add_u32 s23, s23, 0
rd 72,1,14336
mT 88,76,248
wl 9
mT 96,48,192
s_add_u32 m0, s21, 0
rd 76,1,15360
mT 100,48,196
wl 8
lw 0
mT 108,52,196
rd 48,1,18432
mT 104,52,192
wl 7
mT 96,56,200
rd 52,1,19456
v_fmac_f32 v80, v216, v176
v_fmac_f32 v81, v216, v177
mT 100,56,204
wl 6
lw 1024
v_fmac_f32 v82, v216, v178
mT 108,60,204
rd 56,1,22528
v_fmac_f32 v83, v216, v179
v_fma_f32 v80, v80, v217, s40
mT 104,60,200
wl 5
v_fma_f32 v81, v81, v217, s40
v_fma_f32 v82, v82, v217, s40
v_fma_f32 v83, v83, v217, s40
mT 96,64,208
rd 60,1,23552
v_mul_f32 v236, s41, v80
v_mul_f32 v237, s41, v81
mT 100,64,212
lw 2048
v_mul_f32 v238, s41, v82
mT 108,68,212
rd 64,1,26624
v_mul_f32 v239, s41, v83
v_max_f32 v80, s40, v80
mT 104,68,208
wl 5
lw 3072
v_max_f32 v81, s40, v81
mT 96,72,216
s_mul_i32 s23, s77, 16384
rd 68,1,27648
v_exp_f32_e64 v236, v236 clamp
mT 100,72,220
v_exp_f32_e64 v237, v237 clamp
v_max_f32 v82, s40, v82
mT 108,76,220
s_add_u32 s23, s23, s26
rd 72,1,30720
v_exp_f32_e64 v238, v238 clamp
mT 104,76,216
wl 5
v_exp_f32_e64 v239, v239 clamp
v_max_f32 v83, s40, v83
mT 96,48,224
s_add_u32 s23, s23, 16384
rd 76,1,31744
v_add_f32 v80, v80, v236
v_add_f32 v81, v81, v237
mT 100,48,228
v_add_f32 v82, v82, v238
v_add_f32 v83, v83, v239
v_cvt_pk_bf16_f32 v220, v80, v81
mT 108,52,228
s_add_u32 m0, s21, 114688
v_cvt_pk_bf16_f32 v221, v82, v83
v_fmac_f32 v84, v218, v176
v_fmac_f32 v85, v218, v177
mT 104,52,224
wl 4
lw 0
v_fmac_f32 v86, v218, v178
mT 96,56,232
v_fmac_f32 v87, v218, v179
v_fma_f32 v84, v84, v219, s40
v_fma_f32 v85, v85, v219, s40
mT 100,56,236
lw 1024
v_fma_f32 v86, v86, v219, s40
mT 108,60,236
v_add_f32_dpp v244, v244, v244 row_ror:8 row_mask:0xf bank_mask:0xf
v_add_f32_dpp v245, v245, v245 row_ror:8 row_mask:0xf bank_mask:0xf
v_fma_f32 v87, v87, v219, s40
mT 104,60,232
wl 3
v_add_f32_dpp v246, v246, v246 row_ror:8 row_mask:0xf bank_mask:0xf
v_add_f32_dpp v247, v247, v247 row_ror:8 row_mask:0xf bank_mask:0xf
v_mul_f32 v240, s41, v84
mT 96,64,240
s_waitcnt vmcnt(22)
v_add_f32_dpp v248, v248, v248 row_ror:8 row_mask:0xf bank_mask:0xf
v_add_f32_dpp v249, v249, v249 row_ror:8 row_mask:0xf bank_mask:0xf
v_mul_f32 v241, s41, v85
mT 100,64,244
wl 2
lw 2048
v_mul_f32 v242, s41, v86
mT 108,68,244
v_add_f32_dpp v250, v250, v250 row_ror:8 row_mask:0xf bank_mask:0xf
v_add_f32_dpp v251, v251, v251 row_ror:8 row_mask:0xf bank_mask:0xf
v_mul_f32 v243, s41, v87
mT 104,68,240
wl 1
v_add_f32_dpp v244, v244, v244 row_ror:4 row_mask:0xf bank_mask:0xf
v_add_f32_dpp v245, v245, v245 row_ror:4 row_mask:0xf bank_mask:0xf
v_max_f32 v84, s40, v84
mT 96,72,248
lw 3072
v_max_f32 v85, s40, v85
mT 100,72,252
wl 0
v_add_f32_dpp v246, v246, v246 row_ror:4 row_mask:0xf bank_mask:0xf
v_add_f32_dpp v247, v247, v247 row_ror:4 row_mask:0xf bank_mask:0xf
v_max_f32 v86, s40, v86
mT 108,76,252
s_mul_i32 s23, s78, 16384
v_add_f32_dpp v248, v248, v248 row_ror:4 row_mask:0xf bank_mask:0xf
v_add_f32_dpp v249, v249, v249 row_ror:4 row_mask:0xf bank_mask:0xf
v_max_f32 v87, s40, v87
mT 104,76,248
s_waitcnt vmcnt(23)
v_add_f32_dpp v250, v250, v250 row_ror:4 row_mask:0xf bank_mask:0xf
v_add_f32_dpp v251, v251, v251 row_ror:4 row_mask:0xf bank_mask:0xf
v_fmac_f32 v88, v216, v180
v_mfma_f32_16x16x32_bf16 v[208:211], v[18:21], v[112:115], 0
s_add_u32 s23, s23, s26
v_add_f32_dpp v244, v244, v244 row_ror:2 row_mask:0xf bank_mask:0xf
v_add_f32_dpp v245, v245, v245 row_ror:2 row_mask:0xf bank_mask:0xf
v_fmac_f32 v89, v216, v181
v_mfma_f32_16x16x32_bf16 v[212:215], v[16:19], v[112:115], 0
s_waitcnt vmcnt(22)
s_add_u32 s23, s23, 32768
v_add_f32_dpp v246, v246, v246 row_ror:2 row_mask:0xf bank_mask:0xf
v_add_f32_dpp v247, v247, v247 row_ror:2 row_mask:0xf bank_mask:0xf
v_fmac_f32 v90, v216, v182
v_mfma_f32_16x16x32_bf16 v[208:211], v[18:21], v[116:119], v[208:211]
s_add_u32 m0, s21, 16384
v_add_f32_dpp v248, v248, v248 row_ror:2 row_mask:0xf bank_mask:0xf
v_add_f32_dpp v249, v249, v249 row_ror:2 row_mask:0xf bank_mask:0xf
v_fmac_f32 v91, v216, v183
v_mfma_f32_16x16x32_bf16 v[212:215], v[16:19], v[116:119], v[212:215]
s_waitcnt vmcnt(21)
lw 0
v_fma_f32 v88, v88, v217, s40
v_mfma_f32_16x16x32_bf16 v[208:211], v[18:21], v[120:123], v[208:211]
v_add_f32_dpp v250, v250, v250 row_ror:2 row_mask:0xf bank_mask:0xf
v_add_f32_dpp v251, v251, v251 row_ror:2 row_mask:0xf bank_mask:0xf
v_fma_f32 v89, v89, v217, s40
v_mfma_f32_16x16x32_bf16 v[212:215], v[16:19], v[120:123], v[212:215]
s_waitcnt vmcnt(21)
lw 1024
v_fma_f32 v90, v90, v217, s40
v_mfma_f32_16x16x32_bf16 v[208:211], v[18:21], v[124:127], v[208:211]
v_add_f32_dpp v244, v244, v244 row_ror:1 row_mask:0xf bank_mask:0xf
v_add_f32_dpp v245, v245, v245 row_ror:1 row_mask:0xf bank_mask:0xf
v_fma_f32 v91, v91, v217, s40
v_mfma_f32_16x16x32_bf16 v[212:215], v[16:19], v[124:127], v[212:215]
s_waitcnt vmcnt(21)
v_add_f32_dpp v246, v246, v246 row_ror:1 row_mask:0xf bank_mask:0xf
v_add_f32_dpp v247, v247, v247 row_ror:1 row_mask:0xf bank_mask:0xf
v_mul_f32 v236, s41, v88
v_mfma_f32_16x16x32_bf16 v[208:211], v[18:21], v[128:131], v[208:211]
v_add_f32_dpp v248, v248, v248 row_ror:1 row_mask:0xf bank_mask:0xf
v_add_f32_dpp v249, v249, v249 row_ror:1 row_mask:0xf bank_mask:0xf
v_mul_f32 v237, s41, v89
v_mfma_f32_16x16x32_bf16 v[212:215], v[16:19], v[128:131], v[212:215]
s_waitcnt vmcnt(20)
lw 2048
v_mul_f32 v238, s41, v90
v_mfma_f32_16x16x32_bf16 v[208:211], v[18:21], v[132:135], v[208:211]
v_add_f32_dpp v250, v250, v250 row_ror:1 row_mask:0xf bank_mask:0xf
v_add_f32_dpp v251, v251, v251 row_ror:1 row_mask:0xf bank_mask:0xf
v_mul_f32 v239, s41, v91
v_mfma_f32_16x16x32_bf16 v[212:215], v[16:19], v[132:135], v[212:215]
s_waitcnt vmcnt(20)
v_cvt_pk_bf16_f32 v204, v244, v245
v_cvt_pk_bf16_f32 v205, v246, v247
v_max_f32 v88, s40, v88
v_mfma_f32_16x16x32_bf16 v[208:211], v[18:21], v[136:139], v[208:211]
lw 3072
v_max_f32 v89, s40, v89
v_mfma_f32_16x16x32_bf16 v[212:215], v[16:19], v[136:139], v[212:215]
s_waitcnt vmcnt(20)
v_cvt_pk_bf16_f32 v206, v248, v249
v_cvt_pk_bf16_f32 v207, v250, v251
v_max_f32 v90, s40, v90
v_mfma_f32_16x16x32_bf16 v[208:211], v[18:21], v[140:143], v[208:211]
ds_write_b128 v10, v[204:207] offset:4096
v_max_f32 v91, s40, v91
v_mfma_f32_16x16x32_bf16 v[212:215], v[16:19], v[140:143], v[212:215]
s_waitcnt vmcnt(19)
v_exp_f32_e64 v240, v240 clamp
s_nop 0
v_add_f32 v84, v84, v240
v_mfma_f32_16x16x32_bf16 v[208:211], v[18:21], v[144:147], v[208:211]
v_exp_f32_e64 v241, v241 clamp
s_nop 0
v_add_f32 v85, v85, v241
v_mfma_f32_16x16x32_bf16 v[212:215], v[16:19], v[144:147], v[212:215]
s_waitcnt vmcnt(18)
v_exp_f32_e64 v242, v242 clamp
s_nop 0
v_add_f32 v86, v86, v242
v_mfma_f32_16x16x32_bf16 v[208:211], v[18:21], v[148:151], v[208:211]
v_exp_f32_e64 v243, v243 clamp
s_nop 0
v_add_f32 v87, v87, v243
v_mfma_f32_16x16x32_bf16 v[212:215], v[16:19], v[148:151], v[212:215]
s_waitcnt vmcnt(17)
v_cvt_pk_bf16_f32 v228, v84, v85
v_cvt_pk_bf16_f32 v229, v86, v87
v_fmac_f32 v92, v218, v180
v_mfma_f32_16x16x32_bf16 v[208:211], v[18:21], v[152:155], v[208:211]
v_exp_f32_e64 v236, v236 clamp
s_nop 0
v_add_f32 v88, v88, v236
v_mfma_f32_16x16x32_bf16 v[212:215], v[16:19], v[152:155], v[212:215]
s_waitcnt vmcnt(16)
v_exp_f32_e64 v237, v237 clamp
s_nop 0
v_add_f32 v89, v89, v237
v_mfma_f32_16x16x32_bf16 v[208:211], v[18:21], v[156:159], v[208:211]
v_exp_f32_e64 v238, v238 clamp
s_nop 0
v_add_f32 v90, v90, v238
v_mfma_f32_16x16x32_bf16 v[212:215], v[16:19], v[156:159], v[212:215]
s_waitcnt vmcnt(15)
v_exp_f32_e64 v239, v239 clamp
s_nop 0
v_add_f32 v91, v91, v239
v_mfma_f32_16x16x32_bf16 v[208:211], v[18:21], v[160:163], v[208:211]
v_cvt_pk_bf16_f32 v222, v88, v89
v_cvt_pk_bf16_f32 v223, v90, v91
v_fmac_f32 v93, v218, v181
v_mfma_f32_16x16x32_bf16 v[212:215], v[16:19], v[160:163], v[212:215]
s_waitcnt vmcnt(14)
v_fmac_f32 v94, v218, v182
v_fmac_f32 v95, v218, v183
v_fma_f32 v92, v92, v219, s40
v_mfma_f32_16x16x32_bf16 v[208:211], v[18:21], v[164:167], v[208:211]
v_fma_f32 v93, v93, v219, s40
v_fma_f32 v94, v94, v219, s40
v_fma_f32 v95, v95, v219, s40
v_mfma_f32_16x16x32_bf16 v[212:215], v[16:19], v[164:167], v[212:215]
s_waitcnt vmcnt(13)
v_mul_f32 v240, s41, v92
v_mul_f32 v241, s41, v93
v_mul_f32 v242, s41, v94
v_mfma_f32_16x16x32_bf16 v[208:211], v[18:21], v[168:171], v[208:211]
v_mul_f32 v243, s41, v95
v_exp_f32_e64 v240, v240 clamp
v_mfma_f32_16x16x32_bf16 v[212:215], v[16:19], v[168:171], v[212:215]
s_waitcnt vmcnt(12)
v_max_f32 v92, s40, v92
v_exp_f32_e64 v241, v241 clamp
v_mfma_f32_16x16x32_bf16 v[208:211], v[18:21], v[172:175], v[208:211]
v_max_f32 v93, s40, v93
v_exp_f32_e64 v242, v242 clamp
v_mfma_f32_16x16x32_bf16 v[212:215], v[16:19], v[172:175], v[212:215]
v_max_f32 v94, s40, v94
v_exp_f32_e64 v243, v243 clamp
v_max_f32 v95, s40, v95
v_add_f32 v92, v92, v240
v_add_f32 v93, v93, v241
v_add_f32 v94, v94, v242
v_add_f32 v95, v95, v243
v_cvt_pk_bf16_f32 v230, v92, v93
v_cvt_pk_bf16_f32 v231, v94, v95
buffer_store_dwordx4 a[0:3], v0, s[4:7], s45 offen offset:0 sc1
buffer_store_dwordx4 a[4:7], v0, s[4:7], s45 offen offset:1024 sc1
buffer_store_dwordx4 a[8:11], v0, s[4:7], s45 offen offset:2048 sc1
buffer_store_dwordx4 a[12:15], v0, s[4:7], s45 offen offset:3072 sc1
v_pk_fma_f32 v[96:97], v[216:217], v[184:185], v[96:97] op_sel_hi:[0,1,1]
v_pk_fma_f32 v[98:99], v[216:217], v[186:187], v[98:99] op_sel_hi:[0,1,1]
v_pk_fma_f32 v[100:101], v[218:219], v[184:185], v[100:101] op_sel_hi:[0,1,1]
v_pk_fma_f32 v[102:103], v[218:219], v[186:187], v[102:103] op_sel_hi:[0,1,1]
v_pk_fma_f32 v[96:97], v[96:97], v[216:217], s[40:41] op_sel:[0,1,0] op_sel_hi:[1,1,0]
v_pk_fma_f32 v[98:99], v[98:99], v[216:217], s[40:41] op_sel:[0,1,0] op_sel_hi:[1,1,0]
v_pk_fma_f32 v[100:101], v[100:101], v[218:219], s[40:41] op_sel:[0,1,0] op_sel_hi:[1,1,0]
v_pk_fma_f32 v[102:103], v[102:103], v[218:219], s[40:41] op_sel:[0,1,0] op_sel_hi:[1,1,0]
v_pk_mul_f32 v[236:237], v[96:97], s[40:41] op_sel:[0,1]
v_pk_mul_f32 v[238:239], v[98:99], s[40:41] op_sel:[0,1]
v_pk_mul_f32 v[240:241], v[100:101], s[40:41] op_sel:[0,1]
v_pk_mul_f32 v[242:243], v[102:103], s[40:41] op_sel:[0,1]
v_exp_f32_e64 v236, v236 clamp
v_max_f32 v96, s40, v96
v_exp_f32_e64 v237, v237 clamp
v_max_f32 v97, s40, v97
v_exp_f32_e64 v238, v238 clamp
v_max_f32 v98, s40, v98
v_exp_f32_e64 v239, v239 clamp
v_max_f32 v99, s40, v99
v_exp_f32_e64 v240, v240 clamp
v_max_f32 v100, s40, v100
v_exp_f32_e64 v241, v241 clamp
v_max_f32 v101, s40, v101
v_exp_f32_e64 v242, v242 clamp
v_max_f32 v102, s40, v102
v_exp_f32_e64 v243, v243 clamp
v_max_f32 v103, s40, v103
v_pk_add_f32 v[96:97], v[96:97], v[236:237]
v_pk_add_f32 v[98:99], v[98:99], v[238:239]
v_pk_add_f32 v[100:101], v[100:101], v[240:241]
v_pk_add_f32 v[102:103], v[102:103], v[242:243]
v_cvt_pk_bf16_f32 v224, v96, v97
v_cvt_pk_bf16_f32 v225, v98, v99
v_cvt_pk_bf16_f32 v232, v100, v101
v_cvt_pk_bf16_f32 v233, v102, v103
v_cvt_pk_bf16_f32 v200, v208, v209
v_cvt_pk_bf16_f32 v201, v210, v211
v_cvt_pk_bf16_f32 v202, v212, v213
v_cvt_pk_bf16_f32 v203, v214, v215
ds_write_b128 v10, v[200:203]
v_pk_fma_f32 v[104:105], v[216:217], v[188:189], v[104:105] op_sel_hi:[0,1,1]
v_pk_fma_f32 v[106:107], v[216:217], v[190:191], v[106:107] op_sel_hi:[0,1,1]
v_pk_fma_f32 v[108:109], v[218:219], v[188:189], v[108:109] op_sel_hi:[0,1,1]
v_pk_fma_f32 v[110:111], v[218:219], v[190:191], v[110:111] op_sel_hi:[0,1,1]
v_pk_fma_f32 v[104:105], v[104:105], v[216:217], s[40:41] op_sel:[0,1,0] op_sel_hi:[1,1,0]
v_pk_fma_f32 v[106:107], v[106:107], v[216:217], s[40:41] op_sel:[0,1,0] op_sel_hi:[1,1,0]
v_pk_fma_f32 v[108:109], v[108:109], v[218:219], s[40:41] op_sel:[0,1,0] op_sel_hi:[1,1,0]
v_pk_fma_f32 v[110:111], v[110:111], v[218:219], s[40:41] op_sel:[0,1,0] op_sel_hi:[1,1,0]
v_pk_mul_f32 v[236:237], v[104:105], s[40:41] op_sel:[0,1]
v_pk_mul_f32 v[238:239], v[106:107], s[40:41] op_sel:[0,1]
v_pk_mul_f32 v[240:241], v[108:109], s[40:41] op_sel:[0,1]
v_pk_mul_f32 v[242:243], v[110:111], s[40:41] op_sel:[0,1]
v_exp_f32_e64 v236, v236 clamp
v_max_f32 v104, s40, v104
v_exp_f32_e64 v237, v237 clamp
v_max_f32 v105, s40, v105
v_exp_f32_e64 v238, v238 clamp
v_max_f32 v106, s40, v106
v_exp_f32_e64 v239, v239 clamp
v_max_f32 v107, s40, v107
v_exp_f32_e64 v240, v240 clamp
v_max_f32 v108, s40, v108
v_exp_f32_e64 v241, v241 clamp
v_max_f32 v109, s40, v109
v_exp_f32_e64 v242, v242 clamp
v_max_f32 v110, s40, v110
v_exp_f32_e64 v243, v243 clamp
v_max_f32 v111, s40, v111
v_pk_add_f32 v[104:105], v[104:105], v[236:237]
v_pk_add_f32 v[106:107], v[106:107], v[238:239]
v_pk_add_f32 v[108:109], v[108:109], v[240:241]
v_pk_add_f32 v[110:111], v[110:111], v[242:243]
v_cvt_pk_bf16_f32 v226, v104, v105
v_cvt_pk_bf16_f32 v227, v106, v107
v_cvt_pk_bf16_f32 v234, v108, v109
v_cvt_pk_bf16_f32 v235, v110, v111
wl 0
s_barrier
rd 128,29,4096
rd 112,29,0
rd 116,29,1024
rd 132,29,6144
rd 120,29,2048
rd 124,29,3072
s_lshl_b32 s32, s17, 12
s_add_u32 s32, s32, s52
wl 4
v_mfma_f32_16x16x32_bf16 v[136:139], v[128:131], v[220:223], 0
main_cp4:
s_mov_b32 s96, main_cp4-main_cp3
v_lshl_add_u64 v[2:3], v[2:3], 0, s[96:97]
global_load_dword v254, v[2:3], off
v_mfma_f32_16x16x32_bf16 v[144:147], v[128:131], v[228:231], 0
wl 2
v_mfma_f32_16x16x32_bf16 v[140:143], v[132:135], v[224:227], 0
s_mul_i32 s23, s79, 16384
s_add_u32 s23, s23, s26
s_add_u32 s23, s23, 49152
s_add_u32 m0, s21, 49152
s_nop 0
lw 0
v_mfma_f32_16x16x32_bf16 v[148:151], v[132:135], v[232:235], 0
v_mfma_f32_16x16x32_bf16 v[80:83], v[112:115], v[220:223], 0
v_mfma_f32_16x16x32_bf16 v[84:87], v[116:119], v[220:223], 0
v_add_f32 v136, s40, v136
v_rcp_f32 v136, v136
v_mfma_f32_16x16x32_bf16 v[96:99], v[112:115], v[228:231], 0
v_mfma_f32_16x16x32_bf16 v[100:103], v[116:119], v[228:231], 0
wl 1
lw 1024
v_add_f32 v144, s40, v144
v_rcp_f32 v144, v144
v_mfma_f32_16x16x32_bf16 v[88:91], v[120:123], v[224:227], 0
wl 0
v_mfma_f32_16x16x32_bf16 v[92:95], v[124:127], v[224:227], 0
v_add_f32 v140, s40, v140
v_rcp_f32 v140, v140
v_mfma_f32_16x16x32_bf16 v[104:107], v[120:123], v[232:235], 0
lw 2048
v_mfma_f32_16x16x32_bf16 v[108:111], v[124:127], v[232:235], 0
v_add_f32 v148, s40, v148
v_rcp_f32 v148, v148
v_pk_mul_f32 v[80:81], v[80:81], v[136:137] op_sel_hi:[1,0]
v_pk_mul_f32 v[82:83], v[82:83], v[136:137] op_sel_hi:[1,0]
v_pk_mul_f32 v[84:85], v[84:85], v[136:137] op_sel_hi:[1,0]
v_pk_mul_f32 v[86:87], v[86:87], v[136:137] op_sel_hi:[1,0]
v_cvt_pk_bf16_f32 v152, v80, v81
v_cvt_pk_bf16_f32 v153, v82, v83
v_cvt_pk_bf16_f32 v154, v84, v85
v_cvt_pk_bf16_f32 v155, v86, v87
buffer_store_dwordx4 v[152:155], v0, s[4:7], s32 offen offset:0 sc1
v_pk_mul_f32 v[96:97], v[96:97], v[144:145] op_sel_hi:[1,0]
v_pk_mul_f32 v[98:99], v[98:99], v[144:145] op_sel_hi:[1,0]
lw 3072
v_pk_mul_f32 v[100:101], v[100:101], v[144:145] op_sel_hi:[1,0]
v_pk_mul_f32 v[102:103], v[102:103], v[144:145] op_sel_hi:[1,0]
v_cvt_pk_bf16_f32 v160, v96, v97
v_cvt_pk_bf16_f32 v161, v98, v99
v_cvt_pk_bf16_f32 v162, v100, v101
v_cvt_pk_bf16_f32 v163, v102, v103
buffer_store_dwordx4 v[160:163], v0, s[4:7], s32 offen offset:1024 sc1
v_pk_mul_f32 v[88:89], v[88:89], v[140:141] op_sel_hi:[1,0]
v_pk_mul_f32 v[90:91], v[90:91], v[140:141] op_sel_hi:[1,0]
v_pk_mul_f32 v[92:93], v[92:93], v[140:141] op_sel_hi:[1,0]
v_pk_mul_f32 v[94:95], v[94:95], v[140:141] op_sel_hi:[1,0]
v_cvt_pk_bf16_f32 v156, v88, v89
v_cvt_pk_bf16_f32 v157, v90, v91
v_cvt_pk_bf16_f32 v158, v92, v93
v_cvt_pk_bf16_f32 v159, v94, v95
buffer_store_dwordx4 v[156:159], v0, s[4:7], s32 offen offset:2048 sc1
v_pk_mul_f32 v[104:105], v[104:105], v[148:149] op_sel_hi:[1,0]
v_pk_mul_f32 v[106:107], v[106:107], v[148:149] op_sel_hi:[1,0]
s_mul_i32 s23, s76, 16384
s_add_u32 s23, s23, s26
s_add_u32 s23, s23, 65536
s_add_u32 m0, s21, 65536
s_nop 0
lw 0
v_pk_mul_f32 v[108:109], v[108:109], v[148:149] op_sel_hi:[1,0]
v_pk_mul_f32 v[110:111], v[110:111], v[148:149] op_sel_hi:[1,0]
v_cvt_pk_bf16_f32 v164, v104, v105
v_cvt_pk_bf16_f32 v165, v106, v107
v_cvt_pk_bf16_f32 v166, v108, v109
v_cvt_pk_bf16_f32 v167, v110, v111
buffer_store_dwordx4 v[164:167], v0, s[4:7], s32 offen offset:3072 sc1
lw 1024
lw 2048
lw 3072
s_mul_i32 s23, s77, 16384
s_add_u32 s23, s23, s26
s_add_u32 s23, s23, 81920
s_add_u32 m0, s21, 81920
s_nop 0
lw 0
lw 1024
lw 2048
lw 3072
s_add_u32 s36, s48, 32768
v_mov_b32 v31, 1
s_waitcnt vmcnt(7)
buffer_atomic_add v31, v4, s[4:7], s36 offen sc0 sc1
v_and_b32 v251, 0xf0, v0
v_lshlrev_b32 v251, 3, v251
v_lshrrev_b32 v250, 8, v0
v_lshl_add_u32 v251, v250, 4, v251
s_add_u32 s32, s21, 98304
v_add_u32 v251, s32, v251
rd 152,251,0
rd 156,251,2048
rd 160,251,64
rd 164,251,2112
wl 0
v_add_u32 v251, 32768, v7
ds_read_b64_tr_b16 v[168:169], v251 offset:0
ds_read_b64_tr_b16 v[170:171], v251 offset:2048
ds_read_b64_tr_b16 v[172:173], v251 offset:32
ds_read_b64_tr_b16 v[174:175], v251 offset:2080
ds_read_b64_tr_b16 v[176:177], v251 offset:64
ds_read_b64_tr_b16 v[178:179], v251 offset:2112
ds_read_b64_tr_b16 v[180:181], v251 offset:96
ds_read_b64_tr_b16 v[182:183], v251 offset:2144
wl 0
s_barrier
rd 48,0,0
rd 52,0,1024
rd 56,0,2048
rd 60,0,3072
rd 64,0,4096
rd 68,0,5120
rd 72,0,6144
v_lshlrev_b32 v80, 16, v32
v_and_b32 v81, 0xffff0000, v32
v_lshlrev_b32 v82, 16, v33
v_and_b32 v83, 0xffff0000, v33
v_lshlrev_b32 v88, 16, v34
v_and_b32 v89, 0xffff0000, v34
v_lshlrev_b32 v90, 16, v35
v_and_b32 v91, 0xffff0000, v35
v_lshlrev_b32 v96, 16, v36
v_and_b32 v97, 0xffff0000, v36
v_lshlrev_b32 v98, 16, v37
v_and_b32 v99, 0xffff0000, v37
v_lshlrev_b32 v104, 16, v38
v_and_b32 v105, 0xffff0000, v38
v_lshlrev_b32 v106, 16, v39
v_and_b32 v107, 0xffff0000, v39
v_lshlrev_b32 v84, 16, v40
v_and_b32 v85, 0xffff0000, v40
v_lshlrev_b32 v86, 16, v41
v_and_b32 v87, 0xffff0000, v41
v_lshlrev_b32 v92, 16, v42
v_and_b32 v93, 0xffff0000, v42
v_lshlrev_b32 v94, 16, v43
v_and_b32 v95, 0xffff0000, v43
v_lshlrev_b32 v100, 16, v44
v_and_b32 v101, 0xffff0000, v44
v_lshlrev_b32 v102, 16, v45
v_and_b32 v103, 0xffff0000, v45
v_lshlrev_b32 v108, 16, v46
v_and_b32 v109, 0xffff0000, v46
v_lshlrev_b32 v110, 16, v47
v_and_b32 v111, 0xffff0000, v47
v_mov_b32 v251, 0
s_waitcnt vmcnt(0)
v_readfirstlane_b32 s46, v31
buffer_atomic_add v251, v4, s[4:7], s36 offen sc0 sc1
s_mul_i32 s23, s78, 16384
s_add_u32 s23, s23, s26
s_add_u32 s23, s23, 98304
s_add_u32 m0, s21, 32768
s_nop 0
lw 0
lw 1024
lw 2048
lw 3072
s_min_i32 s23, s79, 0
s_mul_i32 s23, s23, 16384
s_add_u32 s23, s23, s26
s_add_u32 s23, s23, 114688
s_add_u32 m0, s21, 98304
s_nop 0
lw 0
lw 1024
lw 2048
lw 3072
s_cmp_ge_u32 s46, 15
s_cbranch_scc1 main_ok36
s_waitcnt vmcnt(8)
v_readfirstlane_b32 s46, v251
s_mov_b32 s47, 0
s_cmp_ge_u32 s46, 16
s_cbranch_scc1 main_ok36
main_poll35:
v_mov_b32 v31, 0
buffer_atomic_add v31, v4, s[4:7], s36 offen sc0 sc1
s_add_u32 s47, s47, 1
s_cmp_gt_u32 s47, 400000
s_cbranch_scc1 main_ok36
s_waitcnt vmcnt(0)
v_readfirstlane_b32 s46, v31
s_nop 0
s_cmp_lt_u32 s46, 16
s_cbranch_scc1 main_poll35
main_ok36:
s_max_i32 s24, s76, 0
s_mul_i32 s24, s24, 8192
s_add_u32 s24, s24, s52
s_add_u32 s24, s24, 0
lx 0,0
lx 4,1024
lx 8,2048
lx 12,3072
s_add_u32 s24, s24, 4096
lx 16,0
lx 20,1024
lx 24,2048
lx 28,3072
s_waitcnt vmcnt(7) lgkmcnt(5)
mT 80,48,0
s_waitcnt vmcnt(6)
s_mul_i32 s24, s77, 8192
rd 76,0,7168
mT 84,48,4
mT 92,52,4
s_add_u32 s24, s24, s52
rd 48,0,8192
mT 88,52,0
wl 5
mT 96,56,0
s_add_u32 s24, s24, 8192
rd 52,0,9216
mT 100,56,4
lx 32,0
mT 108,60,4
rd 56,0,10240
mT 104,60,0
s_waitcnt vmcnt(6) lgkmcnt(5)
lx 36,1024
mT 80,64,8
s_waitcnt vmcnt(6)
rd 60,0,11264
mT 84,64,12
lx 40,2048
mT 92,68,12
rd 64,0,12288
mT 88,68,8
wl 5
lx 44,3072
mT 96,72,8
s_add_u32 s24, s24, 4096
rd 68,0,13312
mT 100,72,12
lx 48,0
mT 108,76,12
rd 72,0,14336
mT 104,76,8
s_waitcnt vmcnt(8) lgkmcnt(5)
lx 52,1024
mT 80,48,16
s_waitcnt vmcnt(8)
rd 76,0,15360
mT 84,48,20
s_barrier
mT 92,52,20
rd 48,1,49152
mT 88,52,16
wl 5
lx 56,2048
mT 96,56,16
rd 52,1,50176
mT 100,56,20
lx 60,3072
mT 108,60,20
s_mul_i32 s24, s78, 8192
rd 56,1,51200
mT 104,60,16
s_waitcnt vmcnt(9) lgkmcnt(5)
mT 80,64,24
s_waitcnt vmcnt(8)
s_add_u32 s24, s24, s52
rd 60,1,52224
mT 84,64,28
mT 92,68,28
s_add_u32 s24, s24, 16384
rd 64,1,53248
mT 88,68,24
wl 5
lx 64,0
mT 96,72,24
rd 68,1,54272
mT 100,72,28
lx 68,1024
mT 108,76,28
rd 72,1,55296
mT 104,76,24
s_waitcnt vmcnt(9) lgkmcnt(5)
lx 72,2048
mT 80,48,32
s_waitcnt vmcnt(9)
rd 76,1,56320
mT 84,48,36
lx 76,3072
mT 92,52,36
s_add_u32 s24, s24, 4096
rd 48,1,57344
mT 88,52,32
wl 5
lx 80,0
mT 96,56,32
rd 52,1,58368
mT 100,56,36
lx 84,1024
mT 108,60,36
rd 56,1,59392
mT 104,60,32
s_waitcnt vmcnt(11) lgkmcnt(5)
mT 80,64,40
s_waitcnt vmcnt(10)
rd 60,1,60416
mT 84,64,44
lx 88,2048
mT 92,68,44
rd 64,1,61440
mT 88,68,40
wl 5
lx 92,3072
mT 96,72,40
rd 68,1,62464
mT 100,72,44
mT 108,76,44
rd 72,1,63488
mT 104,76,40
s_waitcnt vmcnt(11) lgkmcnt(5)
mT 80,48,48
s_waitcnt vmcnt(10)
s_mul_i32 s24, s79, 8192
rd 76,1,64512
mT 84,48,52
s_barrier
mT 92,52,52
s_add_u32 s24, s24, s52
rd 48,0,16384
mT 88,52,48
wl 5
mT 96,56,48
s_add_u32 s24, s24, 24576
rd 52,0,17408
mT 100,56,52
lx 96,0
mT 108,60,52
rd 56,0,18432
mT 104,60,48
s_waitcnt vmcnt(10) lgkmcnt(5)
lx 100,1024
mT 80,64,56
s_waitcnt vmcnt(10)
rd 60,0,19456
mT 84,64,60
lx 104,2048
mT 92,68,60
rd 64,0,20480
mT 88,68,56
wl 5
lx 108,3072
mT 96,72,56
rd 68,0,21504
mT 100,72,60
mT 108,76,60
rd 72,0,22528
mT 104,76,56
s_waitcnt vmcnt(11) lgkmcnt(5)
mT 80,48,64
s_waitcnt vmcnt(10)
s_add_u32 s24, s24, 4096
rd 76,0,23552
mT 84,48,68
lx 112,0
mT 92,52,68
rd 48,0,24576
mT 88,52,64
wl 5
lx 116,1024
mT 96,56,64
rd 52,0,25600
mT 100,56,68
mT 108,60,68
rd 56,0,26624
mT 104,60,64
s_waitcnt vmcnt(11) lgkmcnt(5)
mT 80,64,72
s_waitcnt vmcnt(10)
rd 60,0,27648
mT 84,64,76
lx 120,2048
mT 92,68,76
rd 64,0,28672
mT 88,68,72
wl 5
lx 124,3072
mT 96,72,72
rd 68,0,29696
mT 100,72,76
mT 108,76,76
rd 72,0,30720
mT 104,76,72
s_waitcnt vmcnt(11) lgkmcnt(5)
mT 80,48,80
s_waitcnt vmcnt(10)
s_mul_i32 s24, s76, 8192
rd 76,0,31744
mT 84,48,84
s_barrier
mT 92,52,84
s_add_u32 s24, s24, s52
rd 48,0,49152
mT 88,52,80
wl 5
mT 96,56,80
s_add_u32 s24, s24, 32768
rd 52,0,50176
mT 100,56,84
lx 128,0
mT 108,60,84
rd 56,0,51200
mT 104,60,80
s_waitcnt vmcnt(10) lgkmcnt(5)
lx 132,1024
mT 80,64,88
s_waitcnt vmcnt(10)
rd 60,0,52224
mT 84,64,92
lx 136,2048
mT 92,68,92
rd 64,0,53248
mT 88,68,88
wl 5
lx 140,3072
mT 96,72,88
rd 68,0,54272
mT 100,72,92
mT 108,76,92
rd 72,0,55296
mT 104,76,88
s_waitcnt vmcnt(11) lgkmcnt(5)
mT 80,48,96
s_waitcnt vmcnt(10)
s_add_u32 s24, s24, 4096
rd 76,0,56320
mT 84,48,100
lx 144,0
mT 92,52,100
rd 48,0,57344
mT 88,52,96
wl 5
lx 148,1024
mT 96,56,96
rd 52,0,58368
mT 100,56,100
mT 108,60,100
rd 56,0,59392
mT 104,60,96
s_waitcnt vmcnt(11) lgkmcnt(5)
mT 80,64,104
s_waitcnt vmcnt(10)
rd 60,0,60416
mT 84,64,108
lx 152,2048
mT 92,68,108
rd 64,0,61440
mT 88,68,104
wl 5
lx 156,3072
mT 96,72,104
rd 68,0,62464
mT 100,72,108
mT 108,76,108
rd 72,0,63488
mT 104,76,104
s_waitcnt vmcnt(11) lgkmcnt(5)
mT 80,48,112
s_waitcnt vmcnt(10)
s_mul_i32 s24, s77, 8192
rd 76,0,64512
mT 84,48,116
s_barrier
mT 92,52,116
s_add_u32 s24, s24, s52
rd 48,1,0
mT 88,52,112
wl 5
mT 96,56,112
s_add_u32 s24, s24, 40960
rd 52,1,1024
mT 100,56,116
lx 160,0
mT 108,60,116
rd 56,1,2048
mT 104,60,112
s_waitcnt vmcnt(10) lgkmcnt(5)
lx 164,1024
mT 80,64,120
s_waitcnt vmcnt(10)
rd 60,1,3072
mT 84,64,124
lx 168,2048
mT 92,68,124
rd 64,1,4096
mT 88,68,120
wl 5
lx 172,3072
mT 96,72,120
rd 68,1,5120
mT 100,72,124
mT 108,76,124
rd 72,1,6144
mT 104,76,120
s_waitcnt vmcnt(11) lgkmcnt(5)
mT 80,48,128
s_waitcnt vmcnt(10)
s_add_u32 s24, s24, 4096
rd 76,1,7168
mT 84,48,132
lx 176,0
mT 92,52,132
rd 48,1,8192
mT 88,52,128
wl 5
lx 180,1024
mT 96,56,128
rd 52,1,9216
mT 100,56,132
mT 108,60,132
rd 56,1,10240
mT 104,60,128
s_waitcnt vmcnt(11) lgkmcnt(5)
mT 80,64,136
s_waitcnt vmcnt(10)
rd 60,1,11264
mT 84,64,140
lx 184,2048
mT 92,68,140
rd 64,1,12288
mT 88,68,136
wl 5
lx 188,3072
mT 96,72,136
rd 68,1,13312
mT 100,72,140
mT 108,76,140
rd 72,1,14336
mT 104,76,136
s_waitcnt vmcnt(11) lgkmcnt(5)
mT 80,48,144
s_waitcnt vmcnt(10)
s_mul_i32 s24, s78, 8192
rd 76,1,15360
mT 84,48,148
s_barrier
mT 92,52,148
s_add_u32 s24, s24, s52
rd 48,1,16384
mT 88,52,144
wl 5
mT 96,56,144
s_add_u32 s24, s24, 49152
rd 52,1,17408
mT 100,56,148
lx 192,0
mT 108,60,148
rd 56,1,18432
mT 104,60,144
s_waitcnt vmcnt(10) lgkmcnt(5)
lx 196,1024
mT 80,64,152
s_waitcnt vmcnt(10)
rd 60,1,19456
mT 84,64,156
lx 200,2048
mT 92,68,156
rd 64,1,20480
mT 88,68,152
wl 5
lx 204,3072
mT 96,72,152
rd 68,1,21504
mT 100,72,156
mT 108,76,156
rd 72,1,22528
mT 104,76,152
s_waitcnt vmcnt(11) lgkmcnt(5)
mT 80,48,160
s_waitcnt vmcnt(10)
s_add_u32 s24, s24, 4096
rd 76,1,23552
mT 84,48,164
lx 208,0
mT 92,52,164
rd 48,1,24576
mT 88,52,160
wl 5
lx 212,1024
mT 96,56,160
rd 52,1,25600
mT 100,56,164
mT 108,60,164
rd 56,1,26624
mT 104,60,160
s_waitcnt vmcnt(11) lgkmcnt(5)
mT 80,64,168
s_waitcnt vmcnt(10)
rd 60,1,27648
mT 84,64,172
lx 216,2048
mT 92,68,172
rd 64,1,28672
mT 88,68,168
wl 5
lx 220,3072
mT 96,72,168
rd 68,1,29696
mT 100,72,172
mT 108,76,172
rd 72,1,30720
mT 104,76,168
s_waitcnt vmcnt(11) lgkmcnt(5)
mT 80,48,176
s_waitcnt vmcnt(10)
s_min_i32 s24, s79, 0
rd 76,1,31744
mT 84,48,180
s_barrier
mT 92,52,180
s_mul_i32 s24, s24, 8192
rd 48,0,32768
mT 88,52,176
wl 5
mT 96,56,176
s_add_u32 s24, s24, s52
rd 52,0,33792
mT 100,56,180
main_cp5:
s_mov_b32 s96, main_cp5-main_cp4
v_lshl_add_u64 v[2:3], v[2:3], 0, s[96:97]
global_load_dword v254, v[2:3], off
mT 108,60,180
s_add_u32 s24, s24, 57344
rd 56,0,34816
mT 104,60,176
s_waitcnt vmcnt(10) lgkmcnt(5)
lx 224,0
mT 80,64,184
s_waitcnt vmcnt(10)
rd 60,0,35840
mT 84,64,188
lx 228,1024
mT 92,68,188
rd 64,0,36864
mT 88,68,184
wl 5
lx 232,2048
mT 96,72,184
rd 68,0,37888
mT 100,72,188
lx 236,3072
mT 108,76,188
rd 72,0,38912
mT 104,76,184
s_waitcnt vmcnt(12) lgkmcnt(5)
mT 80,48,192
s_waitcnt vmcnt(11)
s_add_u32 s24, s24, 4096
rd 76,0,39936
mT 84,48,196
lx 240,0
mT 92,52,196
rd 48,0,40960
mT 88,52,192
wl 5
lx 244,1024
mT 96,56,192
rd 52,0,41984
mT 100,56,196
mT 108,60,196
rd 56,0,43008
mT 104,60,192
s_waitcnt vmcnt(12) lgkmcnt(5)
mT 80,64,200
s_waitcnt vmcnt(11)
rd 60,0,44032
mT 84,64,204
lx 248,2048
mT 92,68,204
rd 64,0,45056
mT 88,68,200
wl 5
lx 252,3072
mT 96,72,200
rd 68,0,46080
mT 100,72,204
mT 108,76,204
rd 72,0,47104
mT 104,76,200
s_waitcnt vmcnt(12) lgkmcnt(5)
mT 80,48,208
s_waitcnt vmcnt(11)
s_add_u32 s23, s27, 0
rd 76,0,48128
mT 84,48,212
s_barrier
mT 92,52,212
s_add_u32 m0, s22, 131072
rd 48,1,32768
mT 88,52,208
wl 5
lw 0
mT 96,56,208
rd 52,1,33792
mT 100,56,212
lw 1024
mT 108,60,212
s_add_u32 s45, s45, 4096
rd 56,1,36864
mT 104,60,208
s_waitcnt vmcnt(12) lgkmcnt(5)
buffer_store_dwordx4 v[152:155], v0, s[4:7], s45 offen offset:0 sc1
mT 80,64,216
s_waitcnt vmcnt(12)
rd 60,1,37888
mT 84,64,220
lw 2048
mT 92,68,220
rd 64,1,40960
mT 88,68,216
wl 5
s_mov_b32 exec_hi, 0
lw 3072
s_mov_b32 exec_hi, -1
mT 96,72,216
s_add_u32 s23, s23, 14336
rd 68,1,41984
mT 100,72,220
mT 108,76,220
s_add_u32 m0, s22, 145408
rd 72,1,45056
mT 104,76,216
s_waitcnt vmcnt(12) lgkmcnt(5)
buffer_store_dwordx4 v[156:159], v0, s[4:7], s45 offen offset:1024 sc1
mT 80,48,224
s_waitcnt vmcnt(12)
rd 76,1,46080
mT 84,48,228
lw 0
mT 92,52,228
rd 48,1,34816
mT 88,52,224
s_waitcnt vmcnt(12) lgkmcnt(5)
lw 1024
mT 80,56,232
s_waitcnt vmcnt(12)
rd 52,1,35840
mT 84,56,236
lw 2048
mT 92,60,236
rd 56,1,38912
mT 88,60,232
s_waitcnt vmcnt(12) lgkmcnt(5)
buffer_store_dwordx4 v[160:163], v0, s[4:7], s45 offen offset:2048 sc1
mT 80,64,240
s_waitcnt vmcnt(12)
rd 60,1,39936
mT 84,64,244
s_mov_b32 exec_hi, 0
lw 3072
s_mov_b32 exec_hi, -1
mT 92,68,244
s_add_u32 s23, s27, 28672
rd 64,1,43008
mT 88,68,240
s_waitcnt vmcnt(12) lgkmcnt(5)
mT 80,72,248
s_waitcnt vmcnt(11)
s_add_u32 m0, s22, 2048
rd 68,1,44032
mT 84,72,252
lw 0
mT 92,76,252
rd 72,1,47104
mT 88,76,248
wl 5
buffer_store_dwordx4 v[164:167], v0, s[4:7], s45 offen offset:3072 sc1
mT 96,48,224
rd 76,1,48128
mT 100,48,228
lw 1024
mT 108,52,228
lw 2048
mT 104,52,224
wl 4
mT 96,56,232
s_lshl_b32 s32, s17, 12
s_add_u32 s32, s32, s52
s_add_u32 s32, s32, 65536
v_cvt_pk_bf16_f32 v32, v80, v81
mT 100,56,236
s_mov_b32 exec_hi, 0
lw 3072
s_mov_b32 exec_hi, -1
v_cvt_pk_bf16_f32 v33, v82, v83
mT 108,60,236
s_add_u32 s23, s23, 14336
v_cvt_pk_bf16_f32 v34, v88, v89
v_cvt_pk_bf16_f32 v35, v90, v91
mT 104,60,232
wl 3
buffer_store_dwordx4 v[32:35], v0, s[4:7], s32 offen offset:0 sc1
v_cvt_pk_bf16_f32 v40, v84, v85
mT 96,64,240
s_add_u32 m0, s22, 116736
v_cvt_pk_bf16_f32 v41, v86, v87
v_cvt_pk_bf16_f32 v42, v92, v93
v_cvt_pk_bf16_f32 v43, v94, v95
mT 100,64,244
wl 2
lw 0
mT 108,68,244
lw 1024
mT 104,68,240
wl 1
buffer_store_dwordx4 v[40:43], v0, s[4:7], s32 offen offset:1024 sc1
v_dot2_f32_bf16 v220, v32, v24, 0
mT 96,72,248
v_dot2_f32_bf16 v222, v32, v32, 0
v_dot2_f32_bf16 v221, v40, v24, 0
v_dot2_f32_bf16 v223, v40, v40, 0
mT 100,72,252
wl 0
lw 2048
v_dot2_f32_bf16 v220, v33, v24, v220
mT 108,76,252
v_dot2_f32_bf16 v222, v33, v33, v222
v_dot2_f32_bf16 v221, v41, v24, v221
v_dot2_f32_bf16 v223, v41, v41, v223
mT 104,76,248
s_mov_b32 exec_hi, 0
lw 3072
s_mov_b32 exec_hi, -1
v_dot2_f32_bf16 v220, v34, v24, v220
v_dot2_f32_bf16 v222, v34, v34, v222
v_dot2_f32_bf16 v221, v42, v24, v221
v_dot2_f32_bf16 v223, v42, v42, v223
v_dot2_f32_bf16 v220, v35, v24, v220
v_dot2_f32_bf16 v222, v35, v35, v222
v_dot2_f32_bf16 v221, v43, v24, v221
v_dot2_f32_bf16 v223, v43, v43, v223
v_cvt_pk_bf16_f32 v36, v96, v97
v_cvt_pk_bf16_f32 v37, v98, v99
v_cvt_pk_bf16_f32 v38, v104, v105
v_cvt_pk_bf16_f32 v39, v106, v107
buffer_store_dwordx4 v[36:39], v0, s[4:7], s32 offen offset:2048 sc1
v_cvt_pk_bf16_f32 v44, v100, v101
v_cvt_pk_bf16_f32 v45, v102, v103
v_cvt_pk_bf16_f32 v46, v108, v109
v_cvt_pk_bf16_f32 v47, v110, v111
buffer_store_dwordx4 v[44:47], v0, s[4:7], s32 offen offset:3072 sc1
v_dot2_f32_bf16 v220, v36, v24, v220
v_dot2_f32_bf16 v222, v36, v36, v222
v_dot2_f32_bf16 v221, v44, v24, v221
v_dot2_f32_bf16 v223, v44, v44, v223
v_dot2_f32_bf16 v220, v37, v24, v220
v_dot2_f32_bf16 v222, v37, v37, v222
v_dot2_f32_bf16 v221, v45, v24, v221
v_dot2_f32_bf16 v223, v45, v45, v223
v_dot2_f32_bf16 v220, v38, v24, v220
v_dot2_f32_bf16 v222, v38, v38, v222
v_dot2_f32_bf16 v221, v46, v24, v221
v_dot2_f32_bf16 v223, v46, v46, v223
v_dot2_f32_bf16 v220, v39, v24, v220
v_dot2_f32_bf16 v222, v39, v39, v222
v_dot2_f32_bf16 v221, v47, v24, v221
v_dot2_f32_bf16 v223, v47, v47, v223
s_nop 1
v_permlane32_swap_b32 v220, v221
v_permlane32_swap_b32 v222, v223
v_add_f32 v220, v220, v221
v_add_f32 v222, v222, v223
s_nop 1
v_permlane16_swap_b32 v220, v222
v_add_f32 v220, v220, v222
s_lshl_b32 s33, s17, 8
s_add_u32 s33, s33, s54
s_add_u32 s33, s33, 262144
buffer_store_dword v220, v6, s[4:7], s33 offen sc1
s_add_u32 s36, s48, 49152
v_mov_b32 v31, 1
s_waitcnt vmcnt(0)
buffer_atomic_add v31, v4, s[4:7], s36 offen sc0 sc1
s_barrier
s_add_u32 s23, s27, 57344
s_add_u32 m0, s22, 16384
s_nop 0
lw 0
lw 1024
lw 2048
s_mov_b32 exec_hi, 0
lw 3072
s_mov_b32 exec_hi, -1
s_add_u32 s23, s23, 14336
s_add_u32 m0, s22, 59392
s_nop 0
lw 0
lw 1024
lw 2048
s_mov_b32 exec_hi, 0
lw 3072
s_mov_b32 exec_hi, -1
s_barrier
rd 48,29,0
rd 52,29,1024
rd 56,29,2048
rd 60,29,3072
rd 64,29,4096
rd 68,29,5120
rd 72,29,6144
v_mov_b32 v251, 0
s_waitcnt vmcnt(8)
v_readfirstlane_b32 s46, v31
buffer_atomic_add v251, v4, s[4:7], s36 offen sc0 sc1
s_add_u32 s23, s27, 86016
s_add_u32 m0, s22, 73728
s_nop 0
lw 0
lw 1024
lw 2048
s_mov_b32 exec_hi, 0
lw 3072
s_mov_b32 exec_hi, -1
s_add_u32 s23, s23, 14336
s_add_u32 m0, s22, 30720
s_nop 0
lw 0
lw 1024
lw 2048
s_mov_b32 exec_hi, 0
lw 3072
s_mov_b32 exec_hi, -1
s_cmp_ge_u32 s46, 15
s_cbranch_scc1 main_ok70
s_waitcnt vmcnt(8)
v_readfirstlane_b32 s46, v251
s_mov_b32 s47, 0
s_cmp_ge_u32 s46, 16
s_cbranch_scc1 main_ok70
main_poll69:
v_mov_b32 v31, 0
buffer_atomic_add v31, v4, s[4:7], s36 offen sc0 sc1
s_add_u32 s47, s47, 1
s_cmp_gt_u32 s47, 400000
s_cbranch_scc1 main_ok70
s_waitcnt vmcnt(0)
v_readfirstlane_b32 s46, v31
s_nop 0
s_cmp_lt_u32 s46, 16
s_cbranch_scc1 main_poll69
main_ok70:
s_add_u32 s24, s52, 65536
lx 0,0
lx 4,1024
lx 8,2048
lx 12,3072
s_add_u32 s24, s24, 4096
lx 16,0
lx 20,1024
lx 24,2048
lx 28,3072
s_and_b32 s35, s17, 1
s_lshl_b32 s35, s35, 16
s_add_u32 s35, s35, s53
s_waitcnt vmcnt(7) lgkmcnt(5)
v_mfma_f32_16x16x32_bf16 v[80:83], a[0:3], v[48:51], 0
s_waitcnt vmcnt(6)
s_add_u32 s24, s52, 73728
rd 76,29,7168
v_mfma_f32_16x16x32_bf16 v[84:87], a[4:7], v[48:51], 0
lx 32,0
v_mfma_f32_16x16x32_bf16 v[92:95], a[4:7], v[52:55], 0
rd 48,29,8192
v_mfma_f32_16x16x32_bf16 v[88:91], a[0:3], v[52:55], 0
wl 5
v_mfma_f32_16x16x32_bf16 v[96:99], a[0:3], v[56:59], 0
rd 52,29,9216
v_mfma_f32_16x16x32_bf16 v[100:103], a[4:7], v[56:59], 0
lx 36,1024
v_mfma_f32_16x16x32_bf16 v[108:111], a[4:7], v[60:63], 0
rd 56,29,10240
v_mfma_f32_16x16x32_bf16 v[104:107], a[0:3], v[60:63], 0
wl 5
v_mfma_f32_16x16x32_bf16 v[112:115], a[0:3], v[64:67], 0
rd 60,29,11264
v_mfma_f32_16x16x32_bf16 v[116:119], a[4:7], v[64:67], 0
lx 40,2048
v_mfma_f32_16x16x32_bf16 v[124:127], a[4:7], v[68:71], 0
rd 64,29,12288
v_mfma_f32_16x16x32_bf16 v[120:123], a[0:3], v[68:71], 0
wl 5
v_mfma_f32_16x16x32_bf16 v[128:131], a[0:3], v[72:75], 0
rd 68,29,13312
v_mfma_f32_16x16x32_bf16 v[132:135], a[4:7], v[72:75], 0
s_waitcnt vmcnt(7)
s_barrier
mF 84,76,12
rd 72,29,14336
mF 80,76,8
wl 5
lx 44,3072
mF 88,48,8
s_add_u32 s24, s24, 4096
rd 76,29,15360
mF 92,48,12
mF 100,52,12
rd 48,29,16384
mF 96,52,8
wl 5
lx 48,0
mF 104,56,8
rd 52,29,17408
mF 108,56,12
mF 116,60,12
rd 56,29,18432
mF 112,60,8
wl 5
lx 52,1024
mF 120,64,8
rd 60,29,19456
mF 124,64,12
mF 132,68,12
rd 64,29,20480
mF 128,68,8
s_waitcnt vmcnt(9) lgkmcnt(5)
lx 56,2048
mF 80,72,16
s_waitcnt vmcnt(9)
rd 68,29,21504
mF 84,72,20
mF 92,76,20
rd 72,29,22528
mF 88,76,16
wl 5
lx 60,3072
mF 96,48,16
s_add_u32 s24, s52, 81920
rd 76,29,23552
mF 100,48,20
mF 108,52,20
rd 48,29,24576
mF 104,52,16
wl 5
lx 64,0
mF 112,56,16
rd 52,29,25600
mF 116,56,20
mF 124,60,20
rd 56,29,26624
mF 120,60,16
wl 5
lx 68,1024
mF 128,64,16
rd 60,29,27648
mF 132,64,20
s_waitcnt vmcnt(10)
s_barrier
mF 84,68,28
rd 64,0,2048
mF 80,68,24
wl 5
lx 72,2048
mF 88,72,24
rd 68,0,3072
mF 92,72,28
mF 100,76,28
rd 72,0,4096
mF 96,76,24
wl 5
lx 76,3072
mF 104,48,24
s_add_u32 s24, s24, 4096
rd 76,0,5120
mF 108,48,28
mF 116,52,28
rd 48,0,6144
mF 112,52,24
wl 5
lx 80,0
mF 120,56,24
rd 52,0,7168
mF 124,56,28
mF 132,60,28
rd 56,0,8192
mF 128,60,24
s_waitcnt vmcnt(12) lgkmcnt(5)
lx 84,1024
mF 80,64,32
s_waitcnt vmcnt(12)
rd 60,0,9216
mF 84,64,36
mF 92,68,36
rd 64,0,10240
mF 88,68,32
wl 5
lx 88,2048
mF 96,72,32
rd 68,0,11264
mF 100,72,36
mF 108,76,36
rd 72,0,12288
mF 104,76,32
wl 5
lx 92,3072
mF 112,48,32
s_add_u32 s24, s52, 90112
rd 76,0,13312
mF 116,48,36
mF 124,52,36
rd 48,0,14336
mF 120,52,32
wl 5
lx 96,0
mF 128,56,32
rd 52,0,15360
mF 132,56,36
s_waitcnt vmcnt(13)
s_barrier
mF 84,60,44
rd 56,1,51200
mF 80,60,40
wl 5
lx 100,1024
mF 88,64,40
rd 60,1,52224
mF 92,64,44
mF 100,68,44
rd 64,1,53248
mF 96,68,40
wl 5
lx 104,2048
mF 104,72,40
rd 68,1,54272
mF 108,72,44
mF 116,76,44
rd 72,1,55296
mF 112,76,40
wl 5
lx 108,3072
mF 120,48,40
s_add_u32 s24, s24, 4096
rd 76,1,56320
mF 124,48,44
mF 132,52,44
rd 48,1,57344
mF 128,52,40
s_waitcnt vmcnt(15) lgkmcnt(5)
lx 112,0
mF 80,56,48
s_waitcnt vmcnt(15)
rd 52,1,58368
mF 84,56,52
mF 92,60,52
rd 56,1,59392
mF 88,60,48
wl 5
lx 116,1024
mF 96,64,48
rd 60,1,60416
mF 100,64,52
mF 108,68,52
rd 64,1,61440
mF 104,68,48
wl 5
lx 120,2048
mF 112,72,48
rd 68,1,62464
mF 116,72,52
mF 124,76,52
rd 72,1,63488
mF 120,76,48
wl 5
lx 124,3072
mF 128,48,48
s_add_u32 s24, s52, 98304
rd 76,1,64512
mF 132,48,52
s_waitcnt vmcnt(16)
s_barrier
mF 84,52,60
rd 48,0,16384
mF 80,52,56
wl 5
lx 128,0
mF 88,56,56
s_add_u32 s37, s54, 262144
rd 52,0,17408
mF 92,56,60
mF 100,60,60
rd 56,0,18432
mF 96,60,56
wl 5
buffer_load_dwordx4 v[220:223], v0, s[4:7], s37 offen offset:0 sc1
mF 104,64,56
rd 60,0,19456
mF 108,64,60
mF 116,68,60
rd 64,0,20480
mF 112,68,56
wl 5
buffer_load_dwordx4 v[224:227], v0, s[4:7], s37 offen offset:1024 sc1
mF 120,72,56
rd 68,0,21504
mF 124,72,60
mF 132,76,60
rd 72,0,22528
mF 128,76,56
s_waitcnt vmcnt(18) lgkmcnt(5)
buffer_load_dwordx4 v[228:231], v0, s[4:7], s37 offen offset:2048 sc1
mF 80,48,64
s_waitcnt vmcnt(18)
rd 76,0,23552
mF 84,48,68
mF 92,52,68
rd 48,0,24576
mF 88,52,64
wl 5
buffer_load_dwordx4 v[232:235], v0, s[4:7], s37 offen offset:3072 sc1
mF 96,56,64
rd 52,0,25600
mF 100,56,68
mF 108,60,68
rd 56,0,26624
mF 104,60,64
wl 5
lx 132,1024
mF 112,64,64
rd 60,0,27648
mF 116,64,68
mF 124,68,68
rd 64,0,28672
mF 120,68,64
wl 5
lx 136,2048
mF 128,72,64
rd 68,0,29696
mF 132,72,68
s_waitcnt vmcnt(19)
s_barrier
mF 84,76,76
rd 72,0,59392
mF 80,76,72
wl 5
lx 140,3072
mF 88,48,72
s_add_u32 s24, s24, 4096
rd 76,0,60416
mF 92,48,76
mF 100,52,76
rd 48,0,61440
mF 96,52,72
wl 5
lx 144,0
mF 104,56,72
rd 52,0,62464
mF 108,56,76
mF 116,60,76
rd 56,0,63488
mF 112,60,72
wl 5
lx 148,1024
mF 120,64,72
rd 60,0,64512
mF 124,64,76
mF 132,68,76
rd 64,1,0
mF 128,68,72
s_waitcnt vmcnt(21) lgkmcnt(5)
lx 152,2048
mF 80,72,80
s_waitcnt vmcnt(21)
s_add_u32 s23, s27, 114688
rd 68,1,1024
mF 84,72,84
main_cp6:
s_mov_b32 s96, main_cp6-main_cp5
v_lshl_add_u64 v[2:3], v[2:3], 0, s[96:97]
global_load_dword v254, v[2:3], off
mF 92,76,84
s_add_u32 m0, s22, 45056
rd 72,1,2048
mF 88,76,80
wl 5
lw 0
mF 96,48,80
rd 76,1,3072
mF 100,48,84
mF 108,52,84
rd 48,1,4096
mF 104,52,80
wl 5
lw 1024
mF 112,56,80
rd 52,1,5120
mF 116,56,84
mF 124,60,84
rd 56,1,6144
mF 120,60,80
wl 5
lw 2048
mF 128,64,80
rd 60,1,7168
mF 132,64,84
s_waitcnt vmcnt(23)
s_barrier
mF 84,68,92
rd 64,1,8192
mF 80,68,88
wl 5
s_mov_b32 exec_hi, 0
lw 3072
s_mov_b32 exec_hi, -1
mF 88,72,88
rd 68,1,9216
mF 92,72,92
mF 100,76,92
rd 72,1,10240
mF 96,76,88
wl 5
lx 156,3072
mF 104,48,88
s_add_u32 s24, s52, 106496
rd 76,1,11264
mF 108,48,92
mF 116,52,92
rd 48,1,12288
mF 112,52,88
wl 5
lx 160,0
mF 120,56,88
rd 52,1,13312
mF 124,56,92
mF 132,60,92
rd 56,1,14336
mF 128,60,88
s_waitcnt vmcnt(25) lgkmcnt(5)
lx 164,1024
mF 80,64,96
s_waitcnt vmcnt(25)
s_add_u32 s23, s23, 14336
rd 60,1,15360
mF 84,64,100
mF 92,68,100
s_add_u32 m0, s22, 88064
rd 64,1,16384
mF 88,68,96
wl 5
lw 0
mF 96,72,96
rd 68,1,17408
mF 100,72,100
mF 108,76,100
rd 72,1,18432
mF 104,76,96
wl 5
lw 1024
mF 112,48,96
rd 76,1,19456
mF 116,48,100
mF 124,52,100
rd 48,1,20480
mF 120,52,96
wl 5
lw 2048
mF 128,56,96
rd 52,1,21504
mF 132,56,100
s_waitcnt vmcnt(26)
s_barrier
mF 84,60,108
rd 56,0,30720
mF 80,60,104
wl 5
s_mov_b32 exec_hi, 0
lw 3072
s_mov_b32 exec_hi, -1
mF 88,64,104
rd 60,0,31744
mF 92,64,108
mF 100,68,108
rd 64,0,32768
mF 96,68,104
wl 5
lx 168,2048
mF 104,72,104
rd 68,0,33792
mF 108,72,108
mF 116,76,108
rd 72,0,34816
mF 112,76,104
wl 5
lx 172,3072
mF 120,48,104
s_add_u32 s24, s24, 4096
rd 76,0,35840
mF 124,48,108
mF 132,52,108
rd 48,0,36864
mF 128,52,104
s_waitcnt vmcnt(28) lgkmcnt(5)
lx 176,0
mF 80,56,112
s_waitcnt vmcnt(28)
s_add_u32 s23, s27, 143360
rd 52,0,37888
mF 84,56,116
mF 92,60,116
s_add_u32 m0, s22, 102400
rd 56,0,38912
mF 88,60,112
wl 5
lw 0
mF 96,64,112
rd 60,0,39936
mF 100,64,116
mF 108,68,116
rd 64,0,40960
mF 104,68,112
wl 5
lw 1024
mF 112,72,112
rd 68,0,41984
mF 116,72,116
mF 124,76,116
rd 72,0,43008
mF 120,76,112
wl 5
lw 2048
mF 128,48,112
rd 76,0,44032
mF 132,48,116
s_waitcnt vmcnt(13)
s_barrier
mF 84,52,124
rd 48,0,45056
mF 80,52,120
wl 5
s_mov_b32 exec_hi, 0
lw 3072
s_mov_b32 exec_hi, -1
mF 88,56,120
rd 52,0,46080
mF 92,56,124
mF 100,60,124
rd 56,0,47104
mF 96,60,120
wl 5
lx 180,1024
mF 104,64,120
rd 60,0,48128
mF 108,64,124
mF 116,68,124
rd 64,0,49152
mF 112,68,120
wl 5
lx 184,2048
mF 120,72,120
rd 68,0,50176
mF 124,72,124
mF 132,76,124
rd 72,0,51200
mF 128,76,120
wl 5
lx 188,3072
mF 80,48,128
s_add_u32 s23, s23, 14336
rd 76,0,52224
mF 84,48,132
mF 92,52,132
s_add_u32 m0, s22, 131072
rd 48,0,53248
mF 88,52,128
wl 5
lw 0
mF 96,56,128
rd 52,0,54272
mF 100,56,132
mF 108,60,132
rd 56,0,55296
mF 104,60,128
wl 5
lw 1024
mF 112,64,128
rd 60,0,56320
mF 116,64,132
mF 124,68,132
rd 64,0,57344
mF 120,68,128
wl 5
lw 2048
mF 128,72,128
rd 68,0,58368
mF 132,72,132
s_waitcnt vmcnt(13)
s_barrier
mF 84,76,140
rd 72,1,22528
mF 80,76,136
wl 5
s_mov_b32 exec_hi, 0
lw 3072
s_mov_b32 exec_hi, -1
mF 88,48,136
s_add_u32 s24, s52, 114688
rd 76,1,23552
mF 92,48,140
mF 100,52,140
rd 48,1,24576
mF 96,52,136
wl 5
lx 192,0
mF 104,56,136
rd 52,1,25600
mF 108,56,140
mF 116,60,140
rd 56,1,26624
mF 112,60,136
wl 5
lx 196,1024
mF 120,64,136
rd 60,1,27648
mF 124,64,140
mF 132,68,140
rd 64,1,28672
v_add_f32 v220, v220, v224
mF 128,68,136
wl 5
lx 200,2048
mF 80,72,144
s_add_u32 s23, s27, 172032
rd 68,1,29696
v_add_f32 v221, v221, v225
mF 84,72,148
v_add_f32 v222, v222, v226
v_add_f32 v223, v223, v227
mF 92,76,148
s_add_u32 m0, s22, 145408
rd 72,1,30720
v_add_f32 v228, v228, v232
mF 88,76,144
wl 5
lw 0
mF 96,48,144
rd 76,1,31744
v_add_f32 v229, v229, v233
mF 100,48,148
v_add_f32 v230, v230, v234
v_add_f32 v231, v231, v235
mF 108,52,148
rd 48,1,32768
v_add_f32 v220, v220, v228
mF 104,52,144
wl 5
lw 1024
mF 112,56,144
rd 52,1,33792
v_add_f32 v221, v221, v229
mF 116,56,148
v_add_f32 v222, v222, v230
v_add_f32 v223, v223, v231
mF 124,60,148
rd 56,1,34816
v_permlane32_swap_b32 v220, v222
mF 120,60,144
wl 5
lw 2048
mF 128,64,144
rd 60,1,35840
v_permlane32_swap_b32 v221, v223
mF 132,64,148
s_waitcnt vmcnt(13)
s_barrier
v_add_f32 v220, v220, v222
mF 84,68,156
rd 64,1,36864
v_add_f32 v221, v221, v223
mF 80,68,152
wl 5
s_mov_b32 exec_hi, 0
lw 3072
s_mov_b32 exec_hi, -1
mF 88,72,152
rd 68,1,37888
v_permlane16_swap_b32 v220, v221
mF 92,72,156
v_add_f32 v220, v220, v221
mF 100,76,156
rd 72,1,38912
mF 96,76,152
wl 5
lx 204,3072
mF 104,48,152
s_add_u32 s24, s24, 4096
rd 76,1,39936
mF 108,48,156
ds_write_b32 v13, v220
mF 116,52,156
rd 48,1,40960
mF 112,52,152
wl 6
lx 208,0
mF 120,56,152
rd 52,1,41984
mF 124,56,156
ds_read2_b32 v[224:225], v14 offset0:0 offset1:16
mF 132,60,156
rd 56,1,43008
mF 128,60,152
wl 7
lx 212,1024
mF 80,64,160
s_add_u32 s23, s23, 14336
rd 60,1,44032
mF 84,64,164
ds_read2_b32 v[226:227], v14 offset0:32 offset1:48
mF 92,68,164
s_add_u32 m0, s22, 2048
rd 64,1,45056
mF 88,68,160
wl 8
lw 0
mF 96,72,160
rd 68,1,46080
mF 100,72,164
mF 108,76,164
rd 72,1,47104
mF 104,76,160
wl 7
lw 1024
mF 112,48,160
rd 76,1,48128
mF 116,48,164
wl 4
v_mul_f32 v216, 0xba800000, v224
v_mul_f32 v218, 0xba800000, v226
mF 124,52,164
rd 48,1,49152
v_mul_f32 v225, 0x3a800000, v225
mF 120,52,160
lw 2048
mF 128,56,160
rd 52,1,50176
v_mul_f32 v227, 0x3a800000, v227
mF 132,56,164
s_waitcnt vmcnt(13)
s_barrier
v_fma_f32 v225, -v216, v216, v225
mF 84,60,172
rd 56,29,0
v_fma_f32 v227, -v218, v218, v227
mF 80,60,168
wl 5
s_mov_b32 exec_hi, 0
lw 3072
s_mov_b32 exec_hi, -1
mF 88,64,168
rd 60,29,1024
v_max_f32 v225, 0, v225
mF 92,64,172
v_max_f32 v227, 0, v227
v_add_f32 v225, s44, v225
mF 100,68,172
rd 64,29,2048
v_add_f32 v227, s44, v227
mF 96,68,168
wl 5
lx 216,2048
mF 104,72,168
rd 68,29,3072
mF 108,72,172
v_rsq_f32 v217, v225
mF 116,76,172
rd 72,29,4096
mF 112,76,168
wl 5
lx 220,3072
mF 120,48,168
s_add_u32 s24, s52, 122880
rd 76,29,5120
mF 124,48,172
v_rsq_f32 v219, v227
mF 132,52,172
rd 48,29,6144
mF 128,52,168
wl 5
lx 224,0
mF 80,56,176
s_add_u32 s23, s27, 200704
rd 52,29,7168
mF 84,56,180
ds_write2_b32 v14, v216, v217 offset0:64 offset1:80
mF 92,60,180
s_add_u32 m0, s22, 116736
rd 56,29,8192
mF 88,60,176
wl 6
lw 0
mF 96,64,176
rd 60,29,9216
mF 100,64,180
ds_write2_b32 v14, v218, v219 offset0:96 offset1:112
mF 108,68,180
rd 64,29,10240
mF 104,68,176
wl 7
lw 1024
mF 112,72,176
rd 68,29,11264
mF 116,72,180
rd 200,15,256
mF 124,76,180
rd 72,29,12288
mF 120,76,176
wl 8
lw 2048
mF 128,48,176
rd 76,29,13312
mF 132,48,180
s_waitcnt vmcnt(13)
s_barrier
mF 84,52,188
rd 48,29,14336
mF 80,52,184
wl 7
s_mov_b32 exec_hi, 0
lw 3072
s_mov_b32 exec_hi, -1
mF 88,56,184
rd 52,29,15360
mF 92,56,188
rd 204,15,320
mF 100,60,188
rd 56,29,16384
mF 96,60,184
wl 7
lx 228,1024
mF 104,64,184
rd 60,29,17408
mF 108,64,188
rd 208,15,384
mF 116,68,188
rd 64,29,18432
mF 112,68,184
wl 7
lx 232,2048
mF 120,72,184
rd 68,29,19456
mF 124,72,188
rd 212,15,448
mF 132,76,188
rd 72,29,20480
mF 128,76,184
wl 8
lx 236,3072
mF 80,48,192
s_add_u32 s23, s23, 14336
rd 76,29,21504
mF 84,48,196
mF 92,52,196
s_add_u32 m0, s22, 16384
rd 48,29,22528
mF 88,52,192
wl 7
lw 0
mF 96,56,192
rd 52,29,23552
mF 100,56,196
ds_read_b32 v244, v11 offset:768
mF 108,60,196
rd 56,29,24576
mF 104,60,192
wl 7
lw 1024
mF 112,64,192
rd 60,29,25600
mF 116,64,196
ds_read_b32 v245, v11 offset:832
mF 124,68,196
rd 64,29,26624
mF 120,68,192
wl 7
lw 2048
mF 128,72,192
rd 68,29,27648
mF 132,72,196
s_waitcnt vmcnt(13)
s_barrier
mF 84,76,204
rd 72,0,2048
mF 80,76,200
wl 7
s_mov_b32 exec_hi, 0
lw 3072
s_mov_b32 exec_hi, -1
mF 88,48,200
s_add_u32 s24, s24, 4096
rd 76,0,3072
mF 92,48,204
ds_read_b32 v246, v11 offset:896
mF 100,52,204
rd 48,0,4096
mF 96,52,200
wl 7
lx 240,0
mF 104,56,200
rd 52,0,5120
mF 108,56,204
ds_read_b32 v247, v11 offset:960
mF 116,60,204
rd 56,0,6144
mF 112,60,200
wl 7
lx 244,1024
mF 120,64,200
rd 60,0,7168
mF 124,64,204
ds_read_b32 v248, v11 offset:1024
mF 132,68,204
rd 64,0,8192
mF 128,68,200
wl 8
lx 248,2048
mF 80,72,208
s_add_u32 s23, s27, 229376
rd 68,0,9216
mF 84,72,212
ds_read_b32 v249, v11 offset:1088
mF 92,76,212
s_add_u32 m0, s22, 59392
rd 72,0,10240
mF 88,76,208
wl 8
lw 0
mF 96,48,208
rd 76,0,11264
mF 100,48,212
ds_read_b32 v250, v11 offset:1152
mF 108,52,212
rd 48,0,12288
mF 104,52,208
wl 8
lw 1024
mF 112,56,208
rd 52,0,13312
mF 116,56,212
mF 124,60,212
rd 56,0,14336
mF 120,60,208
wl 7
lw 2048
mF 128,64,208
rd 60,0,15360
mF 132,64,212
s_waitcnt vmcnt(13)
s_barrier
mF 84,68,220
rd 64,1,51200
mF 80,68,216
wl 6
s_mov_b32 exec_hi, 0
lw 3072
s_mov_b32 exec_hi, -1
mF 88,72,216
rd 68,1,52224
mF 92,72,220
mF 100,76,220
rd 72,1,53248
mF 96,76,216
wl 5
lx 252,3072
mF 104,48,216
rd 76,1,54272
mF 108,48,220
mF 116,52,220
rd 48,1,55296
mF 112,52,216
wl 5
mF 120,56,216
rd 52,1,56320
mF 124,56,220
mF 132,60,220
rd 56,1,57344
mF 128,60,216
wl 5
mF 80,64,224
s_waitcnt vmcnt(14)
s_add_u32 s23, s23, 14336
rd 60,1,58368
mF 84,64,228
mF 92,68,228
s_add_u32 m0, s22, 73728
rd 64,1,59392
mF 88,68,224
wl 5
lw 0
mF 96,72,224
rd 68,1,60416
mF 100,72,228
main_cp7:
s_mov_b32 s96, main_cp7-main_cp6
v_lshl_add_u64 v[2:3], v[2:3], 0, s[96:97]
global_load_dword v254, v[2:3], off
mF 108,76,228
rd 72,1,61440
mF 104,76,224
wl 5
lw 1024
mF 112,48,224
rd 76,1,62464
mF 116,48,228
mF 124,52,228
rd 48,1,63488
mF 120,52,224
wl 5
lw 2048
mF 128,56,224
rd 52,1,64512
mF 132,56,228
s_waitcnt vmcnt(12)
s_barrier
mF 84,60,236
rd 56,0,16384
mF 80,60,232
wl 5
s_mov_b32 exec_hi, 0
lw 3072
s_mov_b32 exec_hi, -1
mF 88,64,232
rd 60,0,17408
mF 92,64,236
mF 100,68,236
rd 64,0,18432
mF 96,68,232
wl 5
mF 104,72,232
rd 68,0,19456
mF 108,72,236
mF 116,76,236
rd 72,0,20480
mF 112,76,232
wl 5
mF 120,48,232
rd 76,0,21504
mF 124,48,236
mF 132,52,236
rd 48,0,22528
mF 128,52,232
s_waitcnt vmcnt(12) lgkmcnt(5)
mF 80,56,240
s_waitcnt vmcnt(11)
s_add_u32 s23, s27, 258048
rd 52,0,23552
mF 84,56,244
mF 92,60,244
s_add_u32 m0, s22, 30720
rd 56,0,24576
mF 88,60,240
wl 5
lw 0
mF 96,64,240
rd 60,0,25600
mF 100,64,244
mF 108,68,244
rd 64,0,26624
mF 104,68,240
wl 5
lw 1024
mF 112,72,240
rd 68,0,27648
mF 116,72,244
mF 124,76,244
rd 72,0,28672
mF 120,76,240
wl 5
buffer_store_dwordx4 v[168:171], v0, s[4:7], s100 offen offset:0 sc1
mF 128,48,240
rd 76,0,29696
mF 132,48,244
s_waitcnt vmcnt(8)
s_barrier
mF 84,52,252
rd 48,0,59392
mF 80,52,248
wl 5
lw 2048
mF 88,56,248
rd 52,0,60416
mF 92,56,252
mF 100,60,252
rd 56,0,61440
mF 96,60,248
wl 5
buffer_store_dwordx4 v[172:175], v0, s[4:7], s100 offen offset:1024 sc1
mF 104,64,248
rd 60,0,62464
mF 108,64,252
s_mov_b32 exec_hi, 0
lw 3072
s_mov_b32 exec_hi, -1
mF 116,68,252
rd 64,0,63488
mF 112,68,248
wl 5
mF 120,72,248
rd 68,0,64512
mF 124,72,252
mF 132,76,252
rd 72,1,0
mF 128,76,248
buffer_store_dwordx4 v[176:179], v0, s[4:7], s100 offen offset:2048 sc1
v_pk_fma_f32 v[80:81], v[200:201], v[244:245], v[80:81] op_sel_hi:[1,0,1]
v_pk_fma_f32 v[82:83], v[202:203], v[244:245], v[82:83] op_sel_hi:[1,0,1]
v_pk_fma_f32 v[84:85], v[208:209], v[244:245], v[84:85] op_sel_hi:[1,0,1]
v_pk_fma_f32 v[86:87], v[210:211], v[244:245], v[86:87] op_sel_hi:[1,0,1]
v_pk_mul_f32 v[80:81], v[80:81], v[204:205]
v_pk_mul_f32 v[82:83], v[82:83], v[206:207]
v_pk_mul_f32 v[84:85], v[84:85], v[212:213]
v_pk_mul_f32 v[86:87], v[86:87], v[214:215]
v_pk_mul_f32 v[220:221], v[80:81], v[80:81]
v_pk_mul_f32 v[222:223], v[82:83], v[82:83]
v_pk_mul_f32 v[224:225], v[84:85], v[84:85]
v_pk_mul_f32 v[226:227], v[86:87], v[86:87]
v_pk_fma_f32 v[220:221], v[220:221], s[42:43], v[30:31] op_sel:[0,1,0] op_sel_hi:[1,1,0]
v_pk_fma_f32 v[222:223], v[222:223], s[42:43], v[30:31] op_sel:[0,1,0] op_sel_hi:[1,1,0]
v_pk_fma_f32 v[224:225], v[224:225], s[42:43], v[30:31] op_sel:[0,1,0] op_sel_hi:[1,1,0]
v_pk_fma_f32 v[226:227], v[226:227], s[42:43], v[30:31] op_sel:[0,1,0] op_sel_hi:[1,1,0]
v_pk_mul_f32 v[220:221], v[220:221], v[80:81]
v_pk_mul_f32 v[222:223], v[222:223], v[82:83]
v_pk_mul_f32 v[224:225], v[224:225], v[84:85]
v_pk_mul_f32 v[226:227], v[226:227], v[86:87]
s_add_u32 s23, s23, 14336
s_add_u32 m0, s22, 45056
s_nop 0
lw 0
v_exp_f32 v220, v220
v_exp_f32 v221, v221
v_exp_f32 v222, v222
v_exp_f32 v223, v223
v_exp_f32 v224, v224
v_exp_f32 v225, v225
v_exp_f32 v226, v226
v_exp_f32 v227, v227
v_pk_add_f32 v[220:221], v[220:221], 1.0 op_sel_hi:[1,0]
v_pk_add_f32 v[222:223], v[222:223], 1.0 op_sel_hi:[1,0]
v_pk_add_f32 v[224:225], v[224:225], 1.0 op_sel_hi:[1,0]
v_pk_add_f32 v[226:227], v[226:227], 1.0 op_sel_hi:[1,0]
lw 1024
v_rcp_f32 v220, v220
v_rcp_f32 v221, v221
v_rcp_f32 v222, v222
v_rcp_f32 v223, v223
v_rcp_f32 v224, v224
v_rcp_f32 v225, v225
v_rcp_f32 v226, v226
v_rcp_f32 v227, v227
v_pk_mul_f32 v[80:81], v[80:81], v[220:221]
v_pk_mul_f32 v[82:83], v[82:83], v[222:223]
v_pk_mul_f32 v[84:85], v[84:85], v[224:225]
v_pk_mul_f32 v[86:87], v[86:87], v[226:227]
lw 2048
v_pk_mul_f32 v[228:229], v[80:81], 1.0 op_sel_hi:[1,0]
v_pk_mul_f32 v[232:233], v[80:81], v[80:81]
v_pk_mul_f32 v[230:231], v[82:83], 1.0 op_sel_hi:[1,0]
v_pk_mul_f32 v[234:235], v[82:83], v[82:83]
v_pk_mul_f32 v[236:237], v[84:85], 1.0 op_sel_hi:[1,0]
v_pk_mul_f32 v[240:241], v[84:85], v[84:85]
v_pk_mul_f32 v[238:239], v[86:87], 1.0 op_sel_hi:[1,0]
v_pk_mul_f32 v[242:243], v[86:87], v[86:87]
v_pk_fma_f32 v[88:89], v[200:201], v[244:245], v[88:89] op_sel:[0,1,0]
v_pk_fma_f32 v[90:91], v[202:203], v[244:245], v[90:91] op_sel:[0,1,0]
v_pk_fma_f32 v[92:93], v[208:209], v[244:245], v[92:93] op_sel:[0,1,0]
v_pk_fma_f32 v[94:95], v[210:211], v[244:245], v[94:95] op_sel:[0,1,0]
v_pk_mul_f32 v[88:89], v[88:89], v[204:205]
v_pk_mul_f32 v[90:91], v[90:91], v[206:207]
v_pk_mul_f32 v[92:93], v[92:93], v[212:213]
v_pk_mul_f32 v[94:95], v[94:95], v[214:215]
v_pk_mul_f32 v[220:221], v[88:89], v[88:89]
v_pk_mul_f32 v[222:223], v[90:91], v[90:91]
v_pk_mul_f32 v[224:225], v[92:93], v[92:93]
v_pk_mul_f32 v[226:227], v[94:95], v[94:95]
s_mov_b32 exec_hi, 0
lw 3072
s_mov_b32 exec_hi, -1
v_pk_fma_f32 v[220:221], v[220:221], s[42:43], v[30:31] op_sel:[0,1,0] op_sel_hi:[1,1,0]
v_pk_fma_f32 v[222:223], v[222:223], s[42:43], v[30:31] op_sel:[0,1,0] op_sel_hi:[1,1,0]
v_pk_fma_f32 v[224:225], v[224:225], s[42:43], v[30:31] op_sel:[0,1,0] op_sel_hi:[1,1,0]
v_pk_fma_f32 v[226:227], v[226:227], s[42:43], v[30:31] op_sel:[0,1,0] op_sel_hi:[1,1,0]
v_pk_mul_f32 v[220:221], v[220:221], v[88:89]
v_pk_mul_f32 v[222:223], v[222:223], v[90:91]
v_pk_mul_f32 v[224:225], v[224:225], v[92:93]
v_pk_mul_f32 v[226:227], v[226:227], v[94:95]
v_exp_f32 v220, v220
v_exp_f32 v221, v221
v_exp_f32 v222, v222
v_exp_f32 v223, v223
v_exp_f32 v224, v224
v_exp_f32 v225, v225
s_add_u32 s23, s27, 286720
s_add_u32 m0, s22, 88064
s_nop 0
lw 0
v_exp_f32 v226, v226
v_exp_f32 v227, v227
v_pk_add_f32 v[220:221], v[220:221], 1.0 op_sel_hi:[1,0]
v_pk_add_f32 v[222:223], v[222:223], 1.0 op_sel_hi:[1,0]
v_pk_add_f32 v[224:225], v[224:225], 1.0 op_sel_hi:[1,0]
v_pk_add_f32 v[226:227], v[226:227], 1.0 op_sel_hi:[1,0]
v_rcp_f32 v220, v220
v_rcp_f32 v221, v221
v_rcp_f32 v222, v222
v_rcp_f32 v223, v223
v_rcp_f32 v224, v224
v_rcp_f32 v225, v225
lw 1024
v_rcp_f32 v226, v226
v_rcp_f32 v227, v227
v_pk_mul_f32 v[88:89], v[88:89], v[220:221]
v_pk_mul_f32 v[90:91], v[90:91], v[222:223]
v_pk_mul_f32 v[92:93], v[92:93], v[224:225]
v_pk_mul_f32 v[94:95], v[94:95], v[226:227]
v_pk_add_f32 v[228:229], v[228:229], v[88:89]
v_pk_fma_f32 v[232:233], v[88:89], v[88:89], v[232:233]
v_pk_add_f32 v[230:231], v[230:231], v[90:91]
v_pk_fma_f32 v[234:235], v[90:91], v[90:91], v[234:235]
v_pk_add_f32 v[236:237], v[236:237], v[92:93]
v_pk_fma_f32 v[240:241], v[92:93], v[92:93], v[240:241]
v_pk_add_f32 v[238:239], v[238:239], v[94:95]
v_pk_fma_f32 v[242:243], v[94:95], v[94:95], v[242:243]
v_pk_fma_f32 v[96:97], v[200:201], v[246:247], v[96:97] op_sel_hi:[1,0,1]
v_pk_fma_f32 v[98:99], v[202:203], v[246:247], v[98:99] op_sel_hi:[1,0,1]
v_pk_fma_f32 v[100:101], v[208:209], v[246:247], v[100:101] op_sel_hi:[1,0,1]
v_pk_fma_f32 v[102:103], v[210:211], v[246:247], v[102:103] op_sel_hi:[1,0,1]
lw 2048
v_pk_mul_f32 v[96:97], v[96:97], v[204:205]
v_pk_mul_f32 v[98:99], v[98:99], v[206:207]
v_pk_mul_f32 v[100:101], v[100:101], v[212:213]
v_pk_mul_f32 v[102:103], v[102:103], v[214:215]
v_pk_mul_f32 v[220:221], v[96:97], v[96:97]
v_pk_mul_f32 v[222:223], v[98:99], v[98:99]
v_pk_mul_f32 v[224:225], v[100:101], v[100:101]
v_pk_mul_f32 v[226:227], v[102:103], v[102:103]
v_pk_fma_f32 v[220:221], v[220:221], s[42:43], v[30:31] op_sel:[0,1,0] op_sel_hi:[1,1,0]
v_pk_fma_f32 v[222:223], v[222:223], s[42:43], v[30:31] op_sel:[0,1,0] op_sel_hi:[1,1,0]
v_pk_fma_f32 v[224:225], v[224:225], s[42:43], v[30:31] op_sel:[0,1,0] op_sel_hi:[1,1,0]
v_pk_fma_f32 v[226:227], v[226:227], s[42:43], v[30:31] op_sel:[0,1,0] op_sel_hi:[1,1,0]
v_pk_mul_f32 v[220:221], v[220:221], v[96:97]
v_pk_mul_f32 v[222:223], v[222:223], v[98:99]
v_pk_mul_f32 v[224:225], v[224:225], v[100:101]
v_pk_mul_f32 v[226:227], v[226:227], v[102:103]
v_exp_f32 v220, v220
v_exp_f32 v221, v221
s_mov_b32 exec_hi, 0
lw 3072
s_mov_b32 exec_hi, -1
v_exp_f32 v222, v222
v_exp_f32 v223, v223
v_exp_f32 v224, v224
v_exp_f32 v225, v225
v_exp_f32 v226, v226
v_exp_f32 v227, v227
v_pk_add_f32 v[220:221], v[220:221], 1.0 op_sel_hi:[1,0]
v_pk_add_f32 v[222:223], v[222:223], 1.0 op_sel_hi:[1,0]
v_pk_add_f32 v[224:225], v[224:225], 1.0 op_sel_hi:[1,0]
v_pk_add_f32 v[226:227], v[226:227], 1.0 op_sel_hi:[1,0]
v_rcp_f32 v220, v220
v_rcp_f32 v221, v221
s_add_u32 s23, s23, 14336
s_add_u32 m0, s22, 102400
s_nop 0
lw 0
v_rcp_f32 v222, v222
v_rcp_f32 v223, v223
v_rcp_f32 v224, v224
v_rcp_f32 v225, v225
v_rcp_f32 v226, v226
v_rcp_f32 v227, v227
v_pk_mul_f32 v[96:97], v[96:97], v[220:221]
v_pk_mul_f32 v[98:99], v[98:99], v[222:223]
v_pk_mul_f32 v[100:101], v[100:101], v[224:225]
v_pk_mul_f32 v[102:103], v[102:103], v[226:227]
v_pk_add_f32 v[228:229], v[228:229], v[96:97]
v_pk_fma_f32 v[232:233], v[96:97], v[96:97], v[232:233]
v_pk_add_f32 v[230:231], v[230:231], v[98:99]
v_pk_fma_f32 v[234:235], v[98:99], v[98:99], v[234:235]
lw 1024
v_pk_add_f32 v[236:237], v[236:237], v[100:101]
v_pk_fma_f32 v[240:241], v[100:101], v[100:101], v[240:241]
v_pk_add_f32 v[238:239], v[238:239], v[102:103]
v_pk_fma_f32 v[242:243], v[102:103], v[102:103], v[242:243]
v_pk_fma_f32 v[104:105], v[200:201], v[246:247], v[104:105] op_sel:[0,1,0]
v_pk_fma_f32 v[106:107], v[202:203], v[246:247], v[106:107] op_sel:[0,1,0]
v_pk_fma_f32 v[108:109], v[208:209], v[246:247], v[108:109] op_sel:[0,1,0]
v_pk_fma_f32 v[110:111], v[210:211], v[246:247], v[110:111] op_sel:[0,1,0]
v_pk_mul_f32 v[104:105], v[104:105], v[204:205]
v_pk_mul_f32 v[106:107], v[106:107], v[206:207]
v_pk_mul_f32 v[108:109], v[108:109], v[212:213]
v_pk_mul_f32 v[110:111], v[110:111], v[214:215]
v_pk_mul_f32 v[220:221], v[104:105], v[104:105]
v_pk_mul_f32 v[222:223], v[106:107], v[106:107]
v_pk_mul_f32 v[224:225], v[108:109], v[108:109]
v_pk_mul_f32 v[226:227], v[110:111], v[110:111]
v_pk_fma_f32 v[220:221], v[220:221], s[42:43], v[30:31] op_sel:[0,1,0] op_sel_hi:[1,1,0]
v_pk_fma_f32 v[222:223], v[222:223], s[42:43], v[30:31] op_sel:[0,1,0] op_sel_hi:[1,1,0]
v_pk_fma_f32 v[224:225], v[224:225], s[42:43], v[30:31] op_sel:[0,1,0] op_sel_hi:[1,1,0]
v_pk_fma_f32 v[226:227], v[226:227], s[42:43], v[30:31] op_sel:[0,1,0] op_sel_hi:[1,1,0]
lw 2048
v_pk_mul_f32 v[220:221], v[220:221], v[104:105]
v_pk_mul_f32 v[222:223], v[222:223], v[106:107]
v_pk_mul_f32 v[224:225], v[224:225], v[108:109]
v_pk_mul_f32 v[226:227], v[226:227], v[110:111]
v_exp_f32 v220, v220
v_exp_f32 v221, v221
v_exp_f32 v222, v222
v_exp_f32 v223, v223
v_exp_f32 v224, v224
v_exp_f32 v225, v225
v_exp_f32 v226, v226
v_exp_f32 v227, v227
s_mov_b32 exec_hi, 0
lw 3072
s_mov_b32 exec_hi, -1
v_pk_add_f32 v[220:221], v[220:221], 1.0 op_sel_hi:[1,0]
v_pk_add_f32 v[222:223], v[222:223], 1.0 op_sel_hi:[1,0]
v_pk_add_f32 v[224:225], v[224:225], 1.0 op_sel_hi:[1,0]
v_pk_add_f32 v[226:227], v[226:227], 1.0 op_sel_hi:[1,0]
v_rcp_f32 v220, v220
v_rcp_f32 v221, v221
v_rcp_f32 v222, v222
v_rcp_f32 v223, v223
v_rcp_f32 v224, v224
v_rcp_f32 v225, v225
v_rcp_f32 v226, v226
v_rcp_f32 v227, v227
s_add_u32 s23, s27, 315392
s_add_u32 m0, s22, 131072
s_nop 0
lw 0
v_pk_mul_f32 v[104:105], v[104:105], v[220:221]
v_pk_mul_f32 v[106:107], v[106:107], v[222:223]
v_pk_mul_f32 v[108:109], v[108:109], v[224:225]
v_pk_mul_f32 v[110:111], v[110:111], v[226:227]
v_pk_add_f32 v[228:229], v[228:229], v[104:105]
v_pk_fma_f32 v[232:233], v[104:105], v[104:105], v[232:233]
v_pk_add_f32 v[230:231], v[230:231], v[106:107]
v_pk_fma_f32 v[234:235], v[106:107], v[106:107], v[234:235]
v_pk_add_f32 v[236:237], v[236:237], v[108:109]
v_pk_fma_f32 v[240:241], v[108:109], v[108:109], v[240:241]
v_pk_add_f32 v[238:239], v[238:239], v[110:111]
v_pk_fma_f32 v[242:243], v[110:111], v[110:111], v[242:243]
v_pk_fma_f32 v[112:113], v[200:201], v[248:249], v[112:113] op_sel_hi:[1,0,1]
v_pk_fma_f32 v[114:115], v[202:203], v[248:249], v[114:115] op_sel_hi:[1,0,1]
v_pk_fma_f32 v[116:117], v[208:209], v[248:249], v[116:117] op_sel_hi:[1,0,1]
v_pk_fma_f32 v[118:119], v[210:211], v[248:249], v[118:119] op_sel_hi:[1,0,1]
v_pk_mul_f32 v[112:113], v[112:113], v[204:205]
v_pk_mul_f32 v[114:115], v[114:115], v[206:207]
v_pk_mul_f32 v[116:117], v[116:117], v[212:213]
v_pk_mul_f32 v[118:119], v[118:119], v[214:215]
lw 1024
v_pk_mul_f32 v[220:221], v[112:113], v[112:113]
v_pk_mul_f32 v[222:223], v[114:115], v[114:115]
v_pk_mul_f32 v[224:225], v[116:117], v[116:117]
v_pk_mul_f32 v[226:227], v[118:119], v[118:119]
v_pk_fma_f32 v[220:221], v[220:221], s[42:43], v[30:31] op_sel:[0,1,0] op_sel_hi:[1,1,0]
v_pk_fma_f32 v[222:223], v[222:223], s[42:43], v[30:31] op_sel:[0,1,0] op_sel_hi:[1,1,0]
v_pk_fma_f32 v[224:225], v[224:225], s[42:43], v[30:31] op_sel:[0,1,0] op_sel_hi:[1,1,0]
v_pk_fma_f32 v[226:227], v[226:227], s[42:43], v[30:31] op_sel:[0,1,0] op_sel_hi:[1,1,0]
v_pk_mul_f32 v[220:221], v[220:221], v[112:113]
v_pk_mul_f32 v[222:223], v[222:223], v[114:115]
v_pk_mul_f32 v[224:225], v[224:225], v[116:117]
v_pk_mul_f32 v[226:227], v[226:227], v[118:119]
v_exp_f32 v220, v220
v_exp_f32 v221, v221
v_exp_f32 v222, v222
v_exp_f32 v223, v223
lw 2048
v_exp_f32 v224, v224
v_exp_f32 v225, v225
v_exp_f32 v226, v226
v_exp_f32 v227, v227
v_pk_add_f32 v[220:221], v[220:221], 1.0 op_sel_hi:[1,0]
v_pk_add_f32 v[222:223], v[222:223], 1.0 op_sel_hi:[1,0]
v_pk_add_f32 v[224:225], v[224:225], 1.0 op_sel_hi:[1,0]
v_pk_add_f32 v[226:227], v[226:227], 1.0 op_sel_hi:[1,0]
v_rcp_f32 v220, v220
v_rcp_f32 v221, v221
v_rcp_f32 v222, v222
v_rcp_f32 v223, v223
s_mov_b32 exec_hi, 0
lw 3072
s_mov_b32 exec_hi, -1
v_rcp_f32 v224, v224
v_rcp_f32 v225, v225
v_rcp_f32 v226, v226
v_rcp_f32 v227, v227
v_pk_mul_f32 v[112:113], v[112:113], v[220:221]
v_pk_mul_f32 v[114:115], v[114:115], v[222:223]
v_pk_mul_f32 v[116:117], v[116:117], v[224:225]
v_pk_mul_f32 v[118:119], v[118:119], v[226:227]
v_pk_add_f32 v[228:229], v[228:229], v[112:113]
v_pk_fma_f32 v[232:233], v[112:113], v[112:113], v[232:233]
v_pk_add_f32 v[230:231], v[230:231], v[114:115]
v_pk_fma_f32 v[234:235], v[114:115], v[114:115], v[234:235]
v_pk_add_f32 v[236:237], v[236:237], v[116:117]
v_pk_fma_f32 v[240:241], v[116:117], v[116:117], v[240:241]
v_pk_add_f32 v[238:239], v[238:239], v[118:119]
v_pk_fma_f32 v[242:243], v[118:119], v[118:119], v[242:243]
s_add_u32 s23, s23, 14336
s_add_u32 m0, s22, 145408
s_nop 0
lw 0
v_pk_fma_f32 v[120:121], v[200:201], v[248:249], v[120:121] op_sel:[0,1,0]
v_pk_fma_f32 v[122:123], v[202:203], v[248:249], v[122:123] op_sel:[0,1,0]
v_pk_fma_f32 v[124:125], v[208:209], v[248:249], v[124:125] op_sel:[0,1,0]
v_pk_fma_f32 v[126:127], v[210:211], v[248:249], v[126:127] op_sel:[0,1,0]
v_pk_mul_f32 v[120:121], v[120:121], v[204:205]
v_pk_mul_f32 v[122:123], v[122:123], v[206:207]
v_pk_mul_f32 v[124:125], v[124:125], v[212:213]
v_pk_mul_f32 v[126:127], v[126:127], v[214:215]
v_pk_mul_f32 v[220:221], v[120:121], v[120:121]
v_pk_mul_f32 v[222:223], v[122:123], v[122:123]
v_pk_mul_f32 v[224:225], v[124:125], v[124:125]
v_pk_mul_f32 v[226:227], v[126:127], v[126:127]
v_pk_fma_f32 v[220:221], v[220:221], s[42:43], v[30:31] op_sel:[0,1,0] op_sel_hi:[1,1,0]
v_pk_fma_f32 v[222:223], v[222:223], s[42:43], v[30:31] op_sel:[0,1,0] op_sel_hi:[1,1,0]
v_pk_fma_f32 v[224:225], v[224:225], s[42:43], v[30:31] op_sel:[0,1,0] op_sel_hi:[1,1,0]
v_pk_fma_f32 v[226:227], v[226:227], s[42:43], v[30:31] op_sel:[0,1,0] op_sel_hi:[1,1,0]
v_pk_mul_f32 v[220:221], v[220:221], v[120:121]
v_pk_mul_f32 v[222:223], v[222:223], v[122:123]
v_pk_mul_f32 v[224:225], v[224:225], v[124:125]
v_pk_mul_f32 v[226:227], v[226:227], v[126:127]
lw 1024
v_exp_f32 v220, v220
v_exp_f32 v221, v221
v_exp_f32 v222, v222
v_exp_f32 v223, v223
v_exp_f32 v224, v224
v_exp_f32 v225, v225
v_exp_f32 v226, v226
v_exp_f32 v227, v227
v_pk_add_f32 v[220:221], v[220:221], 1.0 op_sel_hi:[1,0]
v_pk_add_f32 v[222:223], v[222:223], 1.0 op_sel_hi:[1,0]
v_pk_add_f32 v[224:225], v[224:225], 1.0 op_sel_hi:[1,0]
v_pk_add_f32 v[226:227], v[226:227], 1.0 op_sel_hi:[1,0]
lw 2048
v_rcp_f32 v220, v220
v_rcp_f32 v221, v221
v_rcp_f32 v222, v222
v_rcp_f32 v223, v223
v_rcp_f32 v224, v224
v_rcp_f32 v225, v225
v_rcp_f32 v226, v226
v_rcp_f32 v227, v227
v_pk_mul_f32 v[120:121], v[120:121], v[220:221]
v_pk_mul_f32 v[122:123], v[122:123], v[222:223]
v_pk_mul_f32 v[124:125], v[124:125], v[224:225]
v_pk_mul_f32 v[126:127], v[126:127], v[226:227]
s_mov_b32 exec_hi, 0
lw 3072
s_mov_b32 exec_hi, -1
v_pk_add_f32 v[228:229], v[228:229], v[120:121]
v_pk_fma_f32 v[232:233], v[120:121], v[120:121], v[232:233]
v_pk_add_f32 v[230:231], v[230:231], v[122:123]
v_pk_fma_f32 v[234:235], v[122:123], v[122:123], v[234:235]
v_pk_add_f32 v[236:237], v[236:237], v[124:125]
v_pk_fma_f32 v[240:241], v[124:125], v[124:125], v[240:241]
v_pk_add_f32 v[238:239], v[238:239], v[126:127]
v_pk_fma_f32 v[242:243], v[126:127], v[126:127], v[242:243]
v_pk_fma_f32 v[128:129], v[200:201], v[250:251], v[128:129] op_sel_hi:[1,0,1]
v_pk_fma_f32 v[130:131], v[202:203], v[250:251], v[130:131] op_sel_hi:[1,0,1]
v_pk_fma_f32 v[132:133], v[208:209], v[250:251], v[132:133] op_sel_hi:[1,0,1]
v_pk_fma_f32 v[134:135], v[210:211], v[250:251], v[134:135] op_sel_hi:[1,0,1]
v_pk_mul_f32 v[128:129], v[128:129], v[204:205]
v_pk_mul_f32 v[130:131], v[130:131], v[206:207]
v_pk_mul_f32 v[132:133], v[132:133], v[212:213]
v_pk_mul_f32 v[134:135], v[134:135], v[214:215]
v_pk_mul_f32 v[220:221], v[128:129], v[128:129]
v_pk_mul_f32 v[222:223], v[130:131], v[130:131]
v_pk_mul_f32 v[224:225], v[132:133], v[132:133]
v_pk_mul_f32 v[226:227], v[134:135], v[134:135]
s_add_u32 s23, s27, 344064
s_add_u32 m0, s22, 2048
s_nop 0
lw 0
v_pk_fma_f32 v[220:221], v[220:221], s[42:43], v[30:31] op_sel:[0,1,0] op_sel_hi:[1,1,0]
v_pk_fma_f32 v[222:223], v[222:223], s[42:43], v[30:31] op_sel:[0,1,0] op_sel_hi:[1,1,0]
v_pk_fma_f32 v[224:225], v[224:225], s[42:43], v[30:31] op_sel:[0,1,0] op_sel_hi:[1,1,0]
v_pk_fma_f32 v[226:227], v[226:227], s[42:43], v[30:31] op_sel:[0,1,0] op_sel_hi:[1,1,0]
v_pk_mul_f32 v[220:221], v[220:221], v[128:129]
v_pk_mul_f32 v[222:223], v[222:223], v[130:131]
v_pk_mul_f32 v[224:225], v[224:225], v[132:133]
v_pk_mul_f32 v[226:227], v[226:227], v[134:135]
v_exp_f32 v220, v220
v_exp_f32 v221, v221
v_exp_f32 v222, v222
v_exp_f32 v223, v223
v_exp_f32 v224, v224
v_exp_f32 v225, v225
lw 1024
v_exp_f32 v226, v226
v_exp_f32 v227, v227
v_pk_add_f32 v[220:221], v[220:221], 1.0 op_sel_hi:[1,0]
v_pk_add_f32 v[222:223], v[222:223], 1.0 op_sel_hi:[1,0]
v_pk_add_f32 v[224:225], v[224:225], 1.0 op_sel_hi:[1,0]
v_pk_add_f32 v[226:227], v[226:227], 1.0 op_sel_hi:[1,0]
v_rcp_f32 v220, v220
v_rcp_f32 v221, v221
v_rcp_f32 v222, v222
v_rcp_f32 v223, v223
v_rcp_f32 v224, v224
v_rcp_f32 v225, v225
lw 2048
v_rcp_f32 v226, v226
v_rcp_f32 v227, v227
v_pk_mul_f32 v[128:129], v[128:129], v[220:221]
v_pk_mul_f32 v[130:131], v[130:131], v[222:223]
v_pk_mul_f32 v[132:133], v[132:133], v[224:225]
v_pk_mul_f32 v[134:135], v[134:135], v[226:227]
v_pk_add_f32 v[228:229], v[228:229], v[128:129]
v_pk_fma_f32 v[232:233], v[128:129], v[128:129], v[232:233]
v_pk_add_f32 v[230:231], v[230:231], v[130:131]
v_pk_fma_f32 v[234:235], v[130:131], v[130:131], v[234:235]
v_pk_add_f32 v[236:237], v[236:237], v[132:133]
v_pk_fma_f32 v[240:241], v[132:133], v[132:133], v[240:241]
v_pk_add_f32 v[238:239], v[238:239], v[134:135]
v_pk_fma_f32 v[242:243], v[134:135], v[134:135], v[242:243]
v_add_f32_dpp v228, v228, v228 row_ror:8 row_mask:0xf bank_mask:0x3
v_add_f32_dpp v229, v229, v229 row_ror:8 row_mask:0xf bank_mask:0x3
v_add_f32_dpp v230, v230, v230 row_ror:8 row_mask:0xf bank_mask:0x3
v_add_f32_dpp v231, v231, v231 row_ror:8 row_mask:0xf bank_mask:0x3
s_mov_b32 exec_hi, 0
lw 3072
s_mov_b32 exec_hi, -1
v_add_f32_dpp v232, v232, v232 row_ror:8 row_mask:0xf bank_mask:0x3
v_add_f32_dpp v233, v233, v233 row_ror:8 row_mask:0xf bank_mask:0x3
v_add_f32_dpp v234, v234, v234 row_ror:8 row_mask:0xf bank_mask:0x3
v_add_f32_dpp v235, v235, v235 row_ror:8 row_mask:0xf bank_mask:0x3
v_add_f32_dpp v228, v236, v236 row_ror:8 row_mask:0xf bank_mask:0xc
v_add_f32_dpp v229, v237, v237 row_ror:8 row_mask:0xf bank_mask:0xc
v_add_f32_dpp v230, v238, v238 row_ror:8 row_mask:0xf bank_mask:0xc
v_add_f32_dpp v231, v239, v239 row_ror:8 row_mask:0xf bank_mask:0xc
v_add_f32_dpp v232, v240, v240 row_ror:8 row_mask:0xf bank_mask:0xc
v_add_f32_dpp v233, v241, v241 row_ror:8 row_mask:0xf bank_mask:0xc
v_add_f32_dpp v234, v242, v242 row_ror:8 row_mask:0xf bank_mask:0xc
v_add_f32_dpp v235, v243, v243 row_ror:8 row_mask:0xf bank_mask:0xc
v_add_f32_dpp v236, v228, v228 row_half_mirror row_mask:0xf bank_mask:0x5
v_add_f32_dpp v237, v229, v229 row_half_mirror row_mask:0xf bank_mask:0x5
v_add_f32_dpp v238, v230, v230 row_half_mirror row_mask:0xf bank_mask:0x5
v_add_f32_dpp v239, v231, v231 row_half_mirror row_mask:0xf bank_mask:0x5
v_add_f32_dpp v236, v232, v232 row_half_mirror row_mask:0xf bank_mask:0xa
v_add_f32_dpp v237, v233, v233 row_half_mirror row_mask:0xf bank_mask:0xa
v_add_f32_dpp v238, v234, v234 row_half_mirror row_mask:0xf bank_mask:0xa
v_add_f32_dpp v239, v235, v235 row_half_mirror row_mask:0xf bank_mask:0xa
s_add_u32 s23, s23, 14336
s_add_u32 m0, s22, 116736
s_nop 0
lw 0
v_add_f32_dpp v236, v236, v236 quad_perm:[1,0,3,2] row_mask:0xf bank_mask:0xf
v_add_f32_dpp v237, v237, v237 quad_perm:[1,0,3,2] row_mask:0xf bank_mask:0xf
v_add_f32_dpp v238, v238, v238 quad_perm:[1,0,3,2] row_mask:0xf bank_mask:0xf
v_add_f32_dpp v239, v239, v239 quad_perm:[1,0,3,2] row_mask:0xf bank_mask:0xf
v_add_f32_dpp v236, v236, v236 quad_perm:[2,3,0,1] row_mask:0xf bank_mask:0xf
v_add_f32_dpp v237, v237, v237 quad_perm:[2,3,0,1] row_mask:0xf bank_mask:0xf
v_add_f32_dpp v238, v238, v238 quad_perm:[2,3,0,1] row_mask:0xf bank_mask:0xf
v_add_f32_dpp v239, v239, v239 quad_perm:[2,3,0,1] row_mask:0xf bank_mask:0xf
s_lshl_b32 s37, s17, 8
s_add_u32 s37, s37, s54
s_add_u32 s37, s37, 524288
buffer_store_dwordx4 v[236:239], v28, s[4:7], s37 offen sc1
lw 1024
lw 2048
s_mov_b32 exec_hi, 0
lw 3072
s_mov_b32 exec_hi, -1
wl 5
v_mfma_f32_16x16x32_bf16 v[136:139], v[48:51], a[0:3], 0
rd 76,1,1024
v_mfma_f32_16x16x32_bf16 v[140:143], v[48:51], a[4:7], 0
main_cp8:
s_mov_b32 s96, main_cp8-main_cp7
v_lshl_add_u64 v[2:3], v[2:3], 0, s[96:97]
global_load_dword v254, v[2:3], off
v_mfma_f32_16x16x32_bf16 v[148:151], v[52:55], a[4:7], 0
rd 48,1,2048
v_mfma_f32_16x16x32_bf16 v[144:147], v[52:55], a[0:3], 0
wl 5
v_mfma_f32_16x16x32_bf16 v[152:155], v[56:59], a[0:3], 0
rd 52,1,3072
v_mfma_f32_16x16x32_bf16 v[156:159], v[56:59], a[4:7], 0
v_mfma_f32_16x16x32_bf16 v[164:167], v[60:63], a[4:7], 0
rd 56,1,4096
v_mfma_f32_16x16x32_bf16 v[160:163], v[60:63], a[0:3], 0
wl 5
buffer_store_dwordx4 v[180:183], v0, s[4:7], s100 offen offset:3072 sc1
v_mfma_f32_16x16x32_bf16 v[168:171], v[64:67], a[0:3], 0
rd 60,1,5120
v_mfma_f32_16x16x32_bf16 v[172:175], v[64:67], a[4:7], 0
v_mfma_f32_16x16x32_bf16 v[180:183], v[68:71], a[4:7], 0
rd 64,1,6144
v_mfma_f32_16x16x32_bf16 v[176:179], v[68:71], a[0:3], 0
wl 5
v_mfma_f32_16x16x32_bf16 v[184:187], v[72:75], a[0:3], 0
rd 68,1,7168
v_mfma_f32_16x16x32_bf16 v[188:191], v[72:75], a[4:7], 0
s_waitcnt vmcnt(38)
s_barrier
mT 140,76,12
s_add_u32 s23, s27, 372736
rd 72,1,8192
mT 136,76,8
wl 5
mT 144,48,8
s_add_u32 m0, s22, 16384
rd 76,1,9216
mT 148,48,12
lw 0
mT 156,52,12
rd 48,1,10240
mT 152,52,8
wl 5
mT 160,56,8
rd 52,1,11264
mT 164,56,12
lw 1024
mT 172,60,12
rd 56,1,12288
mT 168,60,8
wl 5
mT 176,64,8
rd 60,1,13312
mT 180,64,12
lw 2048
mT 188,68,12
rd 64,1,14336
mT 184,68,8
wl 5
mT 136,72,16
rd 68,1,15360
mT 140,72,20
s_mov_b32 exec_hi, 0
lw 3072
s_mov_b32 exec_hi, -1
mT 148,76,20
s_max_i32 s24, s76, 0
rd 72,1,16384
mT 144,76,16
wl 5
mT 152,48,16
s_mul_i32 s24, s24, 8192
rd 76,1,17408
mT 156,48,20
mT 164,52,20
s_add_u32 s24, s24, s35
rd 48,1,18432
mT 160,52,16
wl 5
mT 168,56,16
s_add_u32 s24, s24, 0
rd 52,1,19456
mT 172,56,20
lx 0,0
mT 180,60,20
rd 56,1,20480
mT 176,60,16
wl 5
mT 184,64,16
rd 60,1,21504
mT 188,64,20
s_waitcnt vmcnt(37)
s_barrier
mT 140,68,28
rd 64,0,30720
mT 136,68,24
wl 5
lx 4,1024
mT 144,72,24
s_add_u32 s23, s23, 14336
rd 68,0,31744
mT 148,72,28
s_waitcnt vmcnt(6)
s_add_u32 s36, s48, 65536
v_mov_b32 v31, 1
mT 156,76,28
s_add_u32 m0, s22, 59392
rd 72,0,32768
buffer_atomic_add v31, v4, s[4:7], s36 offen sc1
mT 152,76,24
wl 5
lw 0
mT 160,48,24
rd 76,0,33792
mT 164,48,28
mT 172,52,28
rd 48,0,34816
mT 168,52,24
wl 5
lw 1024
mT 176,56,24
rd 52,0,35840
mT 180,56,28
mT 188,60,28
rd 56,0,36864
mT 184,60,24
wl 5
lw 2048
mT 136,64,32
rd 60,0,37888
mT 140,64,36
mT 148,68,36
rd 64,0,38912
mT 144,68,32
wl 5
s_mov_b32 exec_hi, 0
lw 3072
s_mov_b32 exec_hi, -1
mT 152,72,32
rd 68,0,39936
mT 156,72,36
mT 164,76,36
rd 72,0,40960
mT 160,76,32
wl 5
lx 8,2048
mT 168,48,32
rd 76,0,41984
mT 172,48,36
mT 180,52,36
rd 48,0,43008
mT 176,52,32
wl 5
mT 184,56,32
rd 52,0,44032
mT 188,56,36
s_barrier
mT 140,60,44
s_add_u32 s23, s27, 401408
rd 56,0,45056
mT 136,60,40
wl 5
lx 12,3072
v_mov_b32 v31, 0
mT 144,64,40
s_add_u32 m0, s22, 73728
rd 60,0,46080
buffer_atomic_add v31, v4, s[4:7], s36 offen sc0 sc1
mT 148,64,44
lw 0
mT 156,68,44
rd 64,0,47104
mT 152,68,40
wl 5
mT 160,72,40
rd 68,0,48128
mT 164,72,44
mT 172,76,44
rd 72,0,49152
mT 168,76,40
wl 5
lw 1024
mT 176,48,40
rd 76,0,50176
mT 180,48,44
mT 188,52,44
rd 48,0,51200
mT 184,52,40
wl 5
lw 2048
mT 136,56,48
rd 52,0,52224
mT 140,56,52
mT 148,60,52
rd 56,0,53248
mT 144,60,48
wl 5
s_mov_b32 exec_hi, 0
lw 3072
s_mov_b32 exec_hi, -1
mT 152,64,48
s_add_u32 s24, s24, 4096
rd 60,0,54272
mT 156,64,52
mT 164,68,52
rd 64,0,55296
mT 160,68,48
wl 5
lx 16,0
mT 168,72,48
rd 68,0,56320
mT 172,72,52
mT 180,76,52
rd 72,0,57344
mT 176,76,48
wl 5
lx 20,1024
mT 184,48,48
rd 76,0,58368
mT 188,48,52
s_barrier
mT 140,52,60
s_add_u32 s23, s23, 14336
rd 48,1,22528
mT 136,52,56
wl 5
mT 144,56,56
s_add_u32 m0, s22, 30720
rd 52,1,23552
mT 148,56,60
lw 0
mT 156,60,60
rd 56,1,24576
mT 152,60,56
wl 5
mT 160,64,56
s_waitcnt vmcnt(7)
rd 60,1,25600
v_readfirstlane_b32 s46, v31
s_nop 0
s_nop 0
s_cmp_ge_u32 s46, 16
s_cbranch_scc1 main_ok72
s_mov_b32 s47, 0
main_poll71:
v_mov_b32 v31, 0
buffer_atomic_add v31, v4, s[4:7], s36 offen sc0 sc1
s_add_u32 s47, s47, 1
s_cmp_gt_u32 s47, 400000
s_cbranch_scc1 main_ok72
s_waitcnt vmcnt(0)
v_readfirstlane_b32 s46, v31
s_nop 0
s_cmp_lt_u32 s46, 16
s_cbranch_scc1 main_poll71
main_ok72:
mT 164,64,60
lw 1024
s_add_u32 s37, s54, 524288
mT 172,68,60
rd 64,1,26624
buffer_load_dwordx4 v[220:223], v0, s[4:7], s37 offen offset:0 sc1
mT 168,68,56
wl 5
buffer_load_dwordx4 v[224:227], v0, s[4:7], s37 offen offset:1024 sc1
mT 176,72,56
rd 68,1,27648
buffer_load_dwordx4 v[228:231], v0, s[4:7], s37 offen offset:2048 sc1
mT 180,72,60
lw 2048
mT 188,76,60
rd 72,1,28672
buffer_load_dwordx4 v[232:235], v0, s[4:7], s37 offen offset:3072 sc1
mT 184,76,56
wl 5
mT 136,48,64
rd 76,1,29696
mT 140,48,68
s_mov_b32 exec_hi, 0
lw 3072
s_mov_b32 exec_hi, -1
mT 148,52,68
rd 48,1,30720
mT 144,52,64
wl 5
mT 152,56,64
rd 52,1,31744
mT 156,56,68
lx 24,2048
mT 164,60,68
rd 56,1,32768
mT 160,60,64
wl 5
mT 168,64,64
rd 60,1,33792
mT 172,64,68
lx 28,3072
mT 180,68,68
s_mul_i32 s24, s77, 8192
rd 64,1,34816
mT 176,68,64
wl 5
mT 184,72,64
s_add_u32 s24, s24, s35
rd 68,1,35840
mT 188,72,68
s_barrier
mT 140,76,76
s_add_u32 s24, s24, 8192
rd 72,1,36864
mT 136,76,72
wl 5
lx 32,0
mT 144,48,72
s_add_u32 s23, s27, 430080
rd 76,1,37888
mT 148,48,76
mT 156,52,76
s_add_u32 m0, s22, 45056
rd 48,1,38912
mT 152,52,72
wl 5
lw 0
mT 160,56,72
rd 52,1,39936
mT 164,56,76
mT 172,60,76
rd 56,1,40960
mT 168,60,72
wl 5
lw 1024
mT 176,64,72
rd 60,1,41984
mT 180,64,76
mT 188,68,76
rd 64,1,43008
mT 184,68,72
wl 5
lw 2048
mT 136,72,80
rd 68,1,44032
mT 140,72,84
mT 148,76,84
s_waitcnt vmcnt(10)
rd 72,1,45056
v_add_f32 v220, v220, v224
v_add_f32 v221, v221, v225
mT 144,76,80
wl 5
s_mov_b32 exec_hi, 0
lw 3072
s_mov_b32 exec_hi, -1
v_add_f32 v222, v222, v226
mT 152,48,80
s_waitcnt vmcnt(8)
rd 76,1,46080
v_add_f32 v223, v223, v227
v_add_f32 v228, v228, v232
mT 156,48,84
v_add_f32 v229, v229, v233
v_add_f32 v230, v230, v234
v_add_f32 v231, v231, v235
mT 164,52,84
rd 48,1,47104
v_add_f32 v220, v220, v228
v_add_f32 v221, v221, v229
mT 160,52,80
wl 5
lx 36,1024
v_add_f32 v222, v222, v230
mT 168,56,80
rd 52,1,48128
v_add_f32 v223, v223, v231
v_permlane32_swap_b32 v220, v222
mT 172,56,84
v_permlane32_swap_b32 v221, v223
v_add_f32 v220, v220, v222
v_add_f32 v221, v221, v223
mT 180,60,84
rd 56,1,49152
v_permlane16_swap_b32 v220, v221
v_add_f32 v220, v220, v221
mT 176,60,80
wl 5
lx 40,2048
mT 184,64,80
rd 60,1,50176
ds_write_b32 v13, v220
mT 188,64,84
s_barrier
ds_read2_b32 v[224:225], v14 offset0:0 offset1:16
ds_read2_b32 v[226:227], v14 offset0:32 offset1:48
mT 140,68,92
s_add_u32 s23, s23, 14336
rd 64,29,0
mT 136,68,88
wl 8
mT 144,72,88
s_add_u32 m0, s22, 88064
rd 68,29,1024
mT 148,72,92
lw 0
mT 156,76,92
rd 72,29,2048
mT 152,76,88
wl 8
mT 160,48,88
rd 76,29,3072
mT 164,48,92
wl 5
lw 1024
v_mul_f32 v236, 0xba124925, v224
mT 172,52,92
wl 4
rd 48,29,4096
v_mul_f32 v238, 0xba124925, v226
v_mul_f32 v225, 0x3a124925, v225
mT 168,52,88
v_mul_f32 v227, 0x3a124925, v227
v_fma_f32 v225, -v236, v236, v225
v_fma_f32 v227, -v238, v238, v227
mT 176,56,88
rd 52,29,5120
v_max_f32 v225, 0, v225
v_max_f32 v227, 0, v227
mT 180,56,92
lw 2048
v_add_f32 v225, s44, v225
mT 188,60,92
rd 56,29,6144
v_add_f32 v227, s44, v227
mT 184,60,88
wl 5
s_mov_b32 exec_hi, 0
lw 3072
s_mov_b32 exec_hi, -1
mT 136,64,96
rd 60,29,7168
v_rsq_f32 v237, v225
mT 140,64,100
v_rsq_f32 v239, v227
v_mul_f32 v236, v236, v237
mT 148,68,100
rd 64,29,8192
v_mul_f32 v238, v238, v239
mT 144,68,96
wl 5
lx 44,3072
mT 152,72,96
rd 68,29,9216
ds_write2_b32 v14, v236, v237 offset0:64 offset1:80
mT 156,72,100
ds_write2_b32 v14, v238, v239 offset0:96 offset1:112
rd 200,15,256
mT 164,76,100
rd 72,29,10240
rd 204,15,320
rd 208,15,384
mT 160,76,96
wl 10
rd 212,15,448
mT 168,48,96
rd 76,29,11264
mT 172,48,100
mT 180,52,100
rd 48,29,12288
mT 176,52,96
wl 11
mT 184,56,96
rd 52,29,13312
mT 188,56,100
s_barrier
mT 140,60,108
rd 56,29,14336
mT 136,60,104
wl 4
s_mov_b32 s37, s57
v_pk_fma_f32 v[80:81], v[80:81], v[204:205], v[200:201]
v_pk_fma_f32 v[82:83], v[82:83], v[206:207], v[202:203]
v_pk_fma_f32 v[84:85], v[84:85], v[212:213], v[208:209]
v_pk_fma_f32 v[86:87], v[86:87], v[214:215], v[210:211]
v_cvt_pk_bf16_f32 v220, v80, v81
v_cvt_pk_bf16_f32 v221, v82, v83
v_cvt_pk_bf16_f32 v222, v84, v85
v_cvt_pk_bf16_f32 v223, v86, v87
buffer_store_dwordx4 v[220:223], v0, s[4:7], s37 offen offset:0 sc1
mT 144,64,104
rd 60,29,15360
mT 148,64,108
mT 156,68,108
rd 64,29,16384
mT 152,68,104
mT 160,72,104
rd 68,29,17408
mT 164,72,108
wl 5
mT 172,76,108
rd 72,29,18432
mT 168,76,104
mT 176,48,104
rd 76,29,19456
mT 180,48,108
v_pk_fma_f32 v[88:89], v[88:89], v[204:205], v[200:201]
v_pk_fma_f32 v[90:91], v[90:91], v[206:207], v[202:203]
v_pk_fma_f32 v[92:93], v[92:93], v[212:213], v[208:209]
v_pk_fma_f32 v[94:95], v[94:95], v[214:215], v[210:211]
v_cvt_pk_bf16_f32 v224, v88, v89
v_cvt_pk_bf16_f32 v225, v90, v91
v_cvt_pk_bf16_f32 v226, v92, v93
v_cvt_pk_bf16_f32 v227, v94, v95
buffer_store_dwordx4 v[224:227], v0, s[4:7], s37 offen offset:1024 sc1
wl 5
mT 188,52,108
rd 48,29,20480
mT 184,52,104
mT 136,56,112
rd 52,29,21504
mT 140,56,116
wl 5
mT 148,60,116
rd 56,29,22528
mT 144,60,112
mT 152,64,112
rd 60,29,23552
mT 156,64,116
wl 5
mT 164,68,116
rd 64,29,24576
mT 160,68,112
v_pk_fma_f32 v[96:97], v[96:97], v[204:205], v[200:201]
v_pk_fma_f32 v[98:99], v[98:99], v[206:207], v[202:203]
v_pk_fma_f32 v[100:101], v[100:101], v[212:213], v[208:209]
v_pk_fma_f32 v[102:103], v[102:103], v[214:215], v[210:211]
v_cvt_pk_bf16_f32 v228, v96, v97
v_cvt_pk_bf16_f32 v229, v98, v99
v_cvt_pk_bf16_f32 v230, v100, v101
v_cvt_pk_bf16_f32 v231, v102, v103
buffer_store_dwordx4 v[228:231], v0, s[4:7], s37 offen offset:2048 sc1
mT 168,72,112
rd 68,29,25600
mT 172,72,116
wl 5
mT 180,76,116
rd 72,29,26624
mT 176,76,112
mT 184,48,112
rd 76,29,27648
mT 188,48,116
wl 5
s_barrier
mT 140,52,124
rd 48,0,2048
mT 136,52,120
mT 144,56,120
rd 52,0,3072
mT 148,56,124
v_pk_fma_f32 v[104:105], v[104:105], v[204:205], v[200:201]
v_pk_fma_f32 v[106:107], v[106:107], v[206:207], v[202:203]
v_pk_fma_f32 v[108:109], v[108:109], v[212:213], v[208:209]
v_pk_fma_f32 v[110:111], v[110:111], v[214:215], v[210:211]
v_cvt_pk_bf16_f32 v220, v104, v105
v_cvt_pk_bf16_f32 v221, v106, v107
v_cvt_pk_bf16_f32 v222, v108, v109
v_cvt_pk_bf16_f32 v223, v110, v111
buffer_store_dwordx4 v[220:223], v0, s[4:7], s37 offen offset:3072 sc1
s_add_u32 s37, s37, 4096
wl 5
mT 156,60,124
rd 56,0,4096
mT 152,60,120
mT 160,64,120
rd 60,0,5120
mT 164,64,124
wl 5
mT 172,68,124
rd 64,0,6144
mT 168,68,120
mT 176,72,120
rd 68,0,7168
mT 180,72,124
wl 5
mT 188,76,124
rd 72,0,8192
mT 184,76,120
v_pk_fma_f32 v[112:113], v[112:113], v[204:205], v[200:201]
v_pk_fma_f32 v[114:115], v[114:115], v[206:207], v[202:203]
v_pk_fma_f32 v[116:117], v[116:117], v[212:213], v[208:209]
v_pk_fma_f32 v[118:119], v[118:119], v[214:215], v[210:211]
v_cvt_pk_bf16_f32 v224, v112, v113
v_cvt_pk_bf16_f32 v225, v114, v115
v_cvt_pk_bf16_f32 v226, v116, v117
v_cvt_pk_bf16_f32 v227, v118, v119
buffer_store_dwordx4 v[224:227], v0, s[4:7], s37 offen offset:0 sc1
mT 136,48,128
rd 76,0,9216
mT 140,48,132
wl 5
mT 148,52,132
rd 48,0,10240
mT 144,52,128
mT 152,56,128
rd 52,0,11264
mT 156,56,132
wl 5
mT 164,60,132
rd 56,0,12288
mT 160,60,128
mT 168,64,128
rd 60,0,13312
mT 172,64,132
v_pk_fma_f32 v[120:121], v[120:121], v[204:205], v[200:201]
v_pk_fma_f32 v[122:123], v[122:123], v[206:207], v[202:203]
v_pk_fma_f32 v[124:125], v[124:125], v[212:213], v[208:209]
v_pk_fma_f32 v[126:127], v[126:127], v[214:215], v[210:211]
v_cvt_pk_bf16_f32 v228, v120, v121
v_cvt_pk_bf16_f32 v229, v122, v123
v_cvt_pk_bf16_f32 v230, v124, v125
v_cvt_pk_bf16_f32 v231, v126, v127
buffer_store_dwordx4 v[228:231], v0, s[4:7], s37 offen offset:1024 sc1
wl 5
mT 180,68,132
rd 64,0,14336
mT 176,68,128
main_cp9:
s_mov_b32 s96, main_cp9-main_cp8
v_lshl_add_u64 v[2:3], v[2:3], 0, s[96:97]
global_load_dword v254, v[2:3], off
mT 184,72,128
rd 68,0,15360
mT 188,72,132
wl 5
s_barrier
mT 140,76,140
rd 72,1,51200
mT 136,76,136
mT 144,48,136
rd 76,1,52224
mT 148,48,140
wl 5
mT 156,52,140
rd 48,1,53248
mT 152,52,136
v_pk_fma_f32 v[128:129], v[128:129], v[204:205], v[200:201]
v_pk_fma_f32 v[130:131], v[130:131], v[206:207], v[202:203]
v_pk_fma_f32 v[132:133], v[132:133], v[212:213], v[208:209]
v_pk_fma_f32 v[134:135], v[134:135], v[214:215], v[210:211]
v_cvt_pk_bf16_f32 v220, v128, v129
v_cvt_pk_bf16_f32 v221, v130, v131
v_cvt_pk_bf16_f32 v222, v132, v133
v_cvt_pk_bf16_f32 v223, v134, v135
buffer_store_dwordx4 v[220:223], v0, s[4:7], s37 offen offset:2048 sc1
mT 160,56,136
rd 52,1,54272
mT 164,56,140
wl 5
mT 172,60,140
rd 56,1,55296
mT 168,60,136
mT 176,64,136
rd 60,1,56320
mT 180,64,140
wl 5
mT 188,68,140
rd 64,1,57344
mT 184,68,136
mT 136,72,144
rd 68,1,58368
mT 140,72,148
wl 5
mT 148,76,148
rd 72,1,59392
mT 144,76,144
mT 152,48,144
rd 76,1,60416
mT 156,48,148
wl 5
mT 164,52,148
rd 48,1,61440
mT 160,52,144
mT 168,56,144
rd 52,1,62464
mT 172,56,148
wl 5
mT 180,60,148
rd 56,1,63488
mT 176,60,144
mT 184,64,144
rd 60,1,64512
mT 188,64,148
wl 5
s_barrier
mT 140,68,156
rd 64,0,16384
mT 136,68,152
mT 144,72,152
rd 68,0,17408
mT 148,72,156
wl 5
mT 156,76,156
rd 72,0,18432
mT 152,76,152
mT 160,48,152
rd 76,0,19456
mT 164,48,156
wl 5
mT 172,52,156
rd 48,0,20480
mT 168,52,152
mT 176,56,152
s_add_u32 s24, s24, 4096
rd 52,0,21504
mT 180,56,156
wl 5
mT 188,60,156
rd 56,0,22528
mT 184,60,152
lx 48,0
mT 136,64,160
rd 60,0,23552
mT 140,64,164
wl 5
mT 148,68,164
rd 64,0,24576
mT 144,68,160
lx 52,1024
mT 152,72,160
rd 68,0,25600
mT 156,72,164
wl 5
mT 164,76,164
rd 72,0,26624
mT 160,76,160
lx 56,2048
mT 168,48,160
s_waitcnt vmcnt(3)
s_add_u32 s36, s42, 81920
rd 76,0,27648
v_mov_b32 v31, 1
s_barrier
buffer_atomic_add v31, v4, s[4:7], s36 offen sc1
mT 172,48,164
wl 5
mT 180,52,164
rd 48,0,28672
mT 176,52,160
lx 60,3072
mT 184,56,160
s_mul_i32 s24, s78, 8192
rd 52,0,29696
mT 188,56,164
wl 5
s_barrier
mT 140,60,172
s_add_u32 s24, s24, s35
rd 56,0,59392
mT 136,60,168
mT 144,64,168
s_add_u32 s24, s24, 16384
rd 60,0,60416
mT 148,64,172
wl 5
lx 64,0
mT 156,68,172
rd 64,0,61440
mT 152,68,168
mT 160,72,168
rd 68,0,62464
mT 164,72,172
wl 5
lx 68,1024
mT 172,76,172
rd 72,0,63488
mT 168,76,168
mT 176,48,168
rd 76,0,64512
mT 180,48,172
wl 5
lx 72,2048
mT 188,52,172
rd 48,1,0
mT 184,52,168
mT 136,56,176
rd 52,1,1024
mT 140,56,180
wl 5
lx 76,3072
mT 148,60,180
s_add_u32 s24, s24, 4096
rd 56,1,2048
mT 144,60,176
mT 152,64,176
rd 60,1,3072
mT 156,64,180
wl 5
lx 80,0
mT 164,68,180
rd 64,1,4096
mT 160,68,176
mT 168,72,176
rd 68,1,5120
mT 172,72,180
wl 5
lx 84,1024
mT 180,76,180
s_add_u32 s36, s50, 81920
rd 72,1,6144
v_mov_b32 v31, 0
mT 176,76,176
buffer_atomic_add v31, v4, s[4:7], s36 offen sc0 sc1
mT 184,48,176
rd 76,1,7168
mT 188,48,180
wl 5
s_barrier
mT 140,52,188
rd 48,1,8192
mT 136,52,184
lx 88,2048
mT 144,56,184
rd 52,1,9216
mT 148,56,188
wl 5
mT 156,60,188
rd 56,1,10240
mT 152,60,184
lx 92,3072
mT 160,64,184
s_mul_i32 s24, s79, 8192
rd 60,1,11264
mT 164,64,188
wl 5
mT 172,68,188
s_add_u32 s24, s24, s35
rd 64,1,12288
mT 168,68,184
mT 176,72,184
s_add_u32 s24, s24, 24576
rd 68,1,13312
mT 180,72,188
wl 5
lx 96,0
mT 188,76,188
rd 72,1,14336
mT 184,76,184
mT 136,48,192
rd 76,1,15360
mT 140,48,196
wl 5
lx 100,1024
mT 148,52,196
rd 48,1,16384
mT 144,52,192
mT 152,56,192
rd 52,1,17408
mT 156,56,196
wl 5
lx 104,2048
mT 164,60,196
rd 56,1,18432
mT 160,60,192
mT 168,64,192
rd 60,1,19456
mT 172,64,196
wl 5
lx 108,3072
mT 180,68,196
s_add_u32 s24, s24, 4096
rd 64,1,20480
mT 176,68,192
mT 184,72,192
rd 68,1,21504
mT 188,72,196
wl 5
s_barrier
mT 140,76,204
rd 72,0,30720
mT 136,76,200
s_waitcnt vmcnt(6)
lx 112,0
v_readfirstlane_b32 s46, v31
s_nop 0
s_add_u32 s46, s46, s21
s_cmp_ge_u32 s46, 16
s_cbranch_scc1 main_ok74
s_mov_b32 s47, 0
main_poll73:
v_mov_b32 v31, 0
buffer_atomic_add v31, v4, s[4:7], s36 offen sc0 sc1
s_add_u32 s47, s47, 1
s_cmp_gt_u32 s47, 400000
s_cbranch_scc1 main_ok74
s_waitcnt vmcnt(0)
v_readfirstlane_b32 s46, v31
s_nop 0
s_cmp_lt_u32 s46, 16
s_cbranch_scc1 main_poll73
main_ok74:
s_barrier
mT 144,48,200
s_max_i32 s23, s76, 0
rd 76,0,31744
mT 148,48,204
wl 5
mT 156,52,204
s_mul_i32 s23, s23, 28672
rd 48,0,32768
mT 152,52,200
mT 160,56,200
s_add_u32 s23, s23, s73
rd 52,0,33792
mT 164,56,204
wl 5
mT 172,60,204
s_add_u32 s23, s23, 0
rd 56,0,34816
mT 168,60,200
mT 176,64,200
s_add_u32 m0, s22, 102400
rd 60,0,35840
mT 180,64,204
wl 5
lw 0
mT 188,68,204
rd 64,0,36864
mT 184,68,200
mT 136,72,208
rd 68,0,37888
mT 140,72,212
wl 5
lw 1024
mT 148,76,212
rd 72,0,38912
mT 144,76,208
mT 152,48,208
rd 76,0,39936
mT 156,48,212
wl 5
lw 2048
mT 164,52,212
rd 48,0,40960
mT 160,52,208
mT 168,56,208
rd 52,0,41984
mT 172,56,212
wl 5
mT 180,60,212
rd 56,0,43008
mT 176,60,208
s_mov_b32 exec_hi, 0
lw 3072
s_mov_b32 exec_hi, -1
mT 184,64,208
s_add_u32 s23, s23, 14336
rd 60,0,44032
mT 188,64,212
wl 5
s_barrier
mT 140,68,220
s_add_u32 m0, s22, 131072
rd 64,0,45056
mT 136,68,216
lw 0
mT 144,72,216
rd 68,0,46080
mT 148,72,220
wl 5
mT 156,76,220
rd 72,0,47104
mT 152,76,216
lw 1024
mT 160,48,216
rd 76,0,48128
mT 164,48,220
wl 5
mT 172,52,220
rd 48,0,49152
mT 168,52,216
mT 176,56,216
rd 52,0,50176
mT 180,56,220
wl 5
lw 2048
mT 188,60,220
rd 56,0,51200
mT 184,60,216
mT 136,64,224
rd 60,0,52224
mT 140,64,228
wl 5
s_mov_b32 exec_hi, 0
lw 3072
s_mov_b32 exec_hi, -1
mT 148,68,228
rd 64,0,53248
mT 144,68,224
mT 152,72,224
rd 68,0,54272
mT 156,72,228
wl 5
lx 116,1024
mT 164,76,228
rd 72,0,55296
mT 160,76,224
mT 168,48,224
s_mul_i32 s23, s77, 28672
rd 76,0,56320
mT 172,48,228
wl 5
mT 180,52,228
s_add_u32 s23, s23, s73
rd 48,0,57344
mT 176,52,224
mT 184,56,224
s_add_u32 s23, s23, 28672
rd 52,0,58368
mT 188,56,228
wl 5
s_barrier
mT 140,60,236
s_add_u32 m0, s22, 145408
rd 56,1,22528
mT 136,60,232
lw 0
mT 144,64,232
rd 60,1,23552
mT 148,64,236
wl 5
mT 156,68,236
rd 64,1,24576
mT 152,68,232
lw 1024
mT 160,72,232
rd 68,1,25600
mT 164,72,236
wl 5
mT 172,76,236
rd 72,1,26624
mT 168,76,232
lw 2048
mT 176,48,232
rd 76,1,27648
mT 180,48,236
wl 5
mT 188,52,236
rd 48,1,28672
mT 184,52,232
s_mov_b32 exec_hi, 0
lw 3072
s_mov_b32 exec_hi, -1
mT 136,56,240
rd 52,1,29696
mT 140,56,244
wl 5
mT 148,60,244
s_add_u32 s23, s23, 14336
rd 56,1,30720
mT 144,60,240
mT 152,64,240
s_add_u32 m0, s22, 2048
rd 60,1,31744
mT 156,64,244
wl 5
lw 0
mT 164,68,244
rd 64,1,32768
mT 160,68,240
mT 168,72,240
rd 68,1,33792
mT 172,72,244
wl 5
lw 1024
mT 180,76,244
rd 72,1,34816
mT 176,76,240
mT 184,48,240
rd 76,1,35840
mT 188,48,244
s_waitcnt lgkmcnt(5) vmcnt(11)
s_barrier
mT 140,52,252
rd 48,1,36864
mT 136,52,248
lw 2048
mT 144,56,248
rd 52,1,37888
mT 148,56,252
wl 5
mT 156,60,252
rd 56,1,38912
mT 152,60,248
s_mov_b32 exec_hi, 0
lw 3072
s_mov_b32 exec_hi, -1
mT 160,64,248
rd 60,1,39936
mT 164,64,252
wl 5
mT 172,68,252
rd 64,1,40960
mT 168,68,248
lx 120,2048
mT 176,72,248
s_mul_i32 s23, s78, 28672
rd 68,1,41984
mT 180,72,252
wl 5
mT 188,76,252
s_add_u32 s23, s23, s73
rd 72,1,43008
mT 184,76,248
v_mfma_f32_16x16x32_bf16 v[80:83], v[48:51], a[0:3], 0
s_add_u32 s23, s23, 57344
rd 76,1,44032
v_mfma_f32_16x16x32_bf16 v[84:87], v[48:51], a[4:7], 0
wl 5
v_mfma_f32_16x16x32_bf16 v[92:95], v[52:55], a[4:7], 0
s_add_u32 m0, s22, 116736
rd 48,1,45056
v_mfma_f32_16x16x32_bf16 v[88:91], v[52:55], a[0:3], 0
lw 0
v_mfma_f32_16x16x32_bf16 v[96:99], v[56:59], a[0:3], 0
rd 52,1,46080
v_mfma_f32_16x16x32_bf16 v[100:103], v[56:59], a[4:7], 0
wl 5
v_mfma_f32_16x16x32_bf16 v[108:111], v[60:63], a[4:7], 0
rd 56,1,47104
v_mfma_f32_16x16x32_bf16 v[104:107], v[60:63], a[0:3], 0
lw 1024
v_mfma_f32_16x16x32_bf16 v[112:115], v[64:67], a[0:3], 0
rd 60,1,48128
v_mfma_f32_16x16x32_bf16 v[116:119], v[64:67], a[4:7], 0
wl 5
rd 232,12,1216
v_mfma_f32_16x16x32_bf16 v[124:127], v[68:71], a[4:7], 0
rd 64,1,49152
v_mfma_f32_16x16x32_bf16 v[120:123], v[68:71], a[0:3], 0
lw 2048
v_mfma_f32_16x16x32_bf16 v[128:131], v[72:75], a[0:3], 0
rd 68,1,50176
v_mfma_f32_16x16x32_bf16 v[132:135], v[72:75], a[4:7], 0
s_waitcnt lgkmcnt(6) vmcnt(13)
s_barrier
mT 84,76,12
rd 72,29,0
mT 80,76,8
s_mov_b32 exec_hi, 0
lw 3072
s_mov_b32 exec_hi, -1
mT 88,48,8
rd 76,29,1024
mT 92,48,12
wl 6
rd 236,12,1280
mT 100,52,12
s_add_u32 s23, s23, 14336
rd 48,29,2048
mT 96,52,8
mT 104,56,8
s_add_u32 m0, s22, 16384
rd 52,29,3072
mT 108,56,12
wl 7
lw 0
mT 116,60,12
rd 56,29,4096
mT 112,60,8
wl 6
v_fmac_f32 v136, v216, v232
v_fmac_f32 v137, v216, v233
mT 120,64,8
rd 60,29,5120
v_fmac_f32 v138, v216, v234
mT 124,64,12
lw 1024
mT 132,68,12
rd 64,29,6144
v_fmac_f32 v139, v216, v235
mT 128,68,8
wl 6
v_mul_f32 v136, v136, v217
v_mul_f32 v137, v137, v217
mT 80,72,16
rd 68,29,7168
v_mul_f32 v138, v138, v217
mT 84,72,20
lw 2048
mT 92,76,20
rd 72,29,8192
v_mul_f32 v139, v139, v217
mT 88,76,16
wl 5
v_mul_f32 v220, v136, v136
v_mul_f32 v221, v137, v137
mT 96,48,16
rd 76,29,9216
v_mul_f32 v222, v138, v138
mT 100,48,20
v_mul_f32 v223, v139, v139
v_fma_f32 v220, v220, s43, v30
mT 108,52,20
rd 48,29,10240
v_fma_f32 v221, v221, s43, v30
mT 104,52,16
wl 5
s_mov_b32 exec_hi, 0
lw 3072
s_mov_b32 exec_hi, -1
mT 112,56,16
rd 52,29,11264
v_fma_f32 v222, v222, s43, v30
mT 116,56,20
v_fma_f32 v223, v223, s43, v30
v_mul_f32 v220, v220, v136
mT 124,60,20
rd 56,29,12288
v_mul_f32 v221, v221, v137
mT 120,60,16
wl 5
lx 124,3072
mT 128,64,16
s_mul_i32 s23, s79, 28672
rd 60,29,13312
v_mul_f32 v222, v222, v138
mT 132,64,20
s_waitcnt vmcnt(14)
s_barrier
v_mul_f32 v223, v223, v139
mT 84,68,28
s_add_u32 s23, s23, s73
rd 64,29,14336
v_fmac_f32 v140, v218, v232
mT 80,68,24
wl 5
v_exp_f32 v220, v220
mT 88,72,24
s_add_u32 s23, s23, 86016
rd 68,29,15360
v_add_f32 v220, 1.0, v220
mT 92,72,28
v_exp_f32 v221, v221
mT 100,76,28
s_add_u32 m0, s22, 59392
rd 72,29,16384
v_add_f32 v221, 1.0, v221
mT 96,76,24
wl 5
lw 0
mT 104,48,24
rd 76,29,17408
v_fmac_f32 v141, v218, v233
mT 108,48,28
v_exp_f32 v222, v222
mT 116,52,28
rd 48,29,18432
v_add_f32 v222, 1.0, v222
mT 112,52,24
wl 5
lw 1024
mT 120,56,24
rd 52,29,19456
v_fmac_f32 v142, v218, v234
mT 124,56,28
v_exp_f32 v223, v223
mT 132,60,28
rd 56,29,20480
v_add_f32 v223, 1.0, v223
mT 128,60,24
wl 5
lw 2048
mT 80,64,32
rd 60,29,21504
v_fmac_f32 v143, v218, v235
mT 84,64,36
v_rcp_f32 v220, v220
mT 92,68,36
rd 64,29,22528
v_mul_f32 v136, v136, v220
mT 88,68,32
wl 5
s_mov_b32 exec_hi, 0
lw 3072
s_mov_b32 exec_hi, -1
mT 96,72,32
rd 68,29,23552
v_mul_f32 v140, v140, v219
mT 100,72,36
v_rcp_f32 v221, v221
mT 108,76,36
s_add_u32 s23, s23, 14336
rd 72,29,24576
v_mul_f32 v137, v137, v221
mT 104,76,32
wl 5
v_rcp_f32 v222, v222
mT 112,48,32
s_add_u32 m0, s22, 73728
rd 76,29,25600
v_mul_f32 v138, v138, v222
mT 116,48,36
lw 0
mT 124,52,36
rd 48,29,26624
v_mul_f32 v141, v141, v219
mT 120,52,32
wl 5
v_rcp_f32 v223, v223
mT 128,56,32
rd 52,29,27648
v_mul_f32 v139, v139, v223
mT 132,56,36
s_waitcnt vmcnt(15)
s_barrier
v_mul_f32 v142, v142, v219
mT 84,60,44
rd 56,0,2048
v_mul_f32 v143, v143, v219
mT 80,60,40
wl 5
lw 1024
mT 88,64,40
rd 60,0,3072
v_mul_f32 v224, v140, v140
mT 92,64,44
v_mul_f32 v225, v141, v141
v_mul_f32 v226, v142, v142
mT 100,68,44
rd 64,0,4096
v_mul_f32 v227, v143, v143
mT 96,68,40
wl 5
lw 2048
mT 104,72,40
rd 68,0,5120
v_fma_f32 v224, v224, s43, v30
mT 108,72,44
v_fma_f32 v225, v225, s43, v30
v_fma_f32 v226, v226, s43, v30
mT 116,76,44
rd 72,0,6144
v_fma_f32 v227, v227, s43, v30
mT 112,76,40
wl 5
s_mov_b32 exec_hi, 0
lw 3072
s_mov_b32 exec_hi, -1
mT 120,48,40
s_mul_i32 s24, s76, 8192
rd 76,0,7168
v_mul_f32 v224, v224, v140
mT 124,48,44
v_exp_f32 v224, v224
mT 132,52,44
s_add_u32 s24, s24, s35
rd 48,0,8192
v_mul_f32 v225, v225, v141
mT 128,52,40
wl 5
v_exp_f32 v225, v225
mT 80,56,48
s_add_u32 s24, s24, 32768
rd 52,0,9216
v_mul_f32 v226, v226, v142
mT 84,56,52
lx 128,0
mT 92,60,52
s_mul_i32 s23, s76, 28672
rd 56,0,10240
v_mul_f32 v227, v227, v143
mT 88,60,48
wl 5
v_exp_f32 v226, v226
mT 96,64,48
s_add_u32 s23, s23, s73
rd 60,0,11264
v_add_f32 v224, 1.0, v224
mT 100,64,52
v_exp_f32 v227, v227
mT 108,68,52
s_add_u32 s23, s23, 114688
rd 64,0,12288
v_add_f32 v225, 1.0, v225
mT 104,68,48
wl 5
v_rcp_f32 v224, v224
mT 112,72,48
s_add_u32 m0, s22, 30720
rd 68,0,13312
v_add_f32 v226, 1.0, v226
mT 116,72,52
lw 0
mT 124,76,52
rd 72,0,14336
v_add_f32 v227, 1.0, v227
mT 120,76,48
wl 5
v_rcp_f32 v225, v225
mT 128,48,48
rd 76,0,15360
v_mul_f32 v140, v140, v224
mT 132,48,52
s_waitcnt vmcnt(15)
s_barrier
v_mul_f32 v141, v141, v225
mT 84,52,60
rd 48,1,51200
v_fmac_f32 v144, v216, v236
mT 80,52,56
wl 5
lw 1024
mT 88,56,56
rd 52,1,52224
v_fmac_f32 v145, v216, v237
mT 92,56,60
v_rcp_f32 v226, v226
mT 100,60,60
rd 56,1,53248
v_mul_f32 v142, v142, v226
mT 96,60,56
wl 5
lw 2048
mT 104,64,56
rd 60,1,54272
v_fmac_f32 v146, v216, v238
mT 108,64,60
v_rcp_f32 v227, v227
mT 116,68,60
rd 64,1,55296
v_mul_f32 v143, v143, v227
mT 112,68,56
wl 5
s_mov_b32 exec_hi, 0
lw 3072
s_mov_b32 exec_hi, -1
mT 120,72,56
rd 68,1,56320
v_fmac_f32 v147, v216, v239
mT 124,72,60
v_mul_f32 v144, v144, v217
main_cp10:
s_mov_b32 s96, main_cp10-main_cp9
v_lshl_add_u64 v[2:3], v[2:3], 0, s[96:97]
global_load_dword v254, v[2:3], off
v_mul_f32 v145, v145, v217
mT 132,76,60
rd 72,1,57344
v_mul_f32 v146, v146, v217
mT 128,76,56
wl 5
lx 132,1024
mT 80,48,64
s_add_u32 s23, s23, 14336
rd 76,1,58368
v_mul_f32 v147, v147, v217
mT 84,48,68
v_mul_f32 v228, v144, v144
v_mul_f32 v229, v145, v145
mT 92,52,68
s_add_u32 m0, s22, 45056
rd 48,1,59392
v_mul_f32 v230, v146, v146
mT 88,52,64
wl 5
lw 0
mT 96,56,64
rd 52,1,60416
v_mul_f32 v231, v147, v147
mT 100,56,68
v_fma_f32 v228, v228, s43, v30
v_fma_f32 v229, v229, s43, v30
mT 108,60,68
rd 56,1,61440
v_fma_f32 v230, v230, s43, v30
mT 104,60,64
wl 5
v_fma_f32 v231, v231, s43, v30
v_mul_f32 v228, v228, v144
mT 112,64,64
rd 60,1,62464
v_mul_f32 v229, v229, v145
mT 116,64,68
lw 1024
mT 124,68,68
rd 64,1,63488
v_mul_f32 v230, v230, v146
mT 120,68,64
wl 5
v_exp_f32 v228, v228
mT 128,72,64
rd 68,1,64512
v_mul_f32 v231, v231, v147
mT 132,72,68
s_waitcnt vmcnt(18)
s_barrier
v_add_f32 v228, 1.0, v228
mT 84,76,76
rd 72,0,16384
v_fmac_f32 v148, v218, v236
mT 80,76,72
wl 5
lw 2048
mT 88,48,72
rd 76,0,17408
v_fmac_f32 v149, v218, v237
mT 92,48,76
v_exp_f32 v229, v229
mT 100,52,76
rd 48,0,18432
v_add_f32 v229, 1.0, v229
mT 96,52,72
wl 5
s_mov_b32 exec_hi, 0
lw 3072
s_mov_b32 exec_hi, -1
mT 104,56,72
rd 52,0,19456
v_fmac_f32 v150, v218, v238
mT 108,56,76
v_exp_f32 v230, v230
mT 116,60,76
rd 56,0,20480
v_add_f32 v230, 1.0, v230
mT 112,60,72
wl 5
lx 136,2048
mT 120,64,72
rd 60,0,21504
v_fmac_f32 v151, v218, v239
mT 124,64,76
v_exp_f32 v231, v231
mT 132,68,76
rd 64,0,22528
v_add_f32 v231, 1.0, v231
mT 128,68,72
wl 5
lx 140,3072
mT 80,72,80
s_add_u32 s24, s24, 4096
rd 68,0,23552
v_mul_f32 v148, v148, v219
mT 84,72,84
v_rcp_f32 v228, v228
mT 92,76,84
rd 72,0,24576
v_mul_f32 v144, v144, v228
mT 88,76,80
wl 5
lx 144,0
mT 96,48,80
rd 76,0,25600
v_mul_f32 v149, v149, v219
mT 100,48,84
v_rcp_f32 v229, v229
mT 108,52,84
rd 48,0,26624
v_mul_f32 v145, v145, v229
mT 104,52,80
wl 5
v_rcp_f32 v230, v230
mT 112,56,80
rd 52,0,27648
v_mul_f32 v146, v146, v230
mT 116,56,84
lx 148,1024
mT 124,60,84
s_mul_i32 s23, s77, 28672
rd 56,0,28672
v_mul_f32 v150, v150, v219
mT 120,60,80
wl 5
v_rcp_f32 v231, v231
mT 128,64,80
s_add_u32 s23, s23, s73
rd 60,0,29696
v_mul_f32 v147, v147, v231
mT 132,64,84
s_waitcnt vmcnt(19)
s_barrier
v_mul_f32 v151, v151, v219
mT 84,68,92
s_add_u32 s23, s23, 143360
rd 64,0,59392
v_mul_f32 v220, v148, v148
mT 80,68,88
wl 5
v_mul_f32 v221, v149, v149
v_mul_f32 v222, v150, v150
mT 88,72,88
s_add_u32 m0, s22, 88064
rd 68,0,60416
v_mul_f32 v223, v151, v151
mT 92,72,92
lw 0
mT 100,76,92
rd 72,0,61440
v_fma_f32 v220, v220, s43, v30
mT 96,76,88
wl 5
v_fma_f32 v221, v221, s43, v30
v_fma_f32 v222, v222, s43, v30
mT 104,48,88
rd 76,0,62464
v_fma_f32 v223, v223, s43, v30
mT 108,48,92
lw 1024
mT 116,52,92
rd 48,0,63488
v_mul_f32 v220, v220, v148
mT 112,52,88
wl 5
v_exp_f32 v220, v220
mT 120,56,88
rd 52,0,64512
v_mul_f32 v221, v221, v149
mT 124,56,92
lw 2048
mT 132,60,92
rd 56,1,0
v_mul_f32 v222, v222, v150
mT 128,60,88
wl 5
v_exp_f32 v221, v221
mT 80,64,96
rd 60,1,1024
v_mul_f32 v223, v223, v151
mT 84,64,100
s_mov_b32 exec_hi, 0
lw 3072
s_mov_b32 exec_hi, -1
mT 92,68,100
rd 64,1,2048
v_add_f32 v220, 1.0, v220
mT 88,68,96
wl 5
v_exp_f32 v222, v222
mT 96,72,96
rd 68,1,3072
v_add_f32 v221, 1.0, v221
mT 100,72,100
lx 152,2048
mT 108,76,100
rd 72,1,4096
v_add_f32 v222, 1.0, v222
mT 104,76,96
wl 5
v_exp_f32 v223, v223
mT 112,48,96
rd 76,1,5120
v_add_f32 v223, 1.0, v223
mT 116,48,100
lx 156,3072
mT 124,52,100
rd 48,1,6144
mT 120,52,96
wl 5
v_rcp_f32 v220, v220
mT 128,56,96
s_mul_i32 s24, s77, 8192
rd 52,1,7168
v_mul_f32 v148, v148, v220
mT 132,56,100
s_waitcnt vmcnt(21)
s_barrier
mT 84,60,108
s_add_u32 s24, s24, s35
rd 56,1,8192
mT 80,60,104
wl 5
v_rcp_f32 v221, v221
mT 88,64,104
s_add_u32 s24, s24, 40960
rd 60,1,9216
v_mul_f32 v149, v149, v221
mT 92,64,108
lx 160,0
mT 100,68,108
rd 64,1,10240
mT 96,68,104
wl 5
v_rcp_f32 v222, v222
mT 104,72,104
rd 68,1,11264
v_mul_f32 v150, v150, v222
mT 108,72,108
lx 164,1024
mT 116,76,108
s_add_u32 s23, s23, 14336
rd 72,1,12288
mT 112,76,104
wl 5
v_rcp_f32 v223, v223
mT 120,48,104
s_add_u32 m0, s22, 102400
rd 76,1,13312
v_mul_f32 v151, v151, v223
mT 124,48,108
lw 0
mT 132,52,108
rd 48,1,14336
mT 128,52,104
wl 5
rd 232,12,1344
mT 80,56,112
rd 52,1,15360
mT 84,56,116
lw 1024
mT 92,60,116
rd 56,1,16384
mT 88,60,112
wl 6
rd 236,12,1408
mT 96,64,112
rd 60,1,17408
mT 100,64,116
lw 2048
mT 108,68,116
rd 64,1,18432
mT 104,68,112
wl 7
mT 112,72,112
rd 68,1,19456
mT 116,72,116
s_mov_b32 exec_hi, 0
lw 3072
s_mov_b32 exec_hi, -1
mT 124,76,116
wl 6
rd 72,1,20480
v_fmac_f32 v152, v216, v232
mT 120,76,112
v_fmac_f32 v153, v216, v233
v_fmac_f32 v154, v216, v234
mT 128,48,112
rd 76,1,21504
v_fmac_f32 v155, v216, v235
mT 132,48,116
s_waitcnt lgkmcnt(6) vmcnt(22)
s_barrier
v_mul_f32 v152, v152, v217
mT 84,52,124
rd 48,0,30720
v_mul_f32 v153, v153, v217
mT 80,52,120
lx 168,2048
mT 88,56,120
rd 52,0,31744
v_mul_f32 v154, v154, v217
mT 92,56,124
wl 5
v_mul_f32 v155, v155, v217
v_mul_f32 v224, v152, v152
mT 100,60,124
rd 56,0,32768
v_mul_f32 v225, v153, v153
mT 96,60,120
lx 172,3072
mT 104,64,120
s_add_u32 s24, s24, 4096
rd 60,0,33792
v_mul_f32 v226, v154, v154
mT 108,64,124
wl 5
v_mul_f32 v227, v155, v155
v_fma_f32 v224, v224, s43, v30
mT 116,68,124
rd 64,0,34816
v_fma_f32 v225, v225, s43, v30
mT 112,68,120
lx 176,0
mT 120,72,120
rd 68,0,35840
v_fma_f32 v226, v226, s43, v30
mT 124,72,124
wl 5
v_fma_f32 v227, v227, s43, v30
v_mul_f32 v224, v224, v152
mT 132,76,124
rd 72,0,36864
v_mul_f32 v225, v225, v153
mT 128,76,120
lx 180,1024
mT 80,48,128
s_waitcnt vmcnt(24)
s_mul_i32 s23, s78, 28672
rd 76,0,37888
v_mul_f32 v226, v226, v154
mT 84,48,132
wl 5
v_exp_f32 v224, v224
mT 92,52,132
s_add_u32 s23, s23, s73
rd 48,0,38912
v_mul_f32 v227, v227, v155
mT 88,52,128
v_exp_f32 v225, v225
mT 96,56,128
s_add_u32 s23, s23, 172032
rd 52,0,39936
v_add_f32 v224, 1.0, v224
mT 100,56,132
wl 5
v_exp_f32 v226, v226
mT 108,60,132
s_add_u32 m0, s22, 131072
rd 56,0,40960
v_add_f32 v225, 1.0, v225
mT 104,60,128
lw 0
mT 112,64,128
rd 60,0,41984
v_add_f32 v226, 1.0, v226
mT 116,64,132
wl 5
v_exp_f32 v227, v227
mT 124,68,132
rd 64,0,43008
v_add_f32 v227, 1.0, v227
mT 120,68,128
lw 1024
mT 128,72,128
rd 68,0,44032
v_fmac_f32 v156, v218, v232
mT 132,72,132
s_waitcnt vmcnt(20) lgkmcnt(5)
s_barrier
v_fmac_f32 v157, v218, v233
mT 84,76,140
rd 72,0,45056
v_fmac_f32 v158, v218, v234
mT 80,76,136
lw 2048
mT 88,48,136
rd 76,0,46080
v_fmac_f32 v159, v218, v235
mT 92,48,140
wl 5
v_rcp_f32 v224, v224
mT 100,52,140
rd 48,0,47104
v_mul_f32 v152, v152, v224
mT 96,52,136
s_mov_b32 exec_hi, 0
lw 3072
s_mov_b32 exec_hi, -1
mT 104,56,136
rd 52,0,48128
v_mul_f32 v156, v156, v219
mT 108,56,140
wl 5
v_rcp_f32 v225, v225
mT 116,60,140
rd 56,0,49152
v_mul_f32 v153, v153, v225
mT 112,60,136
lx 184,2048
mT 120,64,136
rd 60,0,50176
v_mul_f32 v157, v157, v219
mT 124,64,140
wl 5
v_rcp_f32 v226, v226
mT 132,68,140
rd 64,0,51200
v_mul_f32 v154, v154, v226
mT 128,68,136
s_waitcnt vmcnt(22)
lx 188,3072
mT 80,72,144
s_waitcnt vmcnt(22)
s_add_u32 s23, s23, 14336
rd 68,0,52224
v_mul_f32 v158, v158, v219
mT 84,72,148
wl 5
v_rcp_f32 v227, v227
mT 92,76,148
s_add_u32 m0, s22, 145408
rd 72,0,53248
v_mul_f32 v155, v155, v227
mT 88,76,144
lw 0
mT 96,48,144
rd 76,0,54272
v_mul_f32 v159, v159, v219
mT 100,48,148
wl 5
v_mul_f32 v228, v156, v156
v_mul_f32 v229, v157, v157
mT 108,52,148
s_mul_i32 s24, s78, 8192
rd 48,0,55296
v_mul_f32 v230, v158, v158
mT 104,52,144
v_mul_f32 v231, v159, v159
v_fma_f32 v228, v228, s43, v30
mT 112,56,144
s_add_u32 s24, s24, s35
rd 52,0,56320
v_fma_f32 v229, v229, s43, v30
mT 116,56,148
wl 5
v_fma_f32 v230, v230, s43, v30
v_fma_f32 v231, v231, s43, v30
mT 124,60,148
s_add_u32 s24, s24, 49152
rd 56,0,57344
v_mul_f32 v228, v228, v156
mT 120,60,144
lx 192,0
mT 128,64,144
rd 60,0,58368
v_mul_f32 v229, v229, v157
mT 132,64,148
s_waitcnt vmcnt(18) lgkmcnt(5)
s_barrier
v_mul_f32 v230, v230, v158
mT 84,68,156
rd 64,1,22528
v_mul_f32 v231, v231, v159
mT 80,68,152
lx 196,1024
mT 88,72,152
rd 68,1,23552
v_fmac_f32 v160, v216, v236
mT 92,72,156
wl 5
v_exp_f32 v228, v228
mT 100,76,156
rd 72,1,24576
v_add_f32 v228, 1.0, v228
mT 96,76,152
lw 1024
mT 104,48,152
rd 76,1,25600
v_fmac_f32 v161, v216, v237
mT 108,48,156
wl 5
v_exp_f32 v229, v229
mT 116,52,156
rd 48,1,26624
v_add_f32 v229, 1.0, v229
mT 112,52,152
lw 2048
mT 120,56,152
rd 52,1,27648
v_fmac_f32 v162, v216, v238
mT 124,56,156
wl 5
v_exp_f32 v230, v230
mT 132,60,156
rd 56,1,28672
v_add_f32 v230, 1.0, v230
mT 128,60,152
s_waitcnt vmcnt(20)
s_mov_b32 exec_hi, 0
lw 3072
s_mov_b32 exec_hi, -1
mT 80,64,160
s_waitcnt vmcnt(20)
rd 60,1,29696
v_fmac_f32 v163, v216, v239
mT 84,64,164
wl 5
v_exp_f32 v231, v231
mT 92,68,164
rd 64,1,30720
v_add_f32 v231, 1.0, v231
mT 88,68,160
lx 200,2048
mT 96,72,160
rd 68,1,31744
v_mul_f32 v160, v160, v217
mT 100,72,164
wl 5
v_rcp_f32 v228, v228
mT 108,76,164
rd 72,1,32768
v_mul_f32 v156, v156, v228
mT 104,76,160
lx 204,3072
mT 112,48,160
s_add_u32 s24, s24, 4096
rd 76,1,33792
v_mul_f32 v161, v161, v217
mT 116,48,164
wl 5
v_rcp_f32 v229, v229
mT 124,52,164
rd 48,1,34816
v_mul_f32 v157, v157, v229
mT 120,52,160
lx 208,0
mT 128,56,160
rd 52,1,35840
v_mul_f32 v162, v162, v217
mT 132,56,164
s_waitcnt vmcnt(17) lgkmcnt(5)
s_barrier
v_mul_f32 v163, v163, v217
mT 84,60,172
rd 56,1,36864
v_mul_f32 v220, v160, v160
mT 80,60,168
lx 212,1024
mT 88,64,168
rd 60,1,37888
v_mul_f32 v221, v161, v161
mT 92,64,172
wl 5
v_rcp_f32 v230, v230
mT 100,68,172
s_min_i32 s23, s79, 0
rd 64,1,38912
v_mul_f32 v158, v158, v230
mT 96,68,168
v_rcp_f32 v231, v231
mT 104,72,168
s_mul_i32 s23, s23, 28672
rd 68,1,39936
v_mul_f32 v159, v159, v231
mT 108,72,172
wl 5
v_mul_f32 v222, v162, v162
v_mul_f32 v223, v163, v163
mT 116,76,172
s_add_u32 s23, s23, s73
rd 72,1,40960
v_fma_f32 v220, v220, s43, v30
mT 112,76,168
v_fma_f32 v221, v221, s43, v30
v_fma_f32 v222, v222, s43, v30
mT 120,48,168
s_add_u32 s23, s23, 200704
rd 76,1,41984
v_fma_f32 v223, v223, s43, v30
mT 124,48,172
wl 5
v_mul_f32 v220, v220, v160
v_mul_f32 v221, v221, v161
mT 132,52,172
s_add_u32 m0, s22, 2048
rd 48,1,43008
v_mul_f32 v222, v222, v162
mT 128,52,168
s_waitcnt vmcnt(17)
lw 0
mT 80,56,176
s_waitcnt vmcnt(17)
rd 52,1,44032
v_mul_f32 v223, v223, v163
mT 84,56,180
wl 5
lw 1024
mT 92,60,180
rd 56,1,45056
v_fmac_f32 v164, v218, v236
mT 88,60,176
v_exp_f32 v220, v220
mT 96,64,176
rd 60,1,46080
v_add_f32 v220, 1.0, v220
mT 100,64,180
wl 5
lw 2048
mT 108,68,180
rd 64,1,47104
v_fmac_f32 v165, v218, v237
mT 104,68,176
v_exp_f32 v221, v221
mT 112,72,176
rd 68,1,48128
v_add_f32 v221, 1.0, v221
mT 116,72,180
wl 5
s_mov_b32 exec_hi, 0
lw 3072
s_mov_b32 exec_hi, -1
mT 124,76,180
rd 72,1,49152
v_fmac_f32 v166, v218, v238
mT 120,76,176
v_exp_f32 v222, v222
mT 128,48,176
rd 76,1,50176
v_add_f32 v222, 1.0, v222
mT 132,48,180
s_waitcnt vmcnt(14) lgkmcnt(5)
s_barrier
v_fmac_f32 v167, v218, v239
mT 84,52,188
rd 48,29,0
v_mul_f32 v164, v164, v219
mT 80,52,184
lx 216,2048
mT 88,56,184
rd 52,29,1024
v_mul_f32 v165, v165, v219
mT 92,56,188
wl 5
lx 220,3072
mT 100,60,188
s_add_u32 s23, s23, 14336
rd 56,29,2048
v_mul_f32 v166, v166, v219
mT 96,60,184
v_exp_f32 v223, v223
mT 104,64,184
s_add_u32 m0, s22, 116736
rd 60,29,3072
v_add_f32 v223, 1.0, v223
mT 108,64,188
wl 5
lw 0
mT 116,68,188
s_min_i32 s24, s79, 0
rd 64,29,4096
v_mul_f32 v167, v167, v219
mT 112,68,184
v_rcp_f32 v220, v220
mT 120,72,184
s_mul_i32 s24, s24, 8192
rd 68,29,5120
v_mul_f32 v160, v160, v220
mT 124,72,188
wl 5
v_rcp_f32 v221, v221
mT 132,76,188
s_add_u32 s24, s24, s35
rd 72,29,6144
v_mul_f32 v161, v161, v221
mT 128,76,184
s_waitcnt vmcnt(15)
v_rcp_f32 v222, v222
mT 80,48,192
s_waitcnt vmcnt(14)
s_add_u32 s24, s24, 57344
rd 76,29,7168
v_mul_f32 v162, v162, v222
mT 84,48,196
wl 5
lx 224,0
mT 92,52,196
rd 48,29,8192
v_mul_f32 v224, v164, v164
mT 88,52,192
lx 228,1024
mT 96,56,192
rd 52,29,9216
v_mul_f32 v225, v165, v165
mT 100,56,196
wl 5
v_rcp_f32 v223, v223
mT 108,60,196
rd 56,29,10240
v_mul_f32 v163, v163, v223
mT 104,60,192
lw 1024
mT 112,64,192
rd 60,29,11264
v_mul_f32 v226, v166, v166
mT 116,64,196
v_mul_f32 v227, v167, v167
main_cp11:
s_mov_b32 s96, main_cp11-main_cp10
v_lshl_add_u64 v[2:3], v[2:3], 0, s[96:97]
global_load_dword v254, v[2:3], off
v_fma_f32 v224, v224, s43, v30
wl 5
mT 124,68,196
rd 64,29,12288
v_fma_f32 v225, v225, s43, v30
mT 120,68,192
lw 2048
mT 128,72,192
rd 68,29,13312
v_fma_f32 v226, v226, s43, v30
mT 132,72,196
s_waitcnt vmcnt(14) lgkmcnt(5)
s_barrier
v_fma_f32 v227, v227, s43, v30
mT 84,76,204
rd 72,29,14336
v_mul_f32 v224, v224, v164
mT 80,76,200
s_mov_b32 exec_hi, 0
lw 3072
s_mov_b32 exec_hi, -1
mT 88,48,200
rd 76,29,15360
v_mul_f32 v225, v225, v165
mT 92,48,204
wl 5
v_exp_f32 v224, v224
mT 100,52,204
rd 48,29,16384
v_mul_f32 v226, v226, v166
mT 96,52,200
lx 232,2048
mT 104,56,200
rd 52,29,17408
v_mul_f32 v227, v227, v167
mT 108,56,204
wl 5
v_exp_f32 v225, v225
mT 116,60,204
rd 56,29,18432
v_add_f32 v224, 1.0, v224
mT 112,60,200
lx 236,3072
mT 120,64,200
s_add_u32 s24, s24, 4096
rd 60,29,19456
v_add_f32 v225, 1.0, v225
mT 124,64,204
wl 5
v_exp_f32 v226, v226
mT 132,68,204
rd 64,29,20480
v_add_f32 v226, 1.0, v226
mT 128,68,200
s_waitcnt vmcnt(16)
lx 240,0
mT 80,72,208
s_waitcnt vmcnt(16)
rd 68,29,21504
mT 84,72,212
wl 5
v_exp_f32 v227, v227
mT 92,76,212
s_max_i32 s23, s76, 0
rd 72,29,22528
v_add_f32 v227, 1.0, v227
mT 88,76,208
lx 244,1024
mT 96,48,208
s_mul_i32 s23, s23, 28672
rd 76,29,23552
mT 100,48,212
wl 5
v_rcp_f32 v224, v224
mT 108,52,212
s_add_u32 s23, s23, s28
rd 48,29,24576
v_mul_f32 v164, v164, v224
mT 104,52,208
v_rcp_f32 v225, v225
mT 112,56,208
s_add_u32 s23, s23, 0
rd 52,29,25600
v_mul_f32 v165, v165, v225
mT 116,56,212
wl 5
v_rcp_f32 v226, v226
mT 124,60,212
s_add_u32 m0, s22, 16384
rd 56,29,26624
v_mul_f32 v166, v166, v226
mT 120,60,208
lw 0
mT 128,64,208
rd 60,29,27648
mT 132,64,212
s_waitcnt vmcnt(12) lgkmcnt(5)
s_barrier
mT 84,68,220
rd 64,0,2048
mT 80,68,216
lw 1024
mT 88,72,216
rd 68,0,3072
mT 92,72,220
wl 5
lw 2048
mT 100,76,220
rd 72,0,4096
mT 96,76,216
s_mov_b32 exec_hi, 0
lw 3072
s_mov_b32 exec_hi, -1
mT 104,48,216
rd 76,0,5120
mT 108,48,220
wl 5
v_rcp_f32 v227, v227
mT 116,52,220
rd 48,0,6144
v_mul_f32 v167, v167, v227
mT 112,52,216
lx 248,2048
mT 120,56,216
rd 52,0,7168
mT 124,56,220
wl 5
lx 252,3072
mT 132,60,220
s_add_u32 s23, s23, 14336
rd 56,0,8192
mT 128,60,216
s_waitcnt vmcnt(15)
rd 232,12,1472
mT 80,64,224
s_waitcnt vmcnt(14)
s_add_u32 m0, s22, 59392
rd 60,0,9216
mT 84,64,228
wl 6
lw 0
mT 92,68,228
rd 64,0,10240
mT 88,68,224
rd 236,12,1536
mT 96,72,224
rd 68,0,11264
mT 100,72,228
wl 7
lw 1024
mT 108,76,228
rd 72,0,12288
mT 104,76,224
mT 112,48,224
rd 76,0,13312
mT 116,48,228
wl 6
v_fmac_f32 v168, v216, v232
v_fmac_f32 v169, v216, v233
mT 124,52,228
rd 48,0,14336
v_fmac_f32 v170, v216, v234
mT 120,52,224
lw 2048
mT 128,56,224
rd 52,0,15360
v_fmac_f32 v171, v216, v235
mT 132,56,228
s_waitcnt vmcnt(11) lgkmcnt(6)
s_barrier
v_mul_f32 v168, v168, v217
mT 84,60,236
rd 56,1,51200
v_mul_f32 v169, v169, v217
mT 80,60,232
s_mov_b32 exec_hi, 0
lw 3072
s_mov_b32 exec_hi, -1
mT 88,64,232
s_mul_i32 s23, s77, 28672
rd 60,1,52224
v_mul_f32 v170, v170, v217
mT 92,64,236
wl 5
v_mul_f32 v171, v171, v217
v_mul_f32 v228, v168, v168
mT 100,68,236
s_add_u32 s23, s23, s28
rd 64,1,53248
v_mul_f32 v229, v169, v169
mT 96,68,232
v_mul_f32 v230, v170, v170
v_mul_f32 v231, v171, v171
mT 104,72,232
s_add_u32 s23, s23, 28672
rd 68,1,54272
v_fma_f32 v228, v228, s43, v30
mT 108,72,236
wl 5
v_fma_f32 v229, v229, s43, v30
v_fma_f32 v230, v230, s43, v30
mT 116,76,236
s_add_u32 m0, s22, 73728
rd 72,1,55296
v_fma_f32 v231, v231, s43, v30
mT 112,76,232
lw 0
mT 120,48,232
rd 76,1,56320
v_mul_f32 v228, v228, v168
mT 124,48,236
wl 5
v_exp_f32 v228, v228
mT 132,52,236
rd 48,1,57344
v_mul_f32 v229, v229, v169
mT 128,52,232
s_waitcnt vmcnt(12)
lw 1024
mT 80,56,240
s_waitcnt vmcnt(12)
rd 52,1,58368
v_mul_f32 v230, v230, v170
mT 84,56,244
wl 5
v_exp_f32 v229, v229
mT 92,60,244
rd 56,1,59392
v_mul_f32 v231, v231, v171
mT 88,60,240
lw 2048
mT 96,64,240
rd 60,1,60416
v_add_f32 v228, 1.0, v228
mT 100,64,244
wl 5
v_exp_f32 v230, v230
mT 108,68,244
rd 64,1,61440
v_add_f32 v229, 1.0, v229
mT 104,68,240
v_exp_f32 v231, v231
mT 112,72,240
rd 68,1,62464
v_add_f32 v230, 1.0, v230
mT 116,72,244
wl 5
s_mov_b32 exec_hi, 0
lw 3072
s_mov_b32 exec_hi, -1
mT 124,76,244
s_add_u32 s23, s23, 14336
rd 72,1,63488
v_add_f32 v231, 1.0, v231
mT 120,76,240
v_rcp_f32 v228, v228
mT 128,48,240
s_add_u32 m0, s22, 30720
rd 76,1,64512
v_mul_f32 v168, v168, v228
mT 132,48,244
s_waitcnt vmcnt(8) lgkmcnt(5)
s_barrier
v_fmac_f32 v172, v218, v232
mT 84,52,252
rd 48,0,16384
v_fmac_f32 v173, v218, v233
mT 80,52,248
lw 0
mT 88,56,248
rd 52,0,17408
v_fmac_f32 v174, v218, v234
mT 92,56,252
wl 5
v_rcp_f32 v229, v229
mT 100,60,252
rd 56,0,18432
v_mul_f32 v169, v169, v229
mT 96,60,248
lw 1024
mT 104,64,248
rd 60,0,19456
v_fmac_f32 v175, v218, v235
mT 108,64,252
wl 5
v_rcp_f32 v230, v230
mT 116,68,252
rd 64,0,20480
v_mul_f32 v170, v170, v230
mT 112,68,248
lw 2048
mT 120,72,248
rd 68,0,21504
v_mul_f32 v172, v172, v219
mT 124,72,252
wl 5
v_rcp_f32 v231, v231
mT 132,76,252
rd 72,0,22528
v_mul_f32 v171, v171, v231
mT 128,76,248
s_mov_b32 exec_hi, 0
lw 3072
s_mov_b32 exec_hi, -1
s_mul_i32 s23, s78, 28672
s_add_u32 s23, s23, s28
s_add_u32 s23, s23, 57344
s_add_u32 m0, s22, 45056
s_nop 0
lw 0
v_cvt_pk_bf16_f32 v200, v80, v81
v_cvt_pk_bf16_f32 v201, v82, v83
v_cvt_pk_bf16_f32 v202, v88, v89
v_cvt_pk_bf16_f32 v203, v90, v91
v_cvt_pk_bf16_f32 v204, v84, v85
v_cvt_pk_bf16_f32 v205, v86, v87
v_cvt_pk_bf16_f32 v206, v92, v93
v_cvt_pk_bf16_f32 v207, v94, v95
v_cvt_pk_bf16_f32 v208, v96, v97
v_cvt_pk_bf16_f32 v209, v98, v99
v_cvt_pk_bf16_f32 v210, v104, v105
v_cvt_pk_bf16_f32 v211, v106, v107
v_cvt_pk_bf16_f32 v212, v100, v101
v_cvt_pk_bf16_f32 v213, v102, v103
v_cvt_pk_bf16_f32 v214, v108, v109
v_cvt_pk_bf16_f32 v215, v110, v111
v_cvt_pk_bf16_f32 v240, v112, v113
v_cvt_pk_bf16_f32 v241, v114, v115
v_cvt_pk_bf16_f32 v242, v120, v121
v_cvt_pk_bf16_f32 v243, v122, v123
v_cvt_pk_bf16_f32 v244, v116, v117
v_cvt_pk_bf16_f32 v245, v118, v119
v_cvt_pk_bf16_f32 v246, v124, v125
v_cvt_pk_bf16_f32 v247, v126, v127
v_cvt_pk_bf16_f32 v248, v128, v129
v_cvt_pk_bf16_f32 v249, v130, v131
v_cvt_pk_bf16_f32 v250, v132, v133
v_cvt_pk_bf16_f32 v251, v134, v135
v_mfma_f32_16x16x32_bf16 v[80:83], v[48:51], a[0:3], v[192:195]
rd 76,0,23552
v_mul_f32 v173, v173, v219
v_mfma_f32_16x16x32_bf16 v[84:87], v[48:51], a[4:7], v[196:199]
wl 5
lw 1024
v_mfma_f32_16x16x32_bf16 v[92:95], v[52:55], a[4:7], v[196:199]
s_mov_b32 s37, s74
rd 48,0,24576
v_mul_f32 v174, v174, v219
v_mfma_f32_16x16x32_bf16 v[88:91], v[52:55], a[0:3], v[192:195]
buffer_store_dwordx4 v[200:203], v0, s[4:7], s37 offen offset:0 sc1
v_mfma_f32_16x16x32_bf16 v[96:99], v[56:59], a[0:3], v[192:195]
rd 52,0,25600
v_mul_f32 v175, v175, v219
v_mfma_f32_16x16x32_bf16 v[100:103], v[56:59], a[4:7], v[196:199]
wl 5
v_mul_f32 v220, v172, v172
v_mul_f32 v221, v173, v173
v_mfma_f32_16x16x32_bf16 v[108:111], v[60:63], a[4:7], v[196:199]
rd 56,0,26624
v_mul_f32 v222, v174, v174
v_mfma_f32_16x16x32_bf16 v[104:107], v[60:63], a[0:3], v[192:195]
lw 2048
v_mfma_f32_16x16x32_bf16 v[112:115], v[64:67], a[0:3], v[192:195]
rd 60,0,27648
v_mul_f32 v223, v175, v175
v_mfma_f32_16x16x32_bf16 v[116:119], v[64:67], a[4:7], v[196:199]
wl 5
v_fma_f32 v220, v220, s43, v30
v_fma_f32 v221, v221, s43, v30
v_mfma_f32_16x16x32_bf16 v[124:127], v[68:71], a[4:7], v[196:199]
rd 64,0,28672
v_fma_f32 v222, v222, s43, v30
v_mfma_f32_16x16x32_bf16 v[120:123], v[68:71], a[0:3], v[192:195]
s_mov_b32 exec_hi, 0
lw 3072
s_mov_b32 exec_hi, -1
v_mfma_f32_16x16x32_bf16 v[128:131], v[72:75], a[0:3], v[192:195]
s_add_u32 s23, s23, 14336
rd 68,0,29696
v_fma_f32 v223, v223, s43, v30
v_mfma_f32_16x16x32_bf16 v[132:135], v[72:75], a[4:7], v[196:199]
s_waitcnt lgkmcnt(5) vmcnt(13)
s_barrier
v_mul_f32 v220, v220, v172
mT 84,76,12
s_add_u32 m0, s22, 88064
rd 72,0,59392
v_mul_f32 v221, v221, v173
mT 80,76,8
lw 0
mT 88,48,8
rd 76,0,60416
v_mul_f32 v222, v222, v174
mT 92,48,12
wl 5
buffer_store_dwordx4 v[204:207], v0, s[4:7], s37 offen offset:1024 sc1
mT 100,52,12
rd 48,0,61440
v_mul_f32 v223, v223, v175
mT 96,52,8
v_exp_f32 v220, v220
mT 104,56,8
rd 52,0,62464
v_add_f32 v220, 1.0, v220
mT 108,56,12
wl 5
lw 1024
mT 116,60,12
rd 56,0,63488
v_fmac_f32 v176, v216, v236
mT 112,60,8
v_exp_f32 v221, v221
mT 120,64,8
rd 60,0,64512
v_add_f32 v221, 1.0, v221
mT 124,64,12
wl 5
lw 2048
mT 132,68,12
rd 64,1,0
v_fmac_f32 v177, v216, v237
mT 128,68,8
buffer_store_dwordx4 v[208:211], v0, s[4:7], s37 offen offset:2048 sc1
mT 80,72,16
rd 68,1,1024
v_fmac_f32 v178, v216, v238
mT 84,72,20
wl 5
s_mov_b32 exec_hi, 0
lw 3072
s_mov_b32 exec_hi, -1
mT 92,76,20
rd 72,1,2048
v_fmac_f32 v179, v216, v239
mT 88,76,16
v_exp_f32 v222, v222
mT 96,48,16
rd 76,1,3072
v_add_f32 v222, 1.0, v222
mT 100,48,20
wl 5
v_exp_f32 v223, v223
mT 108,52,20
rd 48,1,4096
v_add_f32 v223, 1.0, v223
mT 104,52,16
v_rcp_f32 v220, v220
mT 112,56,16
rd 52,1,5120
v_mul_f32 v172, v172, v220
mT 116,56,20
wl 5
buffer_store_dwordx4 v[212:215], v0, s[4:7], s37 offen offset:3072 sc1
mT 124,60,20
rd 56,1,6144
v_mul_f32 v176, v176, v217
mT 120,60,16
v_rcp_f32 v221, v221
mT 128,64,16
rd 60,1,7168
v_mul_f32 v173, v173, v221
mT 132,64,20
s_waitcnt lgkmcnt(5) vmcnt(16)
s_barrier
v_mul_f32 v177, v177, v217
mT 84,68,28
rd 64,1,8192
v_mul_f32 v178, v178, v217
mT 80,68,24
v_rcp_f32 v222, v222
mT 88,72,24
rd 68,1,9216
v_mul_f32 v174, v174, v222
mT 92,72,28
wl 5
v_rcp_f32 v223, v223
mT 100,76,28
rd 72,1,10240
v_mul_f32 v175, v175, v223
mT 96,76,24
v_mul_f32 v179, v179, v217
v_mul_f32 v224, v176, v176
mT 104,48,24
s_add_u32 s37, s37, 4096
rd 76,1,11264
v_mul_f32 v225, v177, v177
mT 108,48,28
wl 5
buffer_store_dwordx4 v[240:243], v0, s[4:7], s37 offen offset:0 sc1
mT 116,52,28
rd 48,1,12288
v_mul_f32 v226, v178, v178
mT 112,52,24
v_mul_f32 v227, v179, v179
v_fma_f32 v224, v224, s43, v30
mT 120,56,24
rd 52,1,13312
v_fma_f32 v225, v225, s43, v30
mT 124,56,28
wl 5
v_fma_f32 v226, v226, s43, v30
v_fma_f32 v227, v227, s43, v30
mT 132,60,28
rd 56,1,14336
v_mul_f32 v224, v224, v176
mT 128,60,24
v_exp_f32 v224, v224
mT 80,64,32
rd 60,1,15360
v_mul_f32 v225, v225, v177
mT 84,64,36
wl 5
v_exp_f32 v225, v225
mT 92,68,36
rd 64,1,16384
v_mul_f32 v226, v226, v178
mT 88,68,32
buffer_store_dwordx4 v[244:247], v0, s[4:7], s37 offen offset:1024 sc1
mT 96,72,32
rd 68,1,17408
v_mul_f32 v227, v227, v179
mT 100,72,36
wl 5
v_exp_f32 v226, v226
mT 108,76,36
rd 72,1,18432
v_add_f32 v224, 1.0, v224
mT 104,76,32
v_exp_f32 v227, v227
mT 112,48,32
rd 76,1,19456
v_add_f32 v225, 1.0, v225
mT 116,48,36
wl 5
v_rcp_f32 v224, v224
mT 124,52,36
rd 48,1,20480
v_add_f32 v226, 1.0, v226
mT 120,52,32
v_rcp_f32 v225, v225
mT 128,56,32
rd 52,1,21504
v_add_f32 v227, 1.0, v227
mT 132,56,36
s_waitcnt lgkmcnt(5) vmcnt(14)
s_barrier
v_mul_f32 v176, v176, v224
mT 84,60,44
s_xor_b32 s37, s75, 1024
rd 56,0,30720
v_mul_f32 v177, v177, v225
mT 80,60,40
buffer_store_dwordx4 v[248:251], v0, s[4:7], s37 offen offset:0 sc1
mT 88,64,40
rd 60,0,31744
v_fmac_f32 v180, v218, v236
mT 92,64,44
wl 5
v_rcp_f32 v226, v226
mT 100,68,44
rd 64,0,32768
v_mul_f32 v178, v178, v226
mT 96,68,40
v_rcp_f32 v227, v227
mT 104,72,40
rd 68,0,33792
v_mul_f32 v179, v179, v227
mT 108,72,44
wl 5
v_fmac_f32 v181, v218, v237
v_fmac_f32 v182, v218, v238
mT 116,76,44
s_mul_i32 s23, s79, 28672
rd 72,0,34816
v_fmac_f32 v183, v218, v239
mT 112,76,40
v_mul_f32 v180, v180, v219
v_mul_f32 v181, v181, v219
mT 120,48,40
s_add_u32 s23, s23, s28
rd 76,0,35840
v_mul_f32 v182, v182, v219
mT 124,48,44
wl 5
v_mul_f32 v183, v183, v219
v_mul_f32 v228, v180, v180
mT 132,52,44
s_add_u32 s23, s23, 86016
rd 48,0,36864
v_mul_f32 v229, v181, v181
mT 128,52,40
v_mul_f32 v230, v182, v182
v_mul_f32 v231, v183, v183
mT 80,56,48
s_add_u32 m0, s22, 102400
rd 52,0,37888
v_fma_f32 v228, v228, s43, v30
mT 84,56,52
wl 5
lw 0
mT 92,60,52
rd 56,0,38912
v_fma_f32 v229, v229, s43, v30
mT 88,60,48
v_fma_f32 v230, v230, s43, v30
v_fma_f32 v231, v231, s43, v30
mT 96,64,48
rd 60,0,39936
v_mul_f32 v228, v228, v180
mT 100,64,52
wl 5
lw 1024
mT 108,68,52
rd 64,0,40960
v_mul_f32 v229, v229, v181
mT 104,68,48
v_exp_f32 v228, v228
mT 112,72,48
rd 68,0,41984
v_mul_f32 v230, v230, v182
mT 116,72,52
wl 5
lw 2048
mT 124,76,52
rd 72,0,43008
v_mul_f32 v231, v231, v183
mT 120,76,48
v_exp_f32 v229, v229
mT 128,48,48
rd 76,0,44032
v_add_f32 v228, 1.0, v228
mT 132,48,52
s_waitcnt lgkmcnt(5) vmcnt(13)
s_barrier
v_add_f32 v229, 1.0, v229
mT 84,52,60
rd 48,0,45056
mT 80,52,56
s_mov_b32 exec_hi, 0
lw 3072
s_mov_b32 exec_hi, -1
mT 88,56,56
s_add_u32 s23, s23, 14336
rd 52,0,46080
mT 92,56,60
wl 5
v_exp_f32 v230, v230
mT 100,60,60
s_add_u32 m0, s22, 131072
rd 56,0,47104
v_add_f32 v230, 1.0, v230
mT 96,60,56
lw 0
mT 104,64,56
rd 60,0,48128
mT 108,64,60
wl 5
v_exp_f32 v231, v231
mT 116,68,60
rd 64,0,49152
v_add_f32 v231, 1.0, v231
mT 112,68,56
lw 1024
mT 120,72,56
rd 68,0,50176
mT 124,72,60
wl 5
v_rcp_f32 v228, v228
mT 132,76,60
rd 72,0,51200
v_mul_f32 v180, v180, v228
mT 128,76,56
v_rcp_f32 v229, v229
mT 80,48,64
rd 76,0,52224
v_mul_f32 v181, v181, v229
mT 84,48,68
wl 5
lw 2048
mT 92,52,68
rd 48,0,53248
mT 88,52,64
v_rcp_f32 v230, v230
mT 96,56,64
rd 52,0,54272
v_mul_f32 v182, v182, v230
mT 100,56,68
wl 5
s_mov_b32 exec_hi, 0
lw 3072
s_mov_b32 exec_hi, -1
mT 108,60,68
rd 56,0,55296
mT 104,60,64
v_rcp_f32 v231, v231
mT 112,64,64
s_mul_i32 s23, s76, 28672
rd 60,0,56320
v_mul_f32 v183, v183, v231
mT 116,64,68
wl 5
rd 232,12,1600
mT 124,68,68
s_add_u32 s23, s23, s28
rd 64,0,57344
mT 120,68,64
main_cp12:
s_mov_b32 s96, main_cp12-main_cp11
v_lshl_add_u64 v[2:3], v[2:3], 0, s[96:97]
global_load_dword v254, v[2:3], off
mT 128,72,64
s_add_u32 s23, s23, 114688
rd 68,0,58368
mT 132,72,68
s_waitcnt lgkmcnt(6) vmcnt(13)
s_barrier
mT 84,76,76
s_add_u32 m0, s22, 145408
rd 72,1,22528
mT 80,76,72
lw 0
mT 88,48,72
wl 3
rd 76,1,23552
v_fmac_f32 v184, v216, v232
mT 92,48,76
v_fmac_f32 v185, v216, v233
v_fmac_f32 v186, v216, v234
mT 100,52,76
rd 48,1,24576
v_fmac_f32 v187, v216, v235
mT 96,52,72
lw 1024
mT 104,56,72
rd 52,1,25600
v_mul_f32 v184, v184, v217
mT 108,56,76
v_mul_f32 v185, v185, v217
v_mul_f32 v186, v186, v217
mT 116,60,76
rd 56,1,26624
v_mul_f32 v187, v187, v217
mT 112,60,72
wl 5
lw 2048
mT 120,64,72
rd 60,1,27648
v_mul_f32 v220, v184, v184
mT 124,64,76
v_mul_f32 v221, v185, v185
v_mul_f32 v222, v186, v186
mT 132,68,76
rd 64,1,28672
v_mul_f32 v223, v187, v187
mT 128,68,72
wl 5
v_fma_f32 v220, v220, s43, v30
v_fma_f32 v221, v221, s43, v30
mT 80,72,80
rd 68,1,29696
v_fma_f32 v222, v222, s43, v30
mT 84,72,84
s_mov_b32 exec_hi, 0
lw 3072
s_mov_b32 exec_hi, -1
mT 92,76,84
s_add_u32 s23, s23, 14336
rd 72,1,30720
v_fma_f32 v223, v223, s43, v30
mT 88,76,80
wl 5
v_mul_f32 v220, v220, v184
v_mul_f32 v221, v221, v185
mT 96,48,80
s_add_u32 m0, s22, 2048
rd 76,1,31744
v_mul_f32 v222, v222, v186
mT 100,48,84
lw 0
mT 108,52,84
rd 48,1,32768
v_mul_f32 v223, v223, v187
mT 104,52,80
wl 5
v_exp_f32 v220, v220
mT 112,56,80
rd 52,1,33792
v_add_f32 v220, 1.0, v220
mT 116,56,84
lw 1024
mT 124,60,84
rd 56,1,34816
v_fmac_f32 v188, v218, v232
mT 120,60,80
wl 5
v_exp_f32 v221, v221
mT 128,64,80
s_waitcnt vmcnt(15)
s_mov_b32 s36, s3
rd 60,1,35840
v_mov_b32 v31, 1
mT 132,64,84
s_waitcnt vmcnt(11)
s_barrier
v_add_f32 v221, 1.0, v221
mT 84,68,92
rd 64,1,36864
v_fmac_f32 v189, v218, v233
mT 80,68,88
wl 5
lw 2048
mT 88,72,88
rd 68,1,37888
v_fmac_f32 v190, v218, v234
mT 92,72,92
buffer_atomic_add v31, v4, s[4:7], s36 offen sc1
mT 100,76,92
rd 72,1,38912
v_fmac_f32 v191, v218, v235
mT 96,76,88
wl 5
s_mov_b32 exec_hi, 0
lw 3072
s_mov_b32 exec_hi, -1
mT 104,48,88
rd 76,1,39936
v_mul_f32 v188, v188, v219
mT 108,48,92
v_exp_f32 v222, v222
mT 116,52,92
s_mul_i32 s23, s77, 28672
rd 48,1,40960
v_add_f32 v222, 1.0, v222
mT 112,52,88
wl 5
v_exp_f32 v223, v223
mT 120,56,88
s_add_u32 s23, s23, s28
rd 52,1,41984
v_add_f32 v223, 1.0, v223
mT 124,56,92
v_rcp_f32 v220, v220
mT 132,60,92
s_add_u32 s23, s23, 143360
rd 56,1,43008
v_mul_f32 v184, v184, v220
mT 128,60,88
wl 5
v_rcp_f32 v221, v221
mT 80,64,96
s_add_u32 m0, s22, 116736
rd 60,1,44032
v_mul_f32 v185, v185, v221
mT 84,64,100
lw 0
mT 92,68,100
rd 64,1,45056
v_mul_f32 v189, v189, v219
mT 88,68,96
wl 5
v_rcp_f32 v222, v222
mT 96,72,96
rd 68,1,46080
v_mul_f32 v186, v186, v222
mT 100,72,100
lw 1024
mT 108,76,100
rd 72,1,47104
v_mul_f32 v190, v190, v219
mT 104,76,96
wl 5
v_rcp_f32 v223, v223
mT 112,48,96
rd 76,1,48128
v_mul_f32 v187, v187, v223
mT 116,48,100
lw 2048
mT 124,52,100
rd 48,1,49152
v_mul_f32 v191, v191, v219
mT 120,52,96
wl 5
v_mul_f32 v224, v188, v188
v_mul_f32 v225, v189, v189
mT 128,56,96
rd 52,1,50176
v_mul_f32 v226, v190, v190
mT 132,56,100
s_waitcnt vmcnt(13)
s_barrier
v_mul_f32 v227, v191, v191
mT 84,60,108
rd 56,29,0
v_fma_f32 v224, v224, s43, v30
mT 80,60,104
wl 5
s_mov_b32 exec_hi, 0
lw 3072
s_mov_b32 exec_hi, -1
mT 88,64,104
s_add_u32 s23, s23, 14336
rd 60,29,1024
v_fma_f32 v225, v225, s43, v30
mT 92,64,108
v_fma_f32 v226, v226, s43, v30
v_fma_f32 v227, v227, s43, v30
mT 100,68,108
s_add_u32 m0, s22, 16384
rd 64,29,2048
v_mul_f32 v224, v224, v188
mT 96,68,104
wl 5
lw 0
mT 104,72,104
rd 68,29,3072
v_mov_b32 v31, 0
mT 108,72,108
buffer_atomic_add v31, v4, s[4:7], s36 offen sc0 sc1
mT 116,76,108
rd 72,29,4096
v_mul_f32 v225, v225, v189
mT 112,76,104
wl 5
lw 1024
mT 120,48,104
rd 76,29,5120
v_mul_f32 v226, v226, v190
mT 124,48,108
v_exp_f32 v224, v224
mT 132,52,108
rd 48,29,6144
v_mul_f32 v227, v227, v191
mT 128,52,104
wl 5
v_exp_f32 v225, v225
mT 80,56,112
rd 52,29,7168
v_add_f32 v224, 1.0, v224
mT 84,56,116
lw 2048
mT 92,60,116
rd 56,29,8192
v_add_f32 v225, 1.0, v225
mT 88,60,112
wl 5
v_exp_f32 v226, v226
mT 96,64,112
rd 60,29,9216
v_add_f32 v226, 1.0, v226
mT 100,64,116
s_mov_b32 exec_hi, 0
lw 3072
s_mov_b32 exec_hi, -1
mT 108,68,116
rd 64,29,10240
mT 104,68,112
wl 5
v_exp_f32 v227, v227
mT 112,72,112
s_mul_i32 s23, s78, 28672
rd 68,29,11264
v_add_f32 v227, 1.0, v227
mT 116,72,116
v_rcp_f32 v224, v224
mT 124,76,116
s_add_u32 s23, s23, s28
rd 72,29,12288
v_mul_f32 v188, v188, v224
mT 120,76,112
wl 5
v_rcp_f32 v225, v225
mT 128,48,112
s_add_u32 s23, s23, 172032
rd 76,29,13312
v_mul_f32 v189, v189, v225
mT 132,48,116
s_waitcnt vmcnt(14)
s_barrier
mT 84,52,124
s_add_u32 m0, s22, 59392
rd 48,29,14336
mT 80,52,120
wl 5
lw 0
mT 88,56,120
rd 52,29,15360
mT 92,56,124
v_rcp_f32 v226, v226
mT 100,60,124
rd 56,29,16384
v_mul_f32 v190, v190, v226
mT 96,60,120
wl 5
lw 1024
mT 104,64,120
rd 60,29,17408
mT 108,64,124
v_rcp_f32 v227, v227
mT 116,68,124
rd 64,29,18432
v_mul_f32 v191, v191, v227
mT 112,68,120
wl 5
lw 2048
mT 120,72,120
rd 68,29,19456
mT 124,72,124
mT 132,76,124
rd 72,29,20480
mT 128,76,120
wl 5
mT 80,48,128
rd 76,29,21504
mT 84,48,132
s_mov_b32 exec_hi, 0
lw 3072
s_mov_b32 exec_hi, -1
mT 92,52,132
s_add_u32 s23, s23, 14336
rd 48,29,22528
mT 88,52,128
wl 5
mT 96,56,128
s_add_u32 m0, s22, 73728
rd 52,29,23552
mT 100,56,132
lw 0
mT 108,60,132
rd 56,29,24576
mT 104,60,128
wl 5
mT 112,64,128
rd 60,29,25600
mT 116,64,132
lw 1024
mT 124,68,132
rd 64,29,26624
mT 120,68,128
wl 5
mT 128,72,128
rd 68,29,27648
mT 132,72,132
s_waitcnt vmcnt(15)
s_barrier
mT 84,76,140
rd 72,0,2048
mT 80,76,136
wl 5
lw 2048
mT 88,48,136
rd 76,0,3072
mT 92,48,140
mT 100,52,140
rd 48,0,4096
mT 96,52,136
wl 5
s_mov_b32 exec_hi, 0
lw 3072
s_mov_b32 exec_hi, -1
mT 104,56,136
rd 52,0,5120
mT 108,56,140
mT 116,60,140
s_min_i32 s23, s79, 0
rd 56,0,6144
mT 112,60,136
wl 5
mT 120,64,136
s_mul_i32 s23, s23, 28672
rd 60,0,7168
mT 124,64,140
mT 132,68,140
s_add_u32 s23, s23, s28
rd 64,0,8192
mT 128,68,136
s_waitcnt vmcnt(11)
v_readfirstlane_b32 s46, v31
s_nop 0
s_nop 0
s_cmp_ge_u32 s46, 2
s_cbranch_scc1 main_ok76
s_mov_b32 s47, 0
main_poll75:
v_mov_b32 v31, 0
buffer_atomic_add v31, v4, s[4:7], s36 offen sc0 sc1
s_add_u32 s47, s47, 1
s_cmp_gt_u32 s47, 400000
s_cbranch_scc1 main_ok76
s_waitcnt vmcnt(0)
v_readfirstlane_b32 s46, v31
s_nop 0
s_cmp_lt_u32 s46, 2
s_cbranch_scc1 main_poll75
main_ok76:
wl 5
mT 80,72,144
s_add_u32 s23, s23, 200704
rd 68,0,9216
mT 84,72,148
mT 92,76,148
s_add_u32 m0, s22, 30720
rd 72,0,10240
mT 88,76,144
wl 5
lw 0
mT 96,48,144
s_add_u32 s37, s58, 4096
rd 76,0,11264
mT 100,48,148
buffer_load_dwordx4 v[200:203], v0, s[4:7], s58 offen offset:0 sc1
mT 108,52,148
rd 48,0,12288
mT 104,52,144
wl 5
lw 1024
mT 112,56,144
rd 52,0,13312
mT 116,56,148
buffer_load_dwordx4 v[204:207], v0, s[4:7], s58 offen offset:1024 sc1
mT 124,60,148
rd 56,0,14336
mT 120,60,144
wl 5
lw 2048
mT 128,64,144
rd 60,0,15360
mT 132,64,148
s_barrier
mT 84,68,156
rd 64,1,51200
mT 80,68,152
wl 5
buffer_load_dwordx4 v[208:211], v0, s[4:7], s58 offen offset:2048 sc1
mT 88,72,152
rd 68,1,52224
mT 92,72,156
s_mov_b32 exec_hi, 0
lw 3072
s_mov_b32 exec_hi, -1
mT 100,76,156
s_add_u32 s23, s23, 14336
rd 72,1,53248
mT 96,76,152
wl 5
buffer_load_dwordx4 v[212:215], v0, s[4:7], s58 offen offset:3072 sc1
mT 104,48,152
s_add_u32 m0, s22, 45056
rd 76,1,54272
mT 108,48,156
lw 0
mT 116,52,156
rd 48,1,55296
mT 112,52,152
wl 5
buffer_load_dwordx4 v[240:243], v0, s[4:7], s37 offen offset:0 sc1
mT 120,56,152
rd 52,1,56320
mT 124,56,156
lw 1024
mT 132,60,156
rd 56,1,57344
mT 128,60,152
wl 5
buffer_load_dwordx4 v[244:247], v0, s[4:7], s37 offen offset:1024 sc1
mT 80,64,160
rd 60,1,58368
mT 84,64,164
mT 92,68,164
rd 64,1,59392
mT 88,68,160
wl 5
lw 2048
mT 96,72,160
rd 68,1,60416
mT 100,72,164
buffer_load_dwordx4 v[248:251], v0, s[4:7], s75 offen offset:0 sc1
mT 108,76,164
rd 72,1,61440
mT 104,76,160
wl 5
s_mov_b32 exec_hi, 0
lw 3072
s_mov_b32 exec_hi, -1
mT 112,48,160
rd 76,1,62464
mT 116,48,164
mT 124,52,164
s_max_i32 s23, s76, 0
rd 48,1,63488
mT 120,52,160
wl 5
mT 128,56,160
s_mul_i32 s23, s23, 16384
rd 52,1,64512
mT 132,56,164
s_waitcnt vmcnt(23)
s_barrier
mT 84,60,172
s_add_u32 s23, s23, s72
rd 56,0,16384
mT 80,60,168
wl 5
mT 88,64,168
s_add_u32 s23, s23, 0
rd 60,0,17408
mT 92,64,172
mT 100,68,172
s_add_u32 m0, s21, 98304
rd 64,0,18432
mT 96,68,168
wl 5
lw 0
mT 104,72,168
rd 68,0,19456
mT 108,72,172
mT 116,76,172
rd 72,0,20480
mT 112,76,168
wl 5
lw 1024
mT 120,48,168
rd 76,0,21504
mT 124,48,172
mT 132,52,172
rd 48,0,22528
mT 128,52,168
wl 5
lw 2048
mT 80,56,176
rd 52,0,23552
mT 84,56,180
mT 92,60,180
rd 56,0,24576
mT 88,60,176
wl 5
mT 96,64,176
rd 60,0,25600
mT 100,64,180
lw 3072
mT 108,68,180
s_mul_i32 s23, s77, 16384
rd 64,0,26624
mT 104,68,176
wl 5
mT 112,72,176
s_add_u32 s23, s23, s72
rd 68,0,27648
mT 116,72,180
mT 124,76,180
s_add_u32 s23, s23, 16384
rd 72,0,28672
mT 120,76,176
wl 5
mT 128,48,176
s_add_u32 m0, s21, 131072
rd 76,0,29696
mT 132,48,180
s_waitcnt vmcnt(23)
s_barrier
mT 84,52,188
rd 48,0,59392
mT 80,52,184
wl 5
lw 0
mT 88,56,184
rd 52,0,60416
mT 92,56,188
mT 100,60,188
rd 56,0,61440
mT 96,60,184
wl 5
lw 1024
mT 104,64,184
rd 60,0,62464
mT 108,64,188
mT 116,68,188
rd 64,0,63488
mT 112,68,184
wl 5
lw 2048
mT 120,72,184
rd 68,0,64512
mT 124,72,188
mT 132,76,188
rd 72,1,0
mT 128,76,184
wl 5
mT 80,48,192
rd 76,1,1024
mT 84,48,196
lw 3072
mT 92,52,196
s_mul_i32 s23, s78, 16384
rd 48,1,2048
mT 88,52,192
wl 5
mT 96,56,192
s_add_u32 s23, s23, s72
rd 52,1,3072
mT 100,56,196
mT 108,60,196
s_add_u32 s23, s23, 32768
rd 56,1,4096
mT 104,60,192
wl 5
mT 112,64,192
s_add_u32 m0, s21, 0
rd 60,1,5120
mT 116,64,196
lw 0
mT 124,68,196
rd 64,1,6144
mT 120,68,192
wl 5
mT 128,72,192
rd 68,1,7168
mT 132,72,196
s_waitcnt vmcnt(9)
s_barrier
mT 84,76,204
rd 72,1,8192
mT 80,76,200
lw 1024
v_mfma_f32_16x16x32_bf16 v[80:83], v[18:21], v[200:203], v[80:83]
wl 5
mT 88,48,200
rd 76,1,9216
v_mfma_f32_16x16x32_bf16 v[88:91], v[16:19], v[200:203], v[88:91]
mT 92,48,204
lw 2048
v_mfma_f32_16x16x32_bf16 v[84:87], v[18:21], v[204:207], v[84:87]
mT 100,52,204
rd 48,1,15360
v_mfma_f32_16x16x32_bf16 v[92:95], v[16:19], v[204:207], v[92:95]
main_cp13:
s_mov_b32 s96, main_cp13-main_cp12
v_lshl_add_u64 v[2:3], v[2:3], 0, s[96:97]
global_load_dword v254, v[2:3], off
mT 96,52,200
lw 3072
v_mfma_f32_16x16x32_bf16 v[96:99], v[18:21], v[208:211], v[96:99]
wl 5
mT 104,56,200
s_mul_i32 s23, s79, 16384
rd 52,1,16384
v_mfma_f32_16x16x32_bf16 v[104:107], v[16:19], v[208:211], v[104:107]
mT 108,56,204
v_mfma_f32_16x16x32_bf16 v[100:103], v[18:21], v[212:215], v[100:103]
mT 116,60,204
s_add_u32 s23, s23, s72
rd 56,0,30720
v_mfma_f32_16x16x32_bf16 v[108:111], v[16:19], v[212:215], v[108:111]
mT 112,60,200
v_mfma_f32_16x16x32_bf16 v[112:115], v[18:21], v[240:243], v[112:115]
wl 5
mT 120,64,200
s_add_u32 s23, s23, 49152
rd 60,0,31744
v_mfma_f32_16x16x32_bf16 v[120:123], v[16:19], v[240:243], v[120:123]
mT 124,64,204
v_mfma_f32_16x16x32_bf16 v[116:119], v[18:21], v[244:247], v[116:119]
mT 132,68,204
s_add_u32 m0, s21, 114688
rd 64,0,37888
v_mfma_f32_16x16x32_bf16 v[124:127], v[16:19], v[244:247], v[124:127]
mT 128,68,200
lw 0
v_mfma_f32_16x16x32_bf16 v[128:131], v[18:21], v[248:251], v[128:131]
wl 5
mT 80,72,208
rd 68,0,38912
v_mfma_f32_16x16x32_bf16 v[132:135], v[16:19], v[248:251], v[132:135]
mT 84,72,212
lw 1024
mT 92,76,212
rd 72,0,45056
mT 88,76,208
wl 5
mT 80,48,216
rd 76,0,46080
mT 84,48,220
lw 2048
mT 92,52,220
rd 48,0,52224
mT 88,52,216
wl 5
mT 80,56,224
rd 52,0,53248
mT 84,56,228
lw 3072
mT 92,60,228
rd 56,1,10240
mT 88,60,224
wl 5
mT 80,64,232
rd 60,1,11264
mT 84,64,236
mT 92,68,236
rd 64,1,17408
mT 88,68,232
wl 5
mT 80,72,240
rd 68,1,18432
mT 84,72,244
mT 92,76,244
rd 72,0,32768
mT 88,76,240
wl 5
mT 80,48,248
rd 76,0,33792
mT 84,48,252
mT 92,52,252
rd 48,0,39936
mT 88,52,248
wl 5
mT 96,56,208
rd 52,0,40960
mT 100,56,212
mT 108,60,212
rd 56,0,47104
mT 104,60,208
wl 5
mT 96,64,216
rd 60,0,48128
v_mul_f32 v80, v80, v136
v_mul_f32 v81, v81, v137
mT 100,64,220
v_mul_f32 v82, v82, v138
v_mul_f32 v83, v83, v139
v_cvt_pk_bf16_f32 v220, v80, v81
mT 108,68,220
rd 64,0,54272
v_cvt_pk_bf16_f32 v221, v82, v83
v_mul_f32 v88, v88, v144
mT 104,68,216
wl 5
v_mul_f32 v89, v89, v145
v_mul_f32 v90, v90, v146
v_mul_f32 v91, v91, v147
mT 96,72,224
rd 68,0,55296
v_cvt_pk_bf16_f32 v222, v88, v89
v_cvt_pk_bf16_f32 v223, v90, v91
mT 100,72,228
buffer_store_dwordx4 v[220:223], v0, s[4:7], s58 offen offset:0 sc1
v_mul_f32 v84, v84, v140
mT 108,76,228
rd 72,1,12288
v_mul_f32 v85, v85, v141
v_mul_f32 v86, v86, v142
mT 104,76,224
wl 5
v_mul_f32 v87, v87, v143
v_cvt_pk_bf16_f32 v224, v84, v85
v_cvt_pk_bf16_f32 v225, v86, v87
mT 96,48,232
rd 76,1,13312
v_mul_f32 v92, v92, v148
v_mul_f32 v93, v93, v149
mT 100,48,236
v_mul_f32 v94, v94, v150
v_mul_f32 v95, v95, v151
v_cvt_pk_bf16_f32 v226, v92, v93
mT 108,52,236
rd 48,1,19456
v_cvt_pk_bf16_f32 v227, v94, v95
mT 104,52,232
wl 5
buffer_store_dwordx4 v[224:227], v0, s[4:7], s58 offen offset:1024 sc1
mT 96,56,240
rd 52,1,20480
mT 100,56,244
mT 108,60,244
rd 56,0,34816
mT 104,60,240
wl 5
mT 96,64,248
rd 60,0,35840
mT 100,64,252
mT 108,68,252
rd 64,0,41984
mT 104,68,248
wl 5
mT 112,72,208
rd 68,0,43008
mT 116,72,212
mT 124,76,212
rd 72,0,49152
mT 120,76,208
wl 5
mT 112,48,216
rd 76,0,50176
v_mul_f32 v96, v96, v152
v_mul_f32 v97, v97, v153
mT 116,48,220
v_mul_f32 v98, v98, v154
v_mul_f32 v99, v99, v155
v_cvt_pk_bf16_f32 v228, v96, v97
mT 124,52,220
rd 48,0,56320
v_cvt_pk_bf16_f32 v229, v98, v99
v_mul_f32 v104, v104, v160
mT 120,52,216
wl 5
v_mul_f32 v105, v105, v161
v_mul_f32 v106, v106, v162
v_mul_f32 v107, v107, v163
mT 112,56,224
rd 52,0,57344
v_cvt_pk_bf16_f32 v230, v104, v105
v_cvt_pk_bf16_f32 v231, v106, v107
mT 116,56,228
buffer_store_dwordx4 v[228:231], v0, s[4:7], s58 offen offset:2048 sc1
v_mul_f32 v100, v100, v156
mT 124,60,228
rd 56,1,14336
v_mul_f32 v101, v101, v157
v_mul_f32 v102, v102, v158
mT 120,60,224
wl 5
v_mul_f32 v103, v103, v159
v_cvt_pk_bf16_f32 v232, v100, v101
v_cvt_pk_bf16_f32 v233, v102, v103
mT 112,64,232
rd 60,1,21504
v_mul_f32 v108, v108, v164
v_mul_f32 v109, v109, v165
mT 116,64,236
v_mul_f32 v110, v110, v166
v_mul_f32 v111, v111, v167
v_cvt_pk_bf16_f32 v234, v108, v109
mT 124,68,236
rd 64,0,36864
v_cvt_pk_bf16_f32 v235, v110, v111
mT 120,68,232
wl 5
buffer_store_dwordx4 v[232:235], v0, s[4:7], s58 offen offset:3072 sc1
mT 112,72,240
rd 68,0,44032
mT 116,72,244
mT 124,76,244
rd 72,0,51200
mT 120,76,240
wl 5
mT 112,48,248
rd 76,0,58368
mT 116,48,252
mT 124,52,252
mT 120,52,248
wl 4
mT 128,56,208
mT 132,56,212
mT 132,60,220
mT 128,60,216
wl 3
mT 128,64,224
v_mul_f32 v112, v112, v168
v_mul_f32 v113, v113, v169
v_mul_f32 v114, v114, v170
mT 132,64,228
wl 2
v_mul_f32 v115, v115, v171
v_cvt_pk_bf16_f32 v220, v112, v113
v_cvt_pk_bf16_f32 v221, v114, v115
mT 132,68,236
v_mul_f32 v120, v120, v176
v_mul_f32 v121, v121, v177
v_mul_f32 v122, v122, v178
mT 128,68,232
wl 1
v_mul_f32 v123, v123, v179
v_cvt_pk_bf16_f32 v222, v120, v121
v_cvt_pk_bf16_f32 v223, v122, v123
mT 128,72,240
s_add_u32 s32, s58, 4096
buffer_store_dwordx4 v[220:223], v0, s[4:7], s32 offen offset:0 sc1
v_mul_f32 v116, v116, v172
mT 132,72,244
wl 0
v_mul_f32 v117, v117, v173
v_mul_f32 v118, v118, v174
v_mul_f32 v119, v119, v175
mT 132,76,252
v_cvt_pk_bf16_f32 v224, v116, v117
v_cvt_pk_bf16_f32 v225, v118, v119
v_mul_f32 v124, v124, v180
mT 128,76,248
v_mul_f32 v125, v125, v181
v_mul_f32 v126, v126, v182
v_mul_f32 v127, v127, v183
v_cvt_pk_bf16_f32 v226, v124, v125
v_cvt_pk_bf16_f32 v227, v126, v127
buffer_store_dwordx4 v[224:227], v0, s[4:7], s32 offen offset:1024 sc1
s_nop 1
v_pk_mul_f32 v[128:129], v[128:129], v[184:185]
v_pk_mul_f32 v[130:131], v[130:131], v[186:187]
v_cvt_pk_bf16_f32 v228, v128, v129
v_cvt_pk_bf16_f32 v229, v130, v131
buffer_store_dwordx2 v[228:229], v0, s[4:7], s59 offen offset:0 sc1
v_pk_mul_f32 v[132:133], v[132:133], v[188:189]
v_pk_mul_f32 v[134:135], v[134:135], v[190:191]
v_cvt_pk_bf16_f32 v232, v132, v133
v_cvt_pk_bf16_f32 v233, v134, v135
buffer_store_dwordx2 v[232:233], v0, s[4:7], s59 offen offset:1024 sc1
s_add_u32 s36, s48, 98304
v_mov_b32 v31, 1
s_waitcnt vmcnt(0)
buffer_atomic_add v31, v4, s[4:7], s36 offen sc0 sc1
s_barrier
s_mul_i32 s23, s76, 16384
s_add_u32 s23, s23, s72
s_add_u32 s23, s23, 65536
s_add_u32 m0, s21, 65536
s_nop 0
lw 0
lw 1024
lw 2048
lw 3072
s_mul_i32 s23, s77, 16384
s_add_u32 s23, s23, s72
s_add_u32 s23, s23, 81920
s_add_u32 m0, s21, 81920
s_nop 0
lw 0
lw 1024
lw 2048
lw 3072
s_barrier
rd 48,1,32768
rd 52,1,33792
rd 56,1,34816
rd 60,1,35840
rd 64,1,36864
rd 68,1,37888
rd 72,1,38912
s_and_b32 s35, s17, 1
s_mul_i32 s35, s35, 57344
s_add_u32 s35, s35, s52
v_mov_b32 v251, 0
s_waitcnt vmcnt(8)
v_readfirstlane_b32 s46, v31
buffer_atomic_add v251, v4, s[4:7], s36 offen sc0 sc1
s_min_i32 s23, s78, 0
s_mul_i32 s23, s23, 16384
s_add_u32 s23, s23, s72
s_add_u32 s23, s23, 98304
s_add_u32 m0, s21, 16384
s_nop 0
lw 0
lw 1024
lw 2048
lw 3072
s_max_i32 s23, s76, 0
s_mul_i32 s23, s23, 16384
s_add_u32 s23, s23, s29
s_add_u32 s23, s23, 0
s_add_u32 m0, s21, 32768
s_nop 0
lw 0
lw 1024
lw 2048
lw 3072
s_cmp_ge_u32 s46, 15
s_cbranch_scc1 main_ok102
s_waitcnt vmcnt(8)
v_readfirstlane_b32 s46, v251
s_mov_b32 s47, 0
s_cmp_ge_u32 s46, 16
s_cbranch_scc1 main_ok102
main_poll101:
v_mov_b32 v31, 0
buffer_atomic_add v31, v4, s[4:7], s36 offen sc0 sc1
s_add_u32 s47, s47, 1
s_cmp_gt_u32 s47, 400000
s_cbranch_scc1 main_ok102
s_waitcnt vmcnt(0)
v_readfirstlane_b32 s46, v31
s_nop 0
s_cmp_lt_u32 s46, 16
s_cbranch_scc1 main_poll101
main_ok102:
s_max_i32 s24, s76, 0
s_mul_i32 s24, s24, 8192
s_add_u32 s24, s24, s35
s_add_u32 s24, s24, 0
lx 0,0
lx 4,1024
lx 8,2048
lx 12,3072
s_add_u32 s24, s24, 4096
lx 16,0
lx 20,1024
lx 24,2048
lx 28,3072
s_waitcnt vmcnt(7) lgkmcnt(5)
v_mfma_f32_16x16x32_bf16 v[136:139], v[48:51], a[0:3], 0
s_waitcnt vmcnt(6)
s_mul_i32 s24, s77, 8192
rd 76,1,39936
v_mfma_f32_16x16x32_bf16 v[140:143], v[48:51], a[4:7], 0
v_mfma_f32_16x16x32_bf16 v[148:151], v[52:55], a[4:7], 0
s_add_u32 s24, s24, s35
rd 48,1,40960
v_mfma_f32_16x16x32_bf16 v[144:147], v[52:55], a[0:3], 0
wl 5
v_mfma_f32_16x16x32_bf16 v[152:155], v[56:59], a[0:3], 0
s_add_u32 s24, s24, 8192
rd 52,1,41984
v_mfma_f32_16x16x32_bf16 v[156:159], v[56:59], a[4:7], 0
lx 32,0
v_mfma_f32_16x16x32_bf16 v[164:167], v[60:63], a[4:7], 0
rd 56,1,43008
v_mfma_f32_16x16x32_bf16 v[160:163], v[60:63], a[0:3], 0
s_waitcnt vmcnt(6) lgkmcnt(5)
lx 36,1024
mT 136,64,8
s_waitcnt vmcnt(6)
rd 60,1,44032
mT 140,64,12
lx 40,2048
mT 148,68,12
rd 64,1,45056
mT 144,68,8
wl 5
lx 44,3072
mT 152,72,8
s_add_u32 s24, s24, 4096
rd 68,1,46080
mT 156,72,12
lx 48,0
mT 164,76,12
rd 72,1,47104
mT 160,76,8
s_waitcnt vmcnt(8) lgkmcnt(5)
lx 52,1024
mT 136,48,16
s_waitcnt vmcnt(8)
rd 76,1,48128
mT 140,48,20
s_barrier
mT 148,52,20
rd 48,29,0
mT 144,52,16
wl 5
lx 56,2048
mT 152,56,16
rd 52,29,1024
mT 156,56,20
lx 60,3072
mT 164,60,20
s_mul_i32 s24, s78, 8192
rd 56,29,2048
mT 160,60,16
s_waitcnt vmcnt(9) lgkmcnt(5)
mT 136,64,24
s_waitcnt vmcnt(8)
s_add_u32 s24, s24, s35
rd 60,29,3072
mT 140,64,28
mT 148,68,28
s_add_u32 s24, s24, 16384
rd 64,29,4096
mT 144,68,24
wl 5
lx 64,0
mT 152,72,24
rd 68,29,5120
mT 156,72,28
lx 68,1024
mT 164,76,28
rd 72,29,6144
mT 160,76,24
s_waitcnt vmcnt(9) lgkmcnt(5)
lx 72,2048
mT 136,48,32
s_waitcnt vmcnt(9)
rd 76,29,7168
mT 140,48,36
lx 76,3072
mT 148,52,36
s_add_u32 s24, s24, 4096
rd 48,29,8192
mT 144,52,32
wl 5
lx 80,0
mT 152,56,32
rd 52,29,9216
mT 156,56,36
lx 84,1024
mT 164,60,36
rd 56,29,10240
mT 160,60,32
s_waitcnt vmcnt(11) lgkmcnt(5)
mT 136,64,40
s_waitcnt vmcnt(10)
rd 60,29,11264
mT 140,64,44
lx 88,2048
mT 148,68,44
rd 64,29,12288
mT 144,68,40
wl 5
lx 92,3072
mT 152,72,40
rd 68,29,13312
mT 156,72,44
mT 164,76,44
rd 72,29,14336
mT 160,76,40
s_waitcnt vmcnt(11) lgkmcnt(5)
mT 136,48,48
s_waitcnt vmcnt(10)
s_mul_i32 s24, s79, 8192
rd 76,29,15360
mT 140,48,52
s_barrier
mT 148,52,52
s_add_u32 s24, s24, s35
rd 48,0,0
mT 144,52,48
wl 5
mT 152,56,48
s_add_u32 s24, s24, 24576
rd 52,0,1024
mT 156,56,52
lx 96,0
mT 164,60,52
rd 56,0,2048
mT 160,60,48
s_waitcnt vmcnt(10) lgkmcnt(5)
lx 100,1024
mT 136,64,56
s_waitcnt vmcnt(10)
rd 60,0,3072
mT 140,64,60
lx 104,2048
mT 148,68,60
rd 64,0,4096
mT 144,68,56
wl 5
lx 108,3072
mT 152,72,56
rd 68,0,5120
mT 156,72,60
mT 164,76,60
rd 72,0,6144
mT 160,76,56
s_waitcnt vmcnt(11) lgkmcnt(5)
mT 136,48,64
s_waitcnt vmcnt(10)
s_add_u32 s24, s24, 4096
rd 76,0,7168
mT 140,48,68
lx 112,0
mT 148,52,68
rd 48,0,8192
mT 144,52,64
wl 5
lx 116,1024
mT 152,56,64
rd 52,0,9216
mT 156,56,68
mT 164,60,68
rd 56,0,10240
mT 160,60,64
s_waitcnt vmcnt(11) lgkmcnt(5)
mT 136,64,72
s_waitcnt vmcnt(10)
rd 60,0,11264
mT 140,64,76
lx 120,2048
mT 148,68,76
rd 64,0,12288
mT 144,68,72
wl 5
lx 124,3072
mT 152,72,72
rd 68,0,13312
mT 156,72,76
mT 164,76,76
rd 72,0,14336
mT 160,76,72
s_waitcnt vmcnt(11) lgkmcnt(5)
mT 136,48,80
s_waitcnt vmcnt(10)
s_mul_i32 s24, s76, 8192
rd 76,0,15360
mT 140,48,84
s_barrier
mT 148,52,84
s_add_u32 s24, s24, s35
rd 48,1,49152
mT 144,52,80
wl 5
mT 152,56,80
s_add_u32 s24, s24, 32768
rd 52,1,50176
mT 156,56,84
lx 128,0
mT 164,60,84
rd 56,1,51200
mT 160,60,80
s_waitcnt vmcnt(10) lgkmcnt(5)
lx 132,1024
mT 136,64,88
s_waitcnt vmcnt(10)
rd 60,1,52224
mT 140,64,92
lx 136,2048
mT 148,68,92
rd 64,1,53248
mT 144,68,88
wl 5
lx 140,3072
mT 152,72,88
rd 68,1,54272
mT 156,72,92
mT 164,76,92
rd 72,1,55296
mT 160,76,88
s_waitcnt vmcnt(11) lgkmcnt(5)
mT 136,48,96
s_waitcnt vmcnt(10)
s_add_u32 s24, s24, 4096
rd 76,1,56320
mT 140,48,100
lx 144,0
mT 148,52,100
rd 48,1,57344
mT 144,52,96
wl 5
lx 148,1024
mT 152,56,96
rd 52,1,58368
v_lshlrev_b32 v80, 16, v32
mT 156,56,100
v_and_b32 v81, 0xffff0000, v32
v_lshlrev_b32 v82, 16, v33
mT 164,60,100
rd 56,1,59392
v_and_b32 v83, 0xffff0000, v33
mT 160,60,96
s_waitcnt vmcnt(11) lgkmcnt(5)
v_lshlrev_b32 v88, 16, v34
v_and_b32 v89, 0xffff0000, v34
mT 136,64,104
s_waitcnt vmcnt(10)
rd 60,1,60416
v_lshlrev_b32 v90, 16, v35
mT 140,64,108
lx 152,2048
mT 148,68,108
rd 64,1,61440
v_and_b32 v91, 0xffff0000, v35
mT 144,68,104
wl 5
lx 156,3072
mT 152,72,104
rd 68,1,62464
v_lshlrev_b32 v96, 16, v36
mT 156,72,108
v_and_b32 v97, 0xffff0000, v36
v_lshlrev_b32 v98, 16, v37
mT 164,76,108
rd 72,1,63488
v_and_b32 v99, 0xffff0000, v37
mT 160,76,104
s_waitcnt vmcnt(11) lgkmcnt(5)
v_lshlrev_b32 v104, 16, v38
v_and_b32 v105, 0xffff0000, v38
mT 136,48,112
s_waitcnt vmcnt(10)
s_mul_i32 s24, s77, 8192
rd 76,1,64512
v_lshlrev_b32 v106, 16, v39
mT 140,48,116
s_barrier
v_and_b32 v107, 0xffff0000, v39
mT 148,52,116
s_add_u32 s24, s24, s35
rd 48,1,0
v_lshlrev_b32 v84, 16, v40
mT 144,52,112
wl 5
v_and_b32 v85, 0xffff0000, v40
v_lshlrev_b32 v86, 16, v41
mT 152,56,112
s_add_u32 s24, s24, 40960
rd 52,1,1024
v_and_b32 v87, 0xffff0000, v41
mT 156,56,116
lx 160,0
mT 164,60,116
rd 56,1,2048
v_lshlrev_b32 v92, 16, v42
mT 160,60,112
s_waitcnt vmcnt(10) lgkmcnt(5)
lx 164,1024
mT 136,64,120
s_waitcnt vmcnt(10)
rd 60,1,3072
v_and_b32 v93, 0xffff0000, v42
mT 140,64,124
lx 168,2048
mT 148,68,124
rd 64,1,4096
v_lshlrev_b32 v94, 16, v43
mT 144,68,120
wl 5
lx 172,3072
mT 152,72,120
rd 68,1,5120
v_and_b32 v95, 0xffff0000, v43
mT 156,72,124
v_lshlrev_b32 v100, 16, v44
v_and_b32 v101, 0xffff0000, v44
mT 164,76,124
rd 72,1,6144
v_lshlrev_b32 v102, 16, v45
mT 160,76,120
s_waitcnt vmcnt(11) lgkmcnt(5)
v_and_b32 v103, 0xffff0000, v45
v_lshlrev_b32 v108, 16, v46
mT 136,48,128
s_waitcnt vmcnt(10)
s_add_u32 s24, s24, 4096
rd 76,1,7168
v_and_b32 v109, 0xffff0000, v46
mT 140,48,132
lx 176,0
mT 148,52,132
rd 48,1,8192
v_lshlrev_b32 v110, 16, v47
mT 144,52,128
wl 5
lx 180,1024
mT 152,56,128
rd 52,1,9216
v_and_b32 v111, 0xffff0000, v47
mT 156,56,132
main_cp14:
s_mov_b32 s96, main_cp14-main_cp13
v_lshl_add_u64 v[2:3], v[2:3], 0, s[96:97]
global_load_dword v254, v[2:3], off
mT 164,60,132
rd 56,1,10240
mT 160,60,128
s_waitcnt vmcnt(12) lgkmcnt(5)
mT 136,64,136
s_waitcnt vmcnt(11)
rd 60,1,11264
mT 140,64,140
lx 184,2048
mT 148,68,140
rd 64,1,12288
mT 144,68,136
wl 5
lx 188,3072
mT 152,72,136
rd 68,1,13312
mT 156,72,140
mT 164,76,140
rd 72,1,14336
mT 160,76,136
s_waitcnt vmcnt(12) lgkmcnt(5)
mT 136,48,144
s_waitcnt vmcnt(11)
s_min_i32 s24, s78, 0
rd 76,1,15360
mT 140,48,148
s_barrier
mT 148,52,148
s_mul_i32 s24, s24, 8192
rd 48,1,16384
mT 144,52,144
wl 5
mT 152,56,144
s_add_u32 s24, s24, s35
rd 52,1,17408
mT 156,56,148
mT 164,60,148
s_add_u32 s24, s24, 49152
rd 56,1,18432
mT 160,60,144
s_waitcnt vmcnt(10) lgkmcnt(5)
lx 192,0
mT 136,64,152
s_waitcnt vmcnt(10)
rd 60,1,19456
mT 140,64,156
lx 196,1024
mT 148,68,156
rd 64,1,20480
mT 144,68,152
wl 5
lx 200,2048
mT 152,72,152
rd 68,1,21504
mT 156,72,156
lx 204,3072
mT 164,76,156
rd 72,1,22528
mT 160,76,152
s_waitcnt vmcnt(12) lgkmcnt(5)
mT 136,48,160
s_waitcnt vmcnt(11)
s_add_u32 s24, s24, 4096
rd 76,1,23552
mT 140,48,164
lx 208,0
mT 148,52,164
rd 48,1,24576
mT 144,52,160
wl 5
lx 212,1024
mT 152,56,160
rd 52,1,25600
mT 156,56,164
mT 164,60,164
rd 56,1,26624
mT 160,60,160
s_waitcnt vmcnt(12) lgkmcnt(5)
mT 136,64,168
s_waitcnt vmcnt(11)
rd 60,1,27648
mT 140,64,172
lx 216,2048
mT 148,68,172
rd 64,1,28672
mT 144,68,168
wl 5
lx 220,3072
mT 152,72,168
s_mul_i32 s23, s77, 16384
rd 68,1,29696
mT 156,72,172
mT 164,76,172
s_add_u32 s23, s23, s29
rd 72,1,30720
mT 160,76,168
s_waitcnt vmcnt(12) lgkmcnt(5)
mT 136,48,176
s_waitcnt vmcnt(11)
s_add_u32 s23, s23, 16384
rd 76,1,31744
mT 140,48,180
s_barrier
mT 148,52,180
s_add_u32 m0, s21, 49152
rd 48,0,16384
mT 144,52,176
wl 5
lw 0
mT 152,56,176
rd 52,0,17408
mT 156,56,180
lw 1024
mT 164,60,180
rd 56,0,18432
mT 160,60,176
s_waitcnt vmcnt(11) lgkmcnt(5)
lw 2048
mT 136,64,184
s_waitcnt vmcnt(11)
rd 60,0,19456
mT 140,64,188
lw 3072
mT 148,68,188
s_mul_i32 s23, s78, 16384
rd 64,0,20480
mT 144,68,184
wl 5
mT 152,72,184
s_add_u32 s23, s23, s29
rd 68,0,21504
mT 156,72,188
mT 164,76,188
s_add_u32 s23, s23, 32768
rd 72,0,22528
mT 160,76,184
s_waitcnt vmcnt(11) lgkmcnt(5)
mT 136,48,192
s_waitcnt vmcnt(10)
s_add_u32 m0, s21, 98304
rd 76,0,23552
mT 140,48,196
lw 0
mT 148,52,196
rd 48,0,24576
mT 144,52,192
wl 5
lw 1024
mT 152,56,192
rd 52,0,25600
mT 156,56,196
mT 164,60,196
rd 56,0,26624
mT 160,60,192
s_waitcnt vmcnt(11) lgkmcnt(5)
lw 2048
mT 136,64,200
s_waitcnt vmcnt(11)
rd 60,0,27648
mT 140,64,204
mT 148,68,204
rd 64,0,28672
mT 144,68,200
wl 5
lw 3072
mT 152,72,200
s_mul_i32 s23, s79, 16384
rd 68,0,29696
mT 156,72,204
mT 164,76,204
s_add_u32 s23, s23, s29
rd 72,0,30720
mT 160,76,200
s_waitcnt vmcnt(11) lgkmcnt(5)
mT 136,48,208
s_waitcnt vmcnt(10)
s_add_u32 s23, s23, 49152
rd 76,0,31744
mT 140,48,212
s_barrier
mT 148,52,212
s_add_u32 m0, s21, 131072
rd 48,0,32768
mT 144,52,208
wl 5
lw 0
mT 152,56,208
rd 52,0,33792
mT 156,56,212
mT 164,60,212
rd 56,0,34816
mT 160,60,208
s_waitcnt vmcnt(10) lgkmcnt(5)
lw 1024
mT 136,64,216
s_waitcnt vmcnt(10)
rd 60,0,35840
mT 140,64,220
mT 148,68,220
rd 64,0,36864
mT 144,68,216
wl 5
lw 2048
mT 152,72,216
rd 68,0,37888
mT 156,72,220
mT 164,76,220
rd 72,0,38912
mT 160,76,216
wl 5
lw 3072
mT 80,48,0
s_mul_i32 s23, s76, 16384
rd 76,0,39936
mT 84,48,4
mT 92,52,4
s_add_u32 s23, s23, s29
rd 48,0,40960
mT 88,52,0
wl 5
mT 96,56,0
s_add_u32 s23, s23, 65536
rd 52,0,41984
mT 100,56,4
mT 108,60,4
s_add_u32 m0, s21, 0
rd 56,0,43008
v_cvt_pk_bf16_f32 v168, v136, v137
v_cvt_pk_bf16_f32 v169, v138, v139
mT 104,60,0
wl 5
lw 0
v_cvt_pk_bf16_f32 v170, v144, v145
mT 80,64,8
rd 60,0,44032
v_cvt_pk_bf16_f32 v171, v146, v147
v_cvt_pk_bf16_f32 v172, v140, v141
mT 84,64,12
lw 1024
v_cvt_pk_bf16_f32 v173, v142, v143
mT 92,68,12
rd 64,0,45056
v_cvt_pk_bf16_f32 v174, v148, v149
v_cvt_pk_bf16_f32 v175, v150, v151
mT 88,68,8
wl 5
v_cvt_pk_bf16_f32 v176, v152, v153
v_cvt_pk_bf16_f32 v177, v154, v155
v_cvt_pk_bf16_f32 v178, v160, v161
mT 96,72,8
rd 68,0,46080
v_cvt_pk_bf16_f32 v179, v162, v163
v_cvt_pk_bf16_f32 v180, v156, v157
mT 100,72,12
lw 2048
v_cvt_pk_bf16_f32 v181, v158, v159
mT 108,76,12
rd 72,0,47104
v_cvt_pk_bf16_f32 v182, v164, v165
v_cvt_pk_bf16_f32 v183, v166, v167
mT 104,76,8
wl 5
s_xor_b32 s37, s17, 1
s_lshl_b32 s37, s37, 12
s_add_u32 s37, s37, s51
mT 80,48,16
rd 76,0,48128
buffer_store_dwordx4 v[168:171], v0, s[4:7], s37 offen offset:0 sc1
mT 84,48,20
s_waitcnt vmcnt(12)
s_barrier
buffer_store_dwordx4 v[172:175], v0, s[4:7], s37 offen offset:1024 sc1
mT 92,52,20
rd 48,0,49152
buffer_store_dwordx4 v[176:179], v0, s[4:7], s37 offen offset:2048 sc1
mT 88,52,16
wl 5
lw 3072
mT 96,56,16
rd 52,0,50176
buffer_store_dwordx4 v[180:183], v0, s[4:7], s37 offen offset:3072 sc1
mT 100,56,20
mT 108,60,20
rd 56,0,51200
mT 104,60,16
wl 5
mT 80,64,24
rd 60,0,52224
mT 84,64,28
mT 92,68,28
rd 64,0,53248
mT 88,68,24
wl 5
mT 96,72,24
rd 68,0,54272
mT 100,72,28
mT 108,76,28
rd 72,0,55296
mT 104,76,24
wl 5
mT 80,48,32
rd 76,0,56320
mT 84,48,36
mT 92,52,36
rd 48,0,57344
mT 88,52,32
wl 5
mT 96,56,32
rd 52,0,58368
mT 100,56,36
mT 108,60,36
rd 56,0,59392
mT 104,60,32
wl 5
mT 80,64,40
rd 60,0,60416
mT 84,64,44
mT 92,68,44
rd 64,0,61440
mT 88,68,40
wl 5
mT 96,72,40
rd 68,0,62464
mT 100,72,44
mT 108,76,44
rd 72,0,63488
mT 104,76,40
wl 5
mT 80,48,48
rd 76,0,64512
mT 84,48,52
s_waitcnt vmcnt(12)
s_barrier
mT 92,52,52
rd 48,1,32768
mT 88,52,48
wl 5
mT 96,56,48
rd 52,1,33792
mT 100,56,52
mT 108,60,52
rd 56,1,34816
mT 104,60,48
wl 5
mT 80,64,56
rd 60,1,35840
mT 84,64,60
mT 92,68,60
rd 64,1,36864
mT 88,68,56
wl 5
mT 96,72,56
rd 68,1,37888
mT 100,72,60
mT 108,76,60
rd 72,1,38912
mT 104,76,56
wl 5
mT 80,48,64
s_mul_i32 s23, s77, 16384
rd 76,1,39936
mT 84,48,68
mT 92,52,68
s_waitcnt vmcnt(0)
s_add_u32 s23, s23, s29
rd 48,1,40960
s_add_u32 s36, s3, 65536
v_mov_b32 v31, 1
mT 88,52,64
wl 5
buffer_atomic_add v31, v4, s[4:7], s36 offen sc1
mT 96,56,64
s_add_u32 s23, s23, 81920
rd 52,1,41984
mT 100,56,68
mT 108,60,68
s_add_u32 m0, s21, 114688
rd 56,1,43008
mT 104,60,64
wl 5
lw 0
mT 80,64,72
rd 60,1,44032
mT 84,64,76
mT 92,68,76
rd 64,1,45056
mT 88,68,72
wl 5
lw 1024
mT 96,72,72
rd 68,1,46080
mT 100,72,76
mT 108,76,76
rd 72,1,47104
mT 104,76,72
wl 5
lw 2048
v_mov_b32 v31, 0
mT 80,48,80
rd 76,1,48128
buffer_atomic_add v31, v4, s[4:7], s36 offen sc0 sc1
mT 84,48,84
s_barrier
s_xor_b32 s37, s37, 4096
mT 92,52,84
rd 48,29,0
mT 88,52,80
wl 5
lw 3072
mT 96,56,80
s_min_i32 s23, s78, 0
rd 52,29,1024
mT 100,56,84
mT 108,60,84
s_mul_i32 s23, s23, 16384
rd 56,29,2048
mT 104,60,80
wl 5
mT 80,64,88
s_add_u32 s23, s23, s29
rd 60,29,3072
mT 84,64,92
mT 92,68,92
s_add_u32 s23, s23, 98304
rd 64,29,4096
mT 88,68,88
wl 5
mT 96,72,88
s_add_u32 m0, s21, 65536
rd 68,29,5120
mT 100,72,92
lw 0
mT 108,76,92
rd 72,29,6144
mT 104,76,88
wl 5
mT 80,48,96
rd 76,29,7168
mT 84,48,100
lw 1024
mT 92,52,100
rd 48,29,8192
mT 88,52,96
wl 5
mT 96,56,96
rd 52,29,9216
mT 100,56,100
lw 2048
mT 108,60,100
rd 56,29,10240
mT 104,60,96
wl 5
mT 80,64,104
rd 60,29,11264
mT 84,64,108
lw 3072
mT 92,68,108
s_max_i32 s23, s76, 0
rd 64,29,12288
mT 88,68,104
wl 5
mT 96,72,104
s_mul_i32 s23, s23, 16384
rd 68,29,13312
mT 100,72,108
mT 108,76,108
s_add_u32 s23, s23, s25
rd 72,29,14336
mT 104,76,104
wl 5
mT 80,48,112
s_add_u32 s23, s23, 0
rd 76,29,15360
mT 84,48,116
s_barrier
mT 92,52,116
s_add_u32 m0, s21, 81920
rd 48,0,0
mT 88,52,112
wl 5
lw 0
mT 96,56,112
rd 52,0,1024
mT 100,56,116
mT 108,60,116
rd 56,0,2048
mT 104,60,112
wl 5
lw 1024
mT 80,64,120
rd 60,0,3072
mT 84,64,124
mT 92,68,124
rd 64,0,4096
mT 88,68,120
wl 5
lw 2048
mT 96,72,120
rd 68,0,5120
mT 100,72,124
mT 108,76,124
s_waitcnt vmcnt(8)
rd 72,0,6144
v_readfirstlane_b32 s46, v31
s_nop 0
s_nop 0
s_cmp_ge_u32 s46, 2
s_cbranch_scc1 main_ok104
s_mov_b32 s47, 0
main_poll103:
v_mov_b32 v31, 0
buffer_atomic_add v31, v4, s[4:7], s36 offen sc0 sc1
s_add_u32 s47, s47, 1
s_cmp_gt_u32 s47, 400000
s_cbranch_scc1 main_ok104
s_waitcnt vmcnt(0)
v_readfirstlane_b32 s46, v31
s_nop 0
s_cmp_lt_u32 s46, 2
s_cbranch_scc1 main_poll103
main_ok104:
mT 104,76,120
wl 5
lw 3072
mT 80,48,128
s_max_i32 s23, s76, 0
rd 76,0,7168
buffer_load_dwordx4 v[168:171], v0, s[4:7], s37 offen offset:0 sc1
mT 84,48,132
mT 92,52,132
s_mul_i32 s23, s23, 16384
rd 48,0,8192
buffer_load_dwordx4 v[172:175], v0, s[4:7], s37 offen offset:1024 sc1
mT 88,52,128
wl 5
mT 96,56,128
s_add_u32 s23, s23, s25
rd 52,0,9216
buffer_load_dwordx4 v[176:179], v0, s[4:7], s37 offen offset:2048 sc1
mT 100,56,132
mT 108,60,132
s_add_u32 s23, s23, 131072
rd 56,0,10240
buffer_load_dwordx4 v[180:183], v0, s[4:7], s37 offen offset:3072 sc1
mT 104,60,128
wl 5
mT 80,64,136
s_add_u32 m0, s21, 16384
rd 60,0,11264
mT 84,64,140
lw 0
mT 92,68,140
rd 64,0,12288
mT 88,68,136
wl 5
mT 96,72,136
rd 68,0,13312
mT 100,72,140
lw 1024
mT 108,76,140
rd 72,0,14336
mT 104,76,136
wl 5
mT 80,48,144
rd 76,0,15360
mT 84,48,148
s_waitcnt vmcnt(14)
s_barrier
mT 92,52,148
rd 48,1,49152
mT 88,52,144
wl 5
lw 2048
mT 96,56,144
rd 52,1,50176
mT 100,56,148
mT 108,60,148
rd 56,1,51200
mT 104,60,144
wl 5
lw 3072
mT 80,64,152
s_mul_i32 s23, s77, 16384
rd 60,1,52224
mT 84,64,156
mT 92,68,156
s_add_u32 s23, s23, s25
rd 64,1,53248
mT 88,68,152
wl 5
mT 96,72,152
s_add_u32 s23, s23, 16384
rd 68,1,54272
mT 100,72,156
mT 108,76,156
s_add_u32 m0, s21, 32768
rd 72,1,55296
mT 104,76,152
wl 5
lw 0
mT 80,48,160
rd 76,1,56320
mT 84,48,164
mT 92,52,164
rd 48,1,57344
mT 88,52,160
wl 5
lw 1024
mT 96,56,160
rd 52,1,58368
mT 100,56,164
mT 108,60,164
rd 56,1,59392
mT 104,60,160
wl 5
lw 2048
mT 80,64,168
rd 60,1,60416
mT 84,64,172
mT 92,68,172
rd 64,1,61440
mT 88,68,168
wl 5
lw 3072
mT 96,72,168
s_mul_i32 s23, s78, 16384
rd 68,1,62464
mT 100,72,172
main_cp15:
s_mov_b32 s96, main_cp15-main_cp14
v_lshl_add_u64 v[2:3], v[2:3], 0, s[96:97]
global_load_dword v254, v[2:3], off
mT 108,76,172
s_add_u32 s23, s23, s25
rd 72,1,63488
mT 104,76,168
wl 5
mT 80,48,176
s_add_u32 s23, s23, 32768
rd 76,1,64512
mT 84,48,180
s_waitcnt vmcnt(17)
s_barrier
mT 92,52,180
s_add_u32 m0, s21, 49152
rd 48,1,0
mT 88,52,176
wl 5
lw 0
mT 96,56,176
rd 52,1,1024
mT 100,56,180
lw 1024
lw 2048
mT 108,60,180
s_waitcnt vmcnt(15)
rd 56,1,4096
v_mfma_f32_16x16x32_bf16 v[80:83], v[18:21], v[168:171], v[80:83]
v_mfma_f32_16x16x32_bf16 v[88:91], v[16:19], v[168:171], v[88:91]
s_waitcnt vmcnt(14)
v_mfma_f32_16x16x32_bf16 v[84:87], v[18:21], v[172:175], v[84:87]
v_mfma_f32_16x16x32_bf16 v[92:95], v[16:19], v[172:175], v[92:95]
s_waitcnt vmcnt(13)
v_mfma_f32_16x16x32_bf16 v[96:99], v[18:21], v[176:179], v[96:99]
v_mfma_f32_16x16x32_bf16 v[104:107], v[16:19], v[176:179], v[104:107]
s_waitcnt vmcnt(12)
v_mfma_f32_16x16x32_bf16 v[100:103], v[18:21], v[180:183], v[100:103]
v_mfma_f32_16x16x32_bf16 v[108:111], v[16:19], v[180:183], v[108:111]
mT 104,60,176
wl 5
lw 3072
mT 80,64,184
s_mul_i32 s23, s79, 16384
rd 60,1,5120
mT 84,64,188
mT 92,68,188
s_add_u32 s23, s23, s25
rd 64,1,8192
mT 88,68,184
wl 5
mT 96,72,184
s_add_u32 s23, s23, 49152
rd 68,1,9216
mT 100,72,188
mT 108,76,188
s_add_u32 m0, s21, 98304
rd 72,1,12288
mT 104,76,184
wl 5
lw 0
mT 80,48,192
rd 76,1,13312
mT 84,48,196
mT 92,52,196
rd 48,1,2048
mT 88,52,192
wl 5
lw 1024
mT 80,56,200
rd 52,1,3072
mT 84,56,204
mT 92,60,204
rd 56,1,6144
mT 88,60,200
wl 5
lw 2048
mT 80,64,208
rd 60,1,7168
mT 84,64,212
mT 92,68,212
rd 64,1,10240
mT 88,68,208
wl 5
lw 3072
mT 80,72,216
s_mul_i32 s23, s76, 16384
rd 68,1,11264
mT 84,72,220
mT 92,76,220
s_add_u32 s23, s23, s25
rd 72,1,14336
mT 88,76,216
wl 5
mT 96,48,192
s_add_u32 s23, s23, 65536
rd 76,1,15360
mT 100,48,196
mT 108,52,196
s_add_u32 m0, s21, 0
mT 104,52,192
wl 4
lw 0
mT 96,56,200
s_lshl_b32 s32, s17, 12
s_add_u32 s32, s32, s51
s_add_u32 s32, s32, 0
v_cvt_pk_bf16_f32 v32, v80, v81
mT 100,56,204
lw 1024
v_cvt_pk_bf16_f32 v33, v82, v83
mT 108,60,204
v_cvt_pk_bf16_f32 v34, v88, v89
v_cvt_pk_bf16_f32 v35, v90, v91
mT 104,60,200
wl 3
buffer_store_dwordx4 v[32:35], v0, s[4:7], s32 offen offset:0 sc1
v_cvt_pk_bf16_f32 v40, v84, v85
mT 96,64,208
v_cvt_pk_bf16_f32 v41, v86, v87
v_cvt_pk_bf16_f32 v42, v92, v93
v_cvt_pk_bf16_f32 v43, v94, v95
mT 100,64,212
wl 2
lw 2048
mT 108,68,212
buffer_store_dwordx4 v[40:43], v0, s[4:7], s32 offen offset:1024 sc1
v_dot2_f32_bf16 v220, v32, v24, 0
mT 104,68,208
wl 1
v_dot2_f32_bf16 v222, v32, v32, 0
v_dot2_f32_bf16 v221, v40, v24, 0
v_dot2_f32_bf16 v223, v40, v40, 0
mT 96,72,216
v_dot2_f32_bf16 v220, v33, v24, v220
v_dot2_f32_bf16 v222, v33, v33, v222
v_dot2_f32_bf16 v221, v41, v24, v221
mT 100,72,220
wl 0
lw 3072
v_dot2_f32_bf16 v223, v41, v41, v223
mT 108,76,220
v_dot2_f32_bf16 v220, v34, v24, v220
v_dot2_f32_bf16 v222, v34, v34, v222
v_dot2_f32_bf16 v221, v42, v24, v221
mT 104,76,216
v_dot2_f32_bf16 v223, v42, v42, v223
v_dot2_f32_bf16 v220, v35, v24, v220
v_dot2_f32_bf16 v222, v35, v35, v222
v_dot2_f32_bf16 v221, v43, v24, v221
v_dot2_f32_bf16 v223, v43, v43, v223
v_cvt_pk_bf16_f32 v36, v96, v97
v_cvt_pk_bf16_f32 v37, v98, v99
s_nop 0
v_cvt_pk_bf16_f32 v38, v104, v105
v_cvt_pk_bf16_f32 v39, v106, v107
buffer_store_dwordx4 v[36:39], v0, s[4:7], s32 offen offset:2048 sc1
v_cvt_pk_bf16_f32 v44, v100, v101
v_cvt_pk_bf16_f32 v45, v102, v103
v_cvt_pk_bf16_f32 v46, v108, v109
v_cvt_pk_bf16_f32 v47, v110, v111
buffer_store_dwordx4 v[44:47], v0, s[4:7], s32 offen offset:3072 sc1
v_dot2_f32_bf16 v220, v36, v24, v220
v_dot2_f32_bf16 v222, v36, v36, v222
v_dot2_f32_bf16 v221, v44, v24, v221
v_dot2_f32_bf16 v223, v44, v44, v223
v_dot2_f32_bf16 v220, v37, v24, v220
v_dot2_f32_bf16 v222, v37, v37, v222
v_dot2_f32_bf16 v221, v45, v24, v221
v_dot2_f32_bf16 v223, v45, v45, v223
v_dot2_f32_bf16 v220, v38, v24, v220
v_dot2_f32_bf16 v222, v38, v38, v222
v_dot2_f32_bf16 v221, v46, v24, v221
v_dot2_f32_bf16 v223, v46, v46, v223
v_dot2_f32_bf16 v220, v39, v24, v220
v_dot2_f32_bf16 v222, v39, v39, v222
v_dot2_f32_bf16 v221, v47, v24, v221
v_dot2_f32_bf16 v223, v47, v47, v223
s_nop 1
v_permlane32_swap_b32 v220, v221
v_permlane32_swap_b32 v222, v223
v_add_f32 v220, v220, v221
v_add_f32 v222, v222, v223
s_nop 1
v_permlane16_swap_b32 v220, v222
v_add_f32 v220, v220, v222
s_lshl_b32 s33, s17, 8
s_add_u32 s33, s33, s54
s_add_u32 s33, s33, 0
buffer_store_dword v220, v6, s[4:7], s33 offen sc1
s_add_u32 s48, s48, 524288
s_add_u32 s49, s49, 524288
s_add_u32 s50, s50, 524288
s_add_u32 s3, s3, 524288
s_add_u32 s42, s42, 524288
s_add_u32 s36, s48, 0
v_mov_b32 v31, 1
s_waitcnt vmcnt(0)
buffer_atomic_add v31, v4, s[4:7], s36 offen sc0 sc1
s_barrier
s_mul_i32 s23, s77, 16384
s_add_u32 s23, s23, s25
s_add_u32 s23, s23, 81920
s_add_u32 m0, s21, 114688
s_nop 0
lw 0
lw 1024
lw 2048
lw 3072
s_mul_i32 s23, s78, 16384
s_add_u32 s23, s23, s25
s_add_u32 s23, s23, 98304
s_add_u32 m0, s21, 65536
s_nop 0
lw 0
lw 1024
lw 2048
lw 3072
s_mov_b32 s19, 1
s_barrier
rd 48,1,16384
rd 52,1,17408
rd 56,1,18432
rd 60,1,19456
rd 64,0,16384
rd 68,0,17408
rd 72,0,18432
v_mov_b32 v251, 0
s_waitcnt vmcnt(8)
v_readfirstlane_b32 s46, v31
buffer_atomic_add v251, v4, s[4:7], s36 offen sc0 sc1
s_cmp_ge_u32 s46, 15
s_cbranch_scc1 main_ok130
s_waitcnt vmcnt(0)
v_readfirstlane_b32 s46, v251
s_mov_b32 s47, 0
s_cmp_ge_u32 s46, 16
s_cbranch_scc1 main_ok130
main_poll129:
v_mov_b32 v31, 0
buffer_atomic_add v31, v4, s[4:7], s36 offen sc0 sc1
s_add_u32 s47, s47, 1
s_cmp_gt_u32 s47, 400000
s_cbranch_scc1 main_ok130
s_waitcnt vmcnt(0)
v_readfirstlane_b32 s46, v31
s_nop 0
s_cmp_lt_u32 s46, 16
s_cbranch_scc1 main_poll129
main_ok130:
s_max_i32 s24, s76, 0
s_mul_i32 s24, s24, 8192
s_add_u32 s24, s24, s51
s_add_u32 s24, s24, 0
lx 0,0
lx 4,1024
lx 8,2048
lx 12,3072
s_add_u32 s24, s24, 4096
lx 16,0
lx 20,1024
lx 24,2048
lx 28,3072
s_waitcnt vmcnt(7) lgkmcnt(5)
v_mfma_f32_16x16x32_bf16 v[80:83], a[0:3], v[48:51], 0
s_waitcnt vmcnt(6)
s_mul_i32 s24, s77, 8192
rd 76,0,19456
v_mfma_f32_16x16x32_bf16 v[84:87], a[4:7], v[48:51], 0
v_mfma_f32_16x16x32_bf16 v[92:95], a[4:7], v[52:55], 0
s_add_u32 s24, s24, s51
rd 48,1,20480
v_mfma_f32_16x16x32_bf16 v[88:91], a[0:3], v[52:55], 0
wl 5
v_mfma_f32_16x16x32_bf16 v[96:99], a[0:3], v[56:59], 0
s_add_u32 s24, s24, 8192
rd 52,1,21504
v_mfma_f32_16x16x32_bf16 v[100:103], a[4:7], v[56:59], 0
lx 32,0
v_mfma_f32_16x16x32_bf16 v[108:111], a[4:7], v[60:63], 0
rd 56,1,22528
v_mfma_f32_16x16x32_bf16 v[104:107], a[0:3], v[60:63], 0
wl 5
lx 36,1024
v_mfma_f32_16x16x32_bf16 v[136:139], a[0:3], v[64:67], 0
rd 60,1,23552
v_mfma_f32_16x16x32_bf16 v[140:143], a[4:7], v[64:67], 0
v_mfma_f32_16x16x32_bf16 v[148:151], a[4:7], v[68:71], 0
rd 64,0,20480
v_mfma_f32_16x16x32_bf16 v[144:147], a[0:3], v[68:71], 0
wl 5
lx 40,2048
v_mfma_f32_16x16x32_bf16 v[152:155], a[0:3], v[72:75], 0
rd 68,0,21504
v_mfma_f32_16x16x32_bf16 v[156:159], a[4:7], v[72:75], 0
v_mfma_f32_16x16x32_bf16 v[164:167], a[4:7], v[76:79], 0
rd 72,0,22528
v_mfma_f32_16x16x32_bf16 v[160:163], a[0:3], v[76:79], 0
s_waitcnt vmcnt(8) lgkmcnt(5)
lx 44,3072
mF 80,48,8
s_waitcnt vmcnt(8)
s_add_u32 s24, s24, 4096
rd 76,0,23552
mF 84,48,12
mF 92,52,12
rd 48,1,24576
mF 88,52,8
wl 5
lx 48,0
mF 96,56,8
rd 52,1,25600
mF 100,56,12
lx 52,1024
mF 108,60,12
rd 56,1,26624
mF 104,60,8
wl 5
mF 136,64,8
rd 60,1,27648
mF 140,64,12
lx 56,2048
mF 148,68,12
rd 64,0,24576
mF 144,68,8
wl 5
mF 152,72,8
rd 68,0,25600
mF 156,72,12
lx 60,3072
mF 164,76,12
s_mul_i32 s24, s78, 8192
rd 72,0,26624
mF 160,76,8
s_waitcnt vmcnt(11) lgkmcnt(5)
mF 80,48,16
s_waitcnt vmcnt(10)
s_add_u32 s24, s24, s51
rd 76,0,27648
mF 84,48,20
mF 92,52,20
s_add_u32 s24, s24, 16384
rd 48,1,28672
mF 88,52,16
wl 5
lx 64,0
mF 96,56,16
rd 52,1,29696
mF 100,56,20
lx 68,1024
mF 108,60,20
rd 56,1,30720
mF 104,60,16
wl 5
mF 136,64,16
rd 60,1,31744
mF 140,64,20
lx 72,2048
mF 148,68,20
rd 64,0,28672
mF 144,68,16
wl 5
mF 152,72,16
rd 68,0,29696
mF 156,72,20
lx 76,3072
mF 164,76,20
s_add_u32 s24, s24, 4096
rd 72,0,30720
mF 160,76,16
s_waitcnt vmcnt(13) lgkmcnt(5)
mF 80,48,24
s_waitcnt vmcnt(12)
rd 76,0,31744
mF 84,48,28
s_barrier
mF 92,52,28
rd 48,0,32768
mF 88,52,24
wl 5
lx 80,0
mF 96,56,24
rd 52,0,33792
mF 100,56,28
lx 84,1024
mF 108,60,28
rd 56,0,34816
mF 104,60,24
wl 5
mF 136,64,24
rd 60,0,35840
mF 140,64,28
lx 88,2048
mF 148,68,28
rd 64,0,36864
mF 144,68,24
wl 5
mF 152,72,24
s_add_u32 s37, s54, 0
rd 68,0,37888
mF 156,72,28
lx 92,3072
mF 164,76,28
rd 72,0,38912
mF 160,76,24
s_waitcnt vmcnt(15) lgkmcnt(5)
buffer_load_dwordx4 v[220:223], v0, s[4:7], s37 offen offset:0 sc1
mF 80,48,32
s_waitcnt vmcnt(15)
s_mul_i32 s24, s79, 8192
rd 76,0,39936
mF 84,48,36
mF 92,52,36
s_add_u32 s24, s24, s51
rd 48,0,40960
mF 88,52,32
wl 5
mF 96,56,32
s_add_u32 s24, s24, 24576
rd 52,0,41984
mF 100,56,36
lx 96,0
mF 108,60,36
rd 56,0,43008
mF 104,60,32
s_waitcnt vmcnt(15) lgkmcnt(5)
lx 100,1024
mF 80,64,40
s_waitcnt vmcnt(15)
rd 60,0,44032
mF 84,64,44
mF 92,68,44
rd 64,0,45056
mF 88,68,40
wl 5
buffer_load_dwordx4 v[224:227], v0, s[4:7], s37 offen offset:1024 sc1
mF 96,72,40
rd 68,0,46080
mF 100,72,44
mF 108,76,44
rd 72,0,47104
mF 104,76,40
s_waitcnt vmcnt(15) lgkmcnt(5)
buffer_load_dwordx4 v[228:231], v0, s[4:7], s37 offen offset:2048 sc1
mF 80,48,48
s_waitcnt vmcnt(15)
rd 76,0,48128
mF 84,48,52
s_barrier
mF 92,52,52
rd 48,0,49152
mF 88,52,48
wl 5
buffer_load_dwordx4 v[232:235], v0, s[4:7], s37 offen offset:3072 sc1
mF 96,56,48
rd 52,0,50176
mF 100,56,52
lx 104,2048
mF 108,60,52
rd 56,0,51200
mF 104,60,48
s_waitcnt vmcnt(16) lgkmcnt(5)
mF 80,64,56
s_waitcnt vmcnt(15)
rd 60,0,52224
mF 84,64,60
lx 108,3072
mF 92,68,60
s_add_u32 s24, s24, 4096
rd 64,0,53248
mF 88,68,56
wl 5
mF 96,72,56
rd 68,0,54272
mF 100,72,60
lx 112,0
mF 108,76,60
rd 72,0,55296
mF 104,76,56
s_waitcnt vmcnt(16) lgkmcnt(5)
lx 116,1024
mF 80,48,64
s_waitcnt vmcnt(16)
rd 76,0,56320
mF 84,48,68
mF 92,52,68
rd 48,0,57344
mF 88,52,64
wl 5
lx 120,2048
mF 96,56,64
rd 52,0,58368
mF 100,56,68
mF 108,60,68
rd 56,0,59392
mF 104,60,64
s_waitcnt vmcnt(16) lgkmcnt(5)
lx 124,3072
mF 80,64,72
s_waitcnt vmcnt(16)
s_mul_i32 s24, s76, 8192
rd 60,0,60416
mF 84,64,76
mF 92,68,76
s_add_u32 s24, s24, s51
rd 64,0,61440
mF 88,68,72
wl 5
mF 96,72,72
s_add_u32 s24, s24, 32768
rd 68,0,62464
mF 100,72,76
lx 128,0
mF 108,76,76
rd 72,0,63488
mF 104,76,72
s_waitcnt vmcnt(16) lgkmcnt(5)
lx 132,1024
mF 80,48,80
s_waitcnt vmcnt(16)
rd 76,0,64512
mF 84,48,84
s_barrier
mF 92,52,84
rd 48,1,32768
mF 88,52,80
wl 5
lx 136,2048
mF 96,56,80
rd 52,1,33792
mF 100,56,84
mF 108,60,84
rd 56,1,34816
mF 104,60,80
s_waitcnt vmcnt(16) lgkmcnt(5)
lx 140,3072
mF 80,64,88
s_waitcnt vmcnt(16)
s_add_u32 s24, s24, 4096
rd 60,1,35840
mF 84,64,92
lx 144,0
mF 92,68,92
rd 64,1,36864
mF 88,68,88
wl 5
mF 96,72,88
rd 68,1,37888
mF 100,72,92
lx 148,1024
mF 108,76,92
rd 72,1,38912
mF 104,76,88
s_waitcnt vmcnt(16) lgkmcnt(5)
mF 80,48,96
s_waitcnt vmcnt(15)
rd 76,1,39936
mF 84,48,100
lx 152,2048
mF 92,52,100
rd 48,1,40960
mF 88,52,96
wl 5
lx 156,3072
mF 96,56,96
s_mul_i32 s24, s77, 8192
rd 52,1,41984
mF 100,56,100
mF 108,60,100
s_add_u32 s24, s24, s51
rd 56,1,43008
mF 104,60,96
s_waitcnt vmcnt(13) lgkmcnt(5)
mF 80,64,104
s_waitcnt vmcnt(12)
s_add_u32 s24, s24, 40960
rd 60,1,44032
mF 84,64,108
lx 160,0
mF 92,68,108
rd 64,1,45056
mF 88,68,104
wl 5
lx 164,1024
mF 96,72,104
rd 68,1,46080
mF 100,72,108
mF 108,76,108
rd 72,1,47104
mF 104,76,104
s_waitcnt vmcnt(13) lgkmcnt(5)
lx 168,2048
mF 80,48,112
s_waitcnt vmcnt(13)
rd 76,1,48128
mF 84,48,116
s_barrier
mF 92,52,116
rd 48,0,0
mF 88,52,112
wl 5
lx 172,3072
mF 96,56,112
s_add_u32 s24, s24, 4096
rd 52,0,1024
mF 100,56,116
lx 176,0
mF 108,60,116
rd 56,0,2048
v_add_f32 v220, v220, v224
v_add_f32 v221, v221, v225
mF 104,60,112
s_waitcnt vmcnt(14) lgkmcnt(5)
v_add_f32 v222, v222, v226
v_add_f32 v223, v223, v227
v_add_f32 v228, v228, v232
mF 80,64,120
s_waitcnt vmcnt(13)
rd 60,0,3072
v_add_f32 v229, v229, v233
v_add_f32 v230, v230, v234
mF 84,64,124
lx 180,1024
v_add_f32 v231, v231, v235
mF 92,68,124
rd 64,0,4096
v_add_f32 v220, v220, v228
v_add_f32 v221, v221, v229
mF 88,68,120
wl 5
lx 184,2048
v_add_f32 v222, v222, v230
mF 96,72,120
rd 68,0,5120
v_add_f32 v223, v223, v231
v_permlane32_swap_b32 v220, v222
mF 100,72,124
lx 188,3072
v_permlane32_swap_b32 v221, v223
mF 108,76,124
s_mul_i32 s24, s78, 8192
rd 72,0,6144
v_add_f32 v220, v220, v222
v_add_f32 v221, v221, v223
mF 104,76,120
s_waitcnt vmcnt(15) lgkmcnt(5)
v_permlane16_swap_b32 v220, v221
v_add_f32 v220, v220, v221
mF 80,48,128
s_waitcnt vmcnt(14)
s_add_u32 s24, s24, s51
rd 76,0,7168
ds_write_b32 v13, v220
mF 84,48,132
ds_read2_b32 v[224:225], v14 offset0:0 offset1:16
ds_read2_b32 v[226:227], v14 offset0:32 offset1:48
mF 92,52,132
s_add_u32 s24, s24, 49152
rd 48,0,8192
mF 88,52,128
wl 8
lx 192,0
mF 96,56,128
rd 52,0,9216
mF 100,56,132
lx 196,1024
mF 108,60,132
rd 56,0,10240
mF 104,60,128
main_cp16:
s_mov_b32 s96, main_cp16-main_cp15
v_lshl_add_u64 v[2:3], v[2:3], 0, s[96:97]
global_load_dword v254, v[2:3], off
s_waitcnt vmcnt(16) lgkmcnt(8)
mF 80,64,136
s_waitcnt vmcnt(15)
rd 60,0,11264
mF 84,64,140
wl 5
lx 200,2048
v_mul_f32 v216, 0xba800000, v224
mF 92,68,140
wl 4
rd 64,0,12288
v_mul_f32 v218, 0xba800000, v226
v_mul_f32 v225, 0x3a800000, v225
mF 88,68,136
lx 204,3072
v_mul_f32 v227, 0x3a800000, v227
mF 96,72,136
s_add_u32 s24, s24, 4096
rd 68,0,13312
v_fma_f32 v225, -v216, v216, v225
v_fma_f32 v227, -v218, v218, v227
mF 100,72,140
v_max_f32 v225, 0, v225
v_max_f32 v227, 0, v227
v_add_f32 v225, s44, v225
mF 108,76,140
rd 72,0,14336
v_add_f32 v227, s44, v227
mF 104,76,136
s_waitcnt vmcnt(16) lgkmcnt(5)
lx 208,0
mF 80,48,144
s_waitcnt vmcnt(16)
rd 76,0,15360
v_rsq_f32 v217, v225
mF 84,48,148
s_barrier
v_rsq_f32 v219, v227
mF 92,52,148
s_min_i32 s23, s79, 0
rd 48,1,49152
ds_write2_b32 v14, v216, v217 offset0:64 offset1:80
mF 88,52,144
wl 6
lx 212,1024
mF 96,56,144
s_mul_i32 s23, s23, 16384
rd 52,1,50176
ds_write2_b32 v14, v218, v219 offset0:96 offset1:112
mF 100,56,148
rd 200,15,256
rd 204,15,320
rd 208,15,384
mF 108,60,148
s_add_u32 s23, s23, s25
rd 56,1,51200
rd 212,15,448
mF 104,60,144
s_waitcnt vmcnt(16) lgkmcnt(11)
mF 80,64,152
s_waitcnt vmcnt(15)
s_add_u32 s23, s23, 114688
rd 60,1,52224
mF 84,64,156
mF 92,68,156
s_add_u32 m0, s21, 81920
rd 64,1,53248
mF 88,68,152
wl 11
lw 0
mF 96,72,152
rd 68,1,54272
mF 100,72,156
lw 1024
mF 108,76,156
rd 72,1,55296
ds_read_b32 v236, v11 offset:0
ds_read_b32 v240, v11 offset:256
mF 104,76,152
s_waitcnt vmcnt(16) lgkmcnt(13)
lw 2048
ds_read_b32 v237, v11 offset:64
mF 80,48,160
s_waitcnt vmcnt(16)
rd 76,1,56320
ds_read_b32 v241, v11 offset:320
ds_read_b32 v238, v11 offset:128
mF 84,48,164
wl 15
lw 3072
ds_read_b32 v242, v11 offset:384
mF 92,52,164
rd 48,1,57344
ds_read_b32 v239, v11 offset:192
ds_read_b32 v243, v11 offset:448
mF 88,52,160
wl 14
mF 96,56,160
rd 52,1,58368
mF 100,56,164
wl 13
lx 216,2048
mF 108,60,164
rd 56,1,59392
mF 104,60,160
s_waitcnt vmcnt(17)
lx 220,3072
mF 80,64,168
s_waitcnt vmcnt(17)
s_min_i32 s24, s79, 0
rd 60,1,60416
mF 84,64,172
wl 13
mF 92,68,172
s_mul_i32 s24, s24, 8192
rd 64,1,61440
mF 88,68,168
mF 96,72,168
s_add_u32 s24, s24, s51
rd 68,1,62464
mF 100,72,172
wl 10
mF 108,76,172
s_add_u32 s24, s24, 57344
rd 72,1,63488
mF 104,76,168
s_waitcnt vmcnt(16) lgkmcnt(7)
lx 224,0
mF 80,48,176
s_waitcnt vmcnt(16)
rd 76,1,64512
mF 84,48,180
wl 5
s_barrier
mF 92,52,180
rd 48,1,0
mF 88,52,176
lx 228,1024
mF 96,56,176
rd 52,1,1024
mF 100,56,180
wl 5
lx 232,2048
mF 108,60,180
rd 56,1,2048
mF 104,60,176
s_waitcnt vmcnt(17)
lx 236,3072
mF 80,64,184
s_waitcnt vmcnt(17)
s_add_u32 s24, s24, 4096
rd 60,1,3072
mF 84,64,188
wl 5
lx 240,0
mF 92,68,188
s_mul_i32 s23, s77, 16384
rd 64,1,4096
mF 88,68,184
lx 244,1024
mF 96,72,184
s_add_u32 s23, s23, s25
rd 68,1,5120
mF 100,72,188
wl 5
mF 108,76,188
s_add_u32 s23, s23, 147456
rd 72,1,6144
mF 104,76,184
s_waitcnt vmcnt(18)
mF 80,48,192
s_waitcnt vmcnt(17)
s_add_u32 m0, s21, 16384
rd 76,1,7168
mF 84,48,196
wl 5
lw 0
mF 92,52,196
rd 48,1,8192
mF 88,52,192
lw 1024
mF 96,56,192
rd 52,1,9216
mF 100,56,196
wl 5
lw 2048
mF 108,60,196
rd 56,1,10240
mF 104,60,192
s_waitcnt vmcnt(18)
lw 3072
mF 80,64,200
s_waitcnt vmcnt(18)
rd 60,1,11264
mF 84,64,204
wl 5
lx 248,2048
mF 92,68,204
rd 64,1,12288
mF 88,68,200
lx 252,3072
mF 96,72,200
s_mul_i32 s23, s78, 16384
rd 68,1,13312
mF 100,72,204
wl 5
mF 108,76,204
s_add_u32 s23, s23, s25
rd 72,1,14336
mF 104,76,200
s_waitcnt vmcnt(19)
mF 80,48,208
s_waitcnt vmcnt(18)
s_add_u32 s23, s23, 163840
rd 76,1,15360
mF 84,48,212
s_waitcnt lgkmcnt(5) vmcnt(14)
s_barrier
mF 92,52,212
s_add_u32 m0, s21, 32768
rd 48,1,16384
mF 88,52,208
lw 0
mF 96,56,208
rd 52,1,17408
mF 100,56,212
wl 5
mF 108,60,212
rd 56,1,18432
mF 104,60,208
s_waitcnt vmcnt(14)
lw 1024
mF 80,64,216
s_waitcnt vmcnt(14)
rd 60,1,19456
mF 84,64,220
wl 5
mF 92,68,220
rd 64,1,20480
mF 88,68,216
lw 2048
mF 96,72,216
rd 68,1,21504
mF 100,72,220
wl 5
mF 108,76,220
rd 72,1,22528
mF 104,76,216
s_waitcnt vmcnt(14)
mF 80,48,224
s_waitcnt vmcnt(13)
rd 76,1,23552
mF 84,48,228
wl 5
lw 3072
mF 92,52,228
rd 48,1,24576
mF 88,52,224
mF 96,56,224
s_mul_i32 s23, s79, 16384
rd 52,1,25600
mF 100,56,228
wl 5
mF 108,60,228
s_add_u32 s23, s23, s25
rd 56,1,26624
mF 104,60,224
s_waitcnt vmcnt(13)
mF 80,64,232
s_waitcnt vmcnt(12)
s_add_u32 s23, s23, 180224
rd 60,1,27648
mF 84,64,236
wl 5
mF 92,68,236
s_add_u32 m0, s21, 49152
rd 64,1,28672
mF 88,68,232
lw 0
mF 96,72,232
rd 68,1,29696
mF 100,72,236
wl 5
mF 108,76,236
rd 72,1,30720
mF 104,76,232
s_waitcnt vmcnt(12)
mF 80,48,240
s_waitcnt vmcnt(11)
rd 76,1,31744
mF 84,48,244
s_waitcnt lgkmcnt(5) vmcnt(7)
s_barrier
mF 92,52,244
rd 48,0,16384
mF 88,52,240
lw 1024
mF 96,56,240
rd 52,0,17408
mF 100,56,244
wl 5
mF 108,60,244
rd 56,0,18432
mF 104,60,240
s_waitcnt vmcnt(7)
mF 80,64,248
s_waitcnt vmcnt(6)
rd 60,0,19456
mF 84,64,252
wl 5
lw 2048
mF 92,68,252
rd 64,0,20480
mF 88,68,248
mF 96,72,248
rd 68,0,21504
mF 100,72,252
wl 5
mF 108,76,252
rd 72,0,22528
mF 104,76,248
lw 3072
mF 136,48,32
rd 76,0,23552
mF 140,48,36
wl 5
mF 148,52,36
rd 48,0,24576
mF 144,52,32
mF 152,56,32
s_mul_i32 s23, s76, 16384
rd 52,0,25600
mF 156,56,36
wl 5
mF 164,60,36
s_add_u32 s23, s23, s25
rd 56,0,26624
v_fmac_f32 v80, v200, v236
mF 160,60,32
v_fmac_f32 v81, v201, v236
v_fmac_f32 v82, v202, v236
mF 136,64,40
s_add_u32 s23, s23, 196608
rd 60,0,27648
v_fmac_f32 v83, v203, v236
mF 140,64,44
wl 5
v_fma_f32 v80, v80, v204, s40
v_fma_f32 v81, v81, v205, s40
mF 148,68,44
s_add_u32 m0, s21, 98304
rd 64,0,28672
v_fma_f32 v82, v82, v206, s40
mF 144,68,40
lw 0
mF 152,72,40
rd 68,0,29696
v_fma_f32 v83, v83, v207, s40
mF 156,72,44
wl 5
v_mul_f32 v220, s41, v80
v_mul_f32 v221, s41, v81
mF 164,76,44
rd 72,0,30720
v_mul_f32 v222, s41, v82
mF 160,76,40
v_exp_f32_e64 v220, v220 clamp
mF 136,48,48
rd 76,0,31744
v_mul_f32 v223, s41, v83
mF 140,48,52
s_waitcnt lgkmcnt(5) vmcnt(5)
s_barrier
v_max_f32 v80, s40, v80
mF 148,52,52
rd 48,0,32768
v_max_f32 v81, s40, v81
mF 144,52,48
lw 1024
mF 152,56,48
rd 52,0,33792
v_max_f32 v82, s40, v82
mF 156,56,52
wl 5
v_exp_f32_e64 v221, v221 clamp
mF 164,60,52
rd 56,0,34816
v_max_f32 v83, s40, v83
mF 160,60,48
v_exp_f32_e64 v222, v222 clamp
mF 136,64,56
rd 60,0,35840
v_add_f32 v80, v80, v220
mF 140,64,60
wl 5
lw 2048
mF 148,68,60
rd 64,0,36864
v_add_f32 v81, v81, v221
mF 144,68,56
v_exp_f32_e64 v223, v223 clamp
mF 152,72,56
rd 68,0,37888
v_add_f32 v82, v82, v222
mF 156,72,60
wl 5
v_add_f32 v83, v83, v223
v_cvt_pk_bf16_f32 v112, v80, v81
mF 164,76,60
rd 72,0,38912
v_cvt_pk_bf16_f32 v113, v82, v83
mF 160,76,56
lw 3072
mF 136,48,64
rd 76,0,39936
v_fmac_f32 v84, v208, v236
mF 140,48,68
wl 5
v_fmac_f32 v85, v209, v236
v_fmac_f32 v86, v210, v236
mF 148,52,68
rd 48,0,40960
v_fmac_f32 v87, v211, v236
mF 144,52,64
v_fma_f32 v84, v84, v212, s40
v_fma_f32 v85, v85, v213, s40
mF 152,56,64
s_mul_i32 s23, s77, 16384
rd 52,0,41984
v_fma_f32 v86, v86, v214, s40
mF 156,56,68
wl 5
v_fma_f32 v87, v87, v215, s40
v_mul_f32 v224, s41, v84
mF 164,60,68
s_add_u32 s23, s23, s25
rd 56,0,43008
v_mul_f32 v225, s41, v85
mF 160,60,64
v_exp_f32_e64 v224, v224 clamp
mF 136,64,72
s_add_u32 s23, s23, 212992
rd 60,0,44032
v_mul_f32 v226, s41, v86
mF 140,64,76
wl 5
v_exp_f32_e64 v225, v225 clamp
mF 148,68,76
s_add_u32 m0, s21, 0
rd 64,0,45056
v_mul_f32 v227, s41, v87
mF 144,68,72
lw 0
mF 152,72,72
rd 68,0,46080
v_max_f32 v84, s40, v84
mF 156,72,76
wl 5
v_exp_f32_e64 v226, v226 clamp
mF 164,76,76
rd 72,0,47104
v_max_f32 v85, s40, v85
mF 160,76,72
v_exp_f32_e64 v227, v227 clamp
mF 136,48,80
rd 76,0,48128
v_max_f32 v86, s40, v86
mF 140,48,84
s_waitcnt lgkmcnt(5) vmcnt(5)
s_barrier
v_max_f32 v87, s40, v87
mF 148,52,84
rd 48,0,49152
v_add_f32 v84, v84, v224
mF 144,52,80
lw 1024
mF 152,56,80
rd 52,0,50176
v_add_f32 v85, v85, v225
mF 156,56,84
wl 5
v_add_f32 v86, v86, v226
v_add_f32 v87, v87, v227
mF 164,60,84
rd 56,0,51200
v_cvt_pk_bf16_f32 v114, v84, v85
mF 160,60,80
v_cvt_pk_bf16_f32 v115, v86, v87
v_fmac_f32 v88, v200, v237
mF 136,64,88
rd 60,0,52224
v_fmac_f32 v89, v201, v237
mF 140,64,92
wl 5
lw 2048
mF 148,68,92
rd 64,0,53248
v_fmac_f32 v90, v202, v237
mF 144,68,88
v_fmac_f32 v91, v203, v237
v_fma_f32 v88, v88, v204, s40
mF 152,72,88
rd 68,0,54272
v_fma_f32 v89, v89, v205, s40
mF 156,72,92
wl 5
v_fma_f32 v90, v90, v206, s40
v_fma_f32 v91, v91, v207, s40
mF 164,76,92
rd 72,0,55296
v_mul_f32 v228, s41, v88
mF 160,76,88
lw 3072
mF 136,48,96
rd 76,0,56320
v_mul_f32 v229, s41, v89
mF 140,48,100
wl 5
v_exp_f32_e64 v228, v228 clamp
mF 148,52,100
rd 48,0,57344
v_mul_f32 v230, s41, v90
mF 144,52,96
v_exp_f32_e64 v229, v229 clamp
mF 152,56,96
s_mul_i32 s23, s78, 16384
rd 52,0,58368
v_mul_f32 v231, s41, v91
mF 156,56,100
wl 5
v_exp_f32_e64 v230, v230 clamp
mF 164,60,100
s_add_u32 s23, s23, s25
rd 56,0,59392
v_max_f32 v88, s40, v88
mF 160,60,96
v_exp_f32_e64 v231, v231 clamp
mF 136,64,104
s_add_u32 s23, s23, 229376
rd 60,0,60416
v_max_f32 v89, s40, v89
mF 140,64,108
wl 5
v_max_f32 v90, s40, v90
v_max_f32 v91, s40, v91
mF 148,68,108
s_add_u32 m0, s21, 114688
rd 64,0,61440
v_add_f32 v88, v88, v228
mF 144,68,104
lw 0
mF 152,72,104
rd 68,0,62464
v_add_f32 v89, v89, v229
mF 156,72,108
wl 5
v_add_f32 v90, v90, v230
v_add_f32 v91, v91, v231
mF 164,76,108
rd 72,0,63488
v_cvt_pk_bf16_f32 v116, v88, v89
mF 160,76,104
v_cvt_pk_bf16_f32 v117, v90, v91
v_fmac_f32 v92, v208, v237
mF 136,48,112
rd 76,0,64512
v_fmac_f32 v93, v209, v237
mF 140,48,116
s_waitcnt lgkmcnt(5) vmcnt(5)
s_barrier
v_fmac_f32 v94, v210, v237
mF 148,52,116
rd 48,1,32768
v_fmac_f32 v95, v211, v237
mF 144,52,112
lw 1024
mF 152,56,112
rd 52,1,33792
v_fma_f32 v92, v92, v212, s40
mF 156,56,116
wl 5
v_fma_f32 v93, v93, v213, s40
v_fma_f32 v94, v94, v214, s40
mF 164,60,116
rd 56,1,34816
v_fma_f32 v95, v95, v215, s40
mF 160,60,112
v_mul_f32 v232, s41, v92
v_mul_f32 v233, s41, v93
mF 136,64,120
rd 60,1,35840
v_mul_f32 v234, s41, v94
mF 140,64,124
wl 5
lw 2048
mF 148,68,124
rd 64,1,36864
v_mul_f32 v235, s41, v95
mF 144,68,120
v_exp_f32_e64 v232, v232 clamp
mF 152,72,120
rd 68,1,37888
v_max_f32 v92, s40, v92
mF 156,72,124
wl 5
v_exp_f32_e64 v233, v233 clamp
mF 164,76,124
rd 72,1,38912
v_max_f32 v93, s40, v93
mF 160,76,120
lw 3072
mF 136,48,128
rd 76,1,39936
v_max_f32 v94, s40, v94
mF 140,48,132
wl 5
v_exp_f32_e64 v234, v234 clamp
mF 148,52,132
rd 48,1,40960
v_max_f32 v95, s40, v95
mF 144,52,128
v_exp_f32_e64 v235, v235 clamp
mF 152,56,128
s_min_i32 s23, s79, 0
rd 52,1,41984
v_add_f32 v92, v92, v232
mF 156,56,132
wl 5
v_add_f32 v93, v93, v233
v_add_f32 v94, v94, v234
mF 164,60,132
s_mul_i32 s23, s23, 16384
rd 56,1,43008
v_add_f32 v95, v95, v235
mF 160,60,128
v_cvt_pk_bf16_f32 v118, v92, v93
v_cvt_pk_bf16_f32 v119, v94, v95
mF 136,64,136
s_add_u32 s23, s23, s25
rd 60,1,44032
v_fmac_f32 v96, v200, v238
mF 140,64,140
wl 5
v_fmac_f32 v97, v201, v238
v_fmac_f32 v98, v202, v238
mF 148,68,140
s_add_u32 s23, s23, 245760
rd 64,1,45056
v_fmac_f32 v99, v203, v238
mF 144,68,136
v_fma_f32 v96, v96, v204, s40
v_fma_f32 v97, v97, v205, s40
mF 152,72,136
s_add_u32 m0, s21, 65536
rd 68,1,46080
v_fma_f32 v98, v98, v206, s40
mF 156,72,140
wl 5
lw 0
mF 164,76,140
rd 72,1,47104
v_fma_f32 v99, v99, v207, s40
mF 160,76,136
v_mul_f32 v220, s41, v96
v_mul_f32 v221, s41, v97
mF 136,48,144
rd 76,1,48128
v_mul_f32 v222, s41, v98
mF 140,48,148
s_waitcnt lgkmcnt(5) vmcnt(5)
s_barrier
v_mul_f32 v223, s41, v99
mF 148,52,148
rd 48,0,0
v_max_f32 v96, s40, v96
mF 144,52,144
lw 1024
mF 152,56,144
rd 52,0,1024
v_max_f32 v97, s40, v97
mF 156,56,148
wl 5
v_exp_f32_e64 v220, v220 clamp
mF 164,60,148
rd 56,0,2048
v_max_f32 v98, s40, v98
mF 160,60,144
v_exp_f32_e64 v221, v221 clamp
mF 136,64,152
rd 60,0,3072
v_max_f32 v99, s40, v99
mF 140,64,156
wl 5
lw 2048
mF 148,68,156
rd 64,0,4096
v_add_f32 v96, v96, v220
mF 144,68,152
v_exp_f32_e64 v222, v222 clamp
mF 152,72,152
rd 68,0,5120
v_add_f32 v97, v97, v221
mF 156,72,156
wl 5
v_exp_f32_e64 v223, v223 clamp
mF 164,76,156
rd 72,0,6144
v_add_f32 v98, v98, v222
mF 160,76,152
v_add_f32 v99, v99, v223
main_cp17:
s_mov_b32 s96, main_cp17-main_cp16
v_lshl_add_u64 v[2:3], v[2:3], 0, s[96:97]
global_load_dword v254, v[2:3], off
v_cvt_pk_bf16_f32 v120, v96, v97
mF 136,48,160
rd 76,0,7168
v_cvt_pk_bf16_f32 v121, v98, v99
mF 140,48,164
wl 5
lw 3072
mF 148,52,164
rd 48,0,8192
v_fmac_f32 v100, v208, v238
mF 144,52,160
v_fmac_f32 v101, v209, v238
v_fmac_f32 v102, v210, v238
mF 152,56,160
s_max_i32 s23, s76, 0
rd 52,0,9216
v_fmac_f32 v103, v211, v238
mF 156,56,164
wl 5
v_fma_f32 v100, v100, v212, s40
v_fma_f32 v101, v101, v213, s40
mF 164,60,164
s_mul_i32 s23, s23, 16384
rd 56,0,10240
v_fma_f32 v102, v102, v214, s40
mF 160,60,160
v_fma_f32 v103, v103, v215, s40
v_mul_f32 v224, s41, v100
mF 136,64,168
s_add_u32 s23, s23, s25
rd 60,0,11264
v_mul_f32 v225, s41, v101
mF 140,64,172
wl 5
v_exp_f32_e64 v224, v224 clamp
mF 148,68,172
s_add_u32 s23, s23, 262144
rd 64,0,12288
v_mul_f32 v226, s41, v102
mF 144,68,168
v_exp_f32_e64 v225, v225 clamp
mF 152,72,168
s_add_u32 m0, s21, 81920
rd 68,0,13312
v_mul_f32 v227, s41, v103
mF 156,72,172
wl 5
lw 0
mF 164,76,172
rd 72,0,14336
v_max_f32 v100, s40, v100
mF 160,76,168
v_exp_f32_e64 v226, v226 clamp
mF 136,48,176
rd 76,0,15360
v_max_f32 v101, s40, v101
mF 140,48,180
s_waitcnt lgkmcnt(5) vmcnt(6)
s_barrier
v_max_f32 v102, s40, v102
mF 148,52,180
rd 48,1,49152
v_max_f32 v103, s40, v103
mF 144,52,176
lw 1024
mF 152,56,176
rd 52,1,50176
v_add_f32 v100, v100, v224
mF 156,56,180
wl 5
v_exp_f32_e64 v227, v227 clamp
mF 164,60,180
rd 56,1,51200
v_add_f32 v101, v101, v225
mF 160,60,176
v_add_f32 v102, v102, v226
v_add_f32 v103, v103, v227
mF 136,64,184
rd 60,1,52224
v_cvt_pk_bf16_f32 v122, v100, v101
mF 140,64,188
wl 5
lw 2048
mF 148,68,188
rd 64,1,53248
v_cvt_pk_bf16_f32 v123, v102, v103
mF 144,68,184
v_fmac_f32 v104, v200, v239
v_fmac_f32 v105, v201, v239
mF 152,72,184
rd 68,1,54272
v_fmac_f32 v106, v202, v239
mF 156,72,188
wl 5
v_fmac_f32 v107, v203, v239
v_fma_f32 v104, v104, v204, s40
mF 164,76,188
rd 72,1,55296
v_fma_f32 v105, v105, v205, s40
mF 160,76,184
v_fma_f32 v106, v106, v206, s40
v_fma_f32 v107, v107, v207, s40
mF 136,48,192
rd 76,1,56320
v_mul_f32 v228, s41, v104
mF 140,48,196
wl 5
lw 3072
mF 148,52,196
rd 48,1,57344
v_mul_f32 v229, s41, v105
mF 144,52,192
v_exp_f32_e64 v228, v228 clamp
mF 152,56,192
s_mul_i32 s23, s77, 16384
rd 52,1,58368
v_mul_f32 v230, s41, v106
mF 156,56,196
wl 5
v_exp_f32_e64 v229, v229 clamp
mF 164,60,196
s_add_u32 s23, s23, s25
rd 56,1,59392
v_mul_f32 v231, s41, v107
mF 160,60,192
v_exp_f32_e64 v230, v230 clamp
mF 136,64,200
s_add_u32 s23, s23, 278528
rd 60,1,60416
v_max_f32 v104, s40, v104
mF 140,64,204
wl 5
v_exp_f32_e64 v231, v231 clamp
mF 148,68,204
s_add_u32 m0, s21, 16384
rd 64,1,61440
v_max_f32 v105, s40, v105
mF 144,68,200
lw 0
mF 152,72,200
rd 68,1,62464
v_max_f32 v106, s40, v106
mF 156,72,204
wl 5
v_max_f32 v107, s40, v107
v_add_f32 v104, v104, v228
mF 164,76,204
rd 72,1,63488
v_add_f32 v105, v105, v229
mF 160,76,200
v_add_f32 v106, v106, v230
v_add_f32 v107, v107, v231
mF 136,48,208
rd 76,1,64512
v_cvt_pk_bf16_f32 v124, v104, v105
mF 140,48,212
s_waitcnt lgkmcnt(5) vmcnt(5)
s_barrier
v_cvt_pk_bf16_f32 v125, v106, v107
mF 148,52,212
rd 48,1,0
v_fmac_f32 v108, v208, v239
mF 144,52,208
lw 1024
mF 152,56,208
rd 52,1,1024
v_fmac_f32 v109, v209, v239
mF 156,56,212
wl 5
v_fmac_f32 v110, v210, v239
v_fmac_f32 v111, v211, v239
mF 164,60,212
rd 56,1,2048
v_fma_f32 v108, v108, v212, s40
mF 160,60,208
v_fma_f32 v109, v109, v213, s40
v_fma_f32 v110, v110, v214, s40
mF 136,64,216
rd 60,1,3072
v_fma_f32 v111, v111, v215, s40
mF 140,64,220
wl 5
lw 2048
mF 148,68,220
rd 64,1,4096
v_mul_f32 v232, s41, v108
mF 144,68,216
v_exp_f32_e64 v232, v232 clamp
mF 152,72,216
rd 68,1,5120
v_mul_f32 v233, s41, v109
mF 156,72,220
wl 5
v_exp_f32_e64 v233, v233 clamp
mF 164,76,220
rd 72,1,6144
v_mul_f32 v234, s41, v110
mF 160,76,216
lw 3072
mF 136,48,224
rd 76,1,7168
v_mul_f32 v235, s41, v111
mF 140,48,228
wl 5
v_exp_f32_e64 v234, v234 clamp
mF 148,52,228
rd 48,1,8192
v_max_f32 v108, s40, v108
mF 144,52,224
v_exp_f32_e64 v235, v235 clamp
mF 152,56,224
s_mul_i32 s23, s78, 16384
rd 52,1,9216
v_max_f32 v109, s40, v109
mF 156,56,228
wl 5
v_max_f32 v110, s40, v110
v_max_f32 v111, s40, v111
mF 164,60,228
s_add_u32 s23, s23, s25
rd 56,1,10240
v_add_f32 v108, v108, v232
mF 160,60,224
v_add_f32 v109, v109, v233
v_add_f32 v110, v110, v234
mF 136,64,232
s_add_u32 s23, s23, 294912
rd 60,1,11264
v_add_f32 v111, v111, v235
mF 140,64,236
wl 5
v_cvt_pk_bf16_f32 v126, v108, v109
v_cvt_pk_bf16_f32 v127, v110, v111
ds_write_b128 v8, v[112:115] offset:0
mF 148,68,236
s_add_u32 m0, s21, 32768
rd 64,1,12288
ds_write_b128 v8, v[116:119] offset:1024
mF 144,68,232
lw 0
ds_write_b128 v8, v[120:123] offset:2048
mF 152,72,232
rd 68,1,13312
ds_write_b128 v8, v[124:127] offset:3072
mF 156,72,236
wl 9
mF 164,76,236
rd 72,1,14336
mF 160,76,232
lw 1024
mF 136,48,240
rd 76,1,15360
mF 140,48,244
s_waitcnt vmcnt(6) lgkmcnt(2)
s_barrier
mF 148,52,244
rd 48,1,16384
rd 112,9,0
rd 116,9,1024
mF 144,52,240
rd 120,9,4096
rd 124,9,5120
rd 128,9,8192
mF 152,56,240
rd 52,1,17408
rd 132,9,9216
rd 168,9,12288
mF 156,56,244
lw 2048
rd 172,9,13312
mF 164,60,244
rd 56,1,18432
mF 160,60,240
mF 136,64,248
rd 60,1,19456
mF 140,64,252
mF 148,68,252
rd 64,1,20480
mF 144,68,248
wl 10
lw 3072
v_mfma_f32_16x16x32_bf16 v[228:231], v[112:115], v[24:27], 0
v_mfma_f32_16x16x32_bf16 v[232:235], v[116:119], v[24:27], 0
wl 8
v_mfma_f32_16x16x32_bf16 v[228:231], v[120:123], v[24:27], v[228:231]
v_mfma_f32_16x16x32_bf16 v[232:235], v[124:127], v[24:27], v[232:235]
wl 6
v_mfma_f32_16x16x32_bf16 v[228:231], v[128:131], v[24:27], v[228:231]
wl 4
v_mfma_f32_16x16x32_bf16 v[232:235], v[132:135], v[24:27], v[232:235]
v_mfma_f32_16x16x32_bf16 v[228:231], v[168:171], v[24:27], v[228:231]
wl 3
v_mfma_f32_16x16x32_bf16 v[232:235], v[172:175], v[24:27], v[232:235]
s_lshl_b32 s37, s16, 7
s_add_u32 s37, s37, s56
mF 152,72,248
s_mul_i32 s23, s79, 16384
rd 68,1,21504
s_add_u32 s23, s23, s25
s_add_u32 s23, s23, 311296
s_add_u32 m0, s21, 49152
s_nop 0
lw 0
mF 156,72,252
mF 164,76,252
rd 72,1,22528
buffer_store_dwordx4 v[228:231], v22, s[4:7], s37 offen offset:0 sc1
mF 160,76,248
buffer_store_dwordx4 v[232:235], v22, s[4:7], s37 offen offset:16 sc1
s_lshl_b32 s37, s16, 10
v_mfma_f32_16x16x32_bf16 v[80:83], v[48:51], a[0:3], 0
s_add_u32 s37, s37, s55
rd 76,1,23552
v_mfma_f32_16x16x32_bf16 v[84:87], v[48:51], a[4:7], 0
lw 1024
v_mfma_f32_16x16x32_bf16 v[92:95], v[52:55], a[4:7], 0
rd 48,1,24576
v_mfma_f32_16x16x32_bf16 v[88:91], v[52:55], a[0:3], 0
wl 5
v_mfma_f32_16x16x32_bf16 v[96:99], v[56:59], a[0:3], 0
rd 52,1,25600
v_mfma_f32_16x16x32_bf16 v[100:103], v[56:59], a[4:7], 0
lw 2048
v_mfma_f32_16x16x32_bf16 v[108:111], v[60:63], a[4:7], 0
rd 56,1,26624
v_mfma_f32_16x16x32_bf16 v[104:107], v[60:63], a[0:3], 0
wl 5
mT 80,64,8
rd 60,1,27648
mT 84,64,12
lw 3072
mT 92,68,12
s_mul_i32 s23, s76, 16384
rd 64,1,28672
mT 88,68,8
wl 5
mT 96,72,8
s_add_u32 s23, s23, s25
rd 68,1,29696
mT 100,72,12
mT 108,76,12
s_add_u32 s23, s23, 327680
rd 72,1,30720
mT 104,76,8
wl 5
mT 80,48,16
s_add_u32 m0, s21, 98304
rd 76,1,31744
mT 84,48,20
s_waitcnt vmcnt(10)
s_barrier
mT 92,52,20
rd 48,0,16384
v_pk_fma_f32 v[136:137], v[200:201], v[240:241], v[136:137] op_sel_hi:[1,0,1]
v_pk_fma_f32 v[138:139], v[202:203], v[240:241], v[138:139] op_sel_hi:[1,0,1]
v_pk_fma_f32 v[140:141], v[208:209], v[240:241], v[140:141] op_sel_hi:[1,0,1]
v_pk_fma_f32 v[142:143], v[210:211], v[240:241], v[142:143] op_sel_hi:[1,0,1]
v_pk_mul_f32 v[136:137], v[136:137], v[204:205]
v_pk_mul_f32 v[138:139], v[138:139], v[206:207]
v_pk_mul_f32 v[140:141], v[140:141], v[212:213]
v_pk_mul_f32 v[142:143], v[142:143], v[214:215]
v_cvt_pk_bf16_f32 v176, v136, v137
v_cvt_pk_bf16_f32 v177, v138, v139
v_cvt_pk_bf16_f32 v178, v140, v141
v_cvt_pk_bf16_f32 v179, v142, v143
ds_write_b128 v8, v[176:179] offset:0
v_pk_fma_f32 v[144:145], v[200:201], v[240:241], v[144:145] op_sel:[0,1,0]
v_pk_fma_f32 v[146:147], v[202:203], v[240:241], v[146:147] op_sel:[0,1,0]
v_pk_fma_f32 v[148:149], v[208:209], v[240:241], v[148:149] op_sel:[0,1,0]
v_pk_fma_f32 v[150:151], v[210:211], v[240:241], v[150:151] op_sel:[0,1,0]
v_pk_mul_f32 v[144:145], v[144:145], v[204:205]
v_pk_mul_f32 v[146:147], v[146:147], v[206:207]
v_pk_mul_f32 v[148:149], v[148:149], v[212:213]
v_pk_mul_f32 v[150:151], v[150:151], v[214:215]
v_cvt_pk_bf16_f32 v180, v144, v145
v_cvt_pk_bf16_f32 v181, v146, v147
v_cvt_pk_bf16_f32 v182, v148, v149
v_cvt_pk_bf16_f32 v183, v150, v151
ds_write_b128 v8, v[180:183] offset:1024
v_pk_fma_f32 v[152:153], v[200:201], v[242:243], v[152:153] op_sel_hi:[1,0,1]
v_pk_fma_f32 v[154:155], v[202:203], v[242:243], v[154:155] op_sel_hi:[1,0,1]
v_pk_fma_f32 v[156:157], v[208:209], v[242:243], v[156:157] op_sel_hi:[1,0,1]
v_pk_fma_f32 v[158:159], v[210:211], v[242:243], v[158:159] op_sel_hi:[1,0,1]
v_pk_mul_f32 v[152:153], v[152:153], v[204:205]
v_pk_mul_f32 v[154:155], v[154:155], v[206:207]
v_pk_mul_f32 v[156:157], v[156:157], v[212:213]
v_pk_mul_f32 v[158:159], v[158:159], v[214:215]
v_cvt_pk_bf16_f32 v184, v152, v153
v_cvt_pk_bf16_f32 v185, v154, v155
v_cvt_pk_bf16_f32 v186, v156, v157
v_cvt_pk_bf16_f32 v187, v158, v159
ds_write_b128 v8, v[184:187] offset:2048
v_pk_fma_f32 v[160:161], v[200:201], v[242:243], v[160:161] op_sel:[0,1,0]
v_pk_fma_f32 v[162:163], v[202:203], v[242:243], v[162:163] op_sel:[0,1,0]
v_pk_fma_f32 v[164:165], v[208:209], v[242:243], v[164:165] op_sel:[0,1,0]
v_pk_fma_f32 v[166:167], v[210:211], v[242:243], v[166:167] op_sel:[0,1,0]
v_pk_mul_f32 v[160:161], v[160:161], v[204:205]
v_pk_mul_f32 v[162:163], v[162:163], v[206:207]
v_pk_mul_f32 v[164:165], v[164:165], v[212:213]
v_pk_mul_f32 v[166:167], v[166:167], v[214:215]
v_cvt_pk_bf16_f32 v188, v160, v161
v_cvt_pk_bf16_f32 v189, v162, v163
v_cvt_pk_bf16_f32 v190, v164, v165
v_cvt_pk_bf16_f32 v191, v166, v167
ds_write_b128 v8, v[188:191] offset:3072
mT 88,52,16
wl 9
lw 0
mT 96,56,16
rd 52,0,17408
lw 1024
mT 100,56,20
wl 1
s_barrier
rd 176,10,0
rd 180,10,4096
mT 108,60,20
rd 56,0,18432
rd 184,10,8192
rd 188,10,12288
mT 104,60,16
lw 2048
mT 80,64,24
rd 60,0,19456
mT 84,64,28
mT 92,68,28
rd 64,0,20480
mT 88,68,24
wl 5
lw 3072
v_mfma_f32_16x16x32_bf16 v[220:223], v[112:115], v[176:179], 0
v_mfma_f32_16x16x32_bf16 v[224:227], v[116:119], v[176:179], 0
v_mfma_f32_16x16x32_bf16 v[220:223], v[120:123], v[180:183], v[220:223]
v_mfma_f32_16x16x32_bf16 v[224:227], v[124:127], v[180:183], v[224:227]
wl 3
v_mfma_f32_16x16x32_bf16 v[220:223], v[128:131], v[184:187], v[220:223]
v_mfma_f32_16x16x32_bf16 v[224:227], v[132:135], v[184:187], v[224:227]
wl 2
v_mfma_f32_16x16x32_bf16 v[220:223], v[168:171], v[188:191], v[220:223]
v_mfma_f32_16x16x32_bf16 v[224:227], v[172:175], v[188:191], v[224:227]
mT 96,72,24
s_mul_i32 s23, s77, 16384
rd 68,0,21504
s_add_u32 s23, s23, s25
s_add_u32 s23, s23, 344064
s_add_u32 m0, s21, 0
s_nop 0
lw 0
lw 1024
mT 100,72,28
mT 108,76,28
rd 72,0,22528
v_cvt_pk_bf16_f32 v236, v220, v221
v_cvt_pk_bf16_f32 v237, v222, v223
mT 104,76,24
lw 2048
v_cvt_pk_bf16_f32 v238, v224, v225
mT 80,48,32
rd 76,0,23552
v_cvt_pk_bf16_f32 v239, v226, v227
mT 84,48,36
buffer_store_dwordx4 v[236:239], v0, s[4:7], s37 offen sc1
mT 92,52,36
rd 48,0,24576
mT 88,52,32
lw 3072
mT 96,56,32
s_mul_i32 s23, s78, 16384
rd 52,0,25600
mT 100,56,36
wl 5
mT 108,60,36
s_add_u32 s23, s23, s25
rd 56,0,26624
mT 104,60,32
mT 80,64,40
s_add_u32 s23, s23, 360448
rd 60,0,27648
mT 84,64,44
wl 5
mT 92,68,44
s_add_u32 m0, s21, 114688
rd 64,0,28672
mT 88,68,40
lw 0
mT 96,72,40
rd 68,0,29696
mT 100,72,44
wl 5
mT 108,76,44
rd 72,0,30720
mT 104,76,40
lw 1024
mT 80,48,48
rd 76,0,31744
mT 84,48,52
s_waitcnt lgkmcnt(5) vmcnt(17)
s_barrier
mT 92,52,52
rd 48,0,32768
mT 88,52,48
lw 2048
mT 96,56,48
rd 52,0,33792
mT 100,56,52
wl 5
mT 108,60,52
rd 56,0,34816
mT 104,60,48
lw 3072
mT 80,64,56
s_min_i32 s23, s79, 0
rd 60,0,35840
mT 84,64,60
wl 5
mT 92,68,60
s_mul_i32 s23, s23, 16384
rd 64,0,36864
mT 88,68,56
mT 96,72,56
s_add_u32 s23, s23, s25
rd 68,0,37888
mT 100,72,60
wl 5
mT 108,76,60
s_add_u32 s23, s23, 376832
rd 72,0,38912
mT 104,76,56
mT 80,48,64
s_add_u32 m0, s21, 65536
rd 76,0,39936
mT 84,48,68
wl 5
lw 0
mT 92,52,68
rd 48,0,40960
mT 88,52,64
mT 96,56,64
rd 52,0,41984
mT 100,56,68
wl 5
lw 1024
mT 108,60,68
rd 56,0,43008
mT 104,60,64
mT 80,64,72
rd 60,0,44032
mT 84,64,76
wl 5
lw 2048
mT 92,68,76
rd 64,0,45056
mT 88,68,72
mT 96,72,72
rd 68,0,46080
mT 100,72,76
wl 5
lw 3072
mT 108,76,76
s_waitcnt vmcnt(9)
s_max_i32 s23, s76, 0
rd 72,0,47104
s_add_u32 s36, s49, 16384
v_mov_b32 v31, 1
mT 104,76,72
buffer_atomic_add v31, v4, s[4:7], s36 offen sc1
mT 80,48,80
s_mul_i32 s23, s23, 16384
rd 76,0,48128
mT 84,48,84
wl 5
s_barrier
mT 92,52,84
s_add_u32 s23, s23, s26
rd 48,0,49152
mT 88,52,80
main_cp18:
s_mov_b32 s96, main_cp18-main_cp17
v_lshl_add_u64 v[2:3], v[2:3], 0, s[96:97]
global_load_dword v254, v[2:3], off
mT 96,56,80
s_add_u32 s23, s23, 0
rd 52,0,50176
mT 100,56,84
wl 5
mT 108,60,84
s_add_u32 m0, s21, 81920
rd 56,0,51200
mT 104,60,80
lw 0
mT 80,64,88
rd 60,0,52224
mT 84,64,92
wl 5
mT 92,68,92
rd 64,0,53248
mT 88,68,88
lw 1024
mT 96,72,88
rd 68,0,54272
mT 100,72,92
wl 5
mT 108,76,92
rd 72,0,55296
mT 104,76,88
lw 2048
mT 80,48,96
rd 76,0,56320
mT 84,48,100
wl 5
mT 92,52,100
rd 48,0,57344
mT 88,52,96
lw 3072
mT 96,56,96
s_mul_i32 s23, s77, 16384
rd 52,0,58368
mT 100,56,100
wl 5
mT 108,60,100
s_add_u32 s23, s23, s26
rd 56,0,59392
mT 104,60,96
mT 80,64,104
s_add_u32 s23, s23, 16384
rd 60,0,60416
mT 84,64,108
wl 5
mT 92,68,108
s_add_u32 m0, s21, 16384
rd 64,0,61440
mT 88,68,104
lw 0
mT 96,72,104
rd 68,0,62464
mT 100,72,108
wl 5
v_mov_b32 v31, 0
buffer_atomic_add v31, v4, s[4:7], s36 offen sc0 sc1
mT 108,76,108
rd 72,0,63488
mT 104,76,104
lw 1024
mT 80,48,112
rd 76,0,64512
mT 84,48,116
wl 5
s_barrier
mT 92,52,116
rd 48,1,32768
mT 88,52,112
lw 2048
mT 96,56,112
rd 52,1,33792
mT 100,56,116
wl 5
mT 108,60,116
rd 56,1,34816
mT 104,60,112
lw 3072
mT 80,64,120
s_mul_i32 s23, s78, 16384
rd 60,1,35840
mT 84,64,124
wl 5
mT 92,68,124
s_add_u32 s23, s23, s26
rd 64,1,36864
mT 88,68,120
mT 96,72,120
s_add_u32 s23, s23, 32768
rd 68,1,37888
mT 100,72,124
wl 5
mT 108,76,124
s_add_u32 m0, s21, 32768
rd 72,1,38912
mT 104,76,120
lw 0
mT 80,48,128
rd 76,1,39936
mT 84,48,132
wl 5
mT 92,52,132
rd 48,1,40960
mT 88,52,128
lw 1024
mT 96,56,128
rd 52,1,41984
mT 100,56,132
wl 5
mT 108,60,132
rd 56,1,43008
mT 104,60,128
lw 2048
mT 80,64,136
rd 60,1,44032
mT 84,64,140
wl 5
mT 92,68,140
rd 64,1,45056
mT 88,68,136
mT 96,72,136
rd 68,1,46080
mT 100,72,140
s_waitcnt vmcnt(6)
v_readfirstlane_b32 s46, v31
s_nop 0
s_nop 0
s_cmp_ge_u32 s46, 16
s_cbranch_scc1 main_ok132
s_mov_b32 s47, 0
main_poll131:
v_mov_b32 v31, 0
buffer_atomic_add v31, v4, s[4:7], s36 offen sc0 sc1
s_add_u32 s47, s47, 1
s_cmp_gt_u32 s47, 400000
s_cbranch_scc1 main_ok132
s_waitcnt vmcnt(0)
v_readfirstlane_b32 s46, v31
s_nop 0
s_cmp_lt_u32 s46, 16
s_cbranch_scc1 main_poll131
main_ok132:
wl 5
mT 108,76,140
rd 72,1,47104
mT 104,76,136
buffer_load_dwordx4 v[244:247], v23, s[4:7], s56 offen offset:0 sc1
mT 80,48,144
rd 76,1,48128
mT 84,48,148
wl 5
s_barrier
mT 92,52,148
rd 48,0,0
mT 88,52,144
buffer_load_dwordx4 v[248:251], v23, s[4:7], s56 offen offset:16 sc1
mT 96,56,144
rd 52,0,1024
mT 100,56,148
wl 5
mT 108,60,148
s_mov_b32 s37, s55
rd 56,0,2048
mT 104,60,144
buffer_load_dwordx4 v[112:115], v0, s[4:7], s37 offen offset:0 sc1
mT 80,64,152
rd 60,0,3072
mT 84,64,156
wl 5
mT 92,68,156
rd 64,0,4096
mT 88,68,152
buffer_load_dwordx4 v[116:119], v0, s[4:7], s37 offen offset:1024 sc1
mT 96,72,152
rd 68,0,5120
mT 100,72,156
wl 5
mT 108,76,156
rd 72,0,6144
mT 104,76,152
buffer_load_dwordx4 v[120:123], v0, s[4:7], s37 offen offset:2048 sc1
mT 80,48,160
rd 76,0,7168
mT 84,48,164
wl 5
mT 92,52,164
rd 48,0,8192
mT 88,52,160
buffer_load_dwordx4 v[124:127], v0, s[4:7], s37 offen offset:3072 sc1
mT 96,56,160
rd 52,0,9216
mT 100,56,164
wl 5
mT 108,60,164
rd 56,0,10240
mT 104,60,160
mT 80,64,168
s_add_u32 s37, s37, 4096
rd 60,0,11264
mT 84,64,172
wl 5
buffer_load_dwordx4 v[128:131], v0, s[4:7], s37 offen offset:0 sc1
mT 92,68,172
rd 64,0,12288
mT 88,68,168
mT 96,72,168
rd 68,0,13312
mT 100,72,172
wl 5
buffer_load_dwordx4 v[132:135], v0, s[4:7], s37 offen offset:1024 sc1
mT 108,76,172
rd 72,0,14336
mT 104,76,168
mT 80,48,176
rd 76,0,15360
mT 84,48,180
wl 5
s_barrier
mT 92,52,180
rd 48,1,49152
mT 88,52,176
buffer_load_dwordx4 v[136:139], v0, s[4:7], s37 offen offset:2048 sc1
mT 96,56,176
rd 52,1,50176
mT 100,56,180
wl 5
mT 108,60,180
rd 56,1,53248
mT 104,60,176
buffer_load_dwordx4 v[140:143], v0, s[4:7], s37 offen offset:3072 sc1
mT 80,64,184
rd 60,1,54272
mT 84,64,188
wl 5
mT 92,68,188
rd 64,1,57344
mT 88,68,184
mT 96,72,184
s_add_u32 s37, s37, 4096
rd 68,1,58368
mT 100,72,188
wl 5
buffer_load_dwordx4 v[144:147], v0, s[4:7], s37 offen offset:0 sc1
mT 108,76,188
rd 72,1,61440
mT 104,76,184
mT 80,48,192
rd 76,1,62464
mT 84,48,196
wl 5
buffer_load_dwordx4 v[148:151], v0, s[4:7], s37 offen offset:1024 sc1
mT 92,52,196
rd 48,1,0
mT 88,52,192
mT 80,56,200
rd 52,1,1024
mT 84,56,204
wl 5
buffer_load_dwordx4 v[152:155], v0, s[4:7], s37 offen offset:2048 sc1
mT 92,60,204
rd 56,1,4096
mT 88,60,200
mT 80,64,208
rd 60,1,5120
mT 84,64,212
wl 5
buffer_load_dwordx4 v[156:159], v0, s[4:7], s37 offen offset:3072 sc1
mT 92,68,212
rd 64,1,8192
mT 88,68,208
mT 80,72,216
rd 68,1,9216
mT 84,72,220
wl 5
mT 92,76,220
s_add_u32 s37, s37, 4096
rd 72,1,12288
mT 88,76,216
buffer_load_dwordx4 v[160:163], v0, s[4:7], s37 offen offset:0 sc1
mT 80,48,224
rd 76,1,13312
mT 84,48,228
wl 5
mT 92,52,228
rd 48,1,51200
mT 88,52,224
buffer_load_dwordx4 v[164:167], v0, s[4:7], s37 offen offset:1024 sc1
mT 80,56,232
rd 52,1,52224
mT 84,56,236
wl 5
mT 92,60,236
rd 56,1,55296
mT 88,60,232
buffer_load_dwordx4 v[168:171], v0, s[4:7], s37 offen offset:2048 sc1
mT 80,64,240
rd 60,1,56320
mT 84,64,244
wl 5
mT 92,68,244
rd 64,1,59392
mT 88,68,240
buffer_load_dwordx4 v[172:175], v0, s[4:7], s37 offen offset:3072 sc1
mT 80,72,248
rd 68,1,60416
mT 84,72,252
wl 5
mT 92,76,252
rd 72,1,63488
mT 88,76,248
mT 96,48,192
s_add_u32 s37, s37, 4096
rd 76,1,64512
mT 100,48,196
wl 5
lw 3072
mT 108,52,196
s_mul_i32 s23, s79, 16384
rd 48,1,2048
mT 104,52,192
rd 176,12,512
mT 96,56,200
s_add_u32 s23, s23, s26
rd 52,1,3072
mT 100,56,204
wl 6
rd 180,12,576
mT 108,60,204
s_add_u32 s23, s23, 49152
rd 56,1,6144
mT 104,60,200
rd 184,12,640
mT 96,64,208
s_add_u32 m0, s21, 49152
rd 60,1,7168
mT 100,64,212
wl 8
lw 0
mT 108,68,212
rd 64,1,10240
mT 104,68,208
rd 188,12,704
mT 96,72,216
wl 7
rd 68,1,11264
v_fmac_f32 v80, v216, v176
v_fmac_f32 v81, v216, v177
mT 100,72,220
lw 1024
v_fmac_f32 v82, v216, v178
mT 108,76,220
rd 72,1,14336
v_fmac_f32 v83, v216, v179
v_fma_f32 v80, v80, v217, s40
mT 104,76,216
lw 2048
v_fma_f32 v81, v81, v217, s40
mT 96,48,224
rd 76,1,15360
v_fma_f32 v82, v82, v217, s40
v_fma_f32 v83, v83, v217, s40
mT 100,48,228
wl 8
v_mul_f32 v236, s41, v80
v_mul_f32 v237, s41, v81
v_mul_f32 v238, s41, v82
mT 108,52,228
v_mul_f32 v239, s41, v83
v_exp_f32_e64 v236, v236 clamp
mT 104,52,224
wl 6
lw 3072
v_max_f32 v80, s40, v80
mT 96,56,232
s_mul_i32 s23, s76, 16384
v_exp_f32_e64 v237, v237 clamp
v_max_f32 v81, s40, v81
mT 100,56,236
wl 4
v_exp_f32_e64 v238, v238 clamp
v_max_f32 v82, s40, v82
mT 108,60,236
s_add_u32 s23, s23, s26
v_exp_f32_e64 v239, v239 clamp
v_max_f32 v83, s40, v83
mT 104,60,232
v_add_f32 v80, v80, v236
v_add_f32 v81, v81, v237
v_add_f32 v82, v82, v238
mT 96,64,240
s_add_u32 s23, s23, 65536
v_add_f32 v83, v83, v239
v_cvt_pk_bf16_f32 v220, v80, v81
v_cvt_pk_bf16_f32 v221, v82, v83
mT 100,64,244
wl 2
v_fmac_f32 v84, v218, v176
v_fmac_f32 v85, v218, v177
v_fmac_f32 v86, v218, v178
mT 108,68,244
s_add_u32 m0, s21, 98304
v_fmac_f32 v87, v218, v179
v_fma_f32 v84, v84, v219, s40
v_fma_f32 v85, v85, v219, s40
mT 104,68,240
wl 1
lw 0
v_fma_f32 v86, v86, v219, s40
mT 96,72,248
v_fma_f32 v87, v87, v219, s40
v_mul_f32 v240, s41, v84
v_mul_f32 v241, s41, v85
mT 100,72,252
wl 0
lw 1024
v_mul_f32 v242, s41, v86
mT 108,76,252
v_mul_f32 v243, s41, v87
v_exp_f32_e64 v240, v240 clamp
mT 104,76,248
s_waitcnt vmcnt(22)
v_max_f32 v84, s40, v84
v_exp_f32_e64 v241, v241 clamp
v_mfma_f32_16x16x32_bf16 v[208:211], v[18:21], v[112:115], 0
v_max_f32 v85, s40, v85
v_exp_f32_e64 v242, v242 clamp
v_mfma_f32_16x16x32_bf16 v[212:215], v[16:19], v[112:115], 0
s_waitcnt vmcnt(21)
lw 2048
v_max_f32 v86, s40, v86
v_mfma_f32_16x16x32_bf16 v[208:211], v[18:21], v[116:119], v[208:211]
v_exp_f32_e64 v243, v243 clamp
v_max_f32 v87, s40, v87
v_mfma_f32_16x16x32_bf16 v[212:215], v[16:19], v[116:119], v[212:215]
s_waitcnt vmcnt(21)
v_add_f32 v84, v84, v240
v_add_f32 v85, v85, v241
v_add_f32 v86, v86, v242
v_mfma_f32_16x16x32_bf16 v[208:211], v[18:21], v[120:123], v[208:211]
lw 3072
v_add_f32 v87, v87, v243
v_mfma_f32_16x16x32_bf16 v[212:215], v[16:19], v[120:123], v[212:215]
s_waitcnt vmcnt(21)
v_add_f32_dpp v244, v244, v244 row_ror:8 row_mask:0xf bank_mask:0xf
v_add_f32_dpp v245, v245, v245 row_ror:8 row_mask:0xf bank_mask:0xf
v_cvt_pk_bf16_f32 v228, v84, v85
v_mfma_f32_16x16x32_bf16 v[208:211], v[18:21], v[124:127], v[208:211]
v_add_f32_dpp v246, v246, v246 row_ror:8 row_mask:0xf bank_mask:0xf
v_add_f32_dpp v247, v247, v247 row_ror:8 row_mask:0xf bank_mask:0xf
v_cvt_pk_bf16_f32 v229, v86, v87
v_mfma_f32_16x16x32_bf16 v[212:215], v[16:19], v[124:127], v[212:215]
s_waitcnt vmcnt(20)
v_add_f32_dpp v248, v248, v248 row_ror:8 row_mask:0xf bank_mask:0xf
v_add_f32_dpp v249, v249, v249 row_ror:8 row_mask:0xf bank_mask:0xf
v_fmac_f32 v88, v216, v180
v_mfma_f32_16x16x32_bf16 v[208:211], v[18:21], v[128:131], v[208:211]
v_add_f32_dpp v250, v250, v250 row_ror:8 row_mask:0xf bank_mask:0xf
v_add_f32_dpp v251, v251, v251 row_ror:8 row_mask:0xf bank_mask:0xf
v_fmac_f32 v89, v216, v181
v_mfma_f32_16x16x32_bf16 v[212:215], v[16:19], v[128:131], v[212:215]
s_waitcnt vmcnt(19)
v_add_f32_dpp v244, v244, v244 row_ror:4 row_mask:0xf bank_mask:0xf
v_add_f32_dpp v245, v245, v245 row_ror:4 row_mask:0xf bank_mask:0xf
v_fmac_f32 v90, v216, v182
v_mfma_f32_16x16x32_bf16 v[208:211], v[18:21], v[132:135], v[208:211]
v_add_f32_dpp v246, v246, v246 row_ror:4 row_mask:0xf bank_mask:0xf
v_add_f32_dpp v247, v247, v247 row_ror:4 row_mask:0xf bank_mask:0xf
v_fmac_f32 v91, v216, v183
v_mfma_f32_16x16x32_bf16 v[212:215], v[16:19], v[132:135], v[212:215]
s_waitcnt vmcnt(18)
v_add_f32_dpp v248, v248, v248 row_ror:4 row_mask:0xf bank_mask:0xf
v_add_f32_dpp v249, v249, v249 row_ror:4 row_mask:0xf bank_mask:0xf
v_fma_f32 v88, v88, v217, s40
v_mfma_f32_16x16x32_bf16 v[208:211], v[18:21], v[136:139], v[208:211]
v_add_f32_dpp v250, v250, v250 row_ror:4 row_mask:0xf bank_mask:0xf
v_add_f32_dpp v251, v251, v251 row_ror:4 row_mask:0xf bank_mask:0xf
v_fma_f32 v89, v89, v217, s40
v_mfma_f32_16x16x32_bf16 v[212:215], v[16:19], v[136:139], v[212:215]
s_waitcnt vmcnt(17)
v_add_f32_dpp v244, v244, v244 row_ror:2 row_mask:0xf bank_mask:0xf
v_add_f32_dpp v245, v245, v245 row_ror:2 row_mask:0xf bank_mask:0xf
v_fma_f32 v90, v90, v217, s40
v_mfma_f32_16x16x32_bf16 v[208:211], v[18:21], v[140:143], v[208:211]
v_add_f32_dpp v246, v246, v246 row_ror:2 row_mask:0xf bank_mask:0xf
v_add_f32_dpp v247, v247, v247 row_ror:2 row_mask:0xf bank_mask:0xf
v_fma_f32 v91, v91, v217, s40
v_mfma_f32_16x16x32_bf16 v[212:215], v[16:19], v[140:143], v[212:215]
s_waitcnt vmcnt(16)
v_add_f32_dpp v248, v248, v248 row_ror:2 row_mask:0xf bank_mask:0xf
v_add_f32_dpp v249, v249, v249 row_ror:2 row_mask:0xf bank_mask:0xf
v_mul_f32 v236, s41, v88
v_mfma_f32_16x16x32_bf16 v[208:211], v[18:21], v[144:147], v[208:211]
v_add_f32_dpp v250, v250, v250 row_ror:2 row_mask:0xf bank_mask:0xf
v_add_f32_dpp v251, v251, v251 row_ror:2 row_mask:0xf bank_mask:0xf
v_mul_f32 v237, s41, v89
v_mfma_f32_16x16x32_bf16 v[212:215], v[16:19], v[144:147], v[212:215]
s_waitcnt vmcnt(15)
v_add_f32_dpp v244, v244, v244 row_ror:1 row_mask:0xf bank_mask:0xf
v_add_f32_dpp v245, v245, v245 row_ror:1 row_mask:0xf bank_mask:0xf
v_mul_f32 v238, s41, v90
v_mfma_f32_16x16x32_bf16 v[208:211], v[18:21], v[148:151], v[208:211]
v_add_f32_dpp v246, v246, v246 row_ror:1 row_mask:0xf bank_mask:0xf
v_add_f32_dpp v247, v247, v247 row_ror:1 row_mask:0xf bank_mask:0xf
v_mul_f32 v239, s41, v91
v_mfma_f32_16x16x32_bf16 v[212:215], v[16:19], v[148:151], v[212:215]
s_waitcnt vmcnt(14)
v_add_f32_dpp v248, v248, v248 row_ror:1 row_mask:0xf bank_mask:0xf
v_add_f32_dpp v249, v249, v249 row_ror:1 row_mask:0xf bank_mask:0xf
v_max_f32 v88, s40, v88
v_mfma_f32_16x16x32_bf16 v[208:211], v[18:21], v[152:155], v[208:211]
v_add_f32_dpp v250, v250, v250 row_ror:1 row_mask:0xf bank_mask:0xf
v_add_f32_dpp v251, v251, v251 row_ror:1 row_mask:0xf bank_mask:0xf
v_max_f32 v89, s40, v89
v_mfma_f32_16x16x32_bf16 v[212:215], v[16:19], v[152:155], v[212:215]
s_waitcnt vmcnt(13)
v_cvt_pk_bf16_f32 v204, v244, v245
v_cvt_pk_bf16_f32 v205, v246, v247
v_max_f32 v90, s40, v90
v_mfma_f32_16x16x32_bf16 v[208:211], v[18:21], v[156:159], v[208:211]
v_cvt_pk_bf16_f32 v206, v248, v249
v_cvt_pk_bf16_f32 v207, v250, v251
v_max_f32 v91, s40, v91
v_mfma_f32_16x16x32_bf16 v[212:215], v[16:19], v[156:159], v[212:215]
s_waitcnt vmcnt(12)
ds_write_b128 v10, v[204:207] offset:4096
v_fmac_f32 v92, v218, v180
v_mfma_f32_16x16x32_bf16 v[208:211], v[18:21], v[160:163], v[208:211]
v_exp_f32_e64 v236, v236 clamp
s_nop 0
v_add_f32 v88, v88, v236
v_mfma_f32_16x16x32_bf16 v[212:215], v[16:19], v[160:163], v[212:215]
s_waitcnt vmcnt(11)
v_exp_f32_e64 v237, v237 clamp
s_nop 0
v_add_f32 v89, v89, v237
v_mfma_f32_16x16x32_bf16 v[208:211], v[18:21], v[164:167], v[208:211]
v_exp_f32_e64 v238, v238 clamp
s_nop 0
v_add_f32 v90, v90, v238
v_mfma_f32_16x16x32_bf16 v[212:215], v[16:19], v[164:167], v[212:215]
s_waitcnt vmcnt(10)
v_exp_f32_e64 v239, v239 clamp
s_nop 0
v_add_f32 v91, v91, v239
v_mfma_f32_16x16x32_bf16 v[208:211], v[18:21], v[168:171], v[208:211]
v_cvt_pk_bf16_f32 v222, v88, v89
v_cvt_pk_bf16_f32 v223, v90, v91
v_fmac_f32 v93, v218, v181
v_mfma_f32_16x16x32_bf16 v[212:215], v[16:19], v[168:171], v[212:215]
s_waitcnt vmcnt(9)
v_fmac_f32 v94, v218, v182
v_fmac_f32 v95, v218, v183
v_fma_f32 v92, v92, v219, s40
v_mfma_f32_16x16x32_bf16 v[208:211], v[18:21], v[172:175], v[208:211]
v_fma_f32 v93, v93, v219, s40
v_fma_f32 v94, v94, v219, s40
v_fma_f32 v95, v95, v219, s40
v_mfma_f32_16x16x32_bf16 v[212:215], v[16:19], v[172:175], v[212:215]
v_mul_f32 v240, s41, v92
v_mul_f32 v241, s41, v93
v_mul_f32 v242, s41, v94
v_mul_f32 v243, s41, v95
v_exp_f32_e64 v240, v240 clamp
v_max_f32 v92, s40, v92
v_exp_f32_e64 v241, v241 clamp
v_max_f32 v93, s40, v93
v_exp_f32_e64 v242, v242 clamp
v_max_f32 v94, s40, v94
v_exp_f32_e64 v243, v243 clamp
v_max_f32 v95, s40, v95
v_add_f32 v92, v92, v240
v_add_f32 v93, v93, v241
v_add_f32 v94, v94, v242
v_add_f32 v95, v95, v243
v_cvt_pk_bf16_f32 v230, v92, v93
v_cvt_pk_bf16_f32 v231, v94, v95
v_pk_fma_f32 v[96:97], v[216:217], v[184:185], v[96:97] op_sel_hi:[0,1,1]
v_pk_fma_f32 v[98:99], v[216:217], v[186:187], v[98:99] op_sel_hi:[0,1,1]
v_pk_fma_f32 v[100:101], v[218:219], v[184:185], v[100:101] op_sel_hi:[0,1,1]
v_pk_fma_f32 v[102:103], v[218:219], v[186:187], v[102:103] op_sel_hi:[0,1,1]
v_pk_fma_f32 v[96:97], v[96:97], v[216:217], s[40:41] op_sel:[0,1,0] op_sel_hi:[1,1,0]
v_pk_fma_f32 v[98:99], v[98:99], v[216:217], s[40:41] op_sel:[0,1,0] op_sel_hi:[1,1,0]
v_pk_fma_f32 v[100:101], v[100:101], v[218:219], s[40:41] op_sel:[0,1,0] op_sel_hi:[1,1,0]
v_pk_fma_f32 v[102:103], v[102:103], v[218:219], s[40:41] op_sel:[0,1,0] op_sel_hi:[1,1,0]
v_pk_mul_f32 v[236:237], v[96:97], s[40:41] op_sel:[0,1]
v_pk_mul_f32 v[238:239], v[98:99], s[40:41] op_sel:[0,1]
v_pk_mul_f32 v[240:241], v[100:101], s[40:41] op_sel:[0,1]
v_pk_mul_f32 v[242:243], v[102:103], s[40:41] op_sel:[0,1]
v_exp_f32_e64 v236, v236 clamp
v_max_f32 v96, s40, v96
v_exp_f32_e64 v237, v237 clamp
v_max_f32 v97, s40, v97
v_exp_f32_e64 v238, v238 clamp
v_max_f32 v98, s40, v98
v_exp_f32_e64 v239, v239 clamp
v_max_f32 v99, s40, v99
v_exp_f32_e64 v240, v240 clamp
v_max_f32 v100, s40, v100
v_exp_f32_e64 v241, v241 clamp
v_max_f32 v101, s40, v101
v_exp_f32_e64 v242, v242 clamp
v_max_f32 v102, s40, v102
v_exp_f32_e64 v243, v243 clamp
v_max_f32 v103, s40, v103
v_pk_add_f32 v[96:97], v[96:97], v[236:237]
v_pk_add_f32 v[98:99], v[98:99], v[238:239]
v_pk_add_f32 v[100:101], v[100:101], v[240:241]
v_pk_add_f32 v[102:103], v[102:103], v[242:243]
v_cvt_pk_bf16_f32 v224, v96, v97
v_cvt_pk_bf16_f32 v225, v98, v99
v_cvt_pk_bf16_f32 v232, v100, v101
v_cvt_pk_bf16_f32 v233, v102, v103
v_cvt_pk_bf16_f32 v200, v208, v209
v_cvt_pk_bf16_f32 v201, v210, v211
v_cvt_pk_bf16_f32 v202, v212, v213
v_cvt_pk_bf16_f32 v203, v214, v215
ds_write_b128 v10, v[200:203]
v_pk_fma_f32 v[104:105], v[216:217], v[188:189], v[104:105] op_sel_hi:[0,1,1]
v_pk_fma_f32 v[106:107], v[216:217], v[190:191], v[106:107] op_sel_hi:[0,1,1]
v_pk_fma_f32 v[108:109], v[218:219], v[188:189], v[108:109] op_sel_hi:[0,1,1]
v_pk_fma_f32 v[110:111], v[218:219], v[190:191], v[110:111] op_sel_hi:[0,1,1]
v_pk_fma_f32 v[104:105], v[104:105], v[216:217], s[40:41] op_sel:[0,1,0] op_sel_hi:[1,1,0]
v_pk_fma_f32 v[106:107], v[106:107], v[216:217], s[40:41] op_sel:[0,1,0] op_sel_hi:[1,1,0]
v_pk_fma_f32 v[108:109], v[108:109], v[218:219], s[40:41] op_sel:[0,1,0] op_sel_hi:[1,1,0]
v_pk_fma_f32 v[110:111], v[110:111], v[218:219], s[40:41] op_sel:[0,1,0] op_sel_hi:[1,1,0]
v_pk_mul_f32 v[236:237], v[104:105], s[40:41] op_sel:[0,1]
v_pk_mul_f32 v[238:239], v[106:107], s[40:41] op_sel:[0,1]
v_pk_mul_f32 v[240:241], v[108:109], s[40:41] op_sel:[0,1]
v_pk_mul_f32 v[242:243], v[110:111], s[40:41] op_sel:[0,1]
v_exp_f32_e64 v236, v236 clamp
v_max_f32 v104, s40, v104
v_exp_f32_e64 v237, v237 clamp
v_max_f32 v105, s40, v105
v_exp_f32_e64 v238, v238 clamp
v_max_f32 v106, s40, v106
v_exp_f32_e64 v239, v239 clamp
v_max_f32 v107, s40, v107
v_exp_f32_e64 v240, v240 clamp
v_max_f32 v108, s40, v108
v_exp_f32_e64 v241, v241 clamp
v_max_f32 v109, s40, v109
v_exp_f32_e64 v242, v242 clamp
v_max_f32 v110, s40, v110
v_exp_f32_e64 v243, v243 clamp
v_max_f32 v111, s40, v111
v_pk_add_f32 v[104:105], v[104:105], v[236:237]
v_pk_add_f32 v[106:107], v[106:107], v[238:239]
v_pk_add_f32 v[108:109], v[108:109], v[240:241]
v_pk_add_f32 v[110:111], v[110:111], v[242:243]
v_cvt_pk_bf16_f32 v226, v104, v105
v_cvt_pk_bf16_f32 v227, v106, v107
v_cvt_pk_bf16_f32 v234, v108, v109
v_cvt_pk_bf16_f32 v235, v110, v111
wl 0
s_barrier
rd 128,29,4096
rd 112,29,0
rd 116,29,1024
rd 132,29,6144
rd 120,29,2048
rd 124,29,3072
s_lshl_b32 s32, s17, 12
s_add_u32 s32, s32, s52
wl 4
v_mfma_f32_16x16x32_bf16 v[136:139], v[128:131], v[220:223], 0
main_cp19:
s_mov_b32 s96, main_cp19-main_cp18
v_lshl_add_u64 v[2:3], v[2:3], 0, s[96:97]
global_load_dword v254, v[2:3], off
v_mfma_f32_16x16x32_bf16 v[144:147], v[128:131], v[228:231], 0
wl 2
v_mfma_f32_16x16x32_bf16 v[140:143], v[132:135], v[224:227], 0
s_mul_i32 s23, s77, 16384
s_add_u32 s23, s23, s26
s_add_u32 s23, s23, 81920
s_add_u32 m0, s21, 0
s_nop 0
lw 0
v_mfma_f32_16x16x32_bf16 v[148:151], v[132:135], v[232:235], 0
v_mfma_f32_16x16x32_bf16 v[80:83], v[112:115], v[220:223], 0
v_mfma_f32_16x16x32_bf16 v[84:87], v[116:119], v[220:223], 0
v_add_f32 v136, s40, v136
v_rcp_f32 v136, v136
v_mfma_f32_16x16x32_bf16 v[96:99], v[112:115], v[228:231], 0
v_mfma_f32_16x16x32_bf16 v[100:103], v[116:119], v[228:231], 0
wl 1
lw 1024
v_add_f32 v144, s40, v144
v_rcp_f32 v144, v144
v_mfma_f32_16x16x32_bf16 v[88:91], v[120:123], v[224:227], 0
wl 0
v_mfma_f32_16x16x32_bf16 v[92:95], v[124:127], v[224:227], 0
v_add_f32 v140, s40, v140
v_rcp_f32 v140, v140
v_mfma_f32_16x16x32_bf16 v[104:107], v[120:123], v[232:235], 0
lw 2048
v_mfma_f32_16x16x32_bf16 v[108:111], v[124:127], v[232:235], 0
v_add_f32 v148, s40, v148
v_rcp_f32 v148, v148
v_pk_mul_f32 v[80:81], v[80:81], v[136:137] op_sel_hi:[1,0]
v_pk_mul_f32 v[82:83], v[82:83], v[136:137] op_sel_hi:[1,0]
v_pk_mul_f32 v[84:85], v[84:85], v[136:137] op_sel_hi:[1,0]
v_pk_mul_f32 v[86:87], v[86:87], v[136:137] op_sel_hi:[1,0]
v_cvt_pk_bf16_f32 v152, v80, v81
v_cvt_pk_bf16_f32 v153, v82, v83
v_cvt_pk_bf16_f32 v154, v84, v85
v_cvt_pk_bf16_f32 v155, v86, v87
buffer_store_dwordx4 v[152:155], v0, s[4:7], s32 offen offset:0 sc1
v_pk_mul_f32 v[96:97], v[96:97], v[144:145] op_sel_hi:[1,0]
v_pk_mul_f32 v[98:99], v[98:99], v[144:145] op_sel_hi:[1,0]
lw 3072
v_pk_mul_f32 v[100:101], v[100:101], v[144:145] op_sel_hi:[1,0]
v_pk_mul_f32 v[102:103], v[102:103], v[144:145] op_sel_hi:[1,0]
v_cvt_pk_bf16_f32 v160, v96, v97
v_cvt_pk_bf16_f32 v161, v98, v99
v_cvt_pk_bf16_f32 v162, v100, v101
v_cvt_pk_bf16_f32 v163, v102, v103
buffer_store_dwordx4 v[160:163], v0, s[4:7], s32 offen offset:1024 sc1
v_pk_mul_f32 v[88:89], v[88:89], v[140:141] op_sel_hi:[1,0]
v_pk_mul_f32 v[90:91], v[90:91], v[140:141] op_sel_hi:[1,0]
v_pk_mul_f32 v[92:93], v[92:93], v[140:141] op_sel_hi:[1,0]
v_pk_mul_f32 v[94:95], v[94:95], v[140:141] op_sel_hi:[1,0]
v_cvt_pk_bf16_f32 v156, v88, v89
v_cvt_pk_bf16_f32 v157, v90, v91
v_cvt_pk_bf16_f32 v158, v92, v93
v_cvt_pk_bf16_f32 v159, v94, v95
buffer_store_dwordx4 v[156:159], v0, s[4:7], s32 offen offset:2048 sc1
v_pk_mul_f32 v[104:105], v[104:105], v[148:149] op_sel_hi:[1,0]
v_pk_mul_f32 v[106:107], v[106:107], v[148:149] op_sel_hi:[1,0]
s_mul_i32 s23, s78, 16384
s_add_u32 s23, s23, s26
s_add_u32 s23, s23, 98304
s_add_u32 m0, s21, 114688
s_nop 0
lw 0
v_pk_mul_f32 v[108:109], v[108:109], v[148:149] op_sel_hi:[1,0]
v_pk_mul_f32 v[110:111], v[110:111], v[148:149] op_sel_hi:[1,0]
v_cvt_pk_bf16_f32 v164, v104, v105
v_cvt_pk_bf16_f32 v165, v106, v107
v_cvt_pk_bf16_f32 v166, v108, v109
v_cvt_pk_bf16_f32 v167, v110, v111
buffer_store_dwordx4 v[164:167], v0, s[4:7], s32 offen offset:3072 sc1
lw 1024
lw 2048
lw 3072
s_min_i32 s23, s79, 0
s_mul_i32 s23, s23, 16384
s_add_u32 s23, s23, s26
s_add_u32 s23, s23, 114688
s_add_u32 m0, s21, 65536
s_nop 0
lw 0
lw 1024
lw 2048
lw 3072
s_add_u32 s36, s48, 32768
v_mov_b32 v31, 1
s_waitcnt vmcnt(7)
buffer_atomic_add v31, v4, s[4:7], s36 offen sc0 sc1
s_barrier
rd 48,1,16384
rd 52,1,17408
rd 56,1,18432
rd 60,1,19456
rd 64,1,20480
rd 68,1,21504
rd 72,1,22528
v_lshlrev_b32 v80, 16, v32
v_and_b32 v81, 0xffff0000, v32
v_lshlrev_b32 v82, 16, v33
v_and_b32 v83, 0xffff0000, v33
v_lshlrev_b32 v88, 16, v34
v_and_b32 v89, 0xffff0000, v34
v_lshlrev_b32 v90, 16, v35
v_and_b32 v91, 0xffff0000, v35
v_lshlrev_b32 v96, 16, v36
v_and_b32 v97, 0xffff0000, v36
v_lshlrev_b32 v98, 16, v37
v_and_b32 v99, 0xffff0000, v37
v_lshlrev_b32 v104, 16, v38
v_and_b32 v105, 0xffff0000, v38
v_lshlrev_b32 v106, 16, v39
v_and_b32 v107, 0xffff0000, v39
v_lshlrev_b32 v84, 16, v40
v_and_b32 v85, 0xffff0000, v40
v_lshlrev_b32 v86, 16, v41
v_and_b32 v87, 0xffff0000, v41
v_lshlrev_b32 v92, 16, v42
v_and_b32 v93, 0xffff0000, v42
v_lshlrev_b32 v94, 16, v43
v_and_b32 v95, 0xffff0000, v43
v_lshlrev_b32 v100, 16, v44
v_and_b32 v101, 0xffff0000, v44
v_lshlrev_b32 v102, 16, v45
v_and_b32 v103, 0xffff0000, v45
v_lshlrev_b32 v108, 16, v46
v_and_b32 v109, 0xffff0000, v46
v_lshlrev_b32 v110, 16, v47
v_and_b32 v111, 0xffff0000, v47
v_mov_b32 v251, 0
s_waitcnt vmcnt(0)
v_readfirstlane_b32 s46, v31
buffer_atomic_add v251, v4, s[4:7], s36 offen sc0 sc1
s_cmp_ge_u32 s46, 15
s_cbranch_scc1 main_ok134
s_waitcnt vmcnt(0)
v_readfirstlane_b32 s46, v251
s_mov_b32 s47, 0
s_cmp_ge_u32 s46, 16
s_cbranch_scc1 main_ok134
main_poll133:
v_mov_b32 v31, 0
buffer_atomic_add v31, v4, s[4:7], s36 offen sc0 sc1
s_add_u32 s47, s47, 1
s_cmp_gt_u32 s47, 400000
s_cbranch_scc1 main_ok134
s_waitcnt vmcnt(0)
v_readfirstlane_b32 s46, v31
s_nop 0
s_cmp_lt_u32 s46, 16
s_cbranch_scc1 main_poll133
main_ok134:
s_max_i32 s24, s76, 0
s_mul_i32 s24, s24, 8192
s_add_u32 s24, s24, s52
s_add_u32 s24, s24, 0
lx 0,0
lx 4,1024
lx 8,2048
lx 12,3072
s_add_u32 s24, s24, 4096
lx 16,0
lx 20,1024
lx 24,2048
lx 28,3072
s_waitcnt vmcnt(7) lgkmcnt(5)
mT 80,48,0
s_waitcnt vmcnt(6)
s_mul_i32 s24, s77, 8192
rd 76,1,23552
mT 84,48,4
mT 92,52,4
s_add_u32 s24, s24, s52
rd 48,1,24576
mT 88,52,0
wl 5
mT 96,56,0
s_add_u32 s24, s24, 8192
rd 52,1,25600
mT 100,56,4
lx 32,0
mT 108,60,4
rd 56,1,26624
mT 104,60,0
s_waitcnt vmcnt(6) lgkmcnt(5)
lx 36,1024
mT 80,64,8
s_waitcnt vmcnt(6)
rd 60,1,27648
mT 84,64,12
lx 40,2048
mT 92,68,12
rd 64,1,28672
mT 88,68,8
wl 5
lx 44,3072
mT 96,72,8
s_add_u32 s24, s24, 4096
rd 68,1,29696
mT 100,72,12
lx 48,0
mT 108,76,12
rd 72,1,30720
mT 104,76,8
s_waitcnt vmcnt(8) lgkmcnt(5)
lx 52,1024
mT 80,48,16
s_waitcnt vmcnt(8)
rd 76,1,31744
mT 84,48,20
s_barrier
mT 92,52,20
rd 48,0,16384
mT 88,52,16
wl 5
lx 56,2048
mT 96,56,16
rd 52,0,17408
mT 100,56,20
lx 60,3072
mT 108,60,20
s_mul_i32 s24, s78, 8192
rd 56,0,18432
mT 104,60,16
s_waitcnt vmcnt(9) lgkmcnt(5)
mT 80,64,24
s_waitcnt vmcnt(8)
s_add_u32 s24, s24, s52
rd 60,0,19456
mT 84,64,28
mT 92,68,28
s_add_u32 s24, s24, 16384
rd 64,0,20480
mT 88,68,24
wl 5
lx 64,0
mT 96,72,24
rd 68,0,21504
mT 100,72,28
lx 68,1024
mT 108,76,28
rd 72,0,22528
mT 104,76,24
s_waitcnt vmcnt(9) lgkmcnt(5)
lx 72,2048
mT 80,48,32
s_waitcnt vmcnt(9)
rd 76,0,23552
mT 84,48,36
lx 76,3072
mT 92,52,36
s_add_u32 s24, s24, 4096
rd 48,0,24576
mT 88,52,32
wl 5
lx 80,0
mT 96,56,32
rd 52,0,25600
mT 100,56,36
lx 84,1024
mT 108,60,36
rd 56,0,26624
mT 104,60,32
s_waitcnt vmcnt(11) lgkmcnt(5)
mT 80,64,40
s_waitcnt vmcnt(10)
rd 60,0,27648
mT 84,64,44
lx 88,2048
mT 92,68,44
rd 64,0,28672
mT 88,68,40
wl 5
lx 92,3072
mT 96,72,40
rd 68,0,29696
mT 100,72,44
mT 108,76,44
rd 72,0,30720
mT 104,76,40
s_waitcnt vmcnt(11) lgkmcnt(5)
mT 80,48,48
s_waitcnt vmcnt(10)
s_mul_i32 s24, s79, 8192
rd 76,0,31744
mT 84,48,52
s_barrier
mT 92,52,52
s_add_u32 s24, s24, s52
rd 48,0,32768
mT 88,52,48
wl 5
mT 96,56,48
s_add_u32 s24, s24, 24576
rd 52,0,33792
mT 100,56,52
lx 96,0
mT 108,60,52
rd 56,0,34816
mT 104,60,48
s_waitcnt vmcnt(10) lgkmcnt(5)
lx 100,1024
mT 80,64,56
s_waitcnt vmcnt(10)
rd 60,0,35840
mT 84,64,60
lx 104,2048
mT 92,68,60
rd 64,0,36864
mT 88,68,56
wl 5
lx 108,3072
mT 96,72,56
rd 68,0,37888
mT 100,72,60
mT 108,76,60
rd 72,0,38912
mT 104,76,56
s_waitcnt vmcnt(11) lgkmcnt(5)
mT 80,48,64
s_waitcnt vmcnt(10)
s_add_u32 s24, s24, 4096
rd 76,0,39936
mT 84,48,68
lx 112,0
mT 92,52,68
rd 48,0,40960
mT 88,52,64
wl 5
lx 116,1024
mT 96,56,64
rd 52,0,41984
mT 100,56,68
mT 108,60,68
rd 56,0,43008
mT 104,60,64
s_waitcnt vmcnt(11) lgkmcnt(5)
mT 80,64,72
s_waitcnt vmcnt(10)
rd 60,0,44032
mT 84,64,76
lx 120,2048
mT 92,68,76
rd 64,0,45056
mT 88,68,72
wl 5
lx 124,3072
mT 96,72,72
rd 68,0,46080
mT 100,72,76
mT 108,76,76
rd 72,0,47104
mT 104,76,72
s_waitcnt vmcnt(11) lgkmcnt(5)
mT 80,48,80
s_waitcnt vmcnt(10)
s_mul_i32 s24, s76, 8192
rd 76,0,48128
mT 84,48,84
s_barrier
mT 92,52,84
s_add_u32 s24, s24, s52
rd 48,0,49152
mT 88,52,80
wl 5
mT 96,56,80
s_add_u32 s24, s24, 32768
rd 52,0,50176
mT 100,56,84
lx 128,0
mT 108,60,84
rd 56,0,51200
mT 104,60,80
s_waitcnt vmcnt(10) lgkmcnt(5)
lx 132,1024
mT 80,64,88
s_waitcnt vmcnt(10)
rd 60,0,52224
mT 84,64,92
lx 136,2048
mT 92,68,92
rd 64,0,53248
mT 88,68,88
wl 5
lx 140,3072
mT 96,72,88
rd 68,0,54272
mT 100,72,92
mT 108,76,92
rd 72,0,55296
mT 104,76,88
s_waitcnt vmcnt(11) lgkmcnt(5)
mT 80,48,96
s_waitcnt vmcnt(10)
s_add_u32 s24, s24, 4096
rd 76,0,56320
mT 84,48,100
lx 144,0
mT 92,52,100
rd 48,0,57344
mT 88,52,96
wl 5
lx 148,1024
mT 96,56,96
rd 52,0,58368
mT 100,56,100
mT 108,60,100
rd 56,0,59392
mT 104,60,96
s_waitcnt vmcnt(11) lgkmcnt(5)
mT 80,64,104
s_waitcnt vmcnt(10)
rd 60,0,60416
mT 84,64,108
lx 152,2048
mT 92,68,108
rd 64,0,61440
mT 88,68,104
wl 5
lx 156,3072
mT 96,72,104
rd 68,0,62464
mT 100,72,108
mT 108,76,108
rd 72,0,63488
mT 104,76,104
s_waitcnt vmcnt(11) lgkmcnt(5)
mT 80,48,112
s_waitcnt vmcnt(10)
s_mul_i32 s24, s77, 8192
rd 76,0,64512
mT 84,48,116
s_barrier
mT 92,52,116
s_add_u32 s24, s24, s52
rd 48,1,32768
mT 88,52,112
wl 5
mT 96,56,112
s_add_u32 s24, s24, 40960
rd 52,1,33792
mT 100,56,116
lx 160,0
mT 108,60,116
rd 56,1,34816
mT 104,60,112
s_waitcnt vmcnt(10) lgkmcnt(5)
lx 164,1024
mT 80,64,120
s_waitcnt vmcnt(10)
rd 60,1,35840
mT 84,64,124
lx 168,2048
mT 92,68,124
rd 64,1,36864
mT 88,68,120
wl 5
lx 172,3072
mT 96,72,120
rd 68,1,37888
mT 100,72,124
mT 108,76,124
rd 72,1,38912
mT 104,76,120
s_waitcnt vmcnt(11) lgkmcnt(5)
mT 80,48,128
s_waitcnt vmcnt(10)
s_add_u32 s24, s24, 4096
rd 76,1,39936
mT 84,48,132
lx 176,0
mT 92,52,132
rd 48,1,40960
mT 88,52,128
wl 5
lx 180,1024
mT 96,56,128
rd 52,1,41984
mT 100,56,132
mT 108,60,132
rd 56,1,43008
mT 104,60,128
s_waitcnt vmcnt(11) lgkmcnt(5)
mT 80,64,136
s_waitcnt vmcnt(10)
rd 60,1,44032
mT 84,64,140
lx 184,2048
mT 92,68,140
rd 64,1,45056
mT 88,68,136
wl 5
lx 188,3072
mT 96,72,136
rd 68,1,46080
mT 100,72,140
mT 108,76,140
rd 72,1,47104
mT 104,76,136
s_waitcnt vmcnt(11) lgkmcnt(5)
mT 80,48,144
s_waitcnt vmcnt(10)
s_mul_i32 s24, s78, 8192
rd 76,1,48128
mT 84,48,148
s_barrier
mT 92,52,148
s_add_u32 s24, s24, s52
rd 48,0,0
mT 88,52,144
wl 5
mT 96,56,144
s_add_u32 s24, s24, 49152
rd 52,0,1024
mT 100,56,148
lx 192,0
mT 108,60,148
rd 56,0,2048
mT 104,60,144
s_waitcnt vmcnt(10) lgkmcnt(5)
lx 196,1024
mT 80,64,152
s_waitcnt vmcnt(10)
rd 60,0,3072
mT 84,64,156
lx 200,2048
mT 92,68,156
rd 64,0,4096
mT 88,68,152
wl 5
lx 204,3072
mT 96,72,152
rd 68,0,5120
mT 100,72,156
mT 108,76,156
rd 72,0,6144
mT 104,76,152
s_waitcnt vmcnt(11) lgkmcnt(5)
mT 80,48,160
s_waitcnt vmcnt(10)
s_add_u32 s24, s24, 4096
rd 76,0,7168
mT 84,48,164
lx 208,0
mT 92,52,164
rd 48,0,8192
mT 88,52,160
wl 5
lx 212,1024
mT 96,56,160
rd 52,0,9216
mT 100,56,164
mT 108,60,164
rd 56,0,10240
mT 104,60,160
s_waitcnt vmcnt(11) lgkmcnt(5)
mT 80,64,168
s_waitcnt vmcnt(10)
rd 60,0,11264
mT 84,64,172
lx 216,2048
mT 92,68,172
rd 64,0,12288
mT 88,68,168
wl 5
lx 220,3072
mT 96,72,168
rd 68,0,13312
mT 100,72,172
mT 108,76,172
rd 72,0,14336
mT 104,76,168
s_waitcnt vmcnt(11) lgkmcnt(5)
mT 80,48,176
s_waitcnt vmcnt(10)
s_min_i32 s24, s79, 0
rd 76,0,15360
mT 84,48,180
s_barrier
mT 92,52,180
s_mul_i32 s24, s24, 8192
rd 48,1,49152
mT 88,52,176
wl 5
mT 96,56,176
s_add_u32 s24, s24, s52
rd 52,1,50176
mT 100,56,180
mT 108,60,180
s_add_u32 s24, s24, 57344
rd 56,1,51200
mT 104,60,176
s_waitcnt vmcnt(9) lgkmcnt(5)
lx 224,0
mT 80,64,184
s_waitcnt vmcnt(9)
rd 60,1,52224
mT 84,64,188
lx 228,1024
mT 92,68,188
rd 64,1,53248
mT 88,68,184
wl 5
lx 232,2048
mT 96,72,184
rd 68,1,54272
mT 100,72,188
lx 236,3072
mT 108,76,188
rd 72,1,55296
mT 104,76,184
s_waitcnt vmcnt(11) lgkmcnt(5)
mT 80,48,192
s_waitcnt vmcnt(10)
s_add_u32 s24, s24, 4096
rd 76,1,56320
mT 84,48,196
lx 240,0
mT 92,52,196
rd 48,1,57344
mT 88,52,192
wl 5
lx 244,1024
mT 96,56,192
rd 52,1,58368
mT 100,56,196
main_cp20:
s_mov_b32 s96, main_cp20-main_cp19
v_lshl_add_u64 v[2:3], v[2:3], 0, s[96:97]
global_load_dword v254, v[2:3], off
mT 108,60,196
rd 56,1,59392
mT 104,60,192
s_waitcnt vmcnt(12) lgkmcnt(5)
mT 80,64,200
s_waitcnt vmcnt(11)
rd 60,1,60416
mT 84,64,204
lx 248,2048
mT 92,68,204
rd 64,1,61440
mT 88,68,200
wl 5
lx 252,3072
mT 96,72,200
rd 68,1,62464
mT 100,72,204
mT 108,76,204
rd 72,1,63488
mT 104,76,200
s_waitcnt vmcnt(12) lgkmcnt(5)
mT 80,48,208
s_waitcnt vmcnt(11)
s_add_u32 s23, s27, 0
rd 76,1,64512
mT 84,48,212
s_barrier
mT 92,52,212
s_add_u32 m0, s22, 131072
rd 48,1,0
mT 88,52,208
wl 5
lw 0
mT 96,56,208
rd 52,1,1024
mT 100,56,212
lw 1024
mT 108,60,212
rd 56,1,4096
mT 104,60,208
s_waitcnt vmcnt(12) lgkmcnt(5)
lw 2048
mT 80,64,216
s_waitcnt vmcnt(12)
rd 60,1,5120
mT 84,64,220
s_mov_b32 exec_hi, 0
lw 3072
s_mov_b32 exec_hi, -1
mT 92,68,220
s_add_u32 s23, s23, 14336
rd 64,1,8192
mT 88,68,216
wl 5
mT 96,72,216
s_add_u32 m0, s22, 145408
rd 68,1,9216
mT 100,72,220
lw 0
mT 108,76,220
rd 72,1,12288
mT 104,76,216
s_waitcnt vmcnt(13) lgkmcnt(5)
lw 1024
mT 80,48,224
s_waitcnt vmcnt(13)
rd 76,1,13312
mT 84,48,228
lw 2048
mT 92,52,228
rd 48,1,2048
mT 88,52,224
s_waitcnt vmcnt(13) lgkmcnt(5)
s_mov_b32 exec_hi, 0
lw 3072
s_mov_b32 exec_hi, -1
mT 80,56,232
s_waitcnt vmcnt(13)
s_add_u32 s23, s27, 28672
rd 52,1,3072
mT 84,56,236
mT 92,60,236
s_add_u32 m0, s22, 16384
rd 56,1,6144
mT 88,60,232
s_waitcnt vmcnt(12) lgkmcnt(5)
lw 0
mT 80,64,240
s_waitcnt vmcnt(12)
rd 60,1,7168
mT 84,64,244
lw 1024
mT 92,68,244
rd 64,1,10240
mT 88,68,240
s_waitcnt vmcnt(11) lgkmcnt(5)
lw 2048
mT 80,72,248
s_waitcnt vmcnt(11)
rd 68,1,11264
mT 84,72,252
s_mov_b32 exec_hi, 0
lw 3072
s_mov_b32 exec_hi, -1
mT 92,76,252
s_add_u32 s23, s23, 14336
rd 72,1,14336
mT 88,76,248
wl 5
mT 96,48,224
s_add_u32 m0, s22, 30720
rd 76,1,15360
mT 100,48,228
lw 0
mT 108,52,228
lw 1024
mT 104,52,224
wl 4
mT 96,56,232
s_lshl_b32 s32, s17, 12
s_add_u32 s32, s32, s52
s_add_u32 s32, s32, 65536
v_cvt_pk_bf16_f32 v32, v80, v81
mT 100,56,236
lw 2048
v_cvt_pk_bf16_f32 v33, v82, v83
mT 108,60,236
v_cvt_pk_bf16_f32 v34, v88, v89
v_cvt_pk_bf16_f32 v35, v90, v91
mT 104,60,232
wl 3
s_mov_b32 exec_hi, 0
lw 3072
s_mov_b32 exec_hi, -1
mT 96,64,240
buffer_store_dwordx4 v[32:35], v0, s[4:7], s32 offen offset:0 sc1
v_cvt_pk_bf16_f32 v40, v84, v85
mT 100,64,244
wl 2
v_cvt_pk_bf16_f32 v41, v86, v87
v_cvt_pk_bf16_f32 v42, v92, v93
v_cvt_pk_bf16_f32 v43, v94, v95
mT 108,68,244
buffer_store_dwordx4 v[40:43], v0, s[4:7], s32 offen offset:1024 sc1
v_dot2_f32_bf16 v220, v32, v24, 0
mT 104,68,240
wl 1
v_dot2_f32_bf16 v222, v32, v32, 0
v_dot2_f32_bf16 v221, v40, v24, 0
v_dot2_f32_bf16 v223, v40, v40, 0
mT 96,72,248
v_dot2_f32_bf16 v220, v33, v24, v220
v_dot2_f32_bf16 v222, v33, v33, v222
v_dot2_f32_bf16 v221, v41, v24, v221
mT 100,72,252
wl 0
v_dot2_f32_bf16 v223, v41, v41, v223
v_dot2_f32_bf16 v220, v34, v24, v220
v_dot2_f32_bf16 v222, v34, v34, v222
mT 108,76,252
v_dot2_f32_bf16 v221, v42, v24, v221
v_dot2_f32_bf16 v223, v42, v42, v223
v_dot2_f32_bf16 v220, v35, v24, v220
mT 104,76,248
v_dot2_f32_bf16 v222, v35, v35, v222
v_dot2_f32_bf16 v221, v43, v24, v221
v_dot2_f32_bf16 v223, v43, v43, v223
v_cvt_pk_bf16_f32 v36, v96, v97
v_cvt_pk_bf16_f32 v37, v98, v99
s_nop 2
v_cvt_pk_bf16_f32 v38, v104, v105
v_cvt_pk_bf16_f32 v39, v106, v107
buffer_store_dwordx4 v[36:39], v0, s[4:7], s32 offen offset:2048 sc1
v_cvt_pk_bf16_f32 v44, v100, v101
v_cvt_pk_bf16_f32 v45, v102, v103
v_cvt_pk_bf16_f32 v46, v108, v109
v_cvt_pk_bf16_f32 v47, v110, v111
buffer_store_dwordx4 v[44:47], v0, s[4:7], s32 offen offset:3072 sc1
v_dot2_f32_bf16 v220, v36, v24, v220
v_dot2_f32_bf16 v222, v36, v36, v222
v_dot2_f32_bf16 v221, v44, v24, v221
v_dot2_f32_bf16 v223, v44, v44, v223
v_dot2_f32_bf16 v220, v37, v24, v220
v_dot2_f32_bf16 v222, v37, v37, v222
v_dot2_f32_bf16 v221, v45, v24, v221
v_dot2_f32_bf16 v223, v45, v45, v223
v_dot2_f32_bf16 v220, v38, v24, v220
v_dot2_f32_bf16 v222, v38, v38, v222
v_dot2_f32_bf16 v221, v46, v24, v221
v_dot2_f32_bf16 v223, v46, v46, v223
v_dot2_f32_bf16 v220, v39, v24, v220
v_dot2_f32_bf16 v222, v39, v39, v222
v_dot2_f32_bf16 v221, v47, v24, v221
v_dot2_f32_bf16 v223, v47, v47, v223
s_nop 1
v_permlane32_swap_b32 v220, v221
v_permlane32_swap_b32 v222, v223
v_add_f32 v220, v220, v221
v_add_f32 v222, v222, v223
s_nop 1
v_permlane16_swap_b32 v220, v222
v_add_f32 v220, v220, v222
s_lshl_b32 s33, s17, 8
s_add_u32 s33, s33, s54
s_add_u32 s33, s33, 262144
buffer_store_dword v220, v6, s[4:7], s33 offen sc1
s_add_u32 s36, s48, 49152
v_mov_b32 v31, 1
s_waitcnt vmcnt(0)
buffer_atomic_add v31, v4, s[4:7], s36 offen sc0 sc1
s_barrier
s_add_u32 s23, s27, 57344
s_add_u32 m0, s22, 45056
s_nop 0
lw 0
lw 1024
lw 2048
s_mov_b32 exec_hi, 0
lw 3072
s_mov_b32 exec_hi, -1
s_add_u32 s23, s23, 14336
s_add_u32 m0, s22, 88064
s_nop 0
lw 0
lw 1024
lw 2048
s_mov_b32 exec_hi, 0
lw 3072
s_mov_b32 exec_hi, -1
s_barrier
rd 48,29,0
rd 52,29,1024
rd 56,29,2048
rd 60,29,3072
rd 64,29,4096
rd 68,29,5120
rd 72,29,6144
v_mov_b32 v251, 0
s_waitcnt vmcnt(8)
v_readfirstlane_b32 s46, v31
buffer_atomic_add v251, v4, s[4:7], s36 offen sc0 sc1
s_add_u32 s23, s27, 86016
s_add_u32 m0, s22, 2048
s_nop 0
lw 0
lw 1024
lw 2048
s_mov_b32 exec_hi, 0
lw 3072
s_mov_b32 exec_hi, -1
s_add_u32 s23, s23, 14336
s_add_u32 m0, s22, 102400
s_nop 0
lw 0
lw 1024
lw 2048
s_mov_b32 exec_hi, 0
lw 3072
s_mov_b32 exec_hi, -1
s_cmp_ge_u32 s46, 15
s_cbranch_scc1 main_ok168
s_waitcnt vmcnt(8)
v_readfirstlane_b32 s46, v251
s_mov_b32 s47, 0
s_cmp_ge_u32 s46, 16
s_cbranch_scc1 main_ok168
main_poll167:
v_mov_b32 v31, 0
buffer_atomic_add v31, v4, s[4:7], s36 offen sc0 sc1
s_add_u32 s47, s47, 1
s_cmp_gt_u32 s47, 400000
s_cbranch_scc1 main_ok168
s_waitcnt vmcnt(0)
v_readfirstlane_b32 s46, v31
s_nop 0
s_cmp_lt_u32 s46, 16
s_cbranch_scc1 main_poll167
main_ok168:
s_add_u32 s24, s52, 65536
lx 0,0
lx 4,1024
lx 8,2048
lx 12,3072
s_add_u32 s24, s24, 4096
lx 16,0
lx 20,1024
lx 24,2048
lx 28,3072
s_and_b32 s35, s17, 1
s_lshl_b32 s35, s35, 16
s_add_u32 s35, s35, s53
s_waitcnt vmcnt(7) lgkmcnt(5)
v_mfma_f32_16x16x32_bf16 v[80:83], a[0:3], v[48:51], 0
s_waitcnt vmcnt(6)
s_add_u32 s24, s52, 73728
rd 76,29,7168
v_mfma_f32_16x16x32_bf16 v[84:87], a[4:7], v[48:51], 0
lx 32,0
v_mfma_f32_16x16x32_bf16 v[92:95], a[4:7], v[52:55], 0
rd 48,29,8192
v_mfma_f32_16x16x32_bf16 v[88:91], a[0:3], v[52:55], 0
wl 5
v_mfma_f32_16x16x32_bf16 v[96:99], a[0:3], v[56:59], 0
rd 52,29,9216
v_mfma_f32_16x16x32_bf16 v[100:103], a[4:7], v[56:59], 0
lx 36,1024
v_mfma_f32_16x16x32_bf16 v[108:111], a[4:7], v[60:63], 0
rd 56,29,10240
v_mfma_f32_16x16x32_bf16 v[104:107], a[0:3], v[60:63], 0
wl 5
v_mfma_f32_16x16x32_bf16 v[112:115], a[0:3], v[64:67], 0
rd 60,29,11264
v_mfma_f32_16x16x32_bf16 v[116:119], a[4:7], v[64:67], 0
lx 40,2048
v_mfma_f32_16x16x32_bf16 v[124:127], a[4:7], v[68:71], 0
rd 64,29,12288
v_mfma_f32_16x16x32_bf16 v[120:123], a[0:3], v[68:71], 0
wl 5
v_mfma_f32_16x16x32_bf16 v[128:131], a[0:3], v[72:75], 0
rd 68,29,13312
v_mfma_f32_16x16x32_bf16 v[132:135], a[4:7], v[72:75], 0
s_waitcnt vmcnt(7)
s_barrier
mF 84,76,12
rd 72,29,14336
mF 80,76,8
wl 5
lx 44,3072
mF 88,48,8
s_add_u32 s24, s24, 4096
rd 76,29,15360
mF 92,48,12
mF 100,52,12
rd 48,29,16384
mF 96,52,8
wl 5
lx 48,0
mF 104,56,8
rd 52,29,17408
mF 108,56,12
mF 116,60,12
rd 56,29,18432
mF 112,60,8
wl 5
lx 52,1024
mF 120,64,8
rd 60,29,19456
mF 124,64,12
mF 132,68,12
rd 64,29,20480
mF 128,68,8
s_waitcnt vmcnt(9) lgkmcnt(5)
lx 56,2048
mF 80,72,16
s_waitcnt vmcnt(9)
rd 68,29,21504
mF 84,72,20
mF 92,76,20
rd 72,29,22528
mF 88,76,16
wl 5
lx 60,3072
mF 96,48,16
s_add_u32 s24, s52, 81920
rd 76,29,23552
mF 100,48,20
mF 108,52,20
rd 48,29,24576
mF 104,52,16
wl 5
lx 64,0
mF 112,56,16
rd 52,29,25600
mF 116,56,20
mF 124,60,20
rd 56,29,26624
mF 120,60,16
wl 5
lx 68,1024
mF 128,64,16
rd 60,29,27648
mF 132,64,20
s_waitcnt vmcnt(10)
s_barrier
mF 84,68,28
rd 64,0,16384
mF 80,68,24
wl 5
lx 72,2048
mF 88,72,24
rd 68,0,17408
mF 92,72,28
mF 100,76,28
rd 72,0,18432
mF 96,76,24
wl 5
lx 76,3072
mF 104,48,24
s_add_u32 s24, s24, 4096
rd 76,0,19456
mF 108,48,28
mF 116,52,28
rd 48,0,20480
mF 112,52,24
wl 5
lx 80,0
mF 120,56,24
rd 52,0,21504
mF 124,56,28
mF 132,60,28
rd 56,0,22528
mF 128,60,24
s_waitcnt vmcnt(12) lgkmcnt(5)
lx 84,1024
mF 80,64,32
s_waitcnt vmcnt(12)
rd 60,0,23552
mF 84,64,36
mF 92,68,36
rd 64,0,24576
mF 88,68,32
wl 5
lx 88,2048
mF 96,72,32
rd 68,0,25600
mF 100,72,36
mF 108,76,36
rd 72,0,26624
mF 104,76,32
wl 5
lx 92,3072
mF 112,48,32
s_add_u32 s24, s52, 90112
rd 76,0,27648
mF 116,48,36
mF 124,52,36
rd 48,0,28672
mF 120,52,32
wl 5
lx 96,0
mF 128,56,32
rd 52,0,29696
mF 132,56,36
s_waitcnt vmcnt(13)
s_barrier
mF 84,60,44
rd 56,0,30720
mF 80,60,40
wl 5
lx 100,1024
mF 88,64,40
rd 60,0,31744
mF 92,64,44
mF 100,68,44
rd 64,0,32768
mF 96,68,40
wl 5
lx 104,2048
mF 104,72,40
rd 68,0,33792
mF 108,72,44
mF 116,76,44
rd 72,0,34816
mF 112,76,40
wl 5
lx 108,3072
mF 120,48,40
s_add_u32 s24, s24, 4096
rd 76,0,35840
mF 124,48,44
mF 132,52,44
rd 48,0,36864
mF 128,52,40
s_waitcnt vmcnt(15) lgkmcnt(5)
lx 112,0
mF 80,56,48
s_waitcnt vmcnt(15)
rd 52,0,37888
mF 84,56,52
mF 92,60,52
rd 56,0,38912
mF 88,60,48
wl 5
lx 116,1024
mF 96,64,48
rd 60,0,39936
mF 100,64,52
mF 108,68,52
rd 64,0,40960
mF 104,68,48
wl 5
lx 120,2048
mF 112,72,48
rd 68,0,41984
mF 116,72,52
mF 124,76,52
rd 72,0,43008
mF 120,76,48
wl 5
lx 124,3072
mF 128,48,48
s_add_u32 s24, s52, 98304
rd 76,0,44032
mF 132,48,52
s_waitcnt vmcnt(16)
s_barrier
mF 84,52,60
rd 48,0,45056
mF 80,52,56
wl 5
lx 128,0
mF 88,56,56
s_add_u32 s37, s54, 262144
rd 52,0,46080
mF 92,56,60
mF 100,60,60
rd 56,0,47104
mF 96,60,56
wl 5
buffer_load_dwordx4 v[220:223], v0, s[4:7], s37 offen offset:0 sc1
mF 104,64,56
rd 60,0,48128
mF 108,64,60
mF 116,68,60
rd 64,0,49152
mF 112,68,56
wl 5
buffer_load_dwordx4 v[224:227], v0, s[4:7], s37 offen offset:1024 sc1
mF 120,72,56
rd 68,0,50176
mF 124,72,60
mF 132,76,60
rd 72,0,51200
mF 128,76,56
s_waitcnt vmcnt(18) lgkmcnt(5)
buffer_load_dwordx4 v[228:231], v0, s[4:7], s37 offen offset:2048 sc1
mF 80,48,64
s_waitcnt vmcnt(18)
rd 76,0,52224
mF 84,48,68
mF 92,52,68
rd 48,0,53248
mF 88,52,64
wl 5
buffer_load_dwordx4 v[232:235], v0, s[4:7], s37 offen offset:3072 sc1
mF 96,56,64
rd 52,0,54272
mF 100,56,68
mF 108,60,68
rd 56,0,55296
mF 104,60,64
wl 5
lx 132,1024
mF 112,64,64
rd 60,0,56320
mF 116,64,68
mF 124,68,68
rd 64,0,57344
mF 120,68,64
wl 5
lx 136,2048
mF 128,72,64
rd 68,0,58368
mF 132,72,68
s_waitcnt vmcnt(19)
s_barrier
mF 84,76,76
rd 72,1,22528
mF 80,76,72
wl 5
lx 140,3072
mF 88,48,72
s_add_u32 s24, s24, 4096
rd 76,1,23552
mF 92,48,76
mF 100,52,76
rd 48,1,24576
mF 96,52,72
wl 5
lx 144,0
mF 104,56,72
rd 52,1,25600
mF 108,56,76
mF 116,60,76
rd 56,1,26624
mF 112,60,72
wl 5
lx 148,1024
mF 120,64,72
rd 60,1,27648
mF 124,64,76
mF 132,68,76
rd 64,1,28672
mF 128,68,72
s_waitcnt vmcnt(21) lgkmcnt(5)
lx 152,2048
mF 80,72,80
s_waitcnt vmcnt(21)
s_add_u32 s23, s27, 114688
rd 68,1,29696
mF 84,72,84
mF 92,76,84
s_add_u32 m0, s22, 116736
rd 72,1,30720
mF 88,76,80
wl 5
lw 0
mF 96,48,80
rd 76,1,31744
mF 100,48,84
mF 108,52,84
rd 48,1,32768
mF 104,52,80
wl 5
lw 1024
mF 112,56,80
rd 52,1,33792
mF 116,56,84
mF 124,60,84
rd 56,1,34816
mF 120,60,80
wl 5
lw 2048
mF 128,64,80
rd 60,1,35840
mF 132,64,84
s_waitcnt vmcnt(22)
s_barrier
mF 84,68,92
rd 64,0,2048
mF 80,68,88
wl 5
s_mov_b32 exec_hi, 0
lw 3072
s_mov_b32 exec_hi, -1
mF 88,72,88
rd 68,0,3072
mF 92,72,92
mF 100,76,92
rd 72,0,4096
mF 96,76,88
wl 5
lx 156,3072
mF 104,48,88
s_add_u32 s24, s52, 106496
rd 76,0,5120
mF 108,48,92
main_cp21:
s_mov_b32 s96, main_cp21-main_cp20
v_lshl_add_u64 v[2:3], v[2:3], 0, s[96:97]
global_load_dword v254, v[2:3], off
mF 116,52,92
rd 48,0,6144
mF 112,52,88
wl 5
lx 160,0
mF 120,56,88
rd 52,0,7168
mF 124,56,92
mF 132,60,92
rd 56,0,8192
mF 128,60,88
s_waitcnt vmcnt(25) lgkmcnt(5)
lx 164,1024
mF 80,64,96
s_waitcnt vmcnt(25)
s_add_u32 s23, s23, 14336
rd 60,0,9216
mF 84,64,100
mF 92,68,100
s_add_u32 m0, s22, 59392
rd 64,0,10240
mF 88,68,96
wl 5
lw 0
mF 96,72,96
rd 68,0,11264
mF 100,72,100
mF 108,76,100
rd 72,0,12288
mF 104,76,96
wl 5
lw 1024
mF 112,48,96
rd 76,0,13312
mF 116,48,100
mF 124,52,100
rd 48,0,14336
mF 120,52,96
wl 5
lw 2048
mF 128,56,96
rd 52,0,15360
mF 132,56,100
s_waitcnt vmcnt(26)
s_barrier
mF 84,60,108
rd 56,1,36864
mF 80,60,104
wl 5
s_mov_b32 exec_hi, 0
lw 3072
s_mov_b32 exec_hi, -1
mF 88,64,104
rd 60,1,37888
mF 92,64,108
mF 100,68,108
rd 64,1,38912
mF 96,68,104
wl 5
lx 168,2048
mF 104,72,104
rd 68,1,39936
mF 108,72,108
mF 116,76,108
rd 72,1,40960
mF 112,76,104
wl 5
lx 172,3072
mF 120,48,104
s_add_u32 s24, s24, 4096
rd 76,1,41984
mF 124,48,108
mF 132,52,108
rd 48,1,43008
mF 128,52,104
s_waitcnt vmcnt(28) lgkmcnt(5)
lx 176,0
mF 80,56,112
s_waitcnt vmcnt(28)
s_add_u32 s23, s27, 143360
rd 52,1,44032
mF 84,56,116
mF 92,60,116
s_add_u32 m0, s22, 73728
rd 56,1,45056
mF 88,60,112
wl 5
lw 0
mF 96,64,112
rd 60,1,46080
mF 100,64,116
mF 108,68,116
rd 64,1,47104
mF 104,68,112
wl 5
lw 1024
mF 112,72,112
rd 68,1,48128
mF 116,72,116
mF 124,76,116
rd 72,1,49152
mF 120,76,112
wl 5
lw 2048
mF 128,48,112
rd 76,1,50176
mF 132,48,116
s_waitcnt vmcnt(14)
s_barrier
mF 84,52,124
rd 48,1,51200
mF 80,52,120
wl 5
s_mov_b32 exec_hi, 0
lw 3072
s_mov_b32 exec_hi, -1
mF 88,56,120
rd 52,1,52224
mF 92,56,124
mF 100,60,124
rd 56,1,53248
mF 96,60,120
wl 5
lx 180,1024
mF 104,64,120
rd 60,1,54272
mF 108,64,124
mF 116,68,124
rd 64,1,55296
mF 112,68,120
wl 5
lx 184,2048
mF 120,72,120
rd 68,1,56320
mF 124,72,124
mF 132,76,124
rd 72,1,57344
mF 128,76,120
wl 5
lx 188,3072
mF 80,48,128
s_add_u32 s23, s23, 14336
rd 76,1,58368
mF 84,48,132
mF 92,52,132
s_add_u32 m0, s22, 131072
rd 48,1,59392
mF 88,52,128
wl 5
lw 0
mF 96,56,128
rd 52,1,60416
mF 100,56,132
mF 108,60,132
rd 56,1,61440
mF 104,60,128
wl 5
lw 1024
mF 112,64,128
rd 60,1,62464
mF 116,64,132
mF 124,68,132
rd 64,1,63488
mF 120,68,128
wl 5
lw 2048
mF 128,72,128
rd 68,1,64512
mF 132,72,132
s_waitcnt vmcnt(13)
s_barrier
mF 84,76,140
rd 72,0,59392
mF 80,76,136
wl 5
s_mov_b32 exec_hi, 0
lw 3072
s_mov_b32 exec_hi, -1
mF 88,48,136
s_add_u32 s24, s52, 114688
rd 76,0,60416
mF 92,48,140
mF 100,52,140
rd 48,0,61440
mF 96,52,136
wl 5
lx 192,0
mF 104,56,136
rd 52,0,62464
mF 108,56,140
mF 116,60,140
rd 56,0,63488
mF 112,60,136
wl 5
lx 196,1024
mF 120,64,136
rd 60,0,64512
mF 124,64,140
mF 132,68,140
rd 64,1,0
v_add_f32 v220, v220, v224
mF 128,68,136
wl 5
lx 200,2048
mF 80,72,144
s_add_u32 s23, s27, 172032
rd 68,1,1024
v_add_f32 v221, v221, v225
mF 84,72,148
v_add_f32 v222, v222, v226
v_add_f32 v223, v223, v227
mF 92,76,148
s_add_u32 m0, s22, 145408
rd 72,1,2048
v_add_f32 v228, v228, v232
mF 88,76,144
wl 5
lw 0
mF 96,48,144
rd 76,1,3072
v_add_f32 v229, v229, v233
mF 100,48,148
v_add_f32 v230, v230, v234
v_add_f32 v231, v231, v235
mF 108,52,148
rd 48,1,4096
v_add_f32 v220, v220, v228
mF 104,52,144
wl 5
lw 1024
mF 112,56,144
rd 52,1,5120
v_add_f32 v221, v221, v229
mF 116,56,148
v_add_f32 v222, v222, v230
v_add_f32 v223, v223, v231
mF 124,60,148
rd 56,1,6144
v_permlane32_swap_b32 v220, v222
mF 120,60,144
wl 5
lw 2048
mF 128,64,144
rd 60,1,7168
v_permlane32_swap_b32 v221, v223
mF 132,64,148
s_waitcnt vmcnt(13)
s_barrier
v_add_f32 v220, v220, v222
mF 84,68,156
rd 64,1,8192
v_add_f32 v221, v221, v223
mF 80,68,152
wl 5
s_mov_b32 exec_hi, 0
lw 3072
s_mov_b32 exec_hi, -1
mF 88,72,152
rd 68,1,9216
v_permlane16_swap_b32 v220, v221
mF 92,72,156
v_add_f32 v220, v220, v221
mF 100,76,156
rd 72,1,10240
mF 96,76,152
wl 5
lx 204,3072
mF 104,48,152
s_add_u32 s24, s24, 4096
rd 76,1,11264
mF 108,48,156
ds_write_b32 v13, v220
mF 116,52,156
rd 48,1,12288
mF 112,52,152
wl 6
lx 208,0
mF 120,56,152
rd 52,1,13312
mF 124,56,156
ds_read2_b32 v[224:225], v14 offset0:0 offset1:16
mF 132,60,156
rd 56,1,14336
mF 128,60,152
wl 7
lx 212,1024
mF 80,64,160
s_add_u32 s23, s23, 14336
rd 60,1,15360
mF 84,64,164
ds_read2_b32 v[226:227], v14 offset0:32 offset1:48
mF 92,68,164
s_add_u32 m0, s22, 16384
rd 64,1,16384
mF 88,68,160
wl 8
lw 0
mF 96,72,160
rd 68,1,17408
mF 100,72,164
mF 108,76,164
rd 72,1,18432
mF 104,76,160
wl 7
lw 1024
mF 112,48,160
rd 76,1,19456
mF 116,48,164
wl 4
v_mul_f32 v216, 0xba800000, v224
v_mul_f32 v218, 0xba800000, v226
mF 124,52,164
rd 48,1,20480
v_mul_f32 v225, 0x3a800000, v225
mF 120,52,160
lw 2048
mF 128,56,160
rd 52,1,21504
v_mul_f32 v227, 0x3a800000, v227
mF 132,56,164
s_waitcnt vmcnt(13)
s_barrier
v_fma_f32 v225, -v216, v216, v225
mF 84,60,172
rd 56,29,0
v_fma_f32 v227, -v218, v218, v227
mF 80,60,168
wl 5
s_mov_b32 exec_hi, 0
lw 3072
s_mov_b32 exec_hi, -1
mF 88,64,168
rd 60,29,1024
v_max_f32 v225, 0, v225
mF 92,64,172
v_max_f32 v227, 0, v227
v_add_f32 v225, s44, v225
mF 100,68,172
rd 64,29,2048
v_add_f32 v227, s44, v227
mF 96,68,168
wl 5
lx 216,2048
mF 104,72,168
rd 68,29,3072
mF 108,72,172
v_rsq_f32 v217, v225
mF 116,76,172
rd 72,29,4096
mF 112,76,168
wl 5
lx 220,3072
mF 120,48,168
s_add_u32 s24, s52, 122880
rd 76,29,5120
mF 124,48,172
v_rsq_f32 v219, v227
mF 132,52,172
rd 48,29,6144
mF 128,52,168
wl 5
lx 224,0
mF 80,56,176
s_add_u32 s23, s27, 200704
rd 52,29,7168
mF 84,56,180
ds_write2_b32 v14, v216, v217 offset0:64 offset1:80
mF 92,60,180
s_add_u32 m0, s22, 30720
rd 56,29,8192
mF 88,60,176
wl 6
lw 0
mF 96,64,176
rd 60,29,9216
mF 100,64,180
ds_write2_b32 v14, v218, v219 offset0:96 offset1:112
mF 108,68,180
rd 64,29,10240
mF 104,68,176
wl 7
lw 1024
mF 112,72,176
rd 68,29,11264
mF 116,72,180
rd 200,15,256
mF 124,76,180
rd 72,29,12288
mF 120,76,176
wl 8
lw 2048
mF 128,48,176
rd 76,29,13312
mF 132,48,180
s_waitcnt vmcnt(13)
s_barrier
mF 84,52,188
rd 48,29,14336
mF 80,52,184
wl 7
s_mov_b32 exec_hi, 0
lw 3072
s_mov_b32 exec_hi, -1
mF 88,56,184
rd 52,29,15360
mF 92,56,188
rd 204,15,320
mF 100,60,188
rd 56,29,16384
mF 96,60,184
wl 7
lx 228,1024
mF 104,64,184
rd 60,29,17408
mF 108,64,188
rd 208,15,384
mF 116,68,188
rd 64,29,18432
mF 112,68,184
wl 7
lx 232,2048
mF 120,72,184
rd 68,29,19456
mF 124,72,188
rd 212,15,448
mF 132,76,188
rd 72,29,20480
mF 128,76,184
wl 8
lx 236,3072
mF 80,48,192
s_add_u32 s23, s23, 14336
rd 76,29,21504
mF 84,48,196
mF 92,52,196
s_add_u32 m0, s22, 45056
rd 48,29,22528
mF 88,52,192
wl 7
lw 0
mF 96,56,192
rd 52,29,23552
mF 100,56,196
ds_read_b32 v244, v11 offset:768
mF 108,60,196
rd 56,29,24576
mF 104,60,192
wl 7
lw 1024
mF 112,64,192
rd 60,29,25600
mF 116,64,196
ds_read_b32 v245, v11 offset:832
mF 124,68,196
rd 64,29,26624
mF 120,68,192
wl 7
lw 2048
mF 128,72,192
rd 68,29,27648
mF 132,72,196
s_waitcnt vmcnt(13)
s_barrier
mF 84,76,204
rd 72,0,16384
mF 80,76,200
wl 7
s_mov_b32 exec_hi, 0
lw 3072
s_mov_b32 exec_hi, -1
mF 88,48,200
s_add_u32 s24, s24, 4096
rd 76,0,17408
mF 92,48,204
ds_read_b32 v246, v11 offset:896
mF 100,52,204
rd 48,0,18432
mF 96,52,200
wl 7
lx 240,0
mF 104,56,200
rd 52,0,19456
mF 108,56,204
ds_read_b32 v247, v11 offset:960
mF 116,60,204
rd 56,0,20480
mF 112,60,200
wl 7
lx 244,1024
mF 120,64,200
rd 60,0,21504
mF 124,64,204
ds_read_b32 v248, v11 offset:1024
mF 132,68,204
rd 64,0,22528
mF 128,68,200
wl 8
lx 248,2048
mF 80,72,208
s_add_u32 s23, s27, 229376
rd 68,0,23552
mF 84,72,212
ds_read_b32 v249, v11 offset:1088
mF 92,76,212
s_add_u32 m0, s22, 88064
rd 72,0,24576
mF 88,76,208
wl 8
lw 0
mF 96,48,208
rd 76,0,25600
mF 100,48,212
ds_read_b32 v250, v11 offset:1152
mF 108,52,212
rd 48,0,26624
mF 104,52,208
wl 8
lw 1024
mF 112,56,208
rd 52,0,27648
mF 116,56,212
mF 124,60,212
rd 56,0,28672
mF 120,60,208
wl 7
lw 2048
mF 128,64,208
rd 60,0,29696
mF 132,64,212
s_waitcnt vmcnt(13)
s_barrier
mF 84,68,220
rd 64,0,30720
mF 80,68,216
wl 6
s_mov_b32 exec_hi, 0
lw 3072
s_mov_b32 exec_hi, -1
mF 88,72,216
rd 68,0,31744
mF 92,72,220
mF 100,76,220
rd 72,0,32768
mF 96,76,216
wl 5
lx 252,3072
mF 104,48,216
rd 76,0,33792
mF 108,48,220
mF 116,52,220
rd 48,0,34816
mF 112,52,216
wl 5
mF 120,56,216
rd 52,0,35840
mF 124,56,220
mF 132,60,220
rd 56,0,36864
mF 128,60,216
wl 5
mF 80,64,224
s_waitcnt vmcnt(14)
s_add_u32 s23, s23, 14336
rd 60,0,37888
mF 84,64,228
mF 92,68,228
s_add_u32 m0, s22, 2048
rd 64,0,38912
mF 88,68,224
wl 5
lw 0
mF 96,72,224
rd 68,0,39936
mF 100,72,228
mF 108,76,228
rd 72,0,40960
mF 104,76,224
wl 5
lw 1024
mF 112,48,224
rd 76,0,41984
mF 116,48,228
mF 124,52,228
rd 48,0,43008
mF 120,52,224
wl 5
lw 2048
mF 128,56,224
rd 52,0,44032
mF 132,56,228
s_waitcnt vmcnt(11)
s_barrier
mF 84,60,236
rd 56,0,45056
mF 80,60,232
wl 5
s_mov_b32 exec_hi, 0
lw 3072
s_mov_b32 exec_hi, -1
mF 88,64,232
rd 60,0,46080
mF 92,64,236
mF 100,68,236
rd 64,0,47104
mF 96,68,232
wl 5
mF 104,72,232
rd 68,0,48128
mF 108,72,236
mF 116,76,236
rd 72,0,49152
mF 112,76,232
wl 5
mF 120,48,232
rd 76,0,50176
mF 124,48,236
main_cp22:
s_mov_b32 s96, main_cp22-main_cp21
v_lshl_add_u64 v[2:3], v[2:3], 0, s[96:97]
global_load_dword v254, v[2:3], off
mF 132,52,236
rd 48,0,51200
mF 128,52,232
s_waitcnt vmcnt(12) lgkmcnt(5)
mF 80,56,240
s_waitcnt vmcnt(11)
s_add_u32 s23, s27, 258048
rd 52,0,52224
mF 84,56,244
mF 92,60,244
s_add_u32 m0, s22, 102400
rd 56,0,53248
mF 88,60,240
wl 5
lw 0
mF 96,64,240
rd 60,0,54272
mF 100,64,244
mF 108,68,244
rd 64,0,55296
mF 104,68,240
wl 5
lw 1024
mF 112,72,240
rd 68,0,56320
mF 116,72,244
mF 124,76,244
rd 72,0,57344
mF 120,76,240
wl 5
lw 2048
mF 128,48,240
rd 76,0,58368
mF 132,48,244
s_waitcnt vmcnt(8)
s_barrier
mF 84,52,252
rd 48,1,22528
mF 80,52,248
wl 5
s_mov_b32 exec_hi, 0
lw 3072
s_mov_b32 exec_hi, -1
mF 88,56,248
rd 52,1,23552
mF 92,56,252
mF 100,60,252
rd 56,1,24576
mF 96,60,248
wl 5
mF 104,64,248
rd 60,1,25600
mF 108,64,252
mF 116,68,252
rd 64,1,26624
mF 112,68,248
wl 5
mF 120,72,248
rd 68,1,27648
mF 124,72,252
mF 132,76,252
rd 72,1,28672
mF 128,76,248
v_pk_fma_f32 v[80:81], v[200:201], v[244:245], v[80:81] op_sel_hi:[1,0,1]
v_pk_fma_f32 v[82:83], v[202:203], v[244:245], v[82:83] op_sel_hi:[1,0,1]
v_pk_fma_f32 v[84:85], v[208:209], v[244:245], v[84:85] op_sel_hi:[1,0,1]
v_pk_fma_f32 v[86:87], v[210:211], v[244:245], v[86:87] op_sel_hi:[1,0,1]
v_pk_mul_f32 v[80:81], v[80:81], v[204:205]
v_pk_mul_f32 v[82:83], v[82:83], v[206:207]
v_pk_mul_f32 v[84:85], v[84:85], v[212:213]
v_pk_mul_f32 v[86:87], v[86:87], v[214:215]
v_pk_mul_f32 v[220:221], v[80:81], v[80:81]
v_pk_mul_f32 v[222:223], v[82:83], v[82:83]
v_pk_mul_f32 v[224:225], v[84:85], v[84:85]
v_pk_mul_f32 v[226:227], v[86:87], v[86:87]
v_pk_fma_f32 v[220:221], v[220:221], s[42:43], v[30:31] op_sel:[0,1,0] op_sel_hi:[1,1,0]
v_pk_fma_f32 v[222:223], v[222:223], s[42:43], v[30:31] op_sel:[0,1,0] op_sel_hi:[1,1,0]
v_pk_fma_f32 v[224:225], v[224:225], s[42:43], v[30:31] op_sel:[0,1,0] op_sel_hi:[1,1,0]
v_pk_fma_f32 v[226:227], v[226:227], s[42:43], v[30:31] op_sel:[0,1,0] op_sel_hi:[1,1,0]
v_pk_mul_f32 v[220:221], v[220:221], v[80:81]
v_pk_mul_f32 v[222:223], v[222:223], v[82:83]
v_pk_mul_f32 v[224:225], v[224:225], v[84:85]
v_pk_mul_f32 v[226:227], v[226:227], v[86:87]
s_add_u32 s23, s23, 14336
s_add_u32 m0, s22, 116736
s_nop 0
lw 0
v_exp_f32 v220, v220
v_exp_f32 v221, v221
v_exp_f32 v222, v222
v_exp_f32 v223, v223
v_exp_f32 v224, v224
v_exp_f32 v225, v225
v_exp_f32 v226, v226
v_exp_f32 v227, v227
v_pk_add_f32 v[220:221], v[220:221], 1.0 op_sel_hi:[1,0]
v_pk_add_f32 v[222:223], v[222:223], 1.0 op_sel_hi:[1,0]
v_pk_add_f32 v[224:225], v[224:225], 1.0 op_sel_hi:[1,0]
v_pk_add_f32 v[226:227], v[226:227], 1.0 op_sel_hi:[1,0]
lw 1024
v_rcp_f32 v220, v220
v_rcp_f32 v221, v221
v_rcp_f32 v222, v222
v_rcp_f32 v223, v223
v_rcp_f32 v224, v224
v_rcp_f32 v225, v225
v_rcp_f32 v226, v226
v_rcp_f32 v227, v227
v_pk_mul_f32 v[80:81], v[80:81], v[220:221]
v_pk_mul_f32 v[82:83], v[82:83], v[222:223]
v_pk_mul_f32 v[84:85], v[84:85], v[224:225]
v_pk_mul_f32 v[86:87], v[86:87], v[226:227]
lw 2048
v_pk_mul_f32 v[228:229], v[80:81], 1.0 op_sel_hi:[1,0]
v_pk_mul_f32 v[232:233], v[80:81], v[80:81]
v_pk_mul_f32 v[230:231], v[82:83], 1.0 op_sel_hi:[1,0]
v_pk_mul_f32 v[234:235], v[82:83], v[82:83]
v_pk_mul_f32 v[236:237], v[84:85], 1.0 op_sel_hi:[1,0]
v_pk_mul_f32 v[240:241], v[84:85], v[84:85]
v_pk_mul_f32 v[238:239], v[86:87], 1.0 op_sel_hi:[1,0]
v_pk_mul_f32 v[242:243], v[86:87], v[86:87]
v_pk_fma_f32 v[88:89], v[200:201], v[244:245], v[88:89] op_sel:[0,1,0]
v_pk_fma_f32 v[90:91], v[202:203], v[244:245], v[90:91] op_sel:[0,1,0]
v_pk_fma_f32 v[92:93], v[208:209], v[244:245], v[92:93] op_sel:[0,1,0]
v_pk_fma_f32 v[94:95], v[210:211], v[244:245], v[94:95] op_sel:[0,1,0]
v_pk_mul_f32 v[88:89], v[88:89], v[204:205]
v_pk_mul_f32 v[90:91], v[90:91], v[206:207]
v_pk_mul_f32 v[92:93], v[92:93], v[212:213]
v_pk_mul_f32 v[94:95], v[94:95], v[214:215]
v_pk_mul_f32 v[220:221], v[88:89], v[88:89]
v_pk_mul_f32 v[222:223], v[90:91], v[90:91]
v_pk_mul_f32 v[224:225], v[92:93], v[92:93]
v_pk_mul_f32 v[226:227], v[94:95], v[94:95]
s_mov_b32 exec_hi, 0
lw 3072
s_mov_b32 exec_hi, -1
v_pk_fma_f32 v[220:221], v[220:221], s[42:43], v[30:31] op_sel:[0,1,0] op_sel_hi:[1,1,0]
v_pk_fma_f32 v[222:223], v[222:223], s[42:43], v[30:31] op_sel:[0,1,0] op_sel_hi:[1,1,0]
v_pk_fma_f32 v[224:225], v[224:225], s[42:43], v[30:31] op_sel:[0,1,0] op_sel_hi:[1,1,0]
v_pk_fma_f32 v[226:227], v[226:227], s[42:43], v[30:31] op_sel:[0,1,0] op_sel_hi:[1,1,0]
v_pk_mul_f32 v[220:221], v[220:221], v[88:89]
v_pk_mul_f32 v[222:223], v[222:223], v[90:91]
v_pk_mul_f32 v[224:225], v[224:225], v[92:93]
v_pk_mul_f32 v[226:227], v[226:227], v[94:95]
v_exp_f32 v220, v220
v_exp_f32 v221, v221
v_exp_f32 v222, v222
v_exp_f32 v223, v223
v_exp_f32 v224, v224
v_exp_f32 v225, v225
s_add_u32 s23, s27, 286720
s_add_u32 m0, s22, 59392
s_nop 0
lw 0
v_exp_f32 v226, v226
v_exp_f32 v227, v227
v_pk_add_f32 v[220:221], v[220:221], 1.0 op_sel_hi:[1,0]
v_pk_add_f32 v[222:223], v[222:223], 1.0 op_sel_hi:[1,0]
v_pk_add_f32 v[224:225], v[224:225], 1.0 op_sel_hi:[1,0]
v_pk_add_f32 v[226:227], v[226:227], 1.0 op_sel_hi:[1,0]
v_rcp_f32 v220, v220
v_rcp_f32 v221, v221
v_rcp_f32 v222, v222
v_rcp_f32 v223, v223
v_rcp_f32 v224, v224
v_rcp_f32 v225, v225
lw 1024
v_rcp_f32 v226, v226
v_rcp_f32 v227, v227
v_pk_mul_f32 v[88:89], v[88:89], v[220:221]
v_pk_mul_f32 v[90:91], v[90:91], v[222:223]
v_pk_mul_f32 v[92:93], v[92:93], v[224:225]
v_pk_mul_f32 v[94:95], v[94:95], v[226:227]
v_pk_add_f32 v[228:229], v[228:229], v[88:89]
v_pk_fma_f32 v[232:233], v[88:89], v[88:89], v[232:233]
v_pk_add_f32 v[230:231], v[230:231], v[90:91]
v_pk_fma_f32 v[234:235], v[90:91], v[90:91], v[234:235]
v_pk_add_f32 v[236:237], v[236:237], v[92:93]
v_pk_fma_f32 v[240:241], v[92:93], v[92:93], v[240:241]
v_pk_add_f32 v[238:239], v[238:239], v[94:95]
v_pk_fma_f32 v[242:243], v[94:95], v[94:95], v[242:243]
v_pk_fma_f32 v[96:97], v[200:201], v[246:247], v[96:97] op_sel_hi:[1,0,1]
v_pk_fma_f32 v[98:99], v[202:203], v[246:247], v[98:99] op_sel_hi:[1,0,1]
v_pk_fma_f32 v[100:101], v[208:209], v[246:247], v[100:101] op_sel_hi:[1,0,1]
v_pk_fma_f32 v[102:103], v[210:211], v[246:247], v[102:103] op_sel_hi:[1,0,1]
lw 2048
v_pk_mul_f32 v[96:97], v[96:97], v[204:205]
v_pk_mul_f32 v[98:99], v[98:99], v[206:207]
v_pk_mul_f32 v[100:101], v[100:101], v[212:213]
v_pk_mul_f32 v[102:103], v[102:103], v[214:215]
v_pk_mul_f32 v[220:221], v[96:97], v[96:97]
v_pk_mul_f32 v[222:223], v[98:99], v[98:99]
v_pk_mul_f32 v[224:225], v[100:101], v[100:101]
v_pk_mul_f32 v[226:227], v[102:103], v[102:103]
v_pk_fma_f32 v[220:221], v[220:221], s[42:43], v[30:31] op_sel:[0,1,0] op_sel_hi:[1,1,0]
v_pk_fma_f32 v[222:223], v[222:223], s[42:43], v[30:31] op_sel:[0,1,0] op_sel_hi:[1,1,0]
v_pk_fma_f32 v[224:225], v[224:225], s[42:43], v[30:31] op_sel:[0,1,0] op_sel_hi:[1,1,0]
v_pk_fma_f32 v[226:227], v[226:227], s[42:43], v[30:31] op_sel:[0,1,0] op_sel_hi:[1,1,0]
v_pk_mul_f32 v[220:221], v[220:221], v[96:97]
v_pk_mul_f32 v[222:223], v[222:223], v[98:99]
v_pk_mul_f32 v[224:225], v[224:225], v[100:101]
v_pk_mul_f32 v[226:227], v[226:227], v[102:103]
v_exp_f32 v220, v220
v_exp_f32 v221, v221
s_mov_b32 exec_hi, 0
lw 3072
s_mov_b32 exec_hi, -1
v_exp_f32 v222, v222
v_exp_f32 v223, v223
v_exp_f32 v224, v224
v_exp_f32 v225, v225
v_exp_f32 v226, v226
v_exp_f32 v227, v227
v_pk_add_f32 v[220:221], v[220:221], 1.0 op_sel_hi:[1,0]
v_pk_add_f32 v[222:223], v[222:223], 1.0 op_sel_hi:[1,0]
v_pk_add_f32 v[224:225], v[224:225], 1.0 op_sel_hi:[1,0]
v_pk_add_f32 v[226:227], v[226:227], 1.0 op_sel_hi:[1,0]
v_rcp_f32 v220, v220
v_rcp_f32 v221, v221
s_add_u32 s23, s23, 14336
s_add_u32 m0, s22, 73728
s_nop 0
lw 0
v_rcp_f32 v222, v222
v_rcp_f32 v223, v223
v_rcp_f32 v224, v224
v_rcp_f32 v225, v225
v_rcp_f32 v226, v226
v_rcp_f32 v227, v227
v_pk_mul_f32 v[96:97], v[96:97], v[220:221]
v_pk_mul_f32 v[98:99], v[98:99], v[222:223]
v_pk_mul_f32 v[100:101], v[100:101], v[224:225]
v_pk_mul_f32 v[102:103], v[102:103], v[226:227]
v_pk_add_f32 v[228:229], v[228:229], v[96:97]
v_pk_fma_f32 v[232:233], v[96:97], v[96:97], v[232:233]
v_pk_add_f32 v[230:231], v[230:231], v[98:99]
v_pk_fma_f32 v[234:235], v[98:99], v[98:99], v[234:235]
lw 1024
v_pk_add_f32 v[236:237], v[236:237], v[100:101]
v_pk_fma_f32 v[240:241], v[100:101], v[100:101], v[240:241]
v_pk_add_f32 v[238:239], v[238:239], v[102:103]
v_pk_fma_f32 v[242:243], v[102:103], v[102:103], v[242:243]
v_pk_fma_f32 v[104:105], v[200:201], v[246:247], v[104:105] op_sel:[0,1,0]
v_pk_fma_f32 v[106:107], v[202:203], v[246:247], v[106:107] op_sel:[0,1,0]
v_pk_fma_f32 v[108:109], v[208:209], v[246:247], v[108:109] op_sel:[0,1,0]
v_pk_fma_f32 v[110:111], v[210:211], v[246:247], v[110:111] op_sel:[0,1,0]
v_pk_mul_f32 v[104:105], v[104:105], v[204:205]
v_pk_mul_f32 v[106:107], v[106:107], v[206:207]
v_pk_mul_f32 v[108:109], v[108:109], v[212:213]
v_pk_mul_f32 v[110:111], v[110:111], v[214:215]
v_pk_mul_f32 v[220:221], v[104:105], v[104:105]
v_pk_mul_f32 v[222:223], v[106:107], v[106:107]
v_pk_mul_f32 v[224:225], v[108:109], v[108:109]
v_pk_mul_f32 v[226:227], v[110:111], v[110:111]
v_pk_fma_f32 v[220:221], v[220:221], s[42:43], v[30:31] op_sel:[0,1,0] op_sel_hi:[1,1,0]
v_pk_fma_f32 v[222:223], v[222:223], s[42:43], v[30:31] op_sel:[0,1,0] op_sel_hi:[1,1,0]
v_pk_fma_f32 v[224:225], v[224:225], s[42:43], v[30:31] op_sel:[0,1,0] op_sel_hi:[1,1,0]
v_pk_fma_f32 v[226:227], v[226:227], s[42:43], v[30:31] op_sel:[0,1,0] op_sel_hi:[1,1,0]
lw 2048
v_pk_mul_f32 v[220:221], v[220:221], v[104:105]
v_pk_mul_f32 v[222:223], v[222:223], v[106:107]
v_pk_mul_f32 v[224:225], v[224:225], v[108:109]
v_pk_mul_f32 v[226:227], v[226:227], v[110:111]
v_exp_f32 v220, v220
v_exp_f32 v221, v221
v_exp_f32 v222, v222
v_exp_f32 v223, v223
v_exp_f32 v224, v224
v_exp_f32 v225, v225
v_exp_f32 v226, v226
v_exp_f32 v227, v227
s_mov_b32 exec_hi, 0
lw 3072
s_mov_b32 exec_hi, -1
v_pk_add_f32 v[220:221], v[220:221], 1.0 op_sel_hi:[1,0]
v_pk_add_f32 v[222:223], v[222:223], 1.0 op_sel_hi:[1,0]
v_pk_add_f32 v[224:225], v[224:225], 1.0 op_sel_hi:[1,0]
v_pk_add_f32 v[226:227], v[226:227], 1.0 op_sel_hi:[1,0]
v_rcp_f32 v220, v220
v_rcp_f32 v221, v221
v_rcp_f32 v222, v222
v_rcp_f32 v223, v223
v_rcp_f32 v224, v224
v_rcp_f32 v225, v225
v_rcp_f32 v226, v226
v_rcp_f32 v227, v227
s_add_u32 s23, s27, 315392
s_add_u32 m0, s22, 131072
s_nop 0
lw 0
v_pk_mul_f32 v[104:105], v[104:105], v[220:221]
v_pk_mul_f32 v[106:107], v[106:107], v[222:223]
v_pk_mul_f32 v[108:109], v[108:109], v[224:225]
v_pk_mul_f32 v[110:111], v[110:111], v[226:227]
v_pk_add_f32 v[228:229], v[228:229], v[104:105]
v_pk_fma_f32 v[232:233], v[104:105], v[104:105], v[232:233]
v_pk_add_f32 v[230:231], v[230:231], v[106:107]
v_pk_fma_f32 v[234:235], v[106:107], v[106:107], v[234:235]
v_pk_add_f32 v[236:237], v[236:237], v[108:109]
v_pk_fma_f32 v[240:241], v[108:109], v[108:109], v[240:241]
v_pk_add_f32 v[238:239], v[238:239], v[110:111]
v_pk_fma_f32 v[242:243], v[110:111], v[110:111], v[242:243]
v_pk_fma_f32 v[112:113], v[200:201], v[248:249], v[112:113] op_sel_hi:[1,0,1]
v_pk_fma_f32 v[114:115], v[202:203], v[248:249], v[114:115] op_sel_hi:[1,0,1]
v_pk_fma_f32 v[116:117], v[208:209], v[248:249], v[116:117] op_sel_hi:[1,0,1]
v_pk_fma_f32 v[118:119], v[210:211], v[248:249], v[118:119] op_sel_hi:[1,0,1]
v_pk_mul_f32 v[112:113], v[112:113], v[204:205]
v_pk_mul_f32 v[114:115], v[114:115], v[206:207]
v_pk_mul_f32 v[116:117], v[116:117], v[212:213]
v_pk_mul_f32 v[118:119], v[118:119], v[214:215]
lw 1024
v_pk_mul_f32 v[220:221], v[112:113], v[112:113]
v_pk_mul_f32 v[222:223], v[114:115], v[114:115]
v_pk_mul_f32 v[224:225], v[116:117], v[116:117]
v_pk_mul_f32 v[226:227], v[118:119], v[118:119]
v_pk_fma_f32 v[220:221], v[220:221], s[42:43], v[30:31] op_sel:[0,1,0] op_sel_hi:[1,1,0]
v_pk_fma_f32 v[222:223], v[222:223], s[42:43], v[30:31] op_sel:[0,1,0] op_sel_hi:[1,1,0]
v_pk_fma_f32 v[224:225], v[224:225], s[42:43], v[30:31] op_sel:[0,1,0] op_sel_hi:[1,1,0]
v_pk_fma_f32 v[226:227], v[226:227], s[42:43], v[30:31] op_sel:[0,1,0] op_sel_hi:[1,1,0]
v_pk_mul_f32 v[220:221], v[220:221], v[112:113]
v_pk_mul_f32 v[222:223], v[222:223], v[114:115]
v_pk_mul_f32 v[224:225], v[224:225], v[116:117]
v_pk_mul_f32 v[226:227], v[226:227], v[118:119]
v_exp_f32 v220, v220
v_exp_f32 v221, v221
v_exp_f32 v222, v222
v_exp_f32 v223, v223
lw 2048
v_exp_f32 v224, v224
v_exp_f32 v225, v225
v_exp_f32 v226, v226
v_exp_f32 v227, v227
v_pk_add_f32 v[220:221], v[220:221], 1.0 op_sel_hi:[1,0]
v_pk_add_f32 v[222:223], v[222:223], 1.0 op_sel_hi:[1,0]
v_pk_add_f32 v[224:225], v[224:225], 1.0 op_sel_hi:[1,0]
v_pk_add_f32 v[226:227], v[226:227], 1.0 op_sel_hi:[1,0]
v_rcp_f32 v220, v220
v_rcp_f32 v221, v221
v_rcp_f32 v222, v222
v_rcp_f32 v223, v223
s_mov_b32 exec_hi, 0
lw 3072
s_mov_b32 exec_hi, -1
v_rcp_f32 v224, v224
v_rcp_f32 v225, v225
v_rcp_f32 v226, v226
v_rcp_f32 v227, v227
v_pk_mul_f32 v[112:113], v[112:113], v[220:221]
v_pk_mul_f32 v[114:115], v[114:115], v[222:223]
v_pk_mul_f32 v[116:117], v[116:117], v[224:225]
v_pk_mul_f32 v[118:119], v[118:119], v[226:227]
v_pk_add_f32 v[228:229], v[228:229], v[112:113]
v_pk_fma_f32 v[232:233], v[112:113], v[112:113], v[232:233]
v_pk_add_f32 v[230:231], v[230:231], v[114:115]
v_pk_fma_f32 v[234:235], v[114:115], v[114:115], v[234:235]
v_pk_add_f32 v[236:237], v[236:237], v[116:117]
v_pk_fma_f32 v[240:241], v[116:117], v[116:117], v[240:241]
v_pk_add_f32 v[238:239], v[238:239], v[118:119]
v_pk_fma_f32 v[242:243], v[118:119], v[118:119], v[242:243]
s_add_u32 s23, s23, 14336
s_add_u32 m0, s22, 145408
s_nop 0
lw 0
v_pk_fma_f32 v[120:121], v[200:201], v[248:249], v[120:121] op_sel:[0,1,0]
v_pk_fma_f32 v[122:123], v[202:203], v[248:249], v[122:123] op_sel:[0,1,0]
v_pk_fma_f32 v[124:125], v[208:209], v[248:249], v[124:125] op_sel:[0,1,0]
v_pk_fma_f32 v[126:127], v[210:211], v[248:249], v[126:127] op_sel:[0,1,0]
v_pk_mul_f32 v[120:121], v[120:121], v[204:205]
v_pk_mul_f32 v[122:123], v[122:123], v[206:207]
v_pk_mul_f32 v[124:125], v[124:125], v[212:213]
v_pk_mul_f32 v[126:127], v[126:127], v[214:215]
v_pk_mul_f32 v[220:221], v[120:121], v[120:121]
v_pk_mul_f32 v[222:223], v[122:123], v[122:123]
v_pk_mul_f32 v[224:225], v[124:125], v[124:125]
v_pk_mul_f32 v[226:227], v[126:127], v[126:127]
v_pk_fma_f32 v[220:221], v[220:221], s[42:43], v[30:31] op_sel:[0,1,0] op_sel_hi:[1,1,0]
v_pk_fma_f32 v[222:223], v[222:223], s[42:43], v[30:31] op_sel:[0,1,0] op_sel_hi:[1,1,0]
v_pk_fma_f32 v[224:225], v[224:225], s[42:43], v[30:31] op_sel:[0,1,0] op_sel_hi:[1,1,0]
v_pk_fma_f32 v[226:227], v[226:227], s[42:43], v[30:31] op_sel:[0,1,0] op_sel_hi:[1,1,0]
v_pk_mul_f32 v[220:221], v[220:221], v[120:121]
v_pk_mul_f32 v[222:223], v[222:223], v[122:123]
v_pk_mul_f32 v[224:225], v[224:225], v[124:125]
v_pk_mul_f32 v[226:227], v[226:227], v[126:127]
lw 1024
v_exp_f32 v220, v220
v_exp_f32 v221, v221
v_exp_f32 v222, v222
v_exp_f32 v223, v223
v_exp_f32 v224, v224
v_exp_f32 v225, v225
v_exp_f32 v226, v226
v_exp_f32 v227, v227
v_pk_add_f32 v[220:221], v[220:221], 1.0 op_sel_hi:[1,0]
v_pk_add_f32 v[222:223], v[222:223], 1.0 op_sel_hi:[1,0]
v_pk_add_f32 v[224:225], v[224:225], 1.0 op_sel_hi:[1,0]
v_pk_add_f32 v[226:227], v[226:227], 1.0 op_sel_hi:[1,0]
lw 2048
v_rcp_f32 v220, v220
v_rcp_f32 v221, v221
v_rcp_f32 v222, v222
v_rcp_f32 v223, v223
v_rcp_f32 v224, v224
v_rcp_f32 v225, v225
v_rcp_f32 v226, v226
v_rcp_f32 v227, v227
v_pk_mul_f32 v[120:121], v[120:121], v[220:221]
v_pk_mul_f32 v[122:123], v[122:123], v[222:223]
v_pk_mul_f32 v[124:125], v[124:125], v[224:225]
v_pk_mul_f32 v[126:127], v[126:127], v[226:227]
s_mov_b32 exec_hi, 0
lw 3072
s_mov_b32 exec_hi, -1
v_pk_add_f32 v[228:229], v[228:229], v[120:121]
v_pk_fma_f32 v[232:233], v[120:121], v[120:121], v[232:233]
v_pk_add_f32 v[230:231], v[230:231], v[122:123]
v_pk_fma_f32 v[234:235], v[122:123], v[122:123], v[234:235]
v_pk_add_f32 v[236:237], v[236:237], v[124:125]
v_pk_fma_f32 v[240:241], v[124:125], v[124:125], v[240:241]
v_pk_add_f32 v[238:239], v[238:239], v[126:127]
v_pk_fma_f32 v[242:243], v[126:127], v[126:127], v[242:243]
v_pk_fma_f32 v[128:129], v[200:201], v[250:251], v[128:129] op_sel_hi:[1,0,1]
v_pk_fma_f32 v[130:131], v[202:203], v[250:251], v[130:131] op_sel_hi:[1,0,1]
v_pk_fma_f32 v[132:133], v[208:209], v[250:251], v[132:133] op_sel_hi:[1,0,1]
v_pk_fma_f32 v[134:135], v[210:211], v[250:251], v[134:135] op_sel_hi:[1,0,1]
v_pk_mul_f32 v[128:129], v[128:129], v[204:205]
v_pk_mul_f32 v[130:131], v[130:131], v[206:207]
v_pk_mul_f32 v[132:133], v[132:133], v[212:213]
v_pk_mul_f32 v[134:135], v[134:135], v[214:215]
v_pk_mul_f32 v[220:221], v[128:129], v[128:129]
v_pk_mul_f32 v[222:223], v[130:131], v[130:131]
v_pk_mul_f32 v[224:225], v[132:133], v[132:133]
v_pk_mul_f32 v[226:227], v[134:135], v[134:135]
s_add_u32 s23, s27, 344064
s_add_u32 m0, s22, 16384
s_nop 0
lw 0
v_pk_fma_f32 v[220:221], v[220:221], s[42:43], v[30:31] op_sel:[0,1,0] op_sel_hi:[1,1,0]
v_pk_fma_f32 v[222:223], v[222:223], s[42:43], v[30:31] op_sel:[0,1,0] op_sel_hi:[1,1,0]
v_pk_fma_f32 v[224:225], v[224:225], s[42:43], v[30:31] op_sel:[0,1,0] op_sel_hi:[1,1,0]
v_pk_fma_f32 v[226:227], v[226:227], s[42:43], v[30:31] op_sel:[0,1,0] op_sel_hi:[1,1,0]
v_pk_mul_f32 v[220:221], v[220:221], v[128:129]
v_pk_mul_f32 v[222:223], v[222:223], v[130:131]
v_pk_mul_f32 v[224:225], v[224:225], v[132:133]
v_pk_mul_f32 v[226:227], v[226:227], v[134:135]
v_exp_f32 v220, v220
v_exp_f32 v221, v221
v_exp_f32 v222, v222
v_exp_f32 v223, v223
v_exp_f32 v224, v224
v_exp_f32 v225, v225
lw 1024
v_exp_f32 v226, v226
v_exp_f32 v227, v227
v_pk_add_f32 v[220:221], v[220:221], 1.0 op_sel_hi:[1,0]
v_pk_add_f32 v[222:223], v[222:223], 1.0 op_sel_hi:[1,0]
v_pk_add_f32 v[224:225], v[224:225], 1.0 op_sel_hi:[1,0]
v_pk_add_f32 v[226:227], v[226:227], 1.0 op_sel_hi:[1,0]
v_rcp_f32 v220, v220
v_rcp_f32 v221, v221
v_rcp_f32 v222, v222
v_rcp_f32 v223, v223
v_rcp_f32 v224, v224
v_rcp_f32 v225, v225
lw 2048
v_rcp_f32 v226, v226
v_rcp_f32 v227, v227
v_pk_mul_f32 v[128:129], v[128:129], v[220:221]
v_pk_mul_f32 v[130:131], v[130:131], v[222:223]
v_pk_mul_f32 v[132:133], v[132:133], v[224:225]
v_pk_mul_f32 v[134:135], v[134:135], v[226:227]
v_pk_add_f32 v[228:229], v[228:229], v[128:129]
v_pk_fma_f32 v[232:233], v[128:129], v[128:129], v[232:233]
v_pk_add_f32 v[230:231], v[230:231], v[130:131]
v_pk_fma_f32 v[234:235], v[130:131], v[130:131], v[234:235]
v_pk_add_f32 v[236:237], v[236:237], v[132:133]
v_pk_fma_f32 v[240:241], v[132:133], v[132:133], v[240:241]
v_pk_add_f32 v[238:239], v[238:239], v[134:135]
v_pk_fma_f32 v[242:243], v[134:135], v[134:135], v[242:243]
v_add_f32_dpp v228, v228, v228 row_ror:8 row_mask:0xf bank_mask:0x3
v_add_f32_dpp v229, v229, v229 row_ror:8 row_mask:0xf bank_mask:0x3
v_add_f32_dpp v230, v230, v230 row_ror:8 row_mask:0xf bank_mask:0x3
v_add_f32_dpp v231, v231, v231 row_ror:8 row_mask:0xf bank_mask:0x3
s_mov_b32 exec_hi, 0
lw 3072
s_mov_b32 exec_hi, -1
v_add_f32_dpp v232, v232, v232 row_ror:8 row_mask:0xf bank_mask:0x3
v_add_f32_dpp v233, v233, v233 row_ror:8 row_mask:0xf bank_mask:0x3
v_add_f32_dpp v234, v234, v234 row_ror:8 row_mask:0xf bank_mask:0x3
v_add_f32_dpp v235, v235, v235 row_ror:8 row_mask:0xf bank_mask:0x3
v_add_f32_dpp v228, v236, v236 row_ror:8 row_mask:0xf bank_mask:0xc
v_add_f32_dpp v229, v237, v237 row_ror:8 row_mask:0xf bank_mask:0xc
v_add_f32_dpp v230, v238, v238 row_ror:8 row_mask:0xf bank_mask:0xc
v_add_f32_dpp v231, v239, v239 row_ror:8 row_mask:0xf bank_mask:0xc
v_add_f32_dpp v232, v240, v240 row_ror:8 row_mask:0xf bank_mask:0xc
v_add_f32_dpp v233, v241, v241 row_ror:8 row_mask:0xf bank_mask:0xc
v_add_f32_dpp v234, v242, v242 row_ror:8 row_mask:0xf bank_mask:0xc
v_add_f32_dpp v235, v243, v243 row_ror:8 row_mask:0xf bank_mask:0xc
v_add_f32_dpp v236, v228, v228 row_half_mirror row_mask:0xf bank_mask:0x5
v_add_f32_dpp v237, v229, v229 row_half_mirror row_mask:0xf bank_mask:0x5
v_add_f32_dpp v238, v230, v230 row_half_mirror row_mask:0xf bank_mask:0x5
v_add_f32_dpp v239, v231, v231 row_half_mirror row_mask:0xf bank_mask:0x5
v_add_f32_dpp v236, v232, v232 row_half_mirror row_mask:0xf bank_mask:0xa
v_add_f32_dpp v237, v233, v233 row_half_mirror row_mask:0xf bank_mask:0xa
v_add_f32_dpp v238, v234, v234 row_half_mirror row_mask:0xf bank_mask:0xa
v_add_f32_dpp v239, v235, v235 row_half_mirror row_mask:0xf bank_mask:0xa
s_add_u32 s23, s23, 14336
s_add_u32 m0, s22, 30720
s_nop 0
lw 0
v_add_f32_dpp v236, v236, v236 quad_perm:[1,0,3,2] row_mask:0xf bank_mask:0xf
v_add_f32_dpp v237, v237, v237 quad_perm:[1,0,3,2] row_mask:0xf bank_mask:0xf
v_add_f32_dpp v238, v238, v238 quad_perm:[1,0,3,2] row_mask:0xf bank_mask:0xf
v_add_f32_dpp v239, v239, v239 quad_perm:[1,0,3,2] row_mask:0xf bank_mask:0xf
v_add_f32_dpp v236, v236, v236 quad_perm:[2,3,0,1] row_mask:0xf bank_mask:0xf
v_add_f32_dpp v237, v237, v237 quad_perm:[2,3,0,1] row_mask:0xf bank_mask:0xf
v_add_f32_dpp v238, v238, v238 quad_perm:[2,3,0,1] row_mask:0xf bank_mask:0xf
v_add_f32_dpp v239, v239, v239 quad_perm:[2,3,0,1] row_mask:0xf bank_mask:0xf
s_lshl_b32 s37, s17, 8
s_add_u32 s37, s37, s54
s_add_u32 s37, s37, 524288
buffer_store_dwordx4 v[236:239], v28, s[4:7], s37 offen sc1
lw 1024
lw 2048
s_mov_b32 exec_hi, 0
lw 3072
s_mov_b32 exec_hi, -1
wl 5
v_mfma_f32_16x16x32_bf16 v[136:139], v[48:51], a[0:3], 0
rd 76,1,29696
v_mfma_f32_16x16x32_bf16 v[140:143], v[48:51], a[4:7], 0
v_mfma_f32_16x16x32_bf16 v[148:151], v[52:55], a[4:7], 0
rd 48,1,30720
v_mfma_f32_16x16x32_bf16 v[144:147], v[52:55], a[0:3], 0
wl 5
v_mfma_f32_16x16x32_bf16 v[152:155], v[56:59], a[0:3], 0
rd 52,1,31744
v_mfma_f32_16x16x32_bf16 v[156:159], v[56:59], a[4:7], 0
v_mfma_f32_16x16x32_bf16 v[164:167], v[60:63], a[4:7], 0
rd 56,1,32768
v_mfma_f32_16x16x32_bf16 v[160:163], v[60:63], a[0:3], 0
wl 5
v_mfma_f32_16x16x32_bf16 v[168:171], v[64:67], a[0:3], 0
rd 60,1,33792
v_mfma_f32_16x16x32_bf16 v[172:175], v[64:67], a[4:7], 0
v_mfma_f32_16x16x32_bf16 v[180:183], v[68:71], a[4:7], 0
rd 64,1,34816
v_mfma_f32_16x16x32_bf16 v[176:179], v[68:71], a[0:3], 0
wl 5
v_mfma_f32_16x16x32_bf16 v[184:187], v[72:75], a[0:3], 0
rd 68,1,35840
v_mfma_f32_16x16x32_bf16 v[188:191], v[72:75], a[4:7], 0
s_waitcnt vmcnt(34)
s_barrier
mT 140,76,12
s_add_u32 s23, s27, 372736
rd 72,0,2048
mT 136,76,8
main_cp23:
s_mov_b32 s96, main_cp23-main_cp22
v_lshl_add_u64 v[2:3], v[2:3], 0, s[96:97]
global_load_dword v254, v[2:3], off
wl 5
mT 144,48,8
s_add_u32 m0, s22, 45056
rd 76,0,3072
mT 148,48,12
lw 0
mT 156,52,12
rd 48,0,4096
mT 152,52,8
wl 5
mT 160,56,8
rd 52,0,5120
mT 164,56,12
lw 1024
mT 172,60,12
rd 56,0,6144
mT 168,60,8
wl 5
mT 176,64,8
rd 60,0,7168
mT 180,64,12
lw 2048
mT 188,68,12
rd 64,0,8192
mT 184,68,8
wl 5
mT 136,72,16
rd 68,0,9216
mT 140,72,20
s_mov_b32 exec_hi, 0
lw 3072
s_mov_b32 exec_hi, -1
mT 148,76,20
s_max_i32 s24, s76, 0
rd 72,0,10240
mT 144,76,16
wl 5
mT 152,48,16
s_mul_i32 s24, s24, 8192
rd 76,0,11264
mT 156,48,20
mT 164,52,20
s_add_u32 s24, s24, s35
rd 48,0,12288
mT 160,52,16
wl 5
mT 168,56,16
s_add_u32 s24, s24, 0
rd 52,0,13312
mT 172,56,20
lx 0,0
mT 180,60,20
rd 56,0,14336
mT 176,60,16
wl 5
mT 184,64,16
rd 60,0,15360
mT 188,64,20
s_waitcnt vmcnt(35)
s_barrier
mT 140,68,28
rd 64,1,36864
mT 136,68,24
wl 5
lx 4,1024
mT 144,72,24
s_add_u32 s23, s23, 14336
rd 68,1,37888
mT 148,72,28
s_waitcnt vmcnt(10)
s_add_u32 s36, s48, 65536
v_mov_b32 v31, 1
mT 156,76,28
s_add_u32 m0, s22, 88064
rd 72,1,38912
buffer_atomic_add v31, v4, s[4:7], s36 offen sc1
mT 152,76,24
wl 5
lw 0
mT 160,48,24
rd 76,1,39936
mT 164,48,28
mT 172,52,28
rd 48,1,40960
mT 168,52,24
wl 5
lw 1024
mT 176,56,24
rd 52,1,41984
mT 180,56,28
mT 188,60,28
rd 56,1,43008
mT 184,60,24
wl 5
lw 2048
mT 136,64,32
rd 60,1,44032
mT 140,64,36
mT 148,68,36
rd 64,1,45056
mT 144,68,32
wl 5
s_mov_b32 exec_hi, 0
lw 3072
s_mov_b32 exec_hi, -1
mT 152,72,32
rd 68,1,46080
mT 156,72,36
mT 164,76,36
rd 72,1,47104
mT 160,76,32
wl 5
lx 8,2048
mT 168,48,32
rd 76,1,48128
mT 172,48,36
mT 180,52,36
rd 48,1,49152
mT 176,52,32
wl 5
mT 184,56,32
rd 52,1,50176
mT 188,56,36
s_barrier
mT 140,60,44
s_add_u32 s23, s27, 401408
rd 56,1,51200
mT 136,60,40
wl 5
lx 12,3072
v_mov_b32 v31, 0
mT 144,64,40
s_add_u32 m0, s22, 2048
rd 60,1,52224
buffer_atomic_add v31, v4, s[4:7], s36 offen sc0 sc1
mT 148,64,44
lw 0
mT 156,68,44
rd 64,1,53248
mT 152,68,40
wl 5
mT 160,72,40
rd 68,1,54272
mT 164,72,44
mT 172,76,44
rd 72,1,55296
mT 168,76,40
wl 5
lw 1024
mT 176,48,40
rd 76,1,56320
mT 180,48,44
mT 188,52,44
rd 48,1,57344
mT 184,52,40
wl 5
lw 2048
mT 136,56,48
rd 52,1,58368
mT 140,56,52
mT 148,60,52
rd 56,1,59392
mT 144,60,48
wl 5
s_mov_b32 exec_hi, 0
lw 3072
s_mov_b32 exec_hi, -1
mT 152,64,48
s_add_u32 s24, s24, 4096
rd 60,1,60416
mT 156,64,52
mT 164,68,52
rd 64,1,61440
mT 160,68,48
wl 5
lx 16,0
mT 168,72,48
rd 68,1,62464
mT 172,72,52
mT 180,76,52
rd 72,1,63488
mT 176,76,48
wl 5
lx 20,1024
mT 184,48,48
rd 76,1,64512
mT 188,48,52
s_barrier
mT 140,52,60
s_add_u32 s23, s23, 14336
rd 48,0,59392
mT 136,52,56
wl 5
mT 144,56,56
s_add_u32 m0, s22, 102400
rd 52,0,60416
mT 148,56,60
lw 0
mT 156,60,60
rd 56,0,61440
mT 152,60,56
wl 5
mT 160,64,56
s_waitcnt vmcnt(7)
rd 60,0,62464
v_readfirstlane_b32 s46, v31
s_nop 0
s_nop 0
s_cmp_ge_u32 s46, 16
s_cbranch_scc1 main_ok170
s_mov_b32 s47, 0
main_poll169:
v_mov_b32 v31, 0
buffer_atomic_add v31, v4, s[4:7], s36 offen sc0 sc1
s_add_u32 s47, s47, 1
s_cmp_gt_u32 s47, 400000
s_cbranch_scc1 main_ok170
s_waitcnt vmcnt(0)
v_readfirstlane_b32 s46, v31
s_nop 0
s_cmp_lt_u32 s46, 16
s_cbranch_scc1 main_poll169
main_ok170:
mT 164,64,60
lw 1024
s_add_u32 s37, s54, 524288
mT 172,68,60
rd 64,0,63488
buffer_load_dwordx4 v[220:223], v0, s[4:7], s37 offen offset:0 sc1
mT 168,68,56
wl 5
buffer_load_dwordx4 v[224:227], v0, s[4:7], s37 offen offset:1024 sc1
mT 176,72,56
rd 68,0,64512
buffer_load_dwordx4 v[228:231], v0, s[4:7], s37 offen offset:2048 sc1
mT 180,72,60
lw 2048
mT 188,76,60
rd 72,1,0
buffer_load_dwordx4 v[232:235], v0, s[4:7], s37 offen offset:3072 sc1
mT 184,76,56
wl 5
mT 136,48,64
rd 76,1,1024
mT 140,48,68
s_mov_b32 exec_hi, 0
lw 3072
s_mov_b32 exec_hi, -1
mT 148,52,68
rd 48,1,2048
mT 144,52,64
wl 5
mT 152,56,64
rd 52,1,3072
mT 156,56,68
lx 24,2048
mT 164,60,68
rd 56,1,4096
mT 160,60,64
wl 5
mT 168,64,64
rd 60,1,5120
mT 172,64,68
lx 28,3072
mT 180,68,68
s_mul_i32 s24, s77, 8192
rd 64,1,6144
mT 176,68,64
wl 5
mT 184,72,64
s_add_u32 s24, s24, s35
rd 68,1,7168
mT 188,72,68
s_barrier
mT 140,76,76
s_add_u32 s24, s24, 8192
rd 72,1,8192
mT 136,76,72
wl 5
lx 32,0
mT 144,48,72
s_add_u32 s23, s27, 430080
rd 76,1,9216
mT 148,48,76
mT 156,52,76
s_add_u32 m0, s22, 116736
rd 48,1,10240
mT 152,52,72
wl 5
lw 0
mT 160,56,72
rd 52,1,11264
mT 164,56,76
mT 172,60,76
rd 56,1,12288
mT 168,60,72
wl 5
lw 1024
mT 176,64,72
rd 60,1,13312
mT 180,64,76
mT 188,68,76
rd 64,1,14336
mT 184,68,72
wl 5
lw 2048
mT 136,72,80
rd 68,1,15360
mT 140,72,84
mT 148,76,84
s_waitcnt vmcnt(10)
rd 72,1,16384
v_add_f32 v220, v220, v224
v_add_f32 v221, v221, v225
mT 144,76,80
wl 5
s_mov_b32 exec_hi, 0
lw 3072
s_mov_b32 exec_hi, -1
v_add_f32 v222, v222, v226
mT 152,48,80
s_waitcnt vmcnt(8)
rd 76,1,17408
v_add_f32 v223, v223, v227
v_add_f32 v228, v228, v232
mT 156,48,84
v_add_f32 v229, v229, v233
v_add_f32 v230, v230, v234
v_add_f32 v231, v231, v235
mT 164,52,84
rd 48,1,18432
v_add_f32 v220, v220, v228
v_add_f32 v221, v221, v229
mT 160,52,80
wl 5
lx 36,1024
v_add_f32 v222, v222, v230
mT 168,56,80
rd 52,1,19456
v_add_f32 v223, v223, v231
v_permlane32_swap_b32 v220, v222
mT 172,56,84
v_permlane32_swap_b32 v221, v223
v_add_f32 v220, v220, v222
v_add_f32 v221, v221, v223
mT 180,60,84
rd 56,1,20480
v_permlane16_swap_b32 v220, v221
v_add_f32 v220, v220, v221
mT 176,60,80
wl 5
lx 40,2048
mT 184,64,80
rd 60,1,21504
ds_write_b32 v13, v220
mT 188,64,84
s_barrier
ds_read2_b32 v[224:225], v14 offset0:0 offset1:16
ds_read2_b32 v[226:227], v14 offset0:32 offset1:48
mT 140,68,92
s_add_u32 s23, s23, 14336
rd 64,29,0
mT 136,68,88
wl 8
mT 144,72,88
s_add_u32 m0, s22, 59392
rd 68,29,1024
mT 148,72,92
lw 0
mT 156,76,92
rd 72,29,2048
mT 152,76,88
wl 8
mT 160,48,88
rd 76,29,3072
mT 164,48,92
wl 5
lw 1024
v_mul_f32 v236, 0xba124925, v224
mT 172,52,92
wl 4
rd 48,29,4096
v_mul_f32 v238, 0xba124925, v226
v_mul_f32 v225, 0x3a124925, v225
mT 168,52,88
v_mul_f32 v227, 0x3a124925, v227
v_fma_f32 v225, -v236, v236, v225
v_fma_f32 v227, -v238, v238, v227
mT 176,56,88
rd 52,29,5120
v_max_f32 v225, 0, v225
v_max_f32 v227, 0, v227
mT 180,56,92
lw 2048
v_add_f32 v225, s44, v225
mT 188,60,92
rd 56,29,6144
v_add_f32 v227, s44, v227
mT 184,60,88
wl 5
s_mov_b32 exec_hi, 0
lw 3072
s_mov_b32 exec_hi, -1
mT 136,64,96
rd 60,29,7168
v_rsq_f32 v237, v225
mT 140,64,100
v_rsq_f32 v239, v227
v_mul_f32 v236, v236, v237
mT 148,68,100
rd 64,29,8192
v_mul_f32 v238, v238, v239
mT 144,68,96
wl 5
lx 44,3072
mT 152,72,96
rd 68,29,9216
ds_write2_b32 v14, v236, v237 offset0:64 offset1:80
mT 156,72,100
ds_write2_b32 v14, v238, v239 offset0:96 offset1:112
rd 200,15,256
mT 164,76,100
rd 72,29,10240
rd 204,15,320
rd 208,15,384
mT 160,76,96
wl 10
rd 212,15,448
mT 168,48,96
rd 76,29,11264
mT 172,48,100
mT 180,52,100
rd 48,29,12288
mT 176,52,96
wl 11
mT 184,56,96
rd 52,29,13312
mT 188,56,100
s_barrier
mT 140,60,108
rd 56,29,14336
mT 136,60,104
wl 4
s_mov_b32 s37, s57
v_pk_fma_f32 v[80:81], v[80:81], v[204:205], v[200:201]
v_pk_fma_f32 v[82:83], v[82:83], v[206:207], v[202:203]
v_pk_fma_f32 v[84:85], v[84:85], v[212:213], v[208:209]
v_pk_fma_f32 v[86:87], v[86:87], v[214:215], v[210:211]
v_cvt_pk_bf16_f32 v220, v80, v81
v_cvt_pk_bf16_f32 v221, v82, v83
v_cvt_pk_bf16_f32 v222, v84, v85
v_cvt_pk_bf16_f32 v223, v86, v87
buffer_store_dwordx4 v[220:223], v0, s[4:7], s37 offen offset:0 sc1
mT 144,64,104
rd 60,29,15360
mT 148,64,108
mT 156,68,108
rd 64,29,16384
mT 152,68,104
mT 160,72,104
rd 68,29,17408
mT 164,72,108
wl 5
mT 172,76,108
rd 72,29,18432
mT 168,76,104
mT 176,48,104
rd 76,29,19456
mT 180,48,108
v_pk_fma_f32 v[88:89], v[88:89], v[204:205], v[200:201]
v_pk_fma_f32 v[90:91], v[90:91], v[206:207], v[202:203]
v_pk_fma_f32 v[92:93], v[92:93], v[212:213], v[208:209]
v_pk_fma_f32 v[94:95], v[94:95], v[214:215], v[210:211]
v_cvt_pk_bf16_f32 v224, v88, v89
v_cvt_pk_bf16_f32 v225, v90, v91
v_cvt_pk_bf16_f32 v226, v92, v93
v_cvt_pk_bf16_f32 v227, v94, v95
buffer_store_dwordx4 v[224:227], v0, s[4:7], s37 offen offset:1024 sc1
wl 5
mT 188,52,108
rd 48,29,20480
mT 184,52,104
mT 136,56,112
rd 52,29,21504
mT 140,56,116
wl 5
mT 148,60,116
rd 56,29,22528
mT 144,60,112
mT 152,64,112
rd 60,29,23552
mT 156,64,116
wl 5
mT 164,68,116
rd 64,29,24576
mT 160,68,112
v_pk_fma_f32 v[96:97], v[96:97], v[204:205], v[200:201]
v_pk_fma_f32 v[98:99], v[98:99], v[206:207], v[202:203]
v_pk_fma_f32 v[100:101], v[100:101], v[212:213], v[208:209]
v_pk_fma_f32 v[102:103], v[102:103], v[214:215], v[210:211]
v_cvt_pk_bf16_f32 v228, v96, v97
v_cvt_pk_bf16_f32 v229, v98, v99
v_cvt_pk_bf16_f32 v230, v100, v101
v_cvt_pk_bf16_f32 v231, v102, v103
buffer_store_dwordx4 v[228:231], v0, s[4:7], s37 offen offset:2048 sc1
mT 168,72,112
rd 68,29,25600
mT 172,72,116
wl 5
mT 180,76,116
rd 72,29,26624
mT 176,76,112
mT 184,48,112
rd 76,29,27648
mT 188,48,116
wl 5
s_barrier
mT 140,52,124
rd 48,0,16384
mT 136,52,120
mT 144,56,120
rd 52,0,17408
mT 148,56,124
v_pk_fma_f32 v[104:105], v[104:105], v[204:205], v[200:201]
v_pk_fma_f32 v[106:107], v[106:107], v[206:207], v[202:203]
v_pk_fma_f32 v[108:109], v[108:109], v[212:213], v[208:209]
v_pk_fma_f32 v[110:111], v[110:111], v[214:215], v[210:211]
v_cvt_pk_bf16_f32 v220, v104, v105
v_cvt_pk_bf16_f32 v221, v106, v107
v_cvt_pk_bf16_f32 v222, v108, v109
v_cvt_pk_bf16_f32 v223, v110, v111
buffer_store_dwordx4 v[220:223], v0, s[4:7], s37 offen offset:3072 sc1
s_add_u32 s37, s37, 4096
wl 5
mT 156,60,124
rd 56,0,18432
mT 152,60,120
mT 160,64,120
rd 60,0,19456
mT 164,64,124
wl 5
mT 172,68,124
rd 64,0,20480
mT 168,68,120
mT 176,72,120
rd 68,0,21504
mT 180,72,124
wl 5
mT 188,76,124
rd 72,0,22528
mT 184,76,120
v_pk_fma_f32 v[112:113], v[112:113], v[204:205], v[200:201]
v_pk_fma_f32 v[114:115], v[114:115], v[206:207], v[202:203]
v_pk_fma_f32 v[116:117], v[116:117], v[212:213], v[208:209]
v_pk_fma_f32 v[118:119], v[118:119], v[214:215], v[210:211]
v_cvt_pk_bf16_f32 v224, v112, v113
v_cvt_pk_bf16_f32 v225, v114, v115
v_cvt_pk_bf16_f32 v226, v116, v117
v_cvt_pk_bf16_f32 v227, v118, v119
buffer_store_dwordx4 v[224:227], v0, s[4:7], s37 offen offset:0 sc1
mT 136,48,128
rd 76,0,23552
mT 140,48,132
wl 5
mT 148,52,132
rd 48,0,24576
mT 144,52,128
mT 152,56,128
rd 52,0,25600
mT 156,56,132
wl 5
mT 164,60,132
rd 56,0,26624
mT 160,60,128
mT 168,64,128
rd 60,0,27648
mT 172,64,132
v_pk_fma_f32 v[120:121], v[120:121], v[204:205], v[200:201]
v_pk_fma_f32 v[122:123], v[122:123], v[206:207], v[202:203]
v_pk_fma_f32 v[124:125], v[124:125], v[212:213], v[208:209]
v_pk_fma_f32 v[126:127], v[126:127], v[214:215], v[210:211]
v_cvt_pk_bf16_f32 v228, v120, v121
v_cvt_pk_bf16_f32 v229, v122, v123
v_cvt_pk_bf16_f32 v230, v124, v125
v_cvt_pk_bf16_f32 v231, v126, v127
buffer_store_dwordx4 v[228:231], v0, s[4:7], s37 offen offset:1024 sc1
wl 5
mT 180,68,132
rd 64,0,28672
mT 176,68,128
mT 184,72,128
rd 68,0,29696
mT 188,72,132
wl 5
s_barrier
mT 140,76,140
rd 72,0,30720
mT 136,76,136
mT 144,48,136
rd 76,0,31744
mT 148,48,140
wl 5
mT 156,52,140
rd 48,0,32768
mT 152,52,136
v_pk_fma_f32 v[128:129], v[128:129], v[204:205], v[200:201]
v_pk_fma_f32 v[130:131], v[130:131], v[206:207], v[202:203]
v_pk_fma_f32 v[132:133], v[132:133], v[212:213], v[208:209]
v_pk_fma_f32 v[134:135], v[134:135], v[214:215], v[210:211]
v_cvt_pk_bf16_f32 v220, v128, v129
v_cvt_pk_bf16_f32 v221, v130, v131
v_cvt_pk_bf16_f32 v222, v132, v133
v_cvt_pk_bf16_f32 v223, v134, v135
buffer_store_dwordx4 v[220:223], v0, s[4:7], s37 offen offset:2048 sc1
mT 160,56,136
rd 52,0,33792
mT 164,56,140
main_cp24:
s_mov_b32 s96, main_cp24-main_cp23
v_lshl_add_u64 v[2:3], v[2:3], 0, s[96:97]
global_load_dword v254, v[2:3], off
wl 5
mT 172,60,140
rd 56,0,34816
mT 168,60,136
mT 176,64,136
rd 60,0,35840
mT 180,64,140
wl 5
mT 188,68,140
rd 64,0,36864
mT 184,68,136
mT 136,72,144
rd 68,0,37888
mT 140,72,148
wl 5
mT 148,76,148
rd 72,0,38912
mT 144,76,144
mT 152,48,144
rd 76,0,39936
mT 156,48,148
wl 5
mT 164,52,148
rd 48,0,40960
mT 160,52,144
mT 168,56,144
rd 52,0,41984
mT 172,56,148
wl 5
mT 180,60,148
rd 56,0,43008
mT 176,60,144
mT 184,64,144
rd 60,0,44032
mT 188,64,148
wl 5
s_barrier
mT 140,68,156
rd 64,0,45056
mT 136,68,152
mT 144,72,152
rd 68,0,46080
mT 148,72,156
wl 5
mT 156,76,156
rd 72,0,47104
mT 152,76,152
mT 160,48,152
rd 76,0,48128
mT 164,48,156
wl 5
mT 172,52,156
rd 48,0,49152
mT 168,52,152
mT 176,56,152
s_add_u32 s24, s24, 4096
rd 52,0,50176
mT 180,56,156
wl 5
mT 188,60,156
rd 56,0,51200
mT 184,60,152
lx 48,0
mT 136,64,160
rd 60,0,52224
mT 140,64,164
wl 5
mT 148,68,164
rd 64,0,53248
mT 144,68,160
lx 52,1024
mT 152,72,160
rd 68,0,54272
mT 156,72,164
wl 5
mT 164,76,164
rd 72,0,55296
mT 160,76,160
lx 56,2048
mT 168,48,160
s_waitcnt vmcnt(4)
s_add_u32 s36, s42, 81920
rd 76,0,56320
v_mov_b32 v31, 1
s_barrier
buffer_atomic_add v31, v4, s[4:7], s36 offen sc1
mT 172,48,164
wl 5
mT 180,52,164
rd 48,0,57344
mT 176,52,160
lx 60,3072
mT 184,56,160
s_mul_i32 s24, s78, 8192
rd 52,0,58368
mT 188,56,164
wl 5
s_barrier
mT 140,60,172
s_add_u32 s24, s24, s35
rd 56,1,22528
mT 136,60,168
mT 144,64,168
s_add_u32 s24, s24, 16384
rd 60,1,23552
mT 148,64,172
wl 5
lx 64,0
mT 156,68,172
rd 64,1,24576
mT 152,68,168
mT 160,72,168
rd 68,1,25600
mT 164,72,172
wl 5
lx 68,1024
mT 172,76,172
rd 72,1,26624
mT 168,76,168
mT 176,48,168
rd 76,1,27648
mT 180,48,172
wl 5
lx 72,2048
mT 188,52,172
rd 48,1,28672
mT 184,52,168
mT 136,56,176
rd 52,1,29696
mT 140,56,180
wl 5
lx 76,3072
mT 148,60,180
s_add_u32 s24, s24, 4096
rd 56,1,30720
mT 144,60,176
mT 152,64,176
rd 60,1,31744
mT 156,64,180
wl 5
lx 80,0
mT 164,68,180
rd 64,1,32768
mT 160,68,176
mT 168,72,176
rd 68,1,33792
mT 172,72,180
wl 5
lx 84,1024
mT 180,76,180
s_add_u32 s36, s50, 81920
rd 72,1,34816
v_mov_b32 v31, 0
mT 176,76,176
buffer_atomic_add v31, v4, s[4:7], s36 offen sc0 sc1
mT 184,48,176
rd 76,1,35840
mT 188,48,180
wl 5
s_barrier
mT 140,52,188
rd 48,0,2048
mT 136,52,184
lx 88,2048
mT 144,56,184
rd 52,0,3072
mT 148,56,188
wl 5
mT 156,60,188
rd 56,0,4096
mT 152,60,184
lx 92,3072
mT 160,64,184
s_mul_i32 s24, s79, 8192
rd 60,0,5120
mT 164,64,188
wl 5
mT 172,68,188
s_add_u32 s24, s24, s35
rd 64,0,6144
mT 168,68,184
mT 176,72,184
s_add_u32 s24, s24, 24576
rd 68,0,7168
mT 180,72,188
wl 5
lx 96,0
mT 188,76,188
rd 72,0,8192
mT 184,76,184
mT 136,48,192
rd 76,0,9216
mT 140,48,196
wl 5
lx 100,1024
mT 148,52,196
rd 48,0,10240
mT 144,52,192
mT 152,56,192
rd 52,0,11264
mT 156,56,196
wl 5
lx 104,2048
mT 164,60,196
rd 56,0,12288
mT 160,60,192
mT 168,64,192
rd 60,0,13312
mT 172,64,196
wl 5
lx 108,3072
mT 180,68,196
s_add_u32 s24, s24, 4096
rd 64,0,14336
mT 176,68,192
mT 184,72,192
rd 68,0,15360
mT 188,72,196
wl 5
s_barrier
mT 140,76,204
rd 72,1,36864
mT 136,76,200
s_waitcnt vmcnt(6)
lx 112,0
v_readfirstlane_b32 s46, v31
s_nop 0
s_add_u32 s46, s46, s21
s_cmp_ge_u32 s46, 16
s_cbranch_scc1 main_ok172
s_mov_b32 s47, 0
main_poll171:
v_mov_b32 v31, 0
buffer_atomic_add v31, v4, s[4:7], s36 offen sc0 sc1
s_add_u32 s47, s47, 1
s_cmp_gt_u32 s47, 400000
s_cbranch_scc1 main_ok172
s_waitcnt vmcnt(0)
v_readfirstlane_b32 s46, v31
s_nop 0
s_cmp_lt_u32 s46, 16
s_cbranch_scc1 main_poll171
main_ok172:
s_barrier
mT 144,48,200
s_max_i32 s23, s76, 0
rd 76,1,37888
mT 148,48,204
wl 5
mT 156,52,204
s_mul_i32 s23, s23, 28672
rd 48,1,38912
mT 152,52,200
mT 160,56,200
s_add_u32 s23, s23, s73
rd 52,1,39936
mT 164,56,204
wl 5
mT 172,60,204
s_add_u32 s23, s23, 0
rd 56,1,40960
mT 168,60,200
mT 176,64,200
s_add_u32 m0, s22, 73728
rd 60,1,41984
mT 180,64,204
wl 5
lw 0
mT 188,68,204
rd 64,1,43008
mT 184,68,200
mT 136,72,208
rd 68,1,44032
mT 140,72,212
wl 5
lw 1024
mT 148,76,212
rd 72,1,45056
mT 144,76,208
mT 152,48,208
rd 76,1,46080
mT 156,48,212
wl 5
lw 2048
mT 164,52,212
rd 48,1,47104
mT 160,52,208
mT 168,56,208
rd 52,1,48128
mT 172,56,212
wl 5
mT 180,60,212
rd 56,1,49152
mT 176,60,208
s_mov_b32 exec_hi, 0
lw 3072
s_mov_b32 exec_hi, -1
mT 184,64,208
s_add_u32 s23, s23, 14336
rd 60,1,50176
mT 188,64,212
wl 5
s_barrier
mT 140,68,220
s_add_u32 m0, s22, 131072
rd 64,1,51200
mT 136,68,216
lw 0
mT 144,72,216
rd 68,1,52224
mT 148,72,220
wl 5
mT 156,76,220
rd 72,1,53248
mT 152,76,216
lw 1024
mT 160,48,216
rd 76,1,54272
mT 164,48,220
wl 5
mT 172,52,220
rd 48,1,55296
mT 168,52,216
mT 176,56,216
rd 52,1,56320
mT 180,56,220
wl 5
lw 2048
mT 188,60,220
rd 56,1,57344
mT 184,60,216
mT 136,64,224
rd 60,1,58368
mT 140,64,228
wl 5
s_mov_b32 exec_hi, 0
lw 3072
s_mov_b32 exec_hi, -1
mT 148,68,228
rd 64,1,59392
mT 144,68,224
mT 152,72,224
rd 68,1,60416
mT 156,72,228
wl 5
lx 116,1024
mT 164,76,228
rd 72,1,61440
mT 160,76,224
mT 168,48,224
s_mul_i32 s23, s77, 28672
rd 76,1,62464
mT 172,48,228
wl 5
mT 180,52,228
s_add_u32 s23, s23, s73
rd 48,1,63488
mT 176,52,224
mT 184,56,224
s_add_u32 s23, s23, 28672
rd 52,1,64512
mT 188,56,228
wl 5
s_barrier
mT 140,60,236
s_add_u32 m0, s22, 145408
rd 56,0,59392
mT 136,60,232
lw 0
mT 144,64,232
rd 60,0,60416
mT 148,64,236
wl 5
mT 156,68,236
rd 64,0,61440
mT 152,68,232
lw 1024
mT 160,72,232
rd 68,0,62464
mT 164,72,236
wl 5
mT 172,76,236
rd 72,0,63488
mT 168,76,232
lw 2048
mT 176,48,232
rd 76,0,64512
mT 180,48,236
wl 5
mT 188,52,236
rd 48,1,0
mT 184,52,232
s_mov_b32 exec_hi, 0
lw 3072
s_mov_b32 exec_hi, -1
mT 136,56,240
rd 52,1,1024
mT 140,56,244
wl 5
mT 148,60,244
s_add_u32 s23, s23, 14336
rd 56,1,2048
mT 144,60,240
mT 152,64,240
s_add_u32 m0, s22, 16384
rd 60,1,3072
mT 156,64,244
wl 5
lw 0
mT 164,68,244
rd 64,1,4096
mT 160,68,240
mT 168,72,240
rd 68,1,5120
mT 172,72,244
wl 5
lw 1024
mT 180,76,244
rd 72,1,6144
mT 176,76,240
mT 184,48,240
rd 76,1,7168
mT 188,48,244
s_waitcnt lgkmcnt(5) vmcnt(11)
s_barrier
mT 140,52,252
rd 48,1,8192
mT 136,52,248
lw 2048
mT 144,56,248
rd 52,1,9216
mT 148,56,252
wl 5
mT 156,60,252
rd 56,1,10240
mT 152,60,248
s_mov_b32 exec_hi, 0
lw 3072
s_mov_b32 exec_hi, -1
mT 160,64,248
rd 60,1,11264
mT 164,64,252
wl 5
mT 172,68,252
rd 64,1,12288
mT 168,68,248
lx 120,2048
mT 176,72,248
s_mul_i32 s23, s78, 28672
rd 68,1,13312
mT 180,72,252
wl 5
mT 188,76,252
s_add_u32 s23, s23, s73
rd 72,1,14336
mT 184,76,248
v_mfma_f32_16x16x32_bf16 v[80:83], v[48:51], a[0:3], 0
s_add_u32 s23, s23, 57344
rd 76,1,15360
v_mfma_f32_16x16x32_bf16 v[84:87], v[48:51], a[4:7], 0
wl 5
v_mfma_f32_16x16x32_bf16 v[92:95], v[52:55], a[4:7], 0
s_add_u32 m0, s22, 30720
rd 48,1,16384
v_mfma_f32_16x16x32_bf16 v[88:91], v[52:55], a[0:3], 0
lw 0
v_mfma_f32_16x16x32_bf16 v[96:99], v[56:59], a[0:3], 0
rd 52,1,17408
v_mfma_f32_16x16x32_bf16 v[100:103], v[56:59], a[4:7], 0
wl 5
v_mfma_f32_16x16x32_bf16 v[108:111], v[60:63], a[4:7], 0
rd 56,1,18432
v_mfma_f32_16x16x32_bf16 v[104:107], v[60:63], a[0:3], 0
lw 1024
v_mfma_f32_16x16x32_bf16 v[112:115], v[64:67], a[0:3], 0
rd 60,1,19456
v_mfma_f32_16x16x32_bf16 v[116:119], v[64:67], a[4:7], 0
wl 5
rd 232,12,1216
v_mfma_f32_16x16x32_bf16 v[124:127], v[68:71], a[4:7], 0
rd 64,1,20480
v_mfma_f32_16x16x32_bf16 v[120:123], v[68:71], a[0:3], 0
lw 2048
v_mfma_f32_16x16x32_bf16 v[128:131], v[72:75], a[0:3], 0
rd 68,1,21504
v_mfma_f32_16x16x32_bf16 v[132:135], v[72:75], a[4:7], 0
s_waitcnt lgkmcnt(6) vmcnt(13)
s_barrier
mT 84,76,12
rd 72,29,0
mT 80,76,8
s_mov_b32 exec_hi, 0
lw 3072
s_mov_b32 exec_hi, -1
mT 88,48,8
rd 76,29,1024
mT 92,48,12
wl 6
rd 236,12,1280
mT 100,52,12
s_add_u32 s23, s23, 14336
rd 48,29,2048
mT 96,52,8
mT 104,56,8
s_add_u32 m0, s22, 45056
rd 52,29,3072
mT 108,56,12
wl 7
lw 0
mT 116,60,12
rd 56,29,4096
mT 112,60,8
wl 6
v_fmac_f32 v136, v216, v232
v_fmac_f32 v137, v216, v233
mT 120,64,8
rd 60,29,5120
v_fmac_f32 v138, v216, v234
mT 124,64,12
lw 1024
mT 132,68,12
rd 64,29,6144
v_fmac_f32 v139, v216, v235
mT 128,68,8
wl 6
v_mul_f32 v136, v136, v217
v_mul_f32 v137, v137, v217
mT 80,72,16
rd 68,29,7168
v_mul_f32 v138, v138, v217
mT 84,72,20
lw 2048
mT 92,76,20
rd 72,29,8192
v_mul_f32 v139, v139, v217
mT 88,76,16
wl 5
v_mul_f32 v220, v136, v136
v_mul_f32 v221, v137, v137
mT 96,48,16
rd 76,29,9216
v_mul_f32 v222, v138, v138
mT 100,48,20
v_mul_f32 v223, v139, v139
v_fma_f32 v220, v220, s43, v30
mT 108,52,20
rd 48,29,10240
v_fma_f32 v221, v221, s43, v30
mT 104,52,16
wl 5
s_mov_b32 exec_hi, 0
lw 3072
s_mov_b32 exec_hi, -1
mT 112,56,16
rd 52,29,11264
v_fma_f32 v222, v222, s43, v30
mT 116,56,20
v_fma_f32 v223, v223, s43, v30
v_mul_f32 v220, v220, v136
mT 124,60,20
rd 56,29,12288
v_mul_f32 v221, v221, v137
mT 120,60,16
wl 5
lx 124,3072
mT 128,64,16
s_mul_i32 s23, s79, 28672
rd 60,29,13312
v_mul_f32 v222, v222, v138
mT 132,64,20
s_waitcnt vmcnt(14)
s_barrier
v_mul_f32 v223, v223, v139
mT 84,68,28
s_add_u32 s23, s23, s73
rd 64,29,14336
v_fmac_f32 v140, v218, v232
mT 80,68,24
wl 5
v_exp_f32 v220, v220
mT 88,72,24
s_add_u32 s23, s23, 86016
rd 68,29,15360
v_add_f32 v220, 1.0, v220
mT 92,72,28
v_exp_f32 v221, v221
mT 100,76,28
s_add_u32 m0, s22, 88064
rd 72,29,16384
v_add_f32 v221, 1.0, v221
mT 96,76,24
wl 5
lw 0
mT 104,48,24
rd 76,29,17408
v_fmac_f32 v141, v218, v233
mT 108,48,28
v_exp_f32 v222, v222
mT 116,52,28
rd 48,29,18432
v_add_f32 v222, 1.0, v222
mT 112,52,24
wl 5
lw 1024
mT 120,56,24
rd 52,29,19456
v_fmac_f32 v142, v218, v234
mT 124,56,28
v_exp_f32 v223, v223
mT 132,60,28
rd 56,29,20480
v_add_f32 v223, 1.0, v223
mT 128,60,24
wl 5
lw 2048
mT 80,64,32
rd 60,29,21504
v_fmac_f32 v143, v218, v235
mT 84,64,36
v_rcp_f32 v220, v220
mT 92,68,36
rd 64,29,22528
v_mul_f32 v136, v136, v220
mT 88,68,32
wl 5
s_mov_b32 exec_hi, 0
lw 3072
s_mov_b32 exec_hi, -1
mT 96,72,32
rd 68,29,23552
v_mul_f32 v140, v140, v219
mT 100,72,36
v_rcp_f32 v221, v221
mT 108,76,36
s_add_u32 s23, s23, 14336
rd 72,29,24576
v_mul_f32 v137, v137, v221
mT 104,76,32
wl 5
v_rcp_f32 v222, v222
mT 112,48,32
s_add_u32 m0, s22, 2048
rd 76,29,25600
v_mul_f32 v138, v138, v222
mT 116,48,36
lw 0
mT 124,52,36
rd 48,29,26624
v_mul_f32 v141, v141, v219
mT 120,52,32
wl 5
v_rcp_f32 v223, v223
mT 128,56,32
rd 52,29,27648
v_mul_f32 v139, v139, v223
mT 132,56,36
s_waitcnt vmcnt(15)
s_barrier
v_mul_f32 v142, v142, v219
mT 84,60,44
rd 56,0,16384
v_mul_f32 v143, v143, v219
mT 80,60,40
wl 5
lw 1024
mT 88,64,40
rd 60,0,17408
v_mul_f32 v224, v140, v140
mT 92,64,44
v_mul_f32 v225, v141, v141
v_mul_f32 v226, v142, v142
mT 100,68,44
rd 64,0,18432
v_mul_f32 v227, v143, v143
mT 96,68,40
wl 5
lw 2048
mT 104,72,40
rd 68,0,19456
v_fma_f32 v224, v224, s43, v30
mT 108,72,44
v_fma_f32 v225, v225, s43, v30
v_fma_f32 v226, v226, s43, v30
mT 116,76,44
rd 72,0,20480
v_fma_f32 v227, v227, s43, v30
mT 112,76,40
wl 5
s_mov_b32 exec_hi, 0
lw 3072
s_mov_b32 exec_hi, -1
mT 120,48,40
s_mul_i32 s24, s76, 8192
rd 76,0,21504
v_mul_f32 v224, v224, v140
mT 124,48,44
v_exp_f32 v224, v224
mT 132,52,44
s_add_u32 s24, s24, s35
rd 48,0,22528
v_mul_f32 v225, v225, v141
mT 128,52,40
wl 5
v_exp_f32 v225, v225
mT 80,56,48
s_add_u32 s24, s24, 32768
rd 52,0,23552
v_mul_f32 v226, v226, v142
mT 84,56,52
lx 128,0
mT 92,60,52
s_mul_i32 s23, s76, 28672
rd 56,0,24576
v_mul_f32 v227, v227, v143
mT 88,60,48
wl 5
v_exp_f32 v226, v226
mT 96,64,48
s_add_u32 s23, s23, s73
rd 60,0,25600
v_add_f32 v224, 1.0, v224
mT 100,64,52
v_exp_f32 v227, v227
mT 108,68,52
s_add_u32 s23, s23, 114688
rd 64,0,26624
v_add_f32 v225, 1.0, v225
mT 104,68,48
wl 5
v_rcp_f32 v224, v224
mT 112,72,48
s_add_u32 m0, s22, 102400
rd 68,0,27648
v_add_f32 v226, 1.0, v226
mT 116,72,52
lw 0
mT 124,76,52
rd 72,0,28672
v_add_f32 v227, 1.0, v227
mT 120,76,48
wl 5
v_rcp_f32 v225, v225
mT 128,48,48
rd 76,0,29696
v_mul_f32 v140, v140, v224
mT 132,48,52
s_waitcnt vmcnt(15)
s_barrier
v_mul_f32 v141, v141, v225
mT 84,52,60
rd 48,0,30720
v_fmac_f32 v144, v216, v236
mT 80,52,56
wl 5
lw 1024
mT 88,56,56
rd 52,0,31744
v_fmac_f32 v145, v216, v237
mT 92,56,60
v_rcp_f32 v226, v226
mT 100,60,60
rd 56,0,32768
v_mul_f32 v142, v142, v226
mT 96,60,56
wl 5
lw 2048
mT 104,64,56
rd 60,0,33792
v_fmac_f32 v146, v216, v238
mT 108,64,60
v_rcp_f32 v227, v227
mT 116,68,60
rd 64,0,34816
v_mul_f32 v143, v143, v227
mT 112,68,56
wl 5
s_mov_b32 exec_hi, 0
lw 3072
s_mov_b32 exec_hi, -1
mT 120,72,56
rd 68,0,35840
v_fmac_f32 v147, v216, v239
mT 124,72,60
v_mul_f32 v144, v144, v217
main_cp25:
s_mov_b32 s96, main_cp25-main_cp24
v_lshl_add_u64 v[2:3], v[2:3], 0, s[96:97]
global_load_dword v254, v[2:3], off
v_mul_f32 v145, v145, v217
mT 132,76,60
rd 72,0,36864
v_mul_f32 v146, v146, v217
mT 128,76,56
wl 5
lx 132,1024
mT 80,48,64
s_add_u32 s23, s23, 14336
rd 76,0,37888
v_mul_f32 v147, v147, v217
mT 84,48,68
v_mul_f32 v228, v144, v144
v_mul_f32 v229, v145, v145
mT 92,52,68
s_add_u32 m0, s22, 116736
rd 48,0,38912
v_mul_f32 v230, v146, v146
mT 88,52,64
wl 5
lw 0
mT 96,56,64
rd 52,0,39936
v_mul_f32 v231, v147, v147
mT 100,56,68
v_fma_f32 v228, v228, s43, v30
v_fma_f32 v229, v229, s43, v30
mT 108,60,68
rd 56,0,40960
v_fma_f32 v230, v230, s43, v30
mT 104,60,64
wl 5
v_fma_f32 v231, v231, s43, v30
v_mul_f32 v228, v228, v144
mT 112,64,64
rd 60,0,41984
v_mul_f32 v229, v229, v145
mT 116,64,68
lw 1024
mT 124,68,68
rd 64,0,43008
v_mul_f32 v230, v230, v146
mT 120,68,64
wl 5
v_exp_f32 v228, v228
mT 128,72,64
rd 68,0,44032
v_mul_f32 v231, v231, v147
mT 132,72,68
s_waitcnt vmcnt(18)
s_barrier
v_add_f32 v228, 1.0, v228
mT 84,76,76
rd 72,0,45056
v_fmac_f32 v148, v218, v236
mT 80,76,72
wl 5
lw 2048
mT 88,48,72
rd 76,0,46080
v_fmac_f32 v149, v218, v237
mT 92,48,76
v_exp_f32 v229, v229
mT 100,52,76
rd 48,0,47104
v_add_f32 v229, 1.0, v229
mT 96,52,72
wl 5
s_mov_b32 exec_hi, 0
lw 3072
s_mov_b32 exec_hi, -1
mT 104,56,72
rd 52,0,48128
v_fmac_f32 v150, v218, v238
mT 108,56,76
v_exp_f32 v230, v230
mT 116,60,76
rd 56,0,49152
v_add_f32 v230, 1.0, v230
mT 112,60,72
wl 5
lx 136,2048
mT 120,64,72
rd 60,0,50176
v_fmac_f32 v151, v218, v239
mT 124,64,76
v_exp_f32 v231, v231
mT 132,68,76
rd 64,0,51200
v_add_f32 v231, 1.0, v231
mT 128,68,72
wl 5
lx 140,3072
mT 80,72,80
s_add_u32 s24, s24, 4096
rd 68,0,52224
v_mul_f32 v148, v148, v219
mT 84,72,84
v_rcp_f32 v228, v228
mT 92,76,84
rd 72,0,53248
v_mul_f32 v144, v144, v228
mT 88,76,80
wl 5
lx 144,0
mT 96,48,80
rd 76,0,54272
v_mul_f32 v149, v149, v219
mT 100,48,84
v_rcp_f32 v229, v229
mT 108,52,84
rd 48,0,55296
v_mul_f32 v145, v145, v229
mT 104,52,80
wl 5
v_rcp_f32 v230, v230
mT 112,56,80
rd 52,0,56320
v_mul_f32 v146, v146, v230
mT 116,56,84
lx 148,1024
mT 124,60,84
s_mul_i32 s23, s77, 28672
rd 56,0,57344
v_mul_f32 v150, v150, v219
mT 120,60,80
wl 5
v_rcp_f32 v231, v231
mT 128,64,80
s_add_u32 s23, s23, s73
rd 60,0,58368
v_mul_f32 v147, v147, v231
mT 132,64,84
s_waitcnt vmcnt(19)
s_barrier
v_mul_f32 v151, v151, v219
mT 84,68,92
s_add_u32 s23, s23, 143360
rd 64,1,22528
v_mul_f32 v220, v148, v148
mT 80,68,88
wl 5
v_mul_f32 v221, v149, v149
v_mul_f32 v222, v150, v150
mT 88,72,88
s_add_u32 m0, s22, 59392
rd 68,1,23552
v_mul_f32 v223, v151, v151
mT 92,72,92
lw 0
mT 100,76,92
rd 72,1,24576
v_fma_f32 v220, v220, s43, v30
mT 96,76,88
wl 5
v_fma_f32 v221, v221, s43, v30
v_fma_f32 v222, v222, s43, v30
mT 104,48,88
rd 76,1,25600
v_fma_f32 v223, v223, s43, v30
mT 108,48,92
lw 1024
mT 116,52,92
rd 48,1,26624
v_mul_f32 v220, v220, v148
mT 112,52,88
wl 5
v_exp_f32 v220, v220
mT 120,56,88
rd 52,1,27648
v_mul_f32 v221, v221, v149
mT 124,56,92
lw 2048
mT 132,60,92
rd 56,1,28672
v_mul_f32 v222, v222, v150
mT 128,60,88
wl 5
v_exp_f32 v221, v221
mT 80,64,96
rd 60,1,29696
v_mul_f32 v223, v223, v151
mT 84,64,100
s_mov_b32 exec_hi, 0
lw 3072
s_mov_b32 exec_hi, -1
mT 92,68,100
rd 64,1,30720
v_add_f32 v220, 1.0, v220
mT 88,68,96
wl 5
v_exp_f32 v222, v222
mT 96,72,96
rd 68,1,31744
v_add_f32 v221, 1.0, v221
mT 100,72,100
lx 152,2048
mT 108,76,100
rd 72,1,32768
v_add_f32 v222, 1.0, v222
mT 104,76,96
wl 5
v_exp_f32 v223, v223
mT 112,48,96
rd 76,1,33792
v_add_f32 v223, 1.0, v223
mT 116,48,100
lx 156,3072
mT 124,52,100
rd 48,1,34816
mT 120,52,96
wl 5
v_rcp_f32 v220, v220
mT 128,56,96
s_mul_i32 s24, s77, 8192
rd 52,1,35840
v_mul_f32 v148, v148, v220
mT 132,56,100
s_waitcnt vmcnt(21)
s_barrier
mT 84,60,108
s_add_u32 s24, s24, s35
rd 56,0,2048
mT 80,60,104
wl 5
v_rcp_f32 v221, v221
mT 88,64,104
s_add_u32 s24, s24, 40960
rd 60,0,3072
v_mul_f32 v149, v149, v221
mT 92,64,108
lx 160,0
mT 100,68,108
rd 64,0,4096
mT 96,68,104
wl 5
v_rcp_f32 v222, v222
mT 104,72,104
rd 68,0,5120
v_mul_f32 v150, v150, v222
mT 108,72,108
lx 164,1024
mT 116,76,108
s_add_u32 s23, s23, 14336
rd 72,0,6144
mT 112,76,104
wl 5
v_rcp_f32 v223, v223
mT 120,48,104
s_add_u32 m0, s22, 73728
rd 76,0,7168
v_mul_f32 v151, v151, v223
mT 124,48,108
lw 0
mT 132,52,108
rd 48,0,8192
mT 128,52,104
wl 5
rd 232,12,1344
mT 80,56,112
rd 52,0,9216
mT 84,56,116
lw 1024
mT 92,60,116
rd 56,0,10240
mT 88,60,112
wl 6
rd 236,12,1408
mT 96,64,112
rd 60,0,11264
mT 100,64,116
lw 2048
mT 108,68,116
rd 64,0,12288
mT 104,68,112
wl 7
mT 112,72,112
rd 68,0,13312
mT 116,72,116
s_mov_b32 exec_hi, 0
lw 3072
s_mov_b32 exec_hi, -1
mT 124,76,116
wl 6
rd 72,0,14336
v_fmac_f32 v152, v216, v232
mT 120,76,112
v_fmac_f32 v153, v216, v233
v_fmac_f32 v154, v216, v234
mT 128,48,112
rd 76,0,15360
v_fmac_f32 v155, v216, v235
mT 132,48,116
s_waitcnt lgkmcnt(6) vmcnt(22)
s_barrier
v_mul_f32 v152, v152, v217
mT 84,52,124
rd 48,1,36864
v_mul_f32 v153, v153, v217
mT 80,52,120
lx 168,2048
mT 88,56,120
rd 52,1,37888
v_mul_f32 v154, v154, v217
mT 92,56,124
wl 5
v_mul_f32 v155, v155, v217
v_mul_f32 v224, v152, v152
mT 100,60,124
rd 56,1,38912
v_mul_f32 v225, v153, v153
mT 96,60,120
lx 172,3072
mT 104,64,120
s_add_u32 s24, s24, 4096
rd 60,1,39936
v_mul_f32 v226, v154, v154
mT 108,64,124
wl 5
v_mul_f32 v227, v155, v155
v_fma_f32 v224, v224, s43, v30
mT 116,68,124
rd 64,1,40960
v_fma_f32 v225, v225, s43, v30
mT 112,68,120
lx 176,0
mT 120,72,120
rd 68,1,41984
v_fma_f32 v226, v226, s43, v30
mT 124,72,124
wl 5
v_fma_f32 v227, v227, s43, v30
v_mul_f32 v224, v224, v152
mT 132,76,124
rd 72,1,43008
v_mul_f32 v225, v225, v153
mT 128,76,120
lx 180,1024
mT 80,48,128
s_waitcnt vmcnt(24)
s_mul_i32 s23, s78, 28672
rd 76,1,44032
v_mul_f32 v226, v226, v154
mT 84,48,132
wl 5
v_exp_f32 v224, v224
mT 92,52,132
s_add_u32 s23, s23, s73
rd 48,1,45056
v_mul_f32 v227, v227, v155
mT 88,52,128
v_exp_f32 v225, v225
mT 96,56,128
s_add_u32 s23, s23, 172032
rd 52,1,46080
v_add_f32 v224, 1.0, v224
mT 100,56,132
wl 5
v_exp_f32 v226, v226
mT 108,60,132
s_add_u32 m0, s22, 131072
rd 56,1,47104
v_add_f32 v225, 1.0, v225
mT 104,60,128
lw 0
mT 112,64,128
rd 60,1,48128
v_add_f32 v226, 1.0, v226
mT 116,64,132
wl 5
v_exp_f32 v227, v227
mT 124,68,132
rd 64,1,49152
v_add_f32 v227, 1.0, v227
mT 120,68,128
lw 1024
mT 128,72,128
rd 68,1,50176
v_fmac_f32 v156, v218, v232
mT 132,72,132
s_waitcnt vmcnt(20) lgkmcnt(5)
s_barrier
v_fmac_f32 v157, v218, v233
mT 84,76,140
rd 72,1,51200
v_fmac_f32 v158, v218, v234
mT 80,76,136
lw 2048
mT 88,48,136
rd 76,1,52224
v_fmac_f32 v159, v218, v235
mT 92,48,140
wl 5
v_rcp_f32 v224, v224
mT 100,52,140
rd 48,1,53248
v_mul_f32 v152, v152, v224
mT 96,52,136
s_mov_b32 exec_hi, 0
lw 3072
s_mov_b32 exec_hi, -1
mT 104,56,136
rd 52,1,54272
v_mul_f32 v156, v156, v219
mT 108,56,140
wl 5
v_rcp_f32 v225, v225
mT 116,60,140
rd 56,1,55296
v_mul_f32 v153, v153, v225
mT 112,60,136
lx 184,2048
mT 120,64,136
rd 60,1,56320
v_mul_f32 v157, v157, v219
mT 124,64,140
wl 5
v_rcp_f32 v226, v226
mT 132,68,140
rd 64,1,57344
v_mul_f32 v154, v154, v226
mT 128,68,136
s_waitcnt vmcnt(22)
lx 188,3072
mT 80,72,144
s_waitcnt vmcnt(22)
s_add_u32 s23, s23, 14336
rd 68,1,58368
v_mul_f32 v158, v158, v219
mT 84,72,148
wl 5
v_rcp_f32 v227, v227
mT 92,76,148
s_add_u32 m0, s22, 145408
rd 72,1,59392
v_mul_f32 v155, v155, v227
mT 88,76,144
lw 0
mT 96,48,144
rd 76,1,60416
v_mul_f32 v159, v159, v219
mT 100,48,148
wl 5
v_mul_f32 v228, v156, v156
v_mul_f32 v229, v157, v157
mT 108,52,148
s_mul_i32 s24, s78, 8192
rd 48,1,61440
v_mul_f32 v230, v158, v158
mT 104,52,144
v_mul_f32 v231, v159, v159
v_fma_f32 v228, v228, s43, v30
mT 112,56,144
s_add_u32 s24, s24, s35
rd 52,1,62464
v_fma_f32 v229, v229, s43, v30
mT 116,56,148
wl 5
v_fma_f32 v230, v230, s43, v30
v_fma_f32 v231, v231, s43, v30
mT 124,60,148
s_add_u32 s24, s24, 49152
rd 56,1,63488
v_mul_f32 v228, v228, v156
mT 120,60,144
lx 192,0
mT 128,64,144
rd 60,1,64512
v_mul_f32 v229, v229, v157
mT 132,64,148
s_waitcnt vmcnt(18) lgkmcnt(5)
s_barrier
v_mul_f32 v230, v230, v158
mT 84,68,156
rd 64,0,59392
v_mul_f32 v231, v231, v159
mT 80,68,152
lx 196,1024
mT 88,72,152
rd 68,0,60416
v_fmac_f32 v160, v216, v236
mT 92,72,156
wl 5
v_exp_f32 v228, v228
mT 100,76,156
rd 72,0,61440
v_add_f32 v228, 1.0, v228
mT 96,76,152
lw 1024
mT 104,48,152
rd 76,0,62464
v_fmac_f32 v161, v216, v237
mT 108,48,156
wl 5
v_exp_f32 v229, v229
mT 116,52,156
rd 48,0,63488
v_add_f32 v229, 1.0, v229
mT 112,52,152
lw 2048
mT 120,56,152
rd 52,0,64512
v_fmac_f32 v162, v216, v238
mT 124,56,156
wl 5
v_exp_f32 v230, v230
mT 132,60,156
rd 56,1,0
v_add_f32 v230, 1.0, v230
mT 128,60,152
s_waitcnt vmcnt(20)
s_mov_b32 exec_hi, 0
lw 3072
s_mov_b32 exec_hi, -1
mT 80,64,160
s_waitcnt vmcnt(20)
rd 60,1,1024
v_fmac_f32 v163, v216, v239
mT 84,64,164
wl 5
v_exp_f32 v231, v231
mT 92,68,164
rd 64,1,2048
v_add_f32 v231, 1.0, v231
mT 88,68,160
lx 200,2048
mT 96,72,160
rd 68,1,3072
v_mul_f32 v160, v160, v217
mT 100,72,164
wl 5
v_rcp_f32 v228, v228
mT 108,76,164
rd 72,1,4096
v_mul_f32 v156, v156, v228
mT 104,76,160
lx 204,3072
mT 112,48,160
s_add_u32 s24, s24, 4096
rd 76,1,5120
v_mul_f32 v161, v161, v217
mT 116,48,164
wl 5
v_rcp_f32 v229, v229
mT 124,52,164
rd 48,1,6144
v_mul_f32 v157, v157, v229
mT 120,52,160
lx 208,0
mT 128,56,160
rd 52,1,7168
v_mul_f32 v162, v162, v217
mT 132,56,164
s_waitcnt vmcnt(17) lgkmcnt(5)
s_barrier
v_mul_f32 v163, v163, v217
mT 84,60,172
rd 56,1,8192
v_mul_f32 v220, v160, v160
mT 80,60,168
lx 212,1024
mT 88,64,168
rd 60,1,9216
v_mul_f32 v221, v161, v161
mT 92,64,172
wl 5
v_rcp_f32 v230, v230
mT 100,68,172
s_min_i32 s23, s79, 0
rd 64,1,10240
v_mul_f32 v158, v158, v230
mT 96,68,168
v_rcp_f32 v231, v231
mT 104,72,168
s_mul_i32 s23, s23, 28672
rd 68,1,11264
v_mul_f32 v159, v159, v231
mT 108,72,172
wl 5
v_mul_f32 v222, v162, v162
v_mul_f32 v223, v163, v163
mT 116,76,172
s_add_u32 s23, s23, s73
rd 72,1,12288
v_fma_f32 v220, v220, s43, v30
mT 112,76,168
v_fma_f32 v221, v221, s43, v30
v_fma_f32 v222, v222, s43, v30
mT 120,48,168
s_add_u32 s23, s23, 200704
rd 76,1,13312
v_fma_f32 v223, v223, s43, v30
mT 124,48,172
wl 5
v_mul_f32 v220, v220, v160
v_mul_f32 v221, v221, v161
mT 132,52,172
s_add_u32 m0, s22, 16384
rd 48,1,14336
v_mul_f32 v222, v222, v162
mT 128,52,168
s_waitcnt vmcnt(17)
lw 0
mT 80,56,176
s_waitcnt vmcnt(17)
rd 52,1,15360
v_mul_f32 v223, v223, v163
mT 84,56,180
wl 5
lw 1024
mT 92,60,180
rd 56,1,16384
v_fmac_f32 v164, v218, v236
mT 88,60,176
v_exp_f32 v220, v220
mT 96,64,176
rd 60,1,17408
v_add_f32 v220, 1.0, v220
mT 100,64,180
wl 5
lw 2048
mT 108,68,180
rd 64,1,18432
v_fmac_f32 v165, v218, v237
mT 104,68,176
v_exp_f32 v221, v221
mT 112,72,176
rd 68,1,19456
v_add_f32 v221, 1.0, v221
mT 116,72,180
wl 5
s_mov_b32 exec_hi, 0
lw 3072
s_mov_b32 exec_hi, -1
mT 124,76,180
rd 72,1,20480
v_fmac_f32 v166, v218, v238
mT 120,76,176
v_exp_f32 v222, v222
mT 128,48,176
rd 76,1,21504
v_add_f32 v222, 1.0, v222
mT 132,48,180
s_waitcnt vmcnt(14) lgkmcnt(5)
s_barrier
v_fmac_f32 v167, v218, v239
mT 84,52,188
rd 48,29,0
v_mul_f32 v164, v164, v219
mT 80,52,184
lx 216,2048
mT 88,56,184
rd 52,29,1024
v_mul_f32 v165, v165, v219
mT 92,56,188
wl 5
lx 220,3072
mT 100,60,188
s_add_u32 s23, s23, 14336
rd 56,29,2048
v_mul_f32 v166, v166, v219
mT 96,60,184
v_exp_f32 v223, v223
mT 104,64,184
s_add_u32 m0, s22, 30720
rd 60,29,3072
v_add_f32 v223, 1.0, v223
mT 108,64,188
wl 5
lw 0
mT 116,68,188
s_min_i32 s24, s79, 0
rd 64,29,4096
v_mul_f32 v167, v167, v219
mT 112,68,184
v_rcp_f32 v220, v220
mT 120,72,184
s_mul_i32 s24, s24, 8192
rd 68,29,5120
v_mul_f32 v160, v160, v220
mT 124,72,188
wl 5
v_rcp_f32 v221, v221
mT 132,76,188
s_add_u32 s24, s24, s35
rd 72,29,6144
v_mul_f32 v161, v161, v221
mT 128,76,184
s_waitcnt vmcnt(15)
v_rcp_f32 v222, v222
mT 80,48,192
s_waitcnt vmcnt(14)
s_add_u32 s24, s24, 57344
rd 76,29,7168
v_mul_f32 v162, v162, v222
mT 84,48,196
wl 5
lx 224,0
mT 92,52,196
rd 48,29,8192
v_mul_f32 v224, v164, v164
mT 88,52,192
lx 228,1024
mT 96,56,192
rd 52,29,9216
v_mul_f32 v225, v165, v165
mT 100,56,196
wl 5
v_rcp_f32 v223, v223
mT 108,60,196
rd 56,29,10240
v_mul_f32 v163, v163, v223
mT 104,60,192
lw 1024
mT 112,64,192
rd 60,29,11264
v_mul_f32 v226, v166, v166
mT 116,64,196
v_mul_f32 v227, v167, v167
main_cp26:
s_mov_b32 s96, main_cp26-main_cp25
v_lshl_add_u64 v[2:3], v[2:3], 0, s[96:97]
global_load_dword v254, v[2:3], off
v_fma_f32 v224, v224, s43, v30
wl 5
mT 124,68,196
rd 64,29,12288
v_fma_f32 v225, v225, s43, v30
mT 120,68,192
lw 2048
mT 128,72,192
rd 68,29,13312
v_fma_f32 v226, v226, s43, v30
mT 132,72,196
s_waitcnt vmcnt(14) lgkmcnt(5)
s_barrier
v_fma_f32 v227, v227, s43, v30
mT 84,76,204
rd 72,29,14336
v_mul_f32 v224, v224, v164
mT 80,76,200
s_mov_b32 exec_hi, 0
lw 3072
s_mov_b32 exec_hi, -1
mT 88,48,200
rd 76,29,15360
v_mul_f32 v225, v225, v165
mT 92,48,204
wl 5
v_exp_f32 v224, v224
mT 100,52,204
rd 48,29,16384
v_mul_f32 v226, v226, v166
mT 96,52,200
lx 232,2048
mT 104,56,200
rd 52,29,17408
v_mul_f32 v227, v227, v167
mT 108,56,204
wl 5
v_exp_f32 v225, v225
mT 116,60,204
rd 56,29,18432
v_add_f32 v224, 1.0, v224
mT 112,60,200
lx 236,3072
mT 120,64,200
s_add_u32 s24, s24, 4096
rd 60,29,19456
v_add_f32 v225, 1.0, v225
mT 124,64,204
wl 5
v_exp_f32 v226, v226
mT 132,68,204
rd 64,29,20480
v_add_f32 v226, 1.0, v226
mT 128,68,200
s_waitcnt vmcnt(16)
lx 240,0
mT 80,72,208
s_waitcnt vmcnt(16)
rd 68,29,21504
mT 84,72,212
wl 5
v_exp_f32 v227, v227
mT 92,76,212
s_max_i32 s23, s76, 0
rd 72,29,22528
v_add_f32 v227, 1.0, v227
mT 88,76,208
lx 244,1024
mT 96,48,208
s_mul_i32 s23, s23, 28672
rd 76,29,23552
mT 100,48,212
wl 5
v_rcp_f32 v224, v224
mT 108,52,212
s_add_u32 s23, s23, s28
rd 48,29,24576
v_mul_f32 v164, v164, v224
mT 104,52,208
v_rcp_f32 v225, v225
mT 112,56,208
s_add_u32 s23, s23, 0
rd 52,29,25600
v_mul_f32 v165, v165, v225
mT 116,56,212
wl 5
v_rcp_f32 v226, v226
mT 124,60,212
s_add_u32 m0, s22, 45056
rd 56,29,26624
v_mul_f32 v166, v166, v226
mT 120,60,208
lw 0
mT 128,64,208
rd 60,29,27648
mT 132,64,212
s_waitcnt vmcnt(12) lgkmcnt(5)
s_barrier
mT 84,68,220
rd 64,0,16384
mT 80,68,216
lw 1024
mT 88,72,216
rd 68,0,17408
mT 92,72,220
wl 5
lw 2048
mT 100,76,220
rd 72,0,18432
mT 96,76,216
s_mov_b32 exec_hi, 0
lw 3072
s_mov_b32 exec_hi, -1
mT 104,48,216
rd 76,0,19456
mT 108,48,220
wl 5
v_rcp_f32 v227, v227
mT 116,52,220
rd 48,0,20480
v_mul_f32 v167, v167, v227
mT 112,52,216
lx 248,2048
mT 120,56,216
rd 52,0,21504
mT 124,56,220
wl 5
lx 252,3072
mT 132,60,220
s_add_u32 s23, s23, 14336
rd 56,0,22528
mT 128,60,216
s_waitcnt vmcnt(15)
rd 232,12,1472
mT 80,64,224
s_waitcnt vmcnt(14)
s_add_u32 m0, s22, 88064
rd 60,0,23552
mT 84,64,228
wl 6
lw 0
mT 92,68,228
rd 64,0,24576
mT 88,68,224
rd 236,12,1536
mT 96,72,224
rd 68,0,25600
mT 100,72,228
wl 7
lw 1024
mT 108,76,228
rd 72,0,26624
mT 104,76,224
mT 112,48,224
rd 76,0,27648
mT 116,48,228
wl 6
v_fmac_f32 v168, v216, v232
v_fmac_f32 v169, v216, v233
mT 124,52,228
rd 48,0,28672
v_fmac_f32 v170, v216, v234
mT 120,52,224
lw 2048
mT 128,56,224
rd 52,0,29696
v_fmac_f32 v171, v216, v235
mT 132,56,228
s_waitcnt vmcnt(11) lgkmcnt(6)
s_barrier
v_mul_f32 v168, v168, v217
mT 84,60,236
rd 56,0,30720
v_mul_f32 v169, v169, v217
mT 80,60,232
s_mov_b32 exec_hi, 0
lw 3072
s_mov_b32 exec_hi, -1
mT 88,64,232
s_mul_i32 s23, s77, 28672
rd 60,0,31744
v_mul_f32 v170, v170, v217
mT 92,64,236
wl 5
v_mul_f32 v171, v171, v217
v_mul_f32 v228, v168, v168
mT 100,68,236
s_add_u32 s23, s23, s28
rd 64,0,32768
v_mul_f32 v229, v169, v169
mT 96,68,232
v_mul_f32 v230, v170, v170
v_mul_f32 v231, v171, v171
mT 104,72,232
s_add_u32 s23, s23, 28672
rd 68,0,33792
v_fma_f32 v228, v228, s43, v30
mT 108,72,236
wl 5
v_fma_f32 v229, v229, s43, v30
v_fma_f32 v230, v230, s43, v30
mT 116,76,236
s_add_u32 m0, s22, 2048
rd 72,0,34816
v_fma_f32 v231, v231, s43, v30
mT 112,76,232
lw 0
mT 120,48,232
rd 76,0,35840
v_mul_f32 v228, v228, v168
mT 124,48,236
wl 5
v_exp_f32 v228, v228
mT 132,52,236
rd 48,0,36864
v_mul_f32 v229, v229, v169
mT 128,52,232
s_waitcnt vmcnt(12)
lw 1024
mT 80,56,240
s_waitcnt vmcnt(12)
rd 52,0,37888
v_mul_f32 v230, v230, v170
mT 84,56,244
wl 5
v_exp_f32 v229, v229
mT 92,60,244
rd 56,0,38912
v_mul_f32 v231, v231, v171
mT 88,60,240
lw 2048
mT 96,64,240
rd 60,0,39936
v_add_f32 v228, 1.0, v228
mT 100,64,244
wl 5
v_exp_f32 v230, v230
mT 108,68,244
rd 64,0,40960
v_add_f32 v229, 1.0, v229
mT 104,68,240
v_exp_f32 v231, v231
mT 112,72,240
rd 68,0,41984
v_add_f32 v230, 1.0, v230
mT 116,72,244
wl 5
s_mov_b32 exec_hi, 0
lw 3072
s_mov_b32 exec_hi, -1
mT 124,76,244
s_add_u32 s23, s23, 14336
rd 72,0,43008
v_add_f32 v231, 1.0, v231
mT 120,76,240
v_rcp_f32 v228, v228
mT 128,48,240
s_add_u32 m0, s22, 102400
rd 76,0,44032
v_mul_f32 v168, v168, v228
mT 132,48,244
s_waitcnt vmcnt(8) lgkmcnt(5)
s_barrier
v_fmac_f32 v172, v218, v232
mT 84,52,252
rd 48,0,45056
v_fmac_f32 v173, v218, v233
mT 80,52,248
lw 0
mT 88,56,248
rd 52,0,46080
v_fmac_f32 v174, v218, v234
mT 92,56,252
wl 5
v_rcp_f32 v229, v229
mT 100,60,252
rd 56,0,47104
v_mul_f32 v169, v169, v229
mT 96,60,248
lw 1024
mT 104,64,248
rd 60,0,48128
v_fmac_f32 v175, v218, v235
mT 108,64,252
wl 5
v_rcp_f32 v230, v230
mT 116,68,252
rd 64,0,49152
v_mul_f32 v170, v170, v230
mT 112,68,248
lw 2048
mT 120,72,248
rd 68,0,50176
v_mul_f32 v172, v172, v219
mT 124,72,252
wl 5
v_rcp_f32 v231, v231
mT 132,76,252
rd 72,0,51200
v_mul_f32 v171, v171, v231
mT 128,76,248
s_mov_b32 exec_hi, 0
lw 3072
s_mov_b32 exec_hi, -1
s_mul_i32 s23, s78, 28672
s_add_u32 s23, s23, s28
s_add_u32 s23, s23, 57344
s_add_u32 m0, s22, 116736
s_nop 0
lw 0
v_cvt_pk_bf16_f32 v200, v80, v81
v_cvt_pk_bf16_f32 v201, v82, v83
v_cvt_pk_bf16_f32 v202, v88, v89
v_cvt_pk_bf16_f32 v203, v90, v91
v_cvt_pk_bf16_f32 v204, v84, v85
v_cvt_pk_bf16_f32 v205, v86, v87
v_cvt_pk_bf16_f32 v206, v92, v93
v_cvt_pk_bf16_f32 v207, v94, v95
v_cvt_pk_bf16_f32 v208, v96, v97
v_cvt_pk_bf16_f32 v209, v98, v99
v_cvt_pk_bf16_f32 v210, v104, v105
v_cvt_pk_bf16_f32 v211, v106, v107
v_cvt_pk_bf16_f32 v212, v100, v101
v_cvt_pk_bf16_f32 v213, v102, v103
v_cvt_pk_bf16_f32 v214, v108, v109
v_cvt_pk_bf16_f32 v215, v110, v111
v_cvt_pk_bf16_f32 v240, v112, v113
v_cvt_pk_bf16_f32 v241, v114, v115
v_cvt_pk_bf16_f32 v242, v120, v121
v_cvt_pk_bf16_f32 v243, v122, v123
v_cvt_pk_bf16_f32 v244, v116, v117
v_cvt_pk_bf16_f32 v245, v118, v119
v_cvt_pk_bf16_f32 v246, v124, v125
v_cvt_pk_bf16_f32 v247, v126, v127
v_cvt_pk_bf16_f32 v248, v128, v129
v_cvt_pk_bf16_f32 v249, v130, v131
v_cvt_pk_bf16_f32 v250, v132, v133
v_cvt_pk_bf16_f32 v251, v134, v135
v_mfma_f32_16x16x32_bf16 v[80:83], v[48:51], a[0:3], v[192:195]
rd 76,0,52224
v_mul_f32 v173, v173, v219
v_mfma_f32_16x16x32_bf16 v[84:87], v[48:51], a[4:7], v[196:199]
wl 5
lw 1024
v_mfma_f32_16x16x32_bf16 v[92:95], v[52:55], a[4:7], v[196:199]
s_mov_b32 s37, s74
rd 48,0,53248
v_mul_f32 v174, v174, v219
v_mfma_f32_16x16x32_bf16 v[88:91], v[52:55], a[0:3], v[192:195]
buffer_store_dwordx4 v[200:203], v0, s[4:7], s37 offen offset:0 sc1
v_mfma_f32_16x16x32_bf16 v[96:99], v[56:59], a[0:3], v[192:195]
rd 52,0,54272
v_mul_f32 v175, v175, v219
v_mfma_f32_16x16x32_bf16 v[100:103], v[56:59], a[4:7], v[196:199]
wl 5
v_mul_f32 v220, v172, v172
v_mul_f32 v221, v173, v173
v_mfma_f32_16x16x32_bf16 v[108:111], v[60:63], a[4:7], v[196:199]
rd 56,0,55296
v_mul_f32 v222, v174, v174
v_mfma_f32_16x16x32_bf16 v[104:107], v[60:63], a[0:3], v[192:195]
lw 2048
v_mfma_f32_16x16x32_bf16 v[112:115], v[64:67], a[0:3], v[192:195]
rd 60,0,56320
v_mul_f32 v223, v175, v175
v_mfma_f32_16x16x32_bf16 v[116:119], v[64:67], a[4:7], v[196:199]
wl 5
v_fma_f32 v220, v220, s43, v30
v_fma_f32 v221, v221, s43, v30
v_mfma_f32_16x16x32_bf16 v[124:127], v[68:71], a[4:7], v[196:199]
rd 64,0,57344
v_fma_f32 v222, v222, s43, v30
v_mfma_f32_16x16x32_bf16 v[120:123], v[68:71], a[0:3], v[192:195]
s_mov_b32 exec_hi, 0
lw 3072
s_mov_b32 exec_hi, -1
v_mfma_f32_16x16x32_bf16 v[128:131], v[72:75], a[0:3], v[192:195]
s_add_u32 s23, s23, 14336
rd 68,0,58368
v_fma_f32 v223, v223, s43, v30
v_mfma_f32_16x16x32_bf16 v[132:135], v[72:75], a[4:7], v[196:199]
s_waitcnt lgkmcnt(5) vmcnt(13)
s_barrier
v_mul_f32 v220, v220, v172
mT 84,76,12
s_add_u32 m0, s22, 59392
rd 72,1,22528
v_mul_f32 v221, v221, v173
mT 80,76,8
lw 0
mT 88,48,8
rd 76,1,23552
v_mul_f32 v222, v222, v174
mT 92,48,12
wl 5
buffer_store_dwordx4 v[204:207], v0, s[4:7], s37 offen offset:1024 sc1
mT 100,52,12
rd 48,1,24576
v_mul_f32 v223, v223, v175
mT 96,52,8
v_exp_f32 v220, v220
mT 104,56,8
rd 52,1,25600
v_add_f32 v220, 1.0, v220
mT 108,56,12
wl 5
lw 1024
mT 116,60,12
rd 56,1,26624
v_fmac_f32 v176, v216, v236
mT 112,60,8
v_exp_f32 v221, v221
mT 120,64,8
rd 60,1,27648
v_add_f32 v221, 1.0, v221
mT 124,64,12
wl 5
lw 2048
mT 132,68,12
rd 64,1,28672
v_fmac_f32 v177, v216, v237
mT 128,68,8
buffer_store_dwordx4 v[208:211], v0, s[4:7], s37 offen offset:2048 sc1
mT 80,72,16
rd 68,1,29696
v_fmac_f32 v178, v216, v238
mT 84,72,20
wl 5
s_mov_b32 exec_hi, 0
lw 3072
s_mov_b32 exec_hi, -1
mT 92,76,20
rd 72,1,30720
v_fmac_f32 v179, v216, v239
mT 88,76,16
v_exp_f32 v222, v222
mT 96,48,16
rd 76,1,31744
v_add_f32 v222, 1.0, v222
mT 100,48,20
wl 5
v_exp_f32 v223, v223
mT 108,52,20
rd 48,1,32768
v_add_f32 v223, 1.0, v223
mT 104,52,16
v_rcp_f32 v220, v220
mT 112,56,16
rd 52,1,33792
v_mul_f32 v172, v172, v220
mT 116,56,20
wl 5
buffer_store_dwordx4 v[212:215], v0, s[4:7], s37 offen offset:3072 sc1
mT 124,60,20
rd 56,1,34816
v_mul_f32 v176, v176, v217
mT 120,60,16
v_rcp_f32 v221, v221
mT 128,64,16
rd 60,1,35840
v_mul_f32 v173, v173, v221
mT 132,64,20
s_waitcnt lgkmcnt(5) vmcnt(16)
s_barrier
v_mul_f32 v177, v177, v217
mT 84,68,28
rd 64,0,2048
v_mul_f32 v178, v178, v217
mT 80,68,24
v_rcp_f32 v222, v222
mT 88,72,24
rd 68,0,3072
v_mul_f32 v174, v174, v222
mT 92,72,28
wl 5
v_rcp_f32 v223, v223
mT 100,76,28
rd 72,0,4096
v_mul_f32 v175, v175, v223
mT 96,76,24
v_mul_f32 v179, v179, v217
v_mul_f32 v224, v176, v176
mT 104,48,24
s_add_u32 s37, s37, 4096
rd 76,0,5120
v_mul_f32 v225, v177, v177
mT 108,48,28
wl 5
buffer_store_dwordx4 v[240:243], v0, s[4:7], s37 offen offset:0 sc1
mT 116,52,28
rd 48,0,6144
v_mul_f32 v226, v178, v178
mT 112,52,24
v_mul_f32 v227, v179, v179
v_fma_f32 v224, v224, s43, v30
mT 120,56,24
rd 52,0,7168
v_fma_f32 v225, v225, s43, v30
mT 124,56,28
wl 5
v_fma_f32 v226, v226, s43, v30
v_fma_f32 v227, v227, s43, v30
mT 132,60,28
rd 56,0,8192
v_mul_f32 v224, v224, v176
mT 128,60,24
v_exp_f32 v224, v224
mT 80,64,32
rd 60,0,9216
v_mul_f32 v225, v225, v177
mT 84,64,36
wl 5
v_exp_f32 v225, v225
mT 92,68,36
rd 64,0,10240
v_mul_f32 v226, v226, v178
mT 88,68,32
buffer_store_dwordx4 v[244:247], v0, s[4:7], s37 offen offset:1024 sc1
mT 96,72,32
rd 68,0,11264
v_mul_f32 v227, v227, v179
mT 100,72,36
wl 5
v_exp_f32 v226, v226
mT 108,76,36
rd 72,0,12288
v_add_f32 v224, 1.0, v224
mT 104,76,32
v_exp_f32 v227, v227
mT 112,48,32
rd 76,0,13312
v_add_f32 v225, 1.0, v225
mT 116,48,36
wl 5
v_rcp_f32 v224, v224
mT 124,52,36
rd 48,0,14336
v_add_f32 v226, 1.0, v226
mT 120,52,32
v_rcp_f32 v225, v225
mT 128,56,32
rd 52,0,15360
v_add_f32 v227, 1.0, v227
mT 132,56,36
s_waitcnt lgkmcnt(5) vmcnt(14)
s_barrier
v_mul_f32 v176, v176, v224
mT 84,60,44
s_xor_b32 s37, s75, 1024
rd 56,1,36864
v_mul_f32 v177, v177, v225
mT 80,60,40
buffer_store_dwordx4 v[248:251], v0, s[4:7], s37 offen offset:0 sc1
mT 88,64,40
rd 60,1,37888
v_fmac_f32 v180, v218, v236
mT 92,64,44
wl 5
v_rcp_f32 v226, v226
mT 100,68,44
rd 64,1,38912
v_mul_f32 v178, v178, v226
mT 96,68,40
v_rcp_f32 v227, v227
mT 104,72,40
rd 68,1,39936
v_mul_f32 v179, v179, v227
mT 108,72,44
wl 5
v_fmac_f32 v181, v218, v237
v_fmac_f32 v182, v218, v238
mT 116,76,44
s_mul_i32 s23, s79, 28672
rd 72,1,40960
v_fmac_f32 v183, v218, v239
mT 112,76,40
v_mul_f32 v180, v180, v219
v_mul_f32 v181, v181, v219
mT 120,48,40
s_add_u32 s23, s23, s28
rd 76,1,41984
v_mul_f32 v182, v182, v219
mT 124,48,44
wl 5
v_mul_f32 v183, v183, v219
v_mul_f32 v228, v180, v180
mT 132,52,44
s_add_u32 s23, s23, 86016
rd 48,1,43008
v_mul_f32 v229, v181, v181
mT 128,52,40
v_mul_f32 v230, v182, v182
v_mul_f32 v231, v183, v183
mT 80,56,48
s_add_u32 m0, s22, 73728
rd 52,1,44032
v_fma_f32 v228, v228, s43, v30
mT 84,56,52
wl 5
lw 0
mT 92,60,52
rd 56,1,45056
v_fma_f32 v229, v229, s43, v30
mT 88,60,48
v_fma_f32 v230, v230, s43, v30
v_fma_f32 v231, v231, s43, v30
mT 96,64,48
rd 60,1,46080
v_mul_f32 v228, v228, v180
mT 100,64,52
wl 5
lw 1024
mT 108,68,52
rd 64,1,47104
v_mul_f32 v229, v229, v181
mT 104,68,48
v_exp_f32 v228, v228
mT 112,72,48
rd 68,1,48128
v_mul_f32 v230, v230, v182
mT 116,72,52
wl 5
lw 2048
mT 124,76,52
rd 72,1,49152
v_mul_f32 v231, v231, v183
mT 120,76,48
v_exp_f32 v229, v229
mT 128,48,48
rd 76,1,50176
v_add_f32 v228, 1.0, v228
mT 132,48,52
s_waitcnt lgkmcnt(5) vmcnt(13)
s_barrier
v_add_f32 v229, 1.0, v229
mT 84,52,60
rd 48,1,51200
mT 80,52,56
s_mov_b32 exec_hi, 0
lw 3072
s_mov_b32 exec_hi, -1
mT 88,56,56
s_add_u32 s23, s23, 14336
rd 52,1,52224
mT 92,56,60
wl 5
v_exp_f32 v230, v230
mT 100,60,60
s_add_u32 m0, s22, 131072
rd 56,1,53248
v_add_f32 v230, 1.0, v230
mT 96,60,56
lw 0
mT 104,64,56
rd 60,1,54272
mT 108,64,60
wl 5
v_exp_f32 v231, v231
mT 116,68,60
rd 64,1,55296
v_add_f32 v231, 1.0, v231
mT 112,68,56
lw 1024
mT 120,72,56
rd 68,1,56320
mT 124,72,60
wl 5
v_rcp_f32 v228, v228
mT 132,76,60
rd 72,1,57344
v_mul_f32 v180, v180, v228
mT 128,76,56
v_rcp_f32 v229, v229
mT 80,48,64
rd 76,1,58368
v_mul_f32 v181, v181, v229
mT 84,48,68
wl 5
lw 2048
mT 92,52,68
rd 48,1,59392
mT 88,52,64
v_rcp_f32 v230, v230
mT 96,56,64
rd 52,1,60416
v_mul_f32 v182, v182, v230
mT 100,56,68
wl 5
s_mov_b32 exec_hi, 0
lw 3072
s_mov_b32 exec_hi, -1
mT 108,60,68
rd 56,1,61440
mT 104,60,64
v_rcp_f32 v231, v231
mT 112,64,64
s_mul_i32 s23, s76, 28672
rd 60,1,62464
v_mul_f32 v183, v183, v231
mT 116,64,68
wl 5
rd 232,12,1600
mT 124,68,68
s_add_u32 s23, s23, s28
rd 64,1,63488
mT 120,68,64
mT 128,72,64
s_add_u32 s23, s23, 114688
rd 68,1,64512
mT 132,72,68
s_waitcnt lgkmcnt(6) vmcnt(12)
s_barrier
mT 84,76,76
s_add_u32 m0, s22, 145408
rd 72,0,59392
mT 80,76,72
lw 0
mT 88,48,72
wl 3
rd 76,0,60416
v_fmac_f32 v184, v216, v232
mT 92,48,76
v_fmac_f32 v185, v216, v233
v_fmac_f32 v186, v216, v234
mT 100,52,76
rd 48,0,61440
v_fmac_f32 v187, v216, v235
mT 96,52,72
lw 1024
mT 104,56,72
rd 52,0,62464
v_mul_f32 v184, v184, v217
mT 108,56,76
v_mul_f32 v185, v185, v217
v_mul_f32 v186, v186, v217
mT 116,60,76
rd 56,0,63488
v_mul_f32 v187, v187, v217
mT 112,60,72
wl 5
lw 2048
mT 120,64,72
rd 60,0,64512
v_mul_f32 v220, v184, v184
mT 124,64,76
v_mul_f32 v221, v185, v185
v_mul_f32 v222, v186, v186
mT 132,68,76
rd 64,1,0
v_mul_f32 v223, v187, v187
mT 128,68,72
wl 5
v_fma_f32 v220, v220, s43, v30
v_fma_f32 v221, v221, s43, v30
mT 80,72,80
rd 68,1,1024
v_fma_f32 v222, v222, s43, v30
mT 84,72,84
s_mov_b32 exec_hi, 0
lw 3072
s_mov_b32 exec_hi, -1
mT 92,76,84
s_add_u32 s23, s23, 14336
rd 72,1,2048
v_fma_f32 v223, v223, s43, v30
mT 88,76,80
wl 5
v_mul_f32 v220, v220, v184
v_mul_f32 v221, v221, v185
mT 96,48,80
s_add_u32 m0, s22, 16384
rd 76,1,3072
v_mul_f32 v222, v222, v186
mT 100,48,84
lw 0
mT 108,52,84
rd 48,1,4096
v_mul_f32 v223, v223, v187
mT 104,52,80
wl 5
v_exp_f32 v220, v220
mT 112,56,80
rd 52,1,5120
v_add_f32 v220, 1.0, v220
mT 116,56,84
lw 1024
mT 124,60,84
rd 56,1,6144
v_fmac_f32 v188, v218, v232
mT 120,60,80
wl 5
v_exp_f32 v221, v221
mT 128,64,80
s_waitcnt vmcnt(14)
s_mov_b32 s36, s3
rd 60,1,7168
v_mov_b32 v31, 1
mT 132,64,84
s_waitcnt vmcnt(10)
s_barrier
v_add_f32 v221, 1.0, v221
mT 84,68,92
rd 64,1,8192
v_fmac_f32 v189, v218, v233
mT 80,68,88
wl 5
lw 2048
mT 88,72,88
rd 68,1,9216
v_fmac_f32 v190, v218, v234
mT 92,72,92
buffer_atomic_add v31, v4, s[4:7], s36 offen sc1
mT 100,76,92
rd 72,1,10240
v_fmac_f32 v191, v218, v235
mT 96,76,88
wl 5
s_mov_b32 exec_hi, 0
lw 3072
s_mov_b32 exec_hi, -1
mT 104,48,88
rd 76,1,11264
v_mul_f32 v188, v188, v219
mT 108,48,92
v_exp_f32 v222, v222
mT 116,52,92
s_mul_i32 s23, s77, 28672
rd 48,1,12288
v_add_f32 v222, 1.0, v222
mT 112,52,88
wl 5
v_exp_f32 v223, v223
mT 120,56,88
s_add_u32 s23, s23, s28
rd 52,1,13312
v_add_f32 v223, 1.0, v223
mT 124,56,92
v_rcp_f32 v220, v220
mT 132,60,92
s_add_u32 s23, s23, 143360
rd 56,1,14336
v_mul_f32 v184, v184, v220
mT 128,60,88
wl 5
v_rcp_f32 v221, v221
mT 80,64,96
s_add_u32 m0, s22, 30720
rd 60,1,15360
v_mul_f32 v185, v185, v221
mT 84,64,100
lw 0
mT 92,68,100
rd 64,1,16384
v_mul_f32 v189, v189, v219
mT 88,68,96
wl 5
v_rcp_f32 v222, v222
mT 96,72,96
rd 68,1,17408
v_mul_f32 v186, v186, v222
mT 100,72,100
lw 1024
mT 108,76,100
rd 72,1,18432
v_mul_f32 v190, v190, v219
mT 104,76,96
wl 5
v_rcp_f32 v223, v223
mT 112,48,96
rd 76,1,19456
v_mul_f32 v187, v187, v223
mT 116,48,100
lw 2048
mT 124,52,100
rd 48,1,20480
v_mul_f32 v191, v191, v219
mT 120,52,96
wl 5
v_mul_f32 v224, v188, v188
v_mul_f32 v225, v189, v189
mT 128,56,96
rd 52,1,21504
v_mul_f32 v226, v190, v190
mT 132,56,100
s_waitcnt vmcnt(12)
s_barrier
v_mul_f32 v227, v191, v191
mT 84,60,108
rd 56,29,0
v_fma_f32 v224, v224, s43, v30
mT 80,60,104
wl 5
s_mov_b32 exec_hi, 0
lw 3072
s_mov_b32 exec_hi, -1
mT 88,64,104
s_add_u32 s23, s23, 14336
rd 60,29,1024
v_fma_f32 v225, v225, s43, v30
mT 92,64,108
v_fma_f32 v226, v226, s43, v30
v_fma_f32 v227, v227, s43, v30
mT 100,68,108
s_add_u32 m0, s22, 45056
rd 64,29,2048
v_mul_f32 v224, v224, v188
mT 96,68,104
wl 5
lw 0
mT 104,72,104
rd 68,29,3072
v_mov_b32 v31, 0
mT 108,72,108
buffer_atomic_add v31, v4, s[4:7], s36 offen sc0 sc1
mT 116,76,108
rd 72,29,4096
v_mul_f32 v225, v225, v189
mT 112,76,104
wl 5
lw 1024
mT 120,48,104
rd 76,29,5120
v_mul_f32 v226, v226, v190
mT 124,48,108
v_exp_f32 v224, v224
mT 132,52,108
rd 48,29,6144
v_mul_f32 v227, v227, v191
mT 128,52,104
wl 5
v_exp_f32 v225, v225
mT 80,56,112
rd 52,29,7168
v_add_f32 v224, 1.0, v224
mT 84,56,116
lw 2048
mT 92,60,116
rd 56,29,8192
v_add_f32 v225, 1.0, v225
mT 88,60,112
wl 5
v_exp_f32 v226, v226
mT 96,64,112
rd 60,29,9216
v_add_f32 v226, 1.0, v226
mT 100,64,116
s_mov_b32 exec_hi, 0
lw 3072
s_mov_b32 exec_hi, -1
mT 108,68,116
rd 64,29,10240
mT 104,68,112
wl 5
v_exp_f32 v227, v227
mT 112,72,112
s_mul_i32 s23, s78, 28672
rd 68,29,11264
v_add_f32 v227, 1.0, v227
mT 116,72,116
v_rcp_f32 v224, v224
mT 124,76,116
s_add_u32 s23, s23, s28
rd 72,29,12288
v_mul_f32 v188, v188, v224
mT 120,76,112
wl 5
v_rcp_f32 v225, v225
mT 128,48,112
s_add_u32 s23, s23, 172032
rd 76,29,13312
v_mul_f32 v189, v189, v225
mT 132,48,116
s_waitcnt vmcnt(14)
s_barrier
mT 84,52,124
s_add_u32 m0, s22, 88064
rd 48,29,14336
mT 80,52,120
wl 5
lw 0
mT 88,56,120
rd 52,29,15360
mT 92,56,124
v_rcp_f32 v226, v226
mT 100,60,124
rd 56,29,16384
v_mul_f32 v190, v190, v226
mT 96,60,120
wl 5
lw 1024
mT 104,64,120
rd 60,29,17408
mT 108,64,124
v_rcp_f32 v227, v227
mT 116,68,124
rd 64,29,18432
v_mul_f32 v191, v191, v227
mT 112,68,120
wl 5
lw 2048
mT 120,72,120
rd 68,29,19456
mT 124,72,124
mT 132,76,124
rd 72,29,20480
mT 128,76,120
wl 5
mT 80,48,128
rd 76,29,21504
mT 84,48,132
s_mov_b32 exec_hi, 0
lw 3072
s_mov_b32 exec_hi, -1
mT 92,52,132
s_add_u32 s23, s23, 14336
rd 48,29,22528
mT 88,52,128
wl 5
mT 96,56,128
s_add_u32 m0, s22, 2048
rd 52,29,23552
mT 100,56,132
lw 0
mT 108,60,132
rd 56,29,24576
mT 104,60,128
wl 5
mT 112,64,128
rd 60,29,25600
mT 116,64,132
lw 1024
mT 124,68,132
rd 64,29,26624
mT 120,68,128
wl 5
mT 128,72,128
rd 68,29,27648
mT 132,72,132
s_waitcnt vmcnt(15)
s_barrier
mT 84,76,140
rd 72,0,16384
mT 80,76,136
wl 5
lw 2048
mT 88,48,136
rd 76,0,17408
mT 92,48,140
mT 100,52,140
rd 48,0,18432
mT 96,52,136
wl 5
s_mov_b32 exec_hi, 0
lw 3072
s_mov_b32 exec_hi, -1
mT 104,56,136
rd 52,0,19456
mT 108,56,140
mT 116,60,140
s_min_i32 s23, s79, 0
rd 56,0,20480
mT 112,60,136
wl 5
mT 120,64,136
s_mul_i32 s23, s23, 28672
rd 60,0,21504
mT 124,64,140
mT 132,68,140
s_add_u32 s23, s23, s28
rd 64,0,22528
mT 128,68,136
s_waitcnt vmcnt(11)
v_readfirstlane_b32 s46, v31
s_nop 0
s_nop 0
s_cmp_ge_u32 s46, 2
s_cbranch_scc1 main_ok174
s_mov_b32 s47, 0
main_poll173:
v_mov_b32 v31, 0
buffer_atomic_add v31, v4, s[4:7], s36 offen sc0 sc1
s_add_u32 s47, s47, 1
s_cmp_gt_u32 s47, 400000
s_cbranch_scc1 main_ok174
s_waitcnt vmcnt(0)
v_readfirstlane_b32 s46, v31
s_nop 0
s_cmp_lt_u32 s46, 2
s_cbranch_scc1 main_poll173
main_ok174:
wl 5
mT 80,72,144
s_add_u32 s23, s23, 200704
rd 68,0,23552
mT 84,72,148
mT 92,76,148
s_add_u32 m0, s22, 102400
rd 72,0,24576
mT 88,76,144
wl 5
lw 0
mT 96,48,144
s_add_u32 s37, s58, 4096
rd 76,0,25600
mT 100,48,148
buffer_load_dwordx4 v[200:203], v0, s[4:7], s58 offen offset:0 sc1
mT 108,52,148
rd 48,0,26624
mT 104,52,144
wl 5
lw 1024
mT 112,56,144
rd 52,0,27648
mT 116,56,148
buffer_load_dwordx4 v[204:207], v0, s[4:7], s58 offen offset:1024 sc1
mT 124,60,148
rd 56,0,28672
mT 120,60,144
wl 5
lw 2048
mT 128,64,144
rd 60,0,29696
mT 132,64,148
s_barrier
mT 84,68,156
rd 64,0,30720
mT 80,68,152
wl 5
buffer_load_dwordx4 v[208:211], v0, s[4:7], s58 offen offset:2048 sc1
mT 88,72,152
rd 68,0,31744
mT 92,72,156
s_mov_b32 exec_hi, 0
lw 3072
s_mov_b32 exec_hi, -1
mT 100,76,156
s_add_u32 s23, s23, 14336
rd 72,0,32768
mT 96,76,152
wl 5
buffer_load_dwordx4 v[212:215], v0, s[4:7], s58 offen offset:3072 sc1
mT 104,48,152
s_add_u32 m0, s22, 116736
rd 76,0,33792
mT 108,48,156
lw 0
mT 116,52,156
rd 48,0,34816
mT 112,52,152
wl 5
buffer_load_dwordx4 v[240:243], v0, s[4:7], s37 offen offset:0 sc1
mT 120,56,152
rd 52,0,35840
mT 124,56,156
lw 1024
mT 132,60,156
rd 56,0,36864
mT 128,60,152
wl 5
buffer_load_dwordx4 v[244:247], v0, s[4:7], s37 offen offset:1024 sc1
mT 80,64,160
rd 60,0,37888
mT 84,64,164
mT 92,68,164
rd 64,0,38912
mT 88,68,160
wl 5
lw 2048
mT 96,72,160
rd 68,0,39936
mT 100,72,164
buffer_load_dwordx4 v[248:251], v0, s[4:7], s75 offen offset:0 sc1
mT 108,76,164
rd 72,0,40960
mT 104,76,160
wl 5
s_mov_b32 exec_hi, 0
lw 3072
s_mov_b32 exec_hi, -1
mT 112,48,160
rd 76,0,41984
mT 116,48,164
mT 124,52,164
s_max_i32 s23, s76, 0
rd 48,0,43008
mT 120,52,160
wl 5
mT 128,56,160
s_mul_i32 s23, s23, 16384
rd 52,0,44032
mT 132,56,164
s_waitcnt vmcnt(23)
s_barrier
mT 84,60,172
s_add_u32 s23, s23, s72
rd 56,0,45056
mT 80,60,168
wl 5
mT 88,64,168
s_add_u32 s23, s23, 0
rd 60,0,46080
mT 92,64,172
mT 100,68,172
s_add_u32 m0, s21, 65536
rd 64,0,47104
mT 96,68,168
wl 5
lw 0
mT 104,72,168
rd 68,0,48128
mT 108,72,172
mT 116,76,172
rd 72,0,49152
mT 112,76,168
wl 5
lw 1024
mT 120,48,168
rd 76,0,50176
mT 124,48,172
mT 132,52,172
rd 48,0,51200
mT 128,52,168
wl 5
lw 2048
mT 80,56,176
rd 52,0,52224
mT 84,56,180
mT 92,60,180
rd 56,0,53248
mT 88,60,176
wl 5
mT 96,64,176
rd 60,0,54272
mT 100,64,180
lw 3072
mT 108,68,180
s_mul_i32 s23, s77, 16384
rd 64,0,55296
mT 104,68,176
wl 5
mT 112,72,176
s_add_u32 s23, s23, s72
rd 68,0,56320
mT 116,72,180
mT 124,76,180
s_add_u32 s23, s23, 16384
rd 72,0,57344
mT 120,76,176
wl 5
mT 128,48,176
s_add_u32 m0, s21, 131072
rd 76,0,58368
mT 132,48,180
s_waitcnt vmcnt(23)
s_barrier
mT 84,52,188
rd 48,1,22528
mT 80,52,184
wl 5
lw 0
mT 88,56,184
rd 52,1,23552
mT 92,56,188
mT 100,60,188
rd 56,1,24576
mT 96,60,184
wl 5
lw 1024
mT 104,64,184
rd 60,1,25600
mT 108,64,188
mT 116,68,188
rd 64,1,26624
mT 112,68,184
wl 5
lw 2048
mT 120,72,184
rd 68,1,27648
mT 124,72,188
mT 132,76,188
rd 72,1,28672
mT 128,76,184
wl 5
mT 80,48,192
rd 76,1,29696
mT 84,48,196
lw 3072
mT 92,52,196
s_mul_i32 s23, s78, 16384
rd 48,1,30720
mT 88,52,192
wl 5
mT 96,56,192
s_add_u32 s23, s23, s72
rd 52,1,31744
mT 100,56,196
mT 108,60,196
s_add_u32 s23, s23, 32768
rd 56,1,32768
mT 104,60,192
wl 5
mT 112,64,192
s_add_u32 m0, s21, 16384
rd 60,1,33792
mT 116,64,196
lw 0
mT 124,68,196
rd 64,1,34816
mT 120,68,192
wl 5
mT 128,72,192
rd 68,1,35840
mT 132,72,196
s_waitcnt vmcnt(9)
s_barrier
mT 84,76,204
rd 72,0,2048
mT 80,76,200
lw 1024
v_mfma_f32_16x16x32_bf16 v[80:83], v[18:21], v[200:203], v[80:83]
wl 5
mT 88,48,200
rd 76,0,3072
v_mfma_f32_16x16x32_bf16 v[88:91], v[16:19], v[200:203], v[88:91]
mT 92,48,204
lw 2048
v_mfma_f32_16x16x32_bf16 v[84:87], v[18:21], v[204:207], v[84:87]
mT 100,52,204
rd 48,0,9216
v_mfma_f32_16x16x32_bf16 v[92:95], v[16:19], v[204:207], v[92:95]
mT 96,52,200
lw 3072
v_mfma_f32_16x16x32_bf16 v[96:99], v[18:21], v[208:211], v[96:99]
wl 5
mT 104,56,200
s_mul_i32 s23, s79, 16384
rd 52,0,10240
v_mfma_f32_16x16x32_bf16 v[104:107], v[16:19], v[208:211], v[104:107]
mT 108,56,204
v_mfma_f32_16x16x32_bf16 v[100:103], v[18:21], v[212:215], v[100:103]
mT 116,60,204
s_add_u32 s23, s23, s72
rd 56,1,36864
v_mfma_f32_16x16x32_bf16 v[108:111], v[16:19], v[212:215], v[108:111]
mT 112,60,200
v_mfma_f32_16x16x32_bf16 v[112:115], v[18:21], v[240:243], v[112:115]
wl 5
mT 120,64,200
s_add_u32 s23, s23, 49152
rd 60,1,37888
v_mfma_f32_16x16x32_bf16 v[120:123], v[16:19], v[240:243], v[120:123]
mT 124,64,204
v_mfma_f32_16x16x32_bf16 v[116:119], v[18:21], v[244:247], v[116:119]
mT 132,68,204
s_add_u32 m0, s21, 32768
rd 64,1,44032
v_mfma_f32_16x16x32_bf16 v[124:127], v[16:19], v[244:247], v[124:127]
mT 128,68,200
lw 0
v_mfma_f32_16x16x32_bf16 v[128:131], v[18:21], v[248:251], v[128:131]
wl 5
mT 80,72,208
rd 68,1,45056
v_mfma_f32_16x16x32_bf16 v[132:135], v[16:19], v[248:251], v[132:135]
mT 84,72,212
lw 1024
mT 92,76,212
rd 72,1,51200
mT 88,76,208
wl 5
mT 80,48,216
rd 76,1,52224
mT 84,48,220
lw 2048
mT 92,52,220
rd 48,1,58368
mT 88,52,216
wl 5
mT 80,56,224
rd 52,1,59392
mT 84,56,228
lw 3072
mT 92,60,228
rd 56,0,4096
mT 88,60,224
wl 5
mT 80,64,232
s_mul_i32 s23, s76, 16384
rd 60,0,5120
mT 84,64,236
mT 92,68,236
s_add_u32 s23, s23, s72
rd 64,0,11264
mT 88,68,232
wl 5
mT 80,72,240
s_add_u32 s23, s23, 65536
rd 68,0,12288
mT 84,72,244
mT 92,76,244
s_add_u32 m0, s21, 49152
rd 72,1,38912
mT 88,76,240
wl 5
lw 0
mT 80,48,248
rd 76,1,39936
mT 84,48,252
mT 92,52,252
rd 48,1,46080
mT 88,52,248
wl 5
lw 1024
mT 96,56,208
rd 52,1,47104
mT 100,56,212
mT 108,60,212
rd 56,1,53248
mT 104,60,208
wl 5
lw 2048
mT 96,64,216
rd 60,1,54272
v_mul_f32 v80, v80, v136
v_mul_f32 v81, v81, v137
mT 100,64,220
v_mul_f32 v82, v82, v138
v_mul_f32 v83, v83, v139
v_cvt_pk_bf16_f32 v220, v80, v81
mT 108,68,220
rd 64,1,60416
v_cvt_pk_bf16_f32 v221, v82, v83
v_mul_f32 v88, v88, v144
mT 104,68,216
wl 5
lw 3072
v_mul_f32 v89, v89, v145
mT 96,72,224
rd 68,1,61440
v_mul_f32 v90, v90, v146
v_mul_f32 v91, v91, v147
mT 100,72,228
v_cvt_pk_bf16_f32 v222, v88, v89
v_cvt_pk_bf16_f32 v223, v90, v91
mT 108,76,228
rd 72,0,6144
buffer_store_dwordx4 v[220:223], v0, s[4:7], s58 offen offset:0 sc1
mT 104,76,224
wl 5
v_mul_f32 v84, v84, v140
v_mul_f32 v85, v85, v141
v_mul_f32 v86, v86, v142
mT 96,48,232
rd 76,0,7168
v_mul_f32 v87, v87, v143
v_cvt_pk_bf16_f32 v224, v84, v85
mT 100,48,236
v_cvt_pk_bf16_f32 v225, v86, v87
v_mul_f32 v92, v92, v148
v_mul_f32 v93, v93, v149
mT 108,52,236
rd 48,0,13312
v_mul_f32 v94, v94, v150
v_mul_f32 v95, v95, v151
mT 104,52,232
wl 5
v_cvt_pk_bf16_f32 v226, v92, v93
v_cvt_pk_bf16_f32 v227, v94, v95
mT 96,56,240
rd 52,0,14336
buffer_store_dwordx4 v[224:227], v0, s[4:7], s58 offen offset:1024 sc1
mT 100,56,244
mT 108,60,244
rd 56,1,40960
mT 104,60,240
wl 5
mT 96,64,248
rd 60,1,41984
mT 100,64,252
mT 108,68,252
rd 64,1,48128
mT 104,68,248
wl 5
mT 112,72,208
rd 68,1,49152
mT 116,72,212
mT 124,76,212
rd 72,1,55296
mT 120,76,208
wl 5
mT 112,48,216
rd 76,1,56320
v_mul_f32 v96, v96, v152
v_mul_f32 v97, v97, v153
mT 116,48,220
v_mul_f32 v98, v98, v154
v_mul_f32 v99, v99, v155
v_cvt_pk_bf16_f32 v228, v96, v97
mT 124,52,220
rd 48,1,62464
v_cvt_pk_bf16_f32 v229, v98, v99
v_mul_f32 v104, v104, v160
mT 120,52,216
wl 5
v_mul_f32 v105, v105, v161
v_mul_f32 v106, v106, v162
v_mul_f32 v107, v107, v163
mT 112,56,224
rd 52,1,63488
v_cvt_pk_bf16_f32 v230, v104, v105
v_cvt_pk_bf16_f32 v231, v106, v107
mT 116,56,228
buffer_store_dwordx4 v[228:231], v0, s[4:7], s58 offen offset:2048 sc1
v_mul_f32 v100, v100, v156
mT 124,60,228
rd 56,0,8192
v_mul_f32 v101, v101, v157
v_mul_f32 v102, v102, v158
mT 120,60,224
wl 5
v_mul_f32 v103, v103, v159
v_cvt_pk_bf16_f32 v232, v100, v101
v_cvt_pk_bf16_f32 v233, v102, v103
mT 112,64,232
rd 60,0,15360
v_mul_f32 v108, v108, v164
v_mul_f32 v109, v109, v165
mT 116,64,236
v_mul_f32 v110, v110, v166
v_mul_f32 v111, v111, v167
v_cvt_pk_bf16_f32 v234, v108, v109
mT 124,68,236
rd 64,1,43008
v_cvt_pk_bf16_f32 v235, v110, v111
mT 120,68,232
wl 5
buffer_store_dwordx4 v[232:235], v0, s[4:7], s58 offen offset:3072 sc1
mT 112,72,240
rd 68,1,50176
mT 116,72,244
mT 124,76,244
rd 72,1,57344
mT 120,76,240
wl 5
mT 112,48,248
rd 76,1,64512
mT 116,48,252
mT 124,52,252
mT 120,52,248
wl 4
mT 128,56,208
mT 132,56,212
mT 132,60,220
mT 128,60,216
wl 3
mT 128,64,224
v_mul_f32 v112, v112, v168
v_mul_f32 v113, v113, v169
v_mul_f32 v114, v114, v170
mT 132,64,228
wl 2
v_mul_f32 v115, v115, v171
v_cvt_pk_bf16_f32 v220, v112, v113
v_cvt_pk_bf16_f32 v221, v114, v115
mT 132,68,236
v_mul_f32 v120, v120, v176
v_mul_f32 v121, v121, v177
v_mul_f32 v122, v122, v178
mT 128,68,232
wl 1
v_mul_f32 v123, v123, v179
v_cvt_pk_bf16_f32 v222, v120, v121
v_cvt_pk_bf16_f32 v223, v122, v123
mT 128,72,240
s_add_u32 s32, s58, 4096
buffer_store_dwordx4 v[220:223], v0, s[4:7], s32 offen offset:0 sc1
v_mul_f32 v116, v116, v172
mT 132,72,244
wl 0
v_mul_f32 v117, v117, v173
v_mul_f32 v118, v118, v174
v_mul_f32 v119, v119, v175
mT 132,76,252
v_cvt_pk_bf16_f32 v224, v116, v117
v_cvt_pk_bf16_f32 v225, v118, v119
v_mul_f32 v124, v124, v180
mT 128,76,248
v_mul_f32 v125, v125, v181
v_mul_f32 v126, v126, v182
v_mul_f32 v127, v127, v183
v_cvt_pk_bf16_f32 v226, v124, v125
v_cvt_pk_bf16_f32 v227, v126, v127
buffer_store_dwordx4 v[224:227], v0, s[4:7], s32 offen offset:1024 sc1
s_nop 1
v_pk_mul_f32 v[128:129], v[128:129], v[184:185]
v_pk_mul_f32 v[130:131], v[130:131], v[186:187]
v_cvt_pk_bf16_f32 v228, v128, v129
v_cvt_pk_bf16_f32 v229, v130, v131
buffer_store_dwordx2 v[228:229], v0, s[4:7], s59 offen offset:0 sc1
v_pk_mul_f32 v[132:133], v[132:133], v[188:189]
v_pk_mul_f32 v[134:135], v[134:135], v[190:191]
v_cvt_pk_bf16_f32 v232, v132, v133
v_cvt_pk_bf16_f32 v233, v134, v135
buffer_store_dwordx2 v[232:233], v0, s[4:7], s59 offen offset:1024 sc1
s_add_u32 s36, s48, 98304
v_mov_b32 v31, 1
s_waitcnt vmcnt(0)
buffer_atomic_add v31, v4, s[4:7], s36 offen sc0 sc1
s_barrier
s_mul_i32 s23, s77, 16384
s_add_u32 s23, s23, s72
s_add_u32 s23, s23, 81920
s_add_u32 m0, s21, 81920
s_nop 0
lw 0
lw 1024
lw 2048
lw 3072
s_min_i32 s23, s78, 0
s_mul_i32 s23, s23, 16384
s_add_u32 s23, s23, s72
s_add_u32 s23, s23, 98304
s_add_u32 m0, s21, 0
s_nop 0
lw 0
lw 1024
lw 2048
lw 3072
s_barrier
rd 48,1,0
rd 52,1,1024
rd 56,1,2048
rd 60,1,3072
rd 64,1,4096
rd 68,1,5120
rd 72,1,6144
s_and_b32 s35, s17, 1
s_mul_i32 s35, s35, 57344
s_add_u32 s35, s35, s52
v_mov_b32 v251, 0
s_waitcnt vmcnt(8)
v_readfirstlane_b32 s46, v31
buffer_atomic_add v251, v4, s[4:7], s36 offen sc0 sc1
s_max_i32 s23, s76, 0
s_mul_i32 s23, s23, 16384
s_add_u32 s23, s23, s29
s_add_u32 s23, s23, 0
s_add_u32 m0, s21, 98304
s_nop 0
lw 0
lw 1024
lw 2048
lw 3072
s_mul_i32 s23, s77, 16384
s_add_u32 s23, s23, s29
s_add_u32 s23, s23, 16384
s_add_u32 m0, s21, 114688
s_nop 0
lw 0
lw 1024
lw 2048
lw 3072
s_cmp_ge_u32 s46, 15
s_cbranch_scc1 main_ok188
s_waitcnt vmcnt(8)
v_readfirstlane_b32 s46, v251
s_mov_b32 s47, 0
s_cmp_ge_u32 s46, 16
s_cbranch_scc1 main_ok188
main_poll187:
v_mov_b32 v31, 0
buffer_atomic_add v31, v4, s[4:7], s36 offen sc0 sc1
s_add_u32 s47, s47, 1
s_cmp_gt_u32 s47, 400000
s_cbranch_scc1 main_ok188
s_waitcnt vmcnt(0)
v_readfirstlane_b32 s46, v31
s_nop 0
s_cmp_lt_u32 s46, 16
s_cbranch_scc1 main_poll187
main_ok188:
s_max_i32 s24, s76, 0
s_mul_i32 s24, s24, 8192
s_add_u32 s24, s24, s35
s_add_u32 s24, s24, 0
lx 0,0
lx 4,1024
lx 8,2048
lx 12,3072
s_add_u32 s24, s24, 4096
lx 16,0
lx 20,1024
lx 24,2048
lx 28,3072
s_waitcnt vmcnt(7) lgkmcnt(5)
v_mfma_f32_16x16x32_bf16 v[136:139], v[48:51], a[0:3], 0
s_waitcnt vmcnt(6)
s_mul_i32 s24, s77, 8192
rd 76,1,7168
v_mfma_f32_16x16x32_bf16 v[140:143], v[48:51], a[4:7], 0
v_mfma_f32_16x16x32_bf16 v[148:151], v[52:55], a[4:7], 0
s_add_u32 s24, s24, s35
rd 48,1,8192
v_mfma_f32_16x16x32_bf16 v[144:147], v[52:55], a[0:3], 0
wl 5
v_mfma_f32_16x16x32_bf16 v[152:155], v[56:59], a[0:3], 0
s_add_u32 s24, s24, 8192
rd 52,1,9216
v_mfma_f32_16x16x32_bf16 v[156:159], v[56:59], a[4:7], 0
lx 32,0
v_mfma_f32_16x16x32_bf16 v[164:167], v[60:63], a[4:7], 0
rd 56,1,10240
v_mfma_f32_16x16x32_bf16 v[160:163], v[60:63], a[0:3], 0
s_waitcnt vmcnt(6) lgkmcnt(5)
lx 36,1024
mT 136,64,8
s_waitcnt vmcnt(6)
rd 60,1,11264
mT 140,64,12
lx 40,2048
mT 148,68,12
rd 64,1,12288
mT 144,68,8
wl 5
lx 44,3072
mT 152,72,8
s_add_u32 s24, s24, 4096
rd 68,1,13312
mT 156,72,12
lx 48,0
mT 164,76,12
rd 72,1,14336
mT 160,76,8
s_waitcnt vmcnt(8) lgkmcnt(5)
lx 52,1024
mT 136,48,16
s_waitcnt vmcnt(8)
rd 76,1,15360
mT 140,48,20
s_barrier
mT 148,52,20
rd 48,29,0
mT 144,52,16
wl 5
lx 56,2048
mT 152,56,16
rd 52,29,1024
v_lshrrev_b32 v224, 4, v0
mT 156,56,20
lx 60,3072
mT 164,60,20
s_mul_i32 s24, s78, 8192
rd 56,29,2048
v_bfe_u32 v225, v224, 2, 2
mT 160,60,16
s_waitcnt vmcnt(9) lgkmcnt(5)
v_lshlrev_b32 v225, 3, v225
v_and_b32 v226, 3, v224
mT 136,64,24
s_waitcnt vmcnt(8)
s_add_u32 s24, s24, s35
rd 60,29,3072
v_add_u32 v225, v225, v226
mT 140,64,28
v_lshlrev_b32 v225, 11, v225
v_bfe_u32 v226, v224, 4, 1
mT 148,68,28
s_add_u32 s24, s24, 16384
rd 64,29,4096
v_lshl_add_u32 v225, v226, 5, v225
mT 144,68,24
wl 5
lx 64,0
mT 152,72,24
rd 68,29,5120
v_lshrrev_b32 v226, 5, v224
mT 156,72,28
lx 68,1024
mT 164,76,28
rd 72,29,6144
v_lshl_add_u32 v225, v226, 4, v225
mT 160,76,24
s_waitcnt vmcnt(9) lgkmcnt(5)
lx 72,2048
mT 136,48,32
s_waitcnt vmcnt(9)
s_lshl_b32 s32, s30, 16
rd 76,29,7168
mT 140,48,36
lx 76,3072
mT 148,52,36
s_add_u32 s24, s24, 4096
rd 48,29,8192
mT 144,52,32
wl 5
lx 80,0
mT 152,56,32
s_lshl_b32 s33, s17, 7
rd 52,29,9216
mT 156,56,36
lx 84,1024
mT 164,60,36
s_add_u32 s32, s32, s33
rd 56,29,10240
mT 160,60,32
s_waitcnt vmcnt(11) lgkmcnt(5)
mT 136,64,40
s_waitcnt vmcnt(10)
s_add_u32 s33, s32, 8192
rd 60,29,11264
mT 140,64,44
lx 88,2048
mT 148,68,44
rd 64,29,12288
mT 144,68,40
wl 5
lx 92,3072
mT 152,72,40
rd 68,29,13312
mT 156,72,44
mT 164,76,44
rd 72,29,14336
mT 160,76,40
s_waitcnt vmcnt(11) lgkmcnt(5)
mT 136,48,48
s_waitcnt vmcnt(10)
s_mul_i32 s24, s79, 8192
rd 76,29,15360
mT 140,48,52
s_barrier
mT 148,52,52
s_add_u32 s24, s24, s35
rd 48,0,16384
mT 144,52,48
wl 5
mT 152,56,48
s_add_u32 s24, s24, 24576
rd 52,0,17408
mT 156,56,52
lx 96,0
mT 164,60,52
rd 56,0,18432
mT 160,60,48
s_waitcnt vmcnt(10) lgkmcnt(5)
lx 100,1024
mT 136,64,56
s_waitcnt vmcnt(10)
rd 60,0,19456
mT 140,64,60
lx 104,2048
mT 148,68,60
rd 64,0,20480
mT 144,68,56
wl 5
lx 108,3072
mT 152,72,56
rd 68,0,21504
mT 156,72,60
mT 164,76,60
rd 72,0,22528
mT 160,76,56
s_waitcnt vmcnt(11) lgkmcnt(5)
mT 136,48,64
s_waitcnt vmcnt(10)
s_add_u32 s24, s24, 4096
rd 76,0,23552
mT 140,48,68
lx 112,0
mT 148,52,68
rd 48,0,24576
mT 144,52,64
wl 5
lx 116,1024
mT 152,56,64
rd 52,0,25600
mT 156,56,68
mT 164,60,68
rd 56,0,26624
mT 160,60,64
s_waitcnt vmcnt(11) lgkmcnt(5)
mT 136,64,72
s_waitcnt vmcnt(10)
rd 60,0,27648
mT 140,64,76
lx 120,2048
mT 148,68,76
rd 64,0,28672
mT 144,68,72
wl 5
lx 124,3072
mT 152,72,72
rd 68,0,29696
mT 156,72,76
mT 164,76,76
rd 72,0,30720
mT 160,76,72
s_waitcnt vmcnt(11) lgkmcnt(5)
mT 136,48,80
s_waitcnt vmcnt(10)
s_mul_i32 s24, s76, 8192
rd 76,0,31744
mT 140,48,84
s_barrier
mT 148,52,84
s_add_u32 s24, s24, s35
rd 48,0,32768
mT 144,52,80
wl 5
mT 152,56,80
s_add_u32 s24, s24, 32768
rd 52,0,33792
mT 156,56,84
lx 128,0
mT 164,60,84
rd 56,0,34816
mT 160,60,80
s_waitcnt vmcnt(10) lgkmcnt(5)
lx 132,1024
mT 136,64,88
s_waitcnt vmcnt(10)
rd 60,0,35840
mT 140,64,92
lx 136,2048
mT 148,68,92
rd 64,0,36864
mT 144,68,88
wl 5
lx 140,3072
mT 152,72,88
rd 68,0,37888
mT 156,72,92
mT 164,76,92
rd 72,0,38912
mT 160,76,88
s_waitcnt vmcnt(11) lgkmcnt(5)
mT 136,48,96
s_waitcnt vmcnt(10)
s_add_u32 s24, s24, 4096
rd 76,0,39936
mT 140,48,100
lx 144,0
mT 148,52,100
rd 48,0,40960
mT 144,52,96
wl 5
lx 148,1024
mT 152,56,96
rd 52,0,41984
v_lshlrev_b32 v80, 16, v32
mT 156,56,100
v_and_b32 v81, 0xffff0000, v32
v_lshlrev_b32 v82, 16, v33
mT 164,60,100
rd 56,0,43008
v_and_b32 v83, 0xffff0000, v33
mT 160,60,96
s_waitcnt vmcnt(11) lgkmcnt(5)
v_lshlrev_b32 v88, 16, v34
v_and_b32 v89, 0xffff0000, v34
mT 136,64,104
s_waitcnt vmcnt(10)
rd 60,0,44032
v_lshlrev_b32 v90, 16, v35
mT 140,64,108
lx 152,2048
mT 148,68,108
rd 64,0,45056
v_and_b32 v91, 0xffff0000, v35
mT 144,68,104
wl 5
lx 156,3072
mT 152,72,104
rd 68,0,46080
v_lshlrev_b32 v96, 16, v36
mT 156,72,108
v_and_b32 v97, 0xffff0000, v36
v_lshlrev_b32 v98, 16, v37
mT 164,76,108
rd 72,0,47104
v_and_b32 v99, 0xffff0000, v37
mT 160,76,104
s_waitcnt vmcnt(11) lgkmcnt(5)
v_lshlrev_b32 v104, 16, v38
v_and_b32 v105, 0xffff0000, v38
mT 136,48,112
s_waitcnt vmcnt(10)
s_mul_i32 s24, s77, 8192
rd 76,0,48128
v_lshlrev_b32 v106, 16, v39
mT 140,48,116
s_barrier
v_and_b32 v107, 0xffff0000, v39
mT 148,52,116
s_add_u32 s24, s24, s35
rd 48,0,49152
v_lshlrev_b32 v84, 16, v40
mT 144,52,112
wl 5
v_and_b32 v85, 0xffff0000, v40
v_lshlrev_b32 v86, 16, v41
mT 152,56,112
s_add_u32 s24, s24, 40960
rd 52,0,50176
v_and_b32 v87, 0xffff0000, v41
mT 156,56,116
lx 160,0
mT 164,60,116
rd 56,0,51200
v_lshlrev_b32 v92, 16, v42
mT 160,60,112
s_waitcnt vmcnt(10) lgkmcnt(5)
lx 164,1024
mT 136,64,120
s_waitcnt vmcnt(10)
rd 60,0,52224
v_and_b32 v93, 0xffff0000, v42
mT 140,64,124
lx 168,2048
mT 148,68,124
rd 64,0,53248
v_lshlrev_b32 v94, 16, v43
mT 144,68,120
wl 5
lx 172,3072
mT 152,72,120
rd 68,0,54272
v_and_b32 v95, 0xffff0000, v43
mT 156,72,124
v_lshlrev_b32 v100, 16, v44
v_and_b32 v101, 0xffff0000, v44
mT 164,76,124
rd 72,0,55296
v_lshlrev_b32 v102, 16, v45
mT 160,76,120
s_waitcnt vmcnt(11) lgkmcnt(5)
v_and_b32 v103, 0xffff0000, v45
v_lshlrev_b32 v108, 16, v46
mT 136,48,128
s_waitcnt vmcnt(10)
s_add_u32 s24, s24, 4096
rd 76,0,56320
v_and_b32 v109, 0xffff0000, v46
mT 140,48,132
lx 176,0
mT 148,52,132
rd 48,0,57344
v_lshlrev_b32 v110, 16, v47
mT 144,52,128
wl 5
lx 180,1024
mT 152,56,128
rd 52,0,58368
v_and_b32 v111, 0xffff0000, v47
mT 156,56,132
mT 164,60,132
rd 56,0,59392
mT 160,60,128
s_waitcnt vmcnt(11) lgkmcnt(5)
mT 136,64,136
s_waitcnt vmcnt(10)
rd 60,0,60416
mT 140,64,140
lx 184,2048
mT 148,68,140
rd 64,0,61440
mT 144,68,136
wl 5
lx 188,3072
mT 152,72,136
rd 68,0,62464
mT 156,72,140
mT 164,76,140
rd 72,0,63488
mT 160,76,136
s_waitcnt vmcnt(11) lgkmcnt(5)
mT 136,48,144
s_waitcnt vmcnt(10)
s_min_i32 s24, s78, 0
rd 76,0,64512
mT 140,48,148
s_barrier
mT 148,52,148
s_mul_i32 s24, s24, 8192
rd 48,1,16384
mT 144,52,144
wl 5
mT 152,56,144
s_add_u32 s24, s24, s35
rd 52,1,17408
mT 156,56,148
mT 164,60,148
s_add_u32 s24, s24, 49152
rd 56,1,18432
mT 160,60,144
s_waitcnt vmcnt(9) lgkmcnt(5)
lx 192,0
mT 136,64,152
s_waitcnt vmcnt(9)
rd 60,1,19456
mT 140,64,156
lx 196,1024
mT 148,68,156
rd 64,1,20480
mT 144,68,152
wl 5
lx 200,2048
mT 152,72,152
rd 68,1,21504
mT 156,72,156
lx 204,3072
mT 164,76,156
rd 72,1,22528
mT 160,76,152
s_waitcnt vmcnt(11) lgkmcnt(5)
mT 136,48,160
s_waitcnt vmcnt(10)
s_add_u32 s24, s24, 4096
rd 76,1,23552
mT 140,48,164
lx 208,0
mT 148,52,164
rd 48,1,24576
mT 144,52,160
wl 5
lx 212,1024
mT 152,56,160
rd 52,1,25600
mT 156,56,164
mT 164,60,164
rd 56,1,26624
mT 160,60,160
s_waitcnt vmcnt(11) lgkmcnt(5)
mT 136,64,168
s_waitcnt vmcnt(10)
rd 60,1,27648
mT 140,64,172
lx 216,2048
mT 148,68,172
rd 64,1,28672
mT 144,68,168
wl 5
lx 220,3072
mT 152,72,168
rd 68,1,29696
mT 156,72,172
mT 164,76,172
rd 72,1,30720
mT 160,76,168
s_waitcnt vmcnt(11) lgkmcnt(5)
mT 136,48,176
s_waitcnt vmcnt(10)
s_mul_i32 s23, s78, 16384
rd 76,1,31744
mT 140,48,180
s_barrier
mT 148,52,180
s_add_u32 s23, s23, s29
rd 48,0,0
mT 144,52,176
wl 5
mT 152,56,176
s_add_u32 s23, s23, 32768
rd 52,0,1024
mT 156,56,180
mT 164,60,180
s_add_u32 m0, s21, 65536
rd 56,0,2048
mT 160,60,176
s_waitcnt vmcnt(9) lgkmcnt(5)
lw 0
mT 136,64,184
s_waitcnt vmcnt(9)
rd 60,0,3072
mT 140,64,188
lw 1024
mT 148,68,188
rd 64,0,4096
mT 144,68,184
wl 5
lw 2048
mT 152,72,184
rd 68,0,5120
mT 156,72,188
lw 3072
mT 164,76,188
s_mul_i32 s23, s79, 16384
rd 72,0,6144
mT 160,76,184
s_waitcnt vmcnt(11) lgkmcnt(5)
mT 136,48,192
s_waitcnt vmcnt(10)
s_add_u32 s23, s23, s29
rd 76,0,7168
mT 140,48,196
mT 148,52,196
s_add_u32 s23, s23, 49152
rd 48,0,8192
mT 144,52,192
wl 5
mT 152,56,192
s_add_u32 m0, s21, 131072
rd 52,0,9216
mT 156,56,196
lw 0
mT 164,60,196
rd 56,0,10240
mT 160,60,192
s_waitcnt vmcnt(10) lgkmcnt(5)
mT 136,64,200
s_waitcnt vmcnt(9)
rd 60,0,11264
mT 140,64,204
lw 1024
mT 148,68,204
rd 64,0,12288
mT 144,68,200
wl 5
mT 152,72,200
rd 68,0,13312
mT 156,72,204
lw 2048
mT 164,76,204
rd 72,0,14336
mT 160,76,200
s_waitcnt vmcnt(10) lgkmcnt(5)
mT 136,48,208
s_waitcnt vmcnt(9)
rd 76,0,15360
mT 140,48,212
s_barrier
mT 148,52,212
rd 48,1,32768
mT 144,52,208
wl 5
lw 3072
mT 152,56,208
s_mul_i32 s23, s76, 16384
rd 52,1,33792
mT 156,56,212
mT 164,60,212
s_add_u32 s23, s23, s29
rd 56,1,34816
mT 160,60,208
s_waitcnt vmcnt(9) lgkmcnt(5)
mT 136,64,216
s_waitcnt vmcnt(8)
s_add_u32 s23, s23, 65536
rd 60,1,35840
mT 140,64,220
mT 148,68,220
s_add_u32 m0, s21, 16384
rd 64,1,36864
mT 144,68,216
wl 5
lw 0
mT 152,72,216
rd 68,1,37888
mT 156,72,220
mT 164,76,220
rd 72,1,38912
mT 160,76,216
wl 5
lw 1024
mT 80,48,0
rd 76,1,39936
mT 84,48,4
mT 92,52,4
rd 48,1,40960
mT 88,52,0
wl 5
lw 2048
mT 96,56,0
rd 52,1,41984
mT 100,56,4
mT 108,60,4
rd 56,1,43008
v_cvt_pk_bf16_f32 v168, v136, v137
v_cvt_pk_bf16_f32 v169, v138, v139
mT 104,60,0
wl 5
lw 3072
v_cvt_pk_bf16_f32 v170, v144, v145
mT 80,64,8
s_mul_i32 s23, s77, 16384
rd 60,1,44032
v_cvt_pk_bf16_f32 v171, v146, v147
v_cvt_pk_bf16_f32 v172, v140, v141
mT 84,64,12
v_cvt_pk_bf16_f32 v173, v142, v143
v_cvt_pk_bf16_f32 v174, v148, v149
v_cvt_pk_bf16_f32 v175, v150, v151
mT 92,68,12
s_add_u32 s23, s23, s29
rd 64,1,45056
v_cvt_pk_bf16_f32 v176, v152, v153
v_cvt_pk_bf16_f32 v177, v154, v155
mT 88,68,8
wl 5
v_cvt_pk_bf16_f32 v178, v160, v161
v_cvt_pk_bf16_f32 v179, v162, v163
v_cvt_pk_bf16_f32 v180, v156, v157
mT 96,72,8
s_add_u32 s23, s23, 81920
rd 68,1,46080
v_cvt_pk_bf16_f32 v181, v158, v159
v_cvt_pk_bf16_f32 v182, v164, v165
mT 100,72,12
v_cvt_pk_bf16_f32 v183, v166, v167
s_xor_b32 s37, s17, 1
s_lshl_b32 s37, s37, 12
mT 108,76,12
s_add_u32 m0, s21, 32768
rd 72,1,47104
s_add_u32 s37, s37, s51
mT 104,76,8
wl 5
lw 0
mT 80,48,16
rd 76,1,48128
buffer_store_dwordx4 v[168:171], v0, s[4:7], s37 offen offset:0 sc1
mT 84,48,20
s_barrier
buffer_store_dwordx4 v[172:175], v0, s[4:7], s37 offen offset:1024 sc1
mT 92,52,20
rd 48,1,49152
buffer_store_dwordx4 v[176:179], v0, s[4:7], s37 offen offset:2048 sc1
mT 88,52,16
wl 5
buffer_store_dwordx4 v[180:183], v0, s[4:7], s37 offen offset:3072 sc1
mT 96,56,16
rd 52,1,50176
mT 100,56,20
mT 108,60,20
rd 56,1,51200
mT 104,60,16
wl 5
mT 80,64,24
rd 60,1,52224
mT 84,64,28
mT 92,68,28
rd 64,1,53248
mT 88,68,24
wl 5
mT 96,72,24
rd 68,1,54272
mT 100,72,28
mT 108,76,28
rd 72,1,55296
mT 104,76,24
wl 5
mT 80,48,32
rd 76,1,56320
mT 84,48,36
mT 92,52,36
rd 48,1,57344
mT 88,52,32
wl 5
mT 96,56,32
rd 52,1,58368
mT 100,56,36
mT 108,60,36
rd 56,1,59392
mT 104,60,32
wl 5
mT 80,64,40
rd 60,1,60416
mT 84,64,44
mT 92,68,44
rd 64,1,61440
mT 88,68,40
wl 5
mT 96,72,40
rd 68,1,62464
mT 100,72,44
mT 108,76,44
rd 72,1,63488
mT 104,76,40
wl 5
mT 80,48,48
rd 76,1,64512
mT 84,48,52
s_waitcnt vmcnt(13)
s_barrier
mT 92,52,52
rd 48,1,0
mT 88,52,48
wl 5
mT 96,56,48
rd 52,1,1024
mT 100,56,52
mT 108,60,52
rd 56,1,2048
mT 104,60,48
wl 5
mT 80,64,56
rd 60,1,3072
mT 84,64,60
mT 92,68,60
rd 64,1,4096
mT 88,68,56
wl 5
mT 96,72,56
rd 68,1,5120
mT 100,72,60
mT 108,76,60
rd 72,1,6144
mT 104,76,56
wl 5
mT 80,48,64
rd 76,1,7168
mT 84,48,68
lw 1024
s_add_u32 s36, s3, 65536
mT 92,52,68
s_waitcnt vmcnt(1)
rd 48,1,8192
v_mov_b32 v31, 1
mT 88,52,64
wl 5
buffer_atomic_add v31, v4, s[4:7], s36 offen sc1
mT 96,56,64
rd 52,1,9216
mT 100,56,68
lw 2048
mT 108,60,68
rd 56,1,10240
mT 104,60,64
wl 5
mT 80,64,72
rd 60,1,11264
mT 84,64,76
lw 3072
mT 92,68,76
s_min_i32 s23, s78, 0
rd 64,1,12288
mT 88,68,72
wl 5
mT 96,72,72
s_mul_i32 s23, s23, 16384
rd 68,1,13312
mT 100,72,76
mT 108,76,76
s_add_u32 s23, s23, s29
rd 72,1,14336
mT 104,76,72
wl 5
v_mov_b32 v31, 0
buffer_atomic_add v31, v4, s[4:7], s36 offen sc0 sc1
mT 80,48,80
s_add_u32 s23, s23, 98304
rd 76,1,15360
s_xor_b32 s37, s37, 4096
mT 84,48,84
s_barrier
mT 92,52,84
s_add_u32 m0, s21, 49152
rd 48,29,0
mT 88,52,80
wl 5
lw 0
mT 96,56,80
rd 52,29,1024
mT 100,56,84
mT 108,60,84
rd 56,29,2048
mT 104,60,80
wl 5
lw 1024
mT 80,64,88
rd 60,29,3072
mT 84,64,92
mT 92,68,92
rd 64,29,4096
mT 88,68,88
wl 5
lw 2048
mT 96,72,88
rd 68,29,5120
mT 100,72,92
mT 108,76,92
rd 72,29,6144
mT 104,76,88
wl 5
lw 3072
mT 80,48,96
rd 76,29,7168
mT 84,48,100
mT 92,52,100
rd 48,29,8192
mT 88,52,96
wl 5
mT 96,56,96
rd 52,29,9216
mT 100,56,100
mT 108,60,100
rd 56,29,10240
mT 104,60,96
wl 5
mT 80,64,104
rd 60,29,11264
mT 84,64,108
mT 92,68,108
rd 64,29,12288
mT 88,68,104
wl 5
mT 96,72,104
rd 68,29,13312
mT 100,72,108
mT 108,76,108
rd 72,29,14336
mT 104,76,104
wl 5
mT 80,48,112
rd 76,29,15360
mT 84,48,116
s_barrier
mT 92,52,116
rd 48,0,16384
mT 88,52,112
wl 5
mT 96,56,112
rd 52,0,17408
mT 100,56,116
mT 108,60,116
rd 56,0,18432
mT 104,60,112
wl 5
mT 80,64,120
rd 60,0,19456
mT 84,64,124
mT 92,68,124
rd 64,0,20480
mT 88,68,120
wl 5
mT 96,72,120
rd 68,0,21504
mT 100,72,124
s_waitcnt vmcnt(4)
v_readfirstlane_b32 s46, v31
s_nop 0
s_nop 0
s_cmp_ge_u32 s46, 2
s_cbranch_scc1 main_ok190
s_mov_b32 s47, 0
main_poll189:
v_mov_b32 v31, 0
buffer_atomic_add v31, v4, s[4:7], s36 offen sc0 sc1
s_add_u32 s47, s47, 1
s_cmp_gt_u32 s47, 400000
s_cbranch_scc1 main_ok190
s_waitcnt vmcnt(0)
v_readfirstlane_b32 s46, v31
s_nop 0
s_cmp_lt_u32 s46, 2
s_cbranch_scc1 main_poll189
main_ok190:
mT 108,76,124
rd 72,0,22528
buffer_load_dwordx4 v[168:171], v0, s[4:7], s37 offen offset:0 sc1
mT 104,76,120
wl 5
mT 80,48,128
rd 76,0,23552
buffer_load_dwordx4 v[172:175], v0, s[4:7], s37 offen offset:1024 sc1
mT 84,48,132
mT 92,52,132
rd 48,0,24576
buffer_load_dwordx4 v[176:179], v0, s[4:7], s37 offen offset:2048 sc1
mT 88,52,128
wl 5
mT 96,56,128
rd 52,0,25600
buffer_load_dwordx4 v[180:183], v0, s[4:7], s37 offen offset:3072 sc1
mT 100,56,132
mT 108,60,132
rd 56,0,26624
mT 104,60,128
wl 5
mT 80,64,136
rd 60,0,27648
mT 84,64,140
mT 92,68,140
rd 64,0,28672
mT 88,68,136
wl 5
mT 96,72,136
rd 68,0,29696
mT 100,72,140
mT 108,76,140
rd 72,0,30720
mT 104,76,136
wl 5
mT 80,48,144
rd 76,0,31744
mT 84,48,148
s_barrier
mT 92,52,148
rd 48,0,32768
mT 88,52,144
wl 5
mT 96,56,144
rd 52,0,33792
mT 100,56,148
mT 108,60,148
rd 56,0,34816
mT 104,60,144
wl 5
mT 80,64,152
rd 60,0,35840
mT 84,64,156
mT 92,68,156
rd 64,0,36864
mT 88,68,152
wl 5
mT 96,72,152
rd 68,0,37888
mT 100,72,156
mT 108,76,156
rd 72,0,38912
mT 104,76,152
wl 5
mT 80,48,160
rd 76,0,39936
mT 84,48,164
mT 92,52,164
rd 48,0,40960
mT 88,52,160
wl 5
mT 96,56,160
rd 52,0,41984
mT 100,56,164
mT 108,60,164
rd 56,0,43008
mT 104,60,160
wl 5
mT 80,64,168
rd 60,0,44032
mT 84,64,172
mT 92,68,172
rd 64,0,45056
mT 88,68,168
wl 5
mT 96,72,168
rd 68,0,46080
mT 100,72,172
mT 108,76,172
rd 72,0,47104
mT 104,76,168
wl 5
mT 80,48,176
rd 76,0,48128
mT 84,48,180
s_waitcnt vmcnt(4)
s_barrier
mT 92,52,180
rd 48,0,49152
mT 88,52,176
s_waitcnt vmcnt(3)
v_mfma_f32_16x16x32_bf16 v[80:83], v[18:21], v[168:171], v[80:83]
v_mfma_f32_16x16x32_bf16 v[88:91], v[16:19], v[168:171], v[88:91]
s_waitcnt vmcnt(2)
v_mfma_f32_16x16x32_bf16 v[84:87], v[18:21], v[172:175], v[84:87]
v_mfma_f32_16x16x32_bf16 v[92:95], v[16:19], v[172:175], v[92:95]
s_waitcnt vmcnt(1)
v_mfma_f32_16x16x32_bf16 v[96:99], v[18:21], v[176:179], v[96:99]
v_mfma_f32_16x16x32_bf16 v[104:107], v[16:19], v[176:179], v[104:107]
s_waitcnt vmcnt(0)
v_mfma_f32_16x16x32_bf16 v[100:103], v[18:21], v[180:183], v[100:103]
v_mfma_f32_16x16x32_bf16 v[108:111], v[16:19], v[180:183], v[108:111]
wl 5
mT 96,56,176
rd 52,0,50176
mT 100,56,180
mT 108,60,180
rd 56,0,53248
mT 104,60,176
wl 5
mT 80,64,184
rd 60,0,54272
mT 84,64,188
mT 92,68,188
rd 64,0,57344
mT 88,68,184
wl 5
mT 96,72,184
rd 68,0,58368
mT 100,72,188
mT 108,76,188
rd 72,0,61440
mT 104,76,184
wl 5
mT 80,48,192
rd 76,0,62464
mT 84,48,196
mT 92,52,196
rd 48,0,51200
mT 88,52,192
wl 5
mT 80,56,200
rd 52,0,52224
mT 84,56,204
mT 92,60,204
rd 56,0,55296
mT 88,60,200
wl 5
mT 80,64,208
rd 60,0,56320
mT 84,64,212
mT 92,68,212
rd 64,0,59392
mT 88,68,208
wl 5
mT 80,72,216
rd 68,0,60416
mT 84,72,220
mT 92,76,220
rd 72,0,63488
mT 88,76,216
wl 5
mT 96,48,192
rd 76,0,64512
mT 100,48,196
mT 108,52,196
mT 104,52,192
wl 4
mT 96,56,200
v_cvt_pk_bf16_f32 v32, v80, v81
v_cvt_pk_bf16_f32 v33, v82, v83
v_cvt_pk_bf16_f32 v34, v88, v89
mT 100,56,204
v_cvt_pk_bf16_f32 v35, v90, v91
v_permlane16_swap_b32 v32, v34
s_nop 0
v_permlane16_swap_b32 v33, v35
mT 108,60,204
buffer_store_dwordx4 v[32:35], v225, s[8:11], s32 offen offset:0
v_cvt_pk_bf16_f32 v40, v84, v85
mT 104,60,200
wl 3
v_cvt_pk_bf16_f32 v41, v86, v87
v_cvt_pk_bf16_f32 v42, v92, v93
v_cvt_pk_bf16_f32 v43, v94, v95
mT 96,64,208
v_permlane16_swap_b32 v40, v42
v_permlane16_swap_b32 v41, v43
mT 100,64,212
wl 2
buffer_store_dwordx4 v[40:43], v225, s[8:11], s33 offen offset:0
mT 108,68,212
mT 104,68,208
wl 1
mT 96,72,216
mT 100,72,220
wl 0
mT 108,76,220
mT 104,76,216
s_nop 3
v_cvt_pk_bf16_f32 v36, v96, v97
v_cvt_pk_bf16_f32 v37, v98, v99
s_nop 1
v_cvt_pk_bf16_f32 v38, v104, v105
v_cvt_pk_bf16_f32 v39, v106, v107
s_nop 0
v_permlane16_swap_b32 v36, v38
v_permlane16_swap_b32 v37, v39
buffer_store_dwordx4 v[36:39], v225, s[8:11], s32 offen offset:64
v_cvt_pk_bf16_f32 v44, v100, v101
v_cvt_pk_bf16_f32 v45, v102, v103
v_cvt_pk_bf16_f32 v46, v108, v109
v_cvt_pk_bf16_f32 v47, v110, v111
s_nop 0
v_permlane16_swap_b32 v44, v46
v_permlane16_swap_b32 v45, v47
buffer_store_dwordx4 v[44:47], v225, s[8:11], s33 offen offset:64
s_endpgm
main_last:
.section .rodata,"a"
.p2align 6
.amdhsa_kernel interleave_layers__linear_attn_block__mixer_gmlp__prompt_kernel
  .amdhsa_next_free_vgpr 512
  .amdhsa_next_free_sgpr 102
  .amdhsa_accum_offset 256
  .amdhsa_group_segment_fixed_size 0
  .amdhsa_kernarg_size 88
  .amdhsa_user_sgpr_count 2
  .amdhsa_user_sgpr_kernarg_segment_ptr 1
  .amdhsa_system_sgpr_workgroup_id_x 1
  .amdhsa_float_denorm_mode_32 3
.end_amdhsa_kernel
```
